```python
import torch

def _softmax(x, axis=-1):
    return torch.softmax(x, dim=axis)
def _gelu(x):
    return torch.nn.functional.gelu(x, approximate="tanh")
def _silu(x):
    return torch.nn.functional.silu(x)
def _sigmoid(x):
    return torch.sigmoid(x)
def _layernorm(x, axis=-1, eps=1e-5):
    m = x.mean(dim=axis, keepdim=True)
    v = x.var(dim=axis, keepdim=True, unbiased=False)
    return (x - m) / torch.sqrt(v + eps)
def _scatter_add(tgt, idx, src, axis=0):
    return tgt.clone().index_add_(axis, idx, src)
def _segment_sum(src, seg, n):
    out = torch.zeros((n,) + src.shape[1:], dtype=src.dtype)
    return out.index_add_(0, seg, src)
def _pad(x, pw):
    flat = tuple(v for pair in reversed(pw) for v in pair)
    return torch.nn.functional.pad(x, flat)

kernel_name = 'recurrent_scan__sliding_block_cached__moe_arch_mod__prompt'

def setup_inputs():

    _w = (lambda a: (lambda t: t.to(torch.bfloat16) if t.is_floating_point() else t)(torch.as_tensor(a)))
    def _A_setup():
        B, Sq, D = 1, 2048, 1024
        Hq, Hkv, Sk, Dh = 32, 4, 2048, 128
        assert Hq % Hkv == 0, (Hq, Hkv)
        return {
            "x": _w((lambda *s: torch.randn(*s, dtype=torch.bfloat16) * 0.05)(B, Sq, D)),
            "k_cache": _w((lambda *s: torch.randn(*s, dtype=torch.bfloat16) * 0.8)(B, Hkv, Sk, Dh)),
            "v_cache": _w((lambda *s: torch.randn(*s, dtype=torch.bfloat16) * 0.2)(B, Hkv, Sk, Dh)),
            "wq": _w((lambda *s: torch.randn(*s, dtype=torch.bfloat16) * 0.8)(D, Hq * Dh) * (D ** -0.5)),
            "wo": _w((lambda *s: torch.randn(*s, dtype=torch.bfloat16) * 0.2)(Hq * Dh, D) * ((Hq * Dh) ** -0.5)),
        }
    _A_in = _A_setup()

    def _B_setup():
        B, S, D, F, C = 1, 2048, 1024, 3584, 1
        return {
            "x": _w((lambda *s: torch.randn(*s, dtype=torch.bfloat16) * 0.05)(B, S, D)),
            "w_r": _w((lambda *s: torch.randn(*s, dtype=torch.bfloat16) * 0.2)(D)),
            "w_gate": _w((lambda *s: torch.randn(*s, dtype=torch.bfloat16) * 0.1)(D, F)),
            "w_up": _w((lambda *s: torch.randn(*s, dtype=torch.bfloat16) * 0.1)(D, F)),
            "w_down": _w((lambda *s: torch.randn(*s, dtype=torch.bfloat16) * 0.1)(F, D)),
        }
    _B_in = _B_setup()

    return {
        "A_x": _A_in["x"],
        "A_k_cache": _A_in["k_cache"],
        "A_v_cache": _A_in["v_cache"],
        "A_wq": _A_in["wq"],
        "A_wo": _A_in["wo"],
        "B_x": _B_in["x"],
        "B_w_r": _B_in["w_r"],
        "B_w_gate": _B_in["w_gate"],
        "B_w_up": _B_in["w_up"],
        "B_w_down": _B_in["w_down"],
    }

def reference(A_x, A_k_cache, A_v_cache, A_wq, A_wo, B_x, B_w_r, B_w_gate, B_w_up, B_w_down):
    def _A_ref(x, k_cache, v_cache, wq, wo):
        B, Sq, D = x.shape
        Hq, Dh = 32, 128
        Hkv, Sk = k_cache.shape[1], k_cache.shape[2]
        W = min(4096, max(256, Sk // 4))
        rep = Hq // Hkv
        q = (lambda x, *d: x.permute(*d))((x @ wq).reshape(B, Sq, Hq, Dh), 0, 2, 1, 3)
        k = (lambda x, n, axis: torch.repeat_interleave(x, n, dim=axis))(k_cache[:, :, Sk - W:, :], rep, axis=1)
        v = (lambda x, n, axis: torch.repeat_interleave(x, n, dim=axis))(v_cache[:, :, Sk - W:, :], rep, axis=1)
        scores = torch.einsum("bhqd,bhkd->bhqk", q, k) * (Dh ** -0.5)
        p = _softmax(scores, axis=-1)
        o = torch.einsum("bhqk,bhkd->bhqd", p, v)
        return (lambda x, *d: x.permute(*d))(o, 0, 2, 1, 3).reshape(B, Sq, Hq * Dh) @ wo

    def _B_ref(x, w_r, w_gate, w_up, w_down):
        B, S, D = x.shape
        C = 1
        r = x @ w_r
        idx = torch.argsort(-r, axis=-1)[:, :C]
        idx_e = (lambda x, n, axis: torch.repeat_interleave(x, n, dim=axis))(idx.reshape(B, C, 1), D, axis=2)
        x_sel = (lambda x, i, axis: torch.take_along_dim(x, i, dim=axis))(x, idx_e, axis=1)
        g = _silu(x_sel @ w_gate)
        u = x_sel @ w_up
        y = (g * u) @ w_down
        r_sel = _sigmoid((lambda x, i, axis: torch.take_along_dim(x, i, dim=axis))(r, idx, axis=1))
        y = y * r_sel.reshape(B, C, 1)
        b_off = (torch.arange(B) * S).reshape(B, 1)
        flat_idx = (idx + b_off).reshape(B * C)
        zero = (x * 0.0).reshape(B * S, D)
        upd = _scatter_add(zero, flat_idx, y.reshape(B * C, D), axis=0)
        return x + upd.reshape(B, S, D)

    x = A_x
    xn = _layernorm(x, axis=-1)
    s = _A_ref(xn, A_k_cache, A_v_cache, A_wq, A_wo)
    g = _silu(_B_ref(xn, B_w_r, B_w_gate, B_w_up, B_w_down))
    return x + s * g
```

```asm
; @launch grid=(256,1,1) block=(256,1,1) lds=163840
.amdgcn_target "amdgcn-amd-amdhsa--gfx950"
.text
.globl recurrent_scan__sliding_block_cached__moe_arch_mod__prompt_kernel
.p2align 8
.type recurrent_scan__sliding_block_cached__moe_arch_mod__prompt_kernel,@function
recurrent_scan__sliding_block_cached__moe_arch_mod__prompt_kernel:
    s_cmp_ge_u32 s2, 256
    s_cbranch_scc1 L_ka_end
    s_load_dwordx8 s[64:71], s[0:1], 0
    s_load_dwordx4 s[4:7], s[0:1], 88
    s_load_dwordx8 s[72:79], s[0:1], 48
    v_lshrrev_b32 v1, 6, v0
    v_and_b32 v2, 63, v0
    v_readfirstlane_b32 s28, v1
    v_mov_b32 v233, v2
    s_cmp_lt_u32 s28, 2
    s_cbranch_scc1 L_ka_noct
    s_getpc_b64 vcc
L_ka_pc0:
    s_bfe_u32 s3, s2, 0x30003
    s_lshl_b32 s3, s3, 13
    s_mov_b32 s31, L_ka_fuse-L_ka_pc0-4
    s_cmp_eq_u32 s28, 2
    s_cselect_b32 s3, L_ka_end-L_ka_pc0, s3
    s_cselect_b32 s31, L_ka_trp1-L_ka_pc0-4, s31
    v_lshl_add_u32 v235, v2, 7, s3
    v_min_u32 v235, s31, v235
    global_load_dword v234, v235, vcc
L_ka_noct:
    s_and_b32 s3, s2, 7
    s_lshr_b32 s31, s2, 3
    s_and_b32 s30, s3, 1
    s_lshl_b32 s30, s30, 2
    s_and_b32 s29, s31, 3
    s_add_u32 s30, s30, s29
    s_lshr_b32 s3, s3, 1
    s_lshr_b32 s31, s31, 2
    s_lshl_b32 s29, s3, 3
    s_add_u32 s29, s29, s31
    v_lshrrev_b32 v3, 4, v2
    v_and_b32 v4, 15, v2
    v_lshlrev_b32 v5, 2, v3
    v_xor_b32 v5, v5, v4
    v_lshlrev_b32 v5, 4, v5
    v_lshl_add_u32 v215, v3, 8, v5
    v_lshl_add_u32 v192, v3, 13, v5
    v_add_u32 v193, 0x7c00, v192
    v_add_u32 v194, 0xf800, v192
    v_add_u32 v195, 0x17400, v192
    v_lshrrev_b32 v6, 3, v2
    v_and_b32 v7, 7, v2
    v_xor_b32 v7, v7, v3
    v_lshlrev_b32 v8, 4, v7
    v_lshl_add_u32 v224, v6, 11, v8
    v_xor_b32 v8, 64, v224
    v_add_u32 v225, 0x3c00, v8
    v_add_u32 v226, 0x7800, v224
    v_add_u32 v227, 0xb400, v8
    s_lshl_b32 s32, s28, 17
    s_lshl_b32 s31, s29, 8
    s_add_u32 s32, s32, s31
    s_lshl_b32 s33, s30, 2
    s_add_u32 s33, s33, s28
    s_lshl_b32 s46, s33, 19
    s_lshl_b32 s31, s29, 13
    s_add_u32 s46, s46, s31
    s_add_u32 s47, s46, 0x40000
    s_lshl_b32 s51, s33, 9
    s_lshl_b32 s33, s33, 17
    s_mov_b32 s31, 0
    s_mov_b32 s45, s33
    s_lshl_b32 s44, s31, 7
    s_add_u32 s33, s45, s44
    s_lshl_b32 s31, s31, 19
    s_add_u32 s32, s32, s31
    s_add_u32 s34, s33, 0x10000
    s_lshl_b32 s37, s28, 12
    s_add_u32 s37, s37, 0x18000
    s_mul_i32 s40, s28, 24576
    s_lshl_b32 s35, s3, 19
    s_add_u32 s35, s35, 0x60000
    s_lshl_b32 s39, s28, 11
    s_add_u32 s35, s35, s39
    s_mov_b32 s36, s35
    s_add_u32 s38, s39, 0x18000
    s_mov_b32 s42, s2
    s_waitcnt lgkmcnt(0)
    s_mov_b32 s8, s70
    s_mov_b32 s9, s71
    s_mov_b32 s10, 0x800000
    s_mov_b32 s11, 0x00020000
    s_mov_b32 s12, s64
    s_mov_b32 s13, s65
    s_mov_b32 s14, 0x400000
    s_mov_b32 s15, 0x00020000
    s_add_u32 m0, s37, 0x0
    s_nop 0
    buffer_load_dwordx4 v192, s[8:11], s32 offen offset:0 lds
    buffer_load_dwordx4 v193, s[8:11], s32 offen offset:1024 lds
    buffer_load_dwordx4 v194, s[8:11], s32 offen offset:2048 lds
    buffer_load_dwordx4 v195, s[8:11], s32 offen offset:3072 lds
    s_add_u32 m0, s40, 0x0
    s_nop 0
    buffer_load_dwordx4 v224, s[12:15], s33 offen offset:0 lds
    buffer_load_dwordx4 v225, s[12:15], s33 offen offset:1024 lds
    buffer_load_dwordx4 v226, s[12:15], s33 offen offset:2048 lds
    buffer_load_dwordx4 v227, s[12:15], s33 offen offset:3072 lds
    s_add_u32 m0, s40, 0x1000
    s_nop 0
    buffer_load_dwordx4 v224, s[12:15], s34 offen offset:0 lds
    buffer_load_dwordx4 v225, s[12:15], s34 offen offset:1024 lds
    buffer_load_dwordx4 v226, s[12:15], s34 offen offset:2048 lds
    buffer_load_dwordx4 v227, s[12:15], s34 offen offset:3072 lds
    s_mov_b32 s60, s72
    s_mov_b32 s61, s73
    s_mov_b32 s62, 0x800
    s_mov_b32 s63, 0x00020000
    s_add_u32 s52, s6, 0x1c08000
    s_addc_u32 s53, s7, 0
    s_mov_b32 s54, 0x98000
    s_mov_b32 s55, 0x00020000
    s_mov_b32 s56, s4
    s_mov_b32 s57, s5
    s_mov_b32 s58, 0x100
    s_mov_b32 s59, 0x00020000
    s_mov_b32 s16, s66
    s_mov_b32 s17, s67
    s_mov_b32 s18, 0x200000
    s_mov_b32 s19, 0x00020000
    s_mov_b32 s20, s68
    s_mov_b32 s21, s69
    s_mov_b32 s22, 0x200000
    s_mov_b32 s23, 0x00020000
    s_add_u32 s24, s6, 0x400000
    s_addc_u32 s25, s7, 0
    s_mov_b32 s26, 0x1000000
    s_mov_b32 s27, 0x00020000
    s_load_dwordx2 s[4:5], s[0:1], 32
    s_load_dwordx2 s[96:97], s[0:1], 80
    s_bfe_u32 s48, s2, 0x30003
    s_mov_b32 s49, 0xffff0000
    s_mov_b32 s41, 0x47800000
    s_add_u32 s32, s32, 0x80000
    s_and_b32 s32, s32, 0x7fffff
    s_add_u32 m0, s37, 0x4000
    s_nop 0
    buffer_load_dwordx4 v192, s[8:11], s32 offen offset:0 lds
    buffer_load_dwordx4 v193, s[8:11], s32 offen offset:1024 lds
    buffer_load_dwordx4 v194, s[8:11], s32 offen offset:2048 lds
    buffer_load_dwordx4 v195, s[8:11], s32 offen offset:3072 lds
    s_add_u32 s44, s44, 128
    s_and_b32 s44, s44, 0x7ff
    s_add_u32 s33, s45, s44
    s_add_u32 s34, s33, 0x10000
    s_add_u32 m0, s40, 0x2000
    s_nop 0
    buffer_load_dwordx4 v224, s[12:15], s33 offen offset:0 lds
    buffer_load_dwordx4 v225, s[12:15], s33 offen offset:1024 lds
    buffer_load_dwordx4 v226, s[12:15], s33 offen offset:2048 lds
    buffer_load_dwordx4 v227, s[12:15], s33 offen offset:3072 lds
    s_add_u32 m0, s40, 0x3000
    s_nop 0
    buffer_load_dwordx4 v224, s[12:15], s34 offen offset:0 lds
    buffer_load_dwordx4 v225, s[12:15], s34 offen offset:1024 lds
    buffer_load_dwordx4 v226, s[12:15], s34 offen offset:2048 lds
    buffer_load_dwordx4 v227, s[12:15], s34 offen offset:3072 lds
    v_mov_b32 v102, v233
    v_lshrrev_b32 v103, 4, v102
    v_and_b32 v104, 15, v102
    v_lshlrev_b32 v196, 4, v102
    v_add_u32 v236, 4096, v196
    s_lshl_b32 s31, s28, 3
    v_add_u32 v105, s31, v103
    v_and_b32 v105, 15, v105
    v_xor_b32 v105, v105, v104
    v_lshlrev_b32 v105, 4, v105
    v_lshl_add_u32 v213, v103, 8, v105
    v_add_u32 v105, s31, v103
    v_add_u32 v105, 4, v105
    v_and_b32 v105, 15, v105
    v_xor_b32 v105, v105, v104
    v_lshlrev_b32 v105, 4, v105
    v_lshl_add_u32 v214, v103, 8, v105
    v_lshrrev_b32 v105, 5, v102
    v_bfe_u32 v106, v102, 2, 2
    v_lshl_add_u32 v107, v105, 3, v106
    v_lshlrev_b32 v107, 8, v107
    v_bfe_u32 v108, v102, 4, 1
    v_lshl_add_u32 v107, v108, 5, v107
    v_and_b32 v108, 1, v102
    v_lshl_add_u32 v107, v108, 4, v107
    v_bfe_u32 v108, v102, 1, 1
    v_lshl_add_u32 v107, v108, 3, v107
    v_xor_b32 v108, 0, v106
    v_lshl_add_u32 v201, v108, 6, v107
    v_add_u32 v197, 0x18000, v201
    v_xor_b32 v108, 1, v106
    v_lshl_add_u32 v202, v108, 6, v107
    v_add_u32 v198, 0x18000, v202
    v_xor_b32 v108, 2, v106
    v_lshl_add_u32 v203, v108, 6, v107
    v_add_u32 v199, 0x18000, v203
    v_xor_b32 v108, 3, v106
    v_lshl_add_u32 v204, v108, 6, v107
    v_add_u32 v200, 0x18000, v204
    v_xor_b32 v108, s28, v106
    v_lshl_add_u32 v108, v108, 6, v107
    v_add_u32 v232, 0x18000, v108
    v_and_b32 v106, 0x13, v102
    v_bfe_u32 v107, v102, 2, 1
    v_lshl_or_b32 v106, v107, 3, v106
    v_bfe_u32 v107, v102, 3, 1
    v_lshl_or_b32 v106, v107, 2, v106
    v_and_b32 v107, 15, v106
    v_xor_b32 v107, v107, v105
    v_lshlrev_b32 v106, 8, v106
    v_add_u32 v106, 0x18000, v106
    v_xor_b32 v108, 0, v107
    v_lshl_add_u32 v205, v108, 4, v106
    v_xor_b32 v108, 2, v107
    v_lshl_add_u32 v206, v108, 4, v106
    v_xor_b32 v108, 4, v107
    v_lshl_add_u32 v207, v108, 4, v106
    v_xor_b32 v108, 6, v107
    v_lshl_add_u32 v208, v108, 4, v106
    v_xor_b32 v108, 8, v107
    v_lshl_add_u32 v209, v108, 4, v106
    v_xor_b32 v108, 10, v107
    v_lshl_add_u32 v210, v108, 4, v106
    v_xor_b32 v108, 12, v107
    v_lshl_add_u32 v211, v108, 4, v106
    v_xor_b32 v108, 14, v107
    v_lshl_add_u32 v212, v108, 4, v106
    v_and_b32 v106, 31, v102
    v_bfe_u32 v107, v102, 1, 3
    v_xor_b32 v107, v107, v105
    v_lshlrev_b32 v106, 7, v106
    v_add_u32 v106, s40, v106
    v_xor_b32 v108, 0, v107
    v_lshl_add_u32 v228, v108, 4, v106
    v_xor_b32 v108, 2, v107
    v_lshl_add_u32 v229, v108, 4, v106
    v_xor_b32 v108, 4, v107
    v_lshl_add_u32 v230, v108, 4, v106
    v_xor_b32 v108, 6, v107
    v_lshl_add_u32 v231, v108, 4, v106
    v_and_b32 v105, 1, v103
    v_cmp_eq_u32 vcc, v104, v105
    v_mov_b32 v106, 0x3f803f80
    s_nop 0
    v_cndmask_b32 v106, 0, v106, vcc
    v_accvgpr_write_b32 a136, v106
    v_accvgpr_write_b32 a137, v106
    v_accvgpr_write_b32 a138, v106
    v_accvgpr_write_b32 a139, v106
    s_mov_b32 s64, s74
    s_mov_b32 s65, s75
    s_mov_b32 s66, 0x700000
    s_mov_b32 s67, 0x00020000
    s_mov_b32 s68, s76
    s_mov_b32 s69, s77
    s_mov_b32 s70, 0x700000
    s_mov_b32 s71, 0x00020000
    s_mov_b32 s72, s78
    s_mov_b32 s73, s79
    s_mov_b32 s74, 0x700000
    s_mov_b32 s75, 0x00020000
    s_add_u32 s76, s6, 0x1d00000
    s_addc_u32 s77, s7, 0
    s_mov_b32 s78, 0xe0000
    s_mov_b32 s79, 0x00020000
    s_waitcnt lgkmcnt(0)
    s_waitcnt vmcnt(12)
    s_barrier
    ds_read_b64_tr_b16 v[128:129], v197 offset:0
    ds_read_b64_tr_b16 v[130:131], v197 offset:1024
    ds_read_b128 a[0:3], v228 offset:0
    s_add_u32 s32, s32, 0x80000
    s_and_b32 s32, s32, 0x7fffff
    s_add_u32 m0, s37, 0x8000
    s_nop 0
    buffer_load_dwordx4 v192, s[8:11], s32 offen offset:0 lds
    ds_read_b64_tr_b16 v[132:133], v198 offset:0
    ds_read_b64_tr_b16 v[134:135], v198 offset:1024
    ds_read_b128 a[4:7], v228 offset:4096
    ds_read_b64_tr_b16 v[136:137], v199 offset:0
    ds_read_b64_tr_b16 v[138:139], v199 offset:1024
    ds_read_b128 a[8:11], v229 offset:0
    buffer_load_dwordx4 v193, s[8:11], s32 offen offset:1024 lds
    ds_read_b64_tr_b16 v[140:141], v200 offset:0
    ds_read_b64_tr_b16 v[142:143], v200 offset:1024
    ds_read_b128 a[12:15], v229 offset:4096
    ds_read_b64_tr_b16 a[128:129], v232 offset:0
    ds_read_b64_tr_b16 a[130:131], v232 offset:1024
    ds_read_b128 a[16:19], v230 offset:0
    buffer_load_dwordx4 v194, s[8:11], s32 offen offset:2048 lds
    ds_read_b128 a[20:23], v230 offset:4096
    s_waitcnt lgkmcnt(5)
    v_mfma_f32_32x32x16_bf16 v[0:15], v[128:131], a[0:3], 0
    ds_read_b64_tr_b16 v[144:145], v197 offset:4096
    ds_read_b64_tr_b16 v[146:147], v197 offset:5120
    ds_read_b128 a[24:27], v231 offset:0
    s_lshl_b32 s3, s42, 3
    v_mfma_f32_32x32x16_bf16 v[16:31], v[128:131], a[4:7], 0
    ds_read_b128 a[28:31], v231 offset:4096
    buffer_load_dwordx4 v195, s[8:11], s32 offen offset:3072 lds
    v_mfma_f32_32x32x16_bf16 v[32:47], v[132:135], a[0:3], 0
    ds_read_b64_tr_b16 v[148:149], v198 offset:4096
    ds_read_b64_tr_b16 v[150:151], v198 offset:5120
    s_lshl_b32 s31, s28, 1
    v_mfma_f32_32x32x16_bf16 v[48:63], v[132:135], a[4:7], 0
    ds_read_b64_tr_b16 v[152:153], v199 offset:4096
    ds_read_b64_tr_b16 v[154:155], v199 offset:5120
    s_add_u32 s44, s44, 128
    s_and_b32 s44, s44, 0x7ff
    s_add_u32 s33, s45, s44
    s_add_u32 s34, s33, 0x10000
    s_add_u32 m0, s40, 0x4000
    v_mfma_f32_32x32x16_bf16 v[64:79], v[136:139], a[0:3], 0
    buffer_load_dwordx4 v224, s[12:15], s33 offen offset:0 lds
    s_add_u32 s3, s3, s31
    v_mfma_f32_32x32x16_bf16 v[80:95], v[136:139], a[4:7], 0
    ds_read_b64_tr_b16 v[156:157], v200 offset:4096
    ds_read_b64_tr_b16 v[158:159], v200 offset:5120
    v_mfma_f32_32x32x16_bf16 v[96:111], v[140:143], a[0:3], 0
    ds_read_b64_tr_b16 a[132:133], v232 offset:4096
    ds_read_b64_tr_b16 a[134:135], v232 offset:5120
    v_lshrrev_b32 v240, 5, v233
    v_mfma_f32_32x32x16_bf16 v[112:127], v[140:143], a[4:7], 0
    buffer_load_dwordx4 v225, s[12:15], s33 offen offset:1024 lds
    s_waitcnt lgkmcnt(14)
    v_mfma_f32_16x16x32_bf16 a[144:147], a[128:131], a[136:139], 0
    s_waitcnt lgkmcnt(2)
    v_mfma_f32_32x32x16_bf16 v[0:15], v[144:147], a[8:11], v[0:15]
    ds_read_b64_tr_b16 v[128:129], v197 offset:8192
    ds_read_b64_tr_b16 v[130:131], v197 offset:9216
    v_add_u32 v240, s3, v240
    v_mfma_f32_32x32x16_bf16 v[16:31], v[144:147], a[12:15], v[16:31]
    buffer_load_dwordx4 v226, s[12:15], s33 offen offset:2048 lds
    v_mfma_f32_32x32x16_bf16 v[32:47], v[148:151], a[8:11], v[32:47]
    ds_read_b64_tr_b16 v[132:133], v198 offset:8192
    ds_read_b64_tr_b16 v[134:135], v198 offset:9216
    v_and_b32 v239, 31, v233
    v_mfma_f32_32x32x16_bf16 v[48:63], v[148:151], a[12:15], v[48:63]
    ds_read_b64_tr_b16 v[136:137], v199 offset:8192
    ds_read_b64_tr_b16 v[138:139], v199 offset:9216
    v_mfma_f32_32x32x16_bf16 v[64:79], v[152:155], a[8:11], v[64:79]
    buffer_load_dwordx4 v227, s[12:15], s33 offen offset:3072 lds
    v_lshlrev_b32 v239, 4, v239
    v_mfma_f32_32x32x16_bf16 v[80:95], v[152:155], a[12:15], v[80:95]
    ds_read_b64_tr_b16 v[140:141], v200 offset:8192
    ds_read_b64_tr_b16 v[142:143], v200 offset:9216
    v_mfma_f32_32x32x16_bf16 v[96:111], v[156:159], a[8:11], v[96:111]
    ds_read_b64_tr_b16 a[128:129], v232 offset:8192
    ds_read_b64_tr_b16 a[130:131], v232 offset:9216
    s_add_u32 m0, s40, 0x5000
    v_lshl_add_u32 v238, v240, 11, v239
    v_mfma_f32_32x32x16_bf16 v[112:127], v[156:159], a[12:15], v[112:127]
    buffer_load_dwordx4 v224, s[12:15], s34 offen offset:0 lds
    s_waitcnt lgkmcnt(10)
    v_mfma_f32_16x16x32_bf16 a[144:147], a[132:135], a[136:139], a[144:147]
    s_waitcnt lgkmcnt(2)
    v_mfma_f32_32x32x16_bf16 v[0:15], v[128:131], a[16:19], v[0:15]
    ds_read_b64_tr_b16 v[144:145], v197 offset:12288
    ds_read_b64_tr_b16 v[146:147], v197 offset:13312
    buffer_load_dwordx4 a[64:67], v238, s[12:15], 0 offen offset:0
    v_mfma_f32_32x32x16_bf16 v[16:31], v[128:131], a[20:23], v[16:31]
    buffer_load_dwordx4 v225, s[12:15], s34 offen offset:1024 lds
    v_mfma_f32_32x32x16_bf16 v[32:47], v[132:135], a[16:19], v[32:47]
    ds_read_b64_tr_b16 v[148:149], v198 offset:12288
    ds_read_b64_tr_b16 v[150:151], v198 offset:13312
    buffer_load_dwordx4 a[68:71], v238, s[12:15], 0 offen offset:512
    v_mfma_f32_32x32x16_bf16 v[48:63], v[132:135], a[20:23], v[48:63]
    ds_read_b64_tr_b16 v[152:153], v199 offset:12288
    ds_read_b64_tr_b16 v[154:155], v199 offset:13312
    v_mfma_f32_32x32x16_bf16 v[64:79], v[136:139], a[16:19], v[64:79]
    buffer_load_dwordx4 v226, s[12:15], s34 offen offset:2048 lds
    buffer_load_dwordx4 a[72:75], v238, s[12:15], 0 offen offset:1024
    v_mfma_f32_32x32x16_bf16 v[80:95], v[136:139], a[20:23], v[80:95]
    ds_read_b64_tr_b16 v[156:157], v200 offset:12288
    ds_read_b64_tr_b16 v[158:159], v200 offset:13312
    v_mfma_f32_32x32x16_bf16 v[96:111], v[140:143], a[16:19], v[96:111]
    ds_read_b64_tr_b16 a[132:133], v232 offset:12288
    ds_read_b64_tr_b16 a[134:135], v232 offset:13312
    buffer_load_dwordx4 a[76:79], v238, s[12:15], 0 offen offset:1536
    v_mfma_f32_32x32x16_bf16 v[112:127], v[140:143], a[20:23], v[112:127]
    buffer_load_dwordx4 v227, s[12:15], s34 offen offset:3072 lds
    s_waitcnt lgkmcnt(10)
    v_mfma_f32_16x16x32_bf16 a[144:147], a[128:131], a[136:139], a[144:147]
    s_waitcnt vmcnt(16)
    s_waitcnt lgkmcnt(0)
    s_barrier
    v_mfma_f32_32x32x16_bf16 v[0:15], v[144:147], a[24:27], v[0:15]
    ds_read_b64_tr_b16 v[128:129], v197 offset:16384
    ds_read_b64_tr_b16 v[130:131], v197 offset:17408
    ds_read_b128 a[32:35], v228 offset:8192
    buffer_load_dwordx4 a[80:83], v239, s[60:63], 0 offen offset:0
    v_mfma_f32_32x32x16_bf16 v[16:31], v[144:147], a[28:31], v[16:31]
    s_add_u32 s32, s32, 0x80000
    s_and_b32 s32, s32, 0x7fffff
    s_add_u32 m0, s37, 0xc000
    s_nop 0
    buffer_load_dwordx4 v192, s[8:11], s32 offen offset:0 lds
    v_mfma_f32_32x32x16_bf16 v[32:47], v[148:151], a[24:27], v[32:47]
    ds_read_b64_tr_b16 v[132:133], v198 offset:16384
    ds_read_b64_tr_b16 v[134:135], v198 offset:17408
    ds_read_b128 a[36:39], v228 offset:12288
    buffer_load_dwordx4 v193, s[8:11], s32 offen offset:1024 lds
    buffer_load_dwordx4 a[84:87], v239, s[60:63], 0 offen offset:512
    v_mfma_f32_32x32x16_bf16 v[48:63], v[148:151], a[28:31], v[48:63]
    ds_read_b64_tr_b16 v[136:137], v199 offset:16384
    ds_read_b64_tr_b16 v[138:139], v199 offset:17408
    ds_read_b128 a[40:43], v229 offset:8192
    v_mfma_f32_32x32x16_bf16 v[64:79], v[152:155], a[24:27], v[64:79]
    buffer_load_dwordx4 v194, s[8:11], s32 offen offset:2048 lds
    buffer_load_dwordx4 a[88:91], v239, s[60:63], 0 offen offset:1024
    v_mfma_f32_32x32x16_bf16 v[80:95], v[152:155], a[28:31], v[80:95]
    ds_read_b64_tr_b16 v[140:141], v200 offset:16384
    ds_read_b64_tr_b16 v[142:143], v200 offset:17408
    ds_read_b128 a[44:47], v229 offset:12288
    buffer_load_dwordx4 v195, s[8:11], s32 offen offset:3072 lds
    v_mfma_f32_32x32x16_bf16 v[96:111], v[156:159], a[24:27], v[96:111]
    ds_read_b64_tr_b16 a[128:129], v232 offset:16384
    ds_read_b64_tr_b16 a[130:131], v232 offset:17408
    ds_read_b128 a[48:51], v230 offset:8192
    buffer_load_dwordx4 a[92:95], v239, s[60:63], 0 offen offset:1536
    v_mfma_f32_32x32x16_bf16 v[112:127], v[156:159], a[28:31], v[112:127]
    s_add_u32 s44, s44, 128
    s_and_b32 s44, s44, 0x7ff
    s_add_u32 s33, s45, s44
    s_add_u32 s34, s33, 0x10000
    s_add_u32 m0, s40, 0x0
    s_nop 0
    buffer_load_dwordx4 v224, s[12:15], s33 offen offset:0 lds
    v_mfma_f32_16x16x32_bf16 a[144:147], a[132:135], a[136:139], a[144:147]
    ds_read_b128 a[52:55], v230 offset:12288
    buffer_load_dwordx4 v225, s[12:15], s33 offen offset:1024 lds
    s_waitcnt lgkmcnt(5)
    v_mfma_f32_32x32x16_bf16 v[0:15], v[128:131], a[32:35], v[0:15]
    ds_read_b64_tr_b16 v[144:145], v197 offset:20480
    ds_read_b64_tr_b16 v[146:147], v197 offset:21504
    ds_read_b128 a[56:59], v231 offset:8192
    v_mfma_f32_32x32x16_bf16 v[16:31], v[128:131], a[36:39], v[16:31]
    ds_read_b128 a[60:63], v231 offset:12288
    buffer_load_dwordx4 v226, s[12:15], s33 offen offset:2048 lds
    v_mfma_f32_32x32x16_bf16 v[32:47], v[132:135], a[32:35], v[32:47]
    ds_read_b64_tr_b16 v[148:149], v198 offset:20480
    ds_read_b64_tr_b16 v[150:151], v198 offset:21504
    buffer_load_dwordx4 v227, s[12:15], s33 offen offset:3072 lds
    v_mfma_f32_32x32x16_bf16 v[48:63], v[132:135], a[36:39], v[48:63]
    ds_read_b64_tr_b16 v[152:153], v199 offset:20480
    ds_read_b64_tr_b16 v[154:155], v199 offset:21504
    v_mfma_f32_32x32x16_bf16 v[64:79], v[136:139], a[32:35], v[64:79]
    s_add_u32 m0, s40, 0x1000
    s_nop 0
    buffer_load_dwordx4 v224, s[12:15], s34 offen offset:0 lds
    v_mfma_f32_32x32x16_bf16 v[80:95], v[136:139], a[36:39], v[80:95]
    ds_read_b64_tr_b16 v[156:157], v200 offset:20480
    ds_read_b64_tr_b16 v[158:159], v200 offset:21504
    buffer_load_dwordx4 v225, s[12:15], s34 offen offset:1024 lds
    v_mfma_f32_32x32x16_bf16 v[96:111], v[140:143], a[32:35], v[96:111]
    ds_read_b64_tr_b16 a[132:133], v232 offset:20480
    ds_read_b64_tr_b16 a[134:135], v232 offset:21504
    v_mfma_f32_32x32x16_bf16 v[112:127], v[140:143], a[36:39], v[112:127]
    buffer_load_dwordx4 v226, s[12:15], s34 offen offset:2048 lds
    s_waitcnt lgkmcnt(14)
    v_mfma_f32_16x16x32_bf16 a[144:147], a[128:131], a[136:139], a[144:147]
    buffer_load_dwordx4 v227, s[12:15], s34 offen offset:3072 lds
    s_waitcnt lgkmcnt(2)
    v_mfma_f32_32x32x16_bf16 v[0:15], v[144:147], a[40:43], v[0:15]
    ds_read_b64_tr_b16 v[128:129], v197 offset:24576
    ds_read_b64_tr_b16 v[130:131], v197 offset:25600
    v_mfma_f32_32x32x16_bf16 v[16:31], v[144:147], a[44:47], v[16:31]
    s_add_u32 s32, s32, 0x80000
    s_and_b32 s32, s32, 0x7fffff
    s_add_u32 m0, s37, 0x0
    s_nop 0
    buffer_load_dwordx4 v192, s[8:11], s32 offen offset:0 lds
    v_mfma_f32_32x32x16_bf16 v[32:47], v[148:151], a[40:43], v[32:47]
    ds_read_b64_tr_b16 v[132:133], v198 offset:24576
    ds_read_b64_tr_b16 v[134:135], v198 offset:25600
    buffer_load_dwordx4 v193, s[8:11], s32 offen offset:1024 lds
    v_mfma_f32_32x32x16_bf16 v[48:63], v[148:151], a[44:47], v[48:63]
    ds_read_b64_tr_b16 v[136:137], v199 offset:24576
    ds_read_b64_tr_b16 v[138:139], v199 offset:25600
    v_mfma_f32_32x32x16_bf16 v[64:79], v[152:155], a[40:43], v[64:79]
    buffer_load_dwordx4 v194, s[8:11], s32 offen offset:2048 lds
    v_mfma_f32_32x32x16_bf16 v[80:95], v[152:155], a[44:47], v[80:95]
    ds_read_b64_tr_b16 v[140:141], v200 offset:24576
    ds_read_b64_tr_b16 v[142:143], v200 offset:25600
    buffer_load_dwordx4 v195, s[8:11], s32 offen offset:3072 lds
    v_mfma_f32_32x32x16_bf16 v[96:111], v[156:159], a[40:43], v[96:111]
    ds_read_b64_tr_b16 a[128:129], v232 offset:24576
    ds_read_b64_tr_b16 a[130:131], v232 offset:25600
    v_mfma_f32_32x32x16_bf16 v[112:127], v[156:159], a[44:47], v[112:127]
    s_add_u32 s44, s44, 128
    s_and_b32 s44, s44, 0x7ff
    s_add_u32 s33, s45, s44
    s_add_u32 s34, s33, 0x10000
    s_add_u32 m0, s40, 0x2000
    s_nop 0
    buffer_load_dwordx4 v224, s[12:15], s33 offen offset:0 lds
    s_waitcnt lgkmcnt(10)
    v_mfma_f32_16x16x32_bf16 a[144:147], a[132:135], a[136:139], a[144:147]
    buffer_load_dwordx4 v225, s[12:15], s33 offen offset:1024 lds
    s_waitcnt lgkmcnt(2)
    v_mfma_f32_32x32x16_bf16 v[0:15], v[128:131], a[48:51], v[0:15]
    ds_read_b64_tr_b16 v[144:145], v197 offset:28672
    ds_read_b64_tr_b16 v[146:147], v197 offset:29696
    v_mfma_f32_32x32x16_bf16 v[16:31], v[128:131], a[52:55], v[16:31]
    buffer_load_dwordx4 v226, s[12:15], s33 offen offset:2048 lds
    v_mfma_f32_32x32x16_bf16 v[32:47], v[132:135], a[48:51], v[32:47]
    ds_read_b64_tr_b16 v[148:149], v198 offset:28672
    ds_read_b64_tr_b16 v[150:151], v198 offset:29696
    buffer_load_dwordx4 v227, s[12:15], s33 offen offset:3072 lds
    v_mfma_f32_32x32x16_bf16 v[48:63], v[132:135], a[52:55], v[48:63]
    ds_read_b64_tr_b16 v[152:153], v199 offset:28672
    ds_read_b64_tr_b16 v[154:155], v199 offset:29696
    v_mfma_f32_32x32x16_bf16 v[64:79], v[136:139], a[48:51], v[64:79]
    s_add_u32 m0, s40, 0x3000
    s_nop 0
    buffer_load_dwordx4 v224, s[12:15], s34 offen offset:0 lds
    v_mfma_f32_32x32x16_bf16 v[80:95], v[136:139], a[52:55], v[80:95]
    ds_read_b64_tr_b16 v[156:157], v200 offset:28672
    ds_read_b64_tr_b16 v[158:159], v200 offset:29696
    buffer_load_dwordx4 v225, s[12:15], s34 offen offset:1024 lds
    v_mfma_f32_32x32x16_bf16 v[96:111], v[140:143], a[48:51], v[96:111]
    ds_read_b64_tr_b16 a[132:133], v232 offset:28672
    ds_read_b64_tr_b16 a[134:135], v232 offset:29696
    v_mfma_f32_32x32x16_bf16 v[112:127], v[140:143], a[52:55], v[112:127]
    buffer_load_dwordx4 v226, s[12:15], s34 offen offset:2048 lds
    s_waitcnt lgkmcnt(10)
    v_mfma_f32_16x16x32_bf16 a[144:147], a[128:131], a[136:139], a[144:147]
    buffer_load_dwordx4 v227, s[12:15], s34 offen offset:3072 lds
    s_waitcnt vmcnt(28)
    s_waitcnt lgkmcnt(0)
    s_barrier
    v_mfma_f32_32x32x16_bf16 v[0:15], v[144:147], a[56:59], v[0:15]
    ds_read_b64_tr_b16 v[128:129], v197 offset:32768
    ds_read_b64_tr_b16 v[130:131], v197 offset:33792
    ds_read_b128 a[0:3], v228 offset:16384
    s_add_u32 s32, s32, 0x80000
    s_and_b32 s32, s32, 0x7fffff
    s_add_u32 m0, s37, 0x4000
    s_waitcnt vmcnt(20)
    v_accvgpr_read_b32 v242, a64
    v_lshlrev_b32 v160, 16, v242
    v_mfma_f32_32x32x16_bf16 v[16:31], v[144:147], a[60:63], v[16:31]
    buffer_load_dwordx4 v192, s[8:11], s32 offen offset:0 lds
    v_and_b32 v161, s49, v242
    v_accvgpr_read_b32 v243, a65
    v_mfma_f32_32x32x16_bf16 v[32:47], v[148:151], a[56:59], v[32:47]
    ds_read_b64_tr_b16 v[132:133], v198 offset:32768
    ds_read_b64_tr_b16 v[134:135], v198 offset:33792
    ds_read_b128 a[4:7], v228 offset:20480
    v_lshlrev_b32 v162, 16, v243
    v_and_b32 v163, s49, v243
    v_accvgpr_read_b32 v242, a66
    v_mfma_f32_32x32x16_bf16 v[48:63], v[148:151], a[60:63], v[48:63]
    ds_read_b64_tr_b16 v[136:137], v199 offset:32768
    ds_read_b64_tr_b16 v[138:139], v199 offset:33792
    ds_read_b128 a[8:11], v229 offset:16384
    v_lshlrev_b32 v164, 16, v242
    v_and_b32 v165, s49, v242
    v_mfma_f32_32x32x16_bf16 v[64:79], v[152:155], a[56:59], v[64:79]
    buffer_load_dwordx4 v193, s[8:11], s32 offen offset:1024 lds
    v_accvgpr_read_b32 v243, a67
    v_lshlrev_b32 v166, 16, v243
    v_and_b32 v167, s49, v243
    v_mfma_f32_32x32x16_bf16 v[80:95], v[152:155], a[60:63], v[80:95]
    ds_read_b64_tr_b16 v[140:141], v200 offset:32768
    ds_read_b64_tr_b16 v[142:143], v200 offset:33792
    ds_read_b128 a[12:15], v229 offset:20480
    v_accvgpr_read_b32 v242, a68
    v_lshlrev_b32 v168, 16, v242
    v_mfma_f32_32x32x16_bf16 v[96:111], v[156:159], a[56:59], v[96:111]
    ds_read_b64_tr_b16 a[128:129], v232 offset:32768
    ds_read_b64_tr_b16 a[130:131], v232 offset:33792
    ds_read_b128 a[16:19], v230 offset:16384
    v_and_b32 v169, s49, v242
    v_accvgpr_read_b32 v243, a69
    v_lshlrev_b32 v170, 16, v243
    v_mfma_f32_32x32x16_bf16 v[112:127], v[156:159], a[60:63], v[112:127]
    buffer_load_dwordx4 v194, s[8:11], s32 offen offset:2048 lds
    v_and_b32 v171, s49, v243
    v_accvgpr_read_b32 v242, a70
    v_mfma_f32_16x16x32_bf16 a[144:147], a[132:135], a[136:139], a[144:147]
    ds_read_b128 a[20:23], v230 offset:20480
    v_lshlrev_b32 v172, 16, v242
    v_and_b32 v173, s49, v242
    s_waitcnt lgkmcnt(5)
    v_mfma_f32_32x32x16_bf16 v[0:15], v[128:131], a[0:3], v[0:15]
    ds_read_b64_tr_b16 v[144:145], v197 offset:36864
    ds_read_b64_tr_b16 v[146:147], v197 offset:37888
    ds_read_b128 a[24:27], v231 offset:16384
    v_accvgpr_read_b32 v243, a71
    v_lshlrev_b32 v174, 16, v243
    v_and_b32 v175, s49, v243
    v_mfma_f32_32x32x16_bf16 v[16:31], v[128:131], a[4:7], v[16:31]
    ds_read_b128 a[28:31], v231 offset:20480
    buffer_load_dwordx4 v195, s[8:11], s32 offen offset:3072 lds
    v_accvgpr_read_b32 v242, a72
    v_lshlrev_b32 v176, 16, v242
    v_mfma_f32_32x32x16_bf16 v[32:47], v[132:135], a[0:3], v[32:47]
    ds_read_b64_tr_b16 v[148:149], v198 offset:36864
    ds_read_b64_tr_b16 v[150:151], v198 offset:37888
    v_and_b32 v177, s49, v242
    v_accvgpr_read_b32 v243, a73
    v_lshlrev_b32 v178, 16, v243
    v_mfma_f32_32x32x16_bf16 v[48:63], v[132:135], a[4:7], v[48:63]
    ds_read_b64_tr_b16 v[152:153], v199 offset:36864
    ds_read_b64_tr_b16 v[154:155], v199 offset:37888
    s_add_u32 s44, s44, 128
    s_and_b32 s44, s44, 0x7ff
    s_add_u32 s33, s45, s44
    s_add_u32 s34, s33, 0x10000
    s_add_u32 m0, s40, 0x4000
    v_and_b32 v179, s49, v243
    v_accvgpr_read_b32 v242, a74
    v_mfma_f32_32x32x16_bf16 v[64:79], v[136:139], a[0:3], v[64:79]
    s_waitcnt lgkmcnt(4)
    buffer_load_dwordx4 v224, s[12:15], s33 offen offset:0 lds
    v_lshlrev_b32 v180, 16, v242
    v_and_b32 v181, s49, v242
    v_accvgpr_read_b32 v243, a75
    v_mfma_f32_32x32x16_bf16 v[80:95], v[136:139], a[4:7], v[80:95]
    ds_read_b64_tr_b16 v[156:157], v200 offset:36864
    ds_read_b64_tr_b16 v[158:159], v200 offset:37888
    v_lshlrev_b32 v182, 16, v243
    v_and_b32 v183, s49, v243
    v_mfma_f32_32x32x16_bf16 v[96:111], v[140:143], a[0:3], v[96:111]
    ds_read_b64_tr_b16 a[132:133], v232 offset:36864
    ds_read_b64_tr_b16 a[134:135], v232 offset:37888
    v_accvgpr_read_b32 v242, a76
    v_lshlrev_b32 v184, 16, v242
    v_and_b32 v185, s49, v242
    v_mfma_f32_32x32x16_bf16 v[112:127], v[140:143], a[4:7], v[112:127]
    buffer_load_dwordx4 v225, s[12:15], s33 offen offset:1024 lds
    v_accvgpr_read_b32 v243, a77
    v_lshlrev_b32 v186, 16, v243
    v_mfma_f32_16x16x32_bf16 a[144:147], a[128:131], a[136:139], a[144:147]
    v_and_b32 v187, s49, v243
    v_accvgpr_read_b32 v242, a78
    s_waitcnt lgkmcnt(2)
    v_mfma_f32_32x32x16_bf16 v[0:15], v[144:147], a[8:11], v[0:15]
    ds_read_b64_tr_b16 v[128:129], v197 offset:40960
    ds_read_b64_tr_b16 v[130:131], v197 offset:41984
    v_lshlrev_b32 v188, 16, v242
    v_and_b32 v189, s49, v242
    v_accvgpr_read_b32 v243, a79
    v_mfma_f32_32x32x16_bf16 v[16:31], v[144:147], a[12:15], v[16:31]
    buffer_load_dwordx4 v226, s[12:15], s33 offen offset:2048 lds
    v_lshlrev_b32 v190, 16, v243
    v_and_b32 v191, s49, v243
    v_mfma_f32_32x32x16_bf16 v[32:47], v[148:151], a[8:11], v[32:47]
    ds_read_b64_tr_b16 v[132:133], v198 offset:40960
    ds_read_b64_tr_b16 v[134:135], v198 offset:41984
    v_add_f32 v220, v160, v161
    v_add_f32 v221, v162, v163
    v_add_f32 v220, v220, v164
    v_mfma_f32_32x32x16_bf16 v[48:63], v[148:151], a[12:15], v[48:63]
    ds_read_b64_tr_b16 v[136:137], v199 offset:40960
    ds_read_b64_tr_b16 v[138:139], v199 offset:41984
    v_add_f32 v221, v221, v165
    v_add_f32 v220, v220, v166
    v_mfma_f32_32x32x16_bf16 v[64:79], v[152:155], a[8:11], v[64:79]
    buffer_load_dwordx4 v227, s[12:15], s33 offen offset:3072 lds
    v_add_f32 v221, v221, v167
    v_add_f32 v220, v220, v168
    v_add_f32 v221, v221, v169
    v_mfma_f32_32x32x16_bf16 v[80:95], v[152:155], a[12:15], v[80:95]
    ds_read_b64_tr_b16 v[140:141], v200 offset:40960
    ds_read_b64_tr_b16 v[142:143], v200 offset:41984
    v_add_f32 v220, v220, v170
    v_add_f32 v221, v221, v171
    v_mfma_f32_32x32x16_bf16 v[96:111], v[156:159], a[8:11], v[96:111]
    ds_read_b64_tr_b16 a[128:129], v232 offset:40960
    ds_read_b64_tr_b16 a[130:131], v232 offset:41984
    s_add_u32 m0, s40, 0x5000
    v_add_f32 v220, v220, v172
    v_add_f32 v221, v221, v173
    v_add_f32 v220, v220, v174
    v_mfma_f32_32x32x16_bf16 v[112:127], v[156:159], a[12:15], v[112:127]
    buffer_load_dwordx4 v224, s[12:15], s34 offen offset:0 lds
    v_add_f32 v221, v221, v175
    v_add_f32 v220, v220, v176
    s_waitcnt lgkmcnt(10)
    v_mfma_f32_16x16x32_bf16 a[144:147], a[132:135], a[136:139], a[144:147]
    v_add_f32 v221, v221, v177
    v_add_f32 v220, v220, v178
    s_waitcnt lgkmcnt(2)
    v_mfma_f32_32x32x16_bf16 v[0:15], v[128:131], a[16:19], v[0:15]
    ds_read_b64_tr_b16 v[144:145], v197 offset:45056
    ds_read_b64_tr_b16 v[146:147], v197 offset:46080
    v_add_f32 v221, v221, v179
    v_add_f32 v220, v220, v180
    v_add_f32 v221, v221, v181
    v_mfma_f32_32x32x16_bf16 v[16:31], v[128:131], a[20:23], v[16:31]
    buffer_load_dwordx4 v225, s[12:15], s34 offen offset:1024 lds
    v_add_f32 v220, v220, v182
    v_add_f32 v221, v221, v183
    v_mfma_f32_32x32x16_bf16 v[32:47], v[132:135], a[16:19], v[32:47]
    ds_read_b64_tr_b16 v[148:149], v198 offset:45056
    ds_read_b64_tr_b16 v[150:151], v198 offset:46080
    v_add_f32 v220, v220, v184
    v_add_f32 v221, v221, v185
    v_add_f32 v220, v220, v186
    v_mfma_f32_32x32x16_bf16 v[48:63], v[132:135], a[20:23], v[48:63]
    ds_read_b64_tr_b16 v[152:153], v199 offset:45056
    ds_read_b64_tr_b16 v[154:155], v199 offset:46080
    v_add_f32 v221, v221, v187
    v_add_f32 v220, v220, v188
    v_mfma_f32_32x32x16_bf16 v[64:79], v[136:139], a[16:19], v[64:79]
    buffer_load_dwordx4 v226, s[12:15], s34 offen offset:2048 lds
    v_add_f32 v221, v221, v189
    v_add_f32 v220, v220, v190
    v_add_f32 v221, v221, v191
    v_mfma_f32_32x32x16_bf16 v[80:95], v[136:139], a[20:23], v[80:95]
    ds_read_b64_tr_b16 v[156:157], v200 offset:45056
    ds_read_b64_tr_b16 v[158:159], v200 offset:46080
    v_add_f32 v220, v220, v221
    s_nop 1
    v_add_f32_dpp v220, v220, v220 quad_perm:[1,0,3,2] row_mask:0xf bank_mask:0xf
    v_mfma_f32_32x32x16_bf16 v[96:111], v[140:143], a[16:19], v[96:111]
    ds_read_b64_tr_b16 a[132:133], v232 offset:45056
    ds_read_b64_tr_b16 a[134:135], v232 offset:46080
    v_add_f32_dpp v220, v220, v220 quad_perm:[2,3,0,1] row_mask:0xf bank_mask:0xf
    s_nop 1
    v_add_f32_dpp v220, v220, v220 row_half_mirror row_mask:0xf bank_mask:0xf
    s_nop 1
    v_add_f32_dpp v220, v220, v220 row_mirror row_mask:0xf bank_mask:0xf
    v_mfma_f32_32x32x16_bf16 v[112:127], v[140:143], a[20:23], v[112:127]
    buffer_load_dwordx4 v227, s[12:15], s34 offen offset:3072 lds
    v_mov_b32 v221, v220
    s_nop 1
    v_permlane16_swap_b32 v220, v221
    s_waitcnt lgkmcnt(10)
    v_mfma_f32_16x16x32_bf16 a[144:147], a[128:131], a[136:139], a[144:147]
    v_add_f32 v220, v220, v221
    v_mul_f32 v220, 0x3a800000, v220
    s_waitcnt vmcnt(24)
    s_waitcnt lgkmcnt(0)
    s_barrier
    v_mfma_f32_32x32x16_bf16 v[0:15], v[144:147], a[24:27], v[0:15]
    ds_read_b64_tr_b16 v[128:129], v197 offset:49152
    ds_read_b64_tr_b16 v[130:131], v197 offset:50176
    ds_read_b128 a[32:35], v228 offset:0
    s_add_u32 s32, s32, 0x80000
    s_and_b32 s32, s32, 0x7fffff
    s_add_u32 m0, s37, 0x8000
    v_sub_f32 v242, v160, v220
    v_sub_f32 v243, v161, v220
    v_mul_f32 v221, v242, v242
    v_mfma_f32_32x32x16_bf16 v[16:31], v[144:147], a[28:31], v[16:31]
    buffer_load_dwordx4 v192, s[8:11], s32 offen offset:0 lds
    v_mul_f32 v222, v243, v243
    v_sub_f32 v242, v162, v220
    v_mfma_f32_32x32x16_bf16 v[32:47], v[148:151], a[24:27], v[32:47]
    ds_read_b64_tr_b16 v[132:133], v198 offset:49152
    ds_read_b64_tr_b16 v[134:135], v198 offset:50176
    ds_read_b128 a[36:39], v228 offset:4096
    v_sub_f32 v243, v163, v220
    v_fmac_f32 v221, v242, v242
    v_fmac_f32 v222, v243, v243
    v_mfma_f32_32x32x16_bf16 v[48:63], v[148:151], a[28:31], v[48:63]
    ds_read_b64_tr_b16 v[136:137], v199 offset:49152
    ds_read_b64_tr_b16 v[138:139], v199 offset:50176
    ds_read_b128 a[40:43], v229 offset:0
    v_sub_f32 v242, v164, v220
    v_sub_f32 v243, v165, v220
    v_mfma_f32_32x32x16_bf16 v[64:79], v[152:155], a[24:27], v[64:79]
    buffer_load_dwordx4 v193, s[8:11], s32 offen offset:1024 lds
    v_fmac_f32 v221, v242, v242
    v_fmac_f32 v222, v243, v243
    v_sub_f32 v242, v166, v220
    v_mfma_f32_32x32x16_bf16 v[80:95], v[152:155], a[28:31], v[80:95]
    ds_read_b64_tr_b16 v[140:141], v200 offset:49152
    ds_read_b64_tr_b16 v[142:143], v200 offset:50176
    ds_read_b128 a[44:47], v229 offset:4096
    v_sub_f32 v243, v167, v220
    v_fmac_f32 v221, v242, v242
    v_mfma_f32_32x32x16_bf16 v[96:111], v[156:159], a[24:27], v[96:111]
    ds_read_b64_tr_b16 a[128:129], v232 offset:49152
    ds_read_b64_tr_b16 a[130:131], v232 offset:50176
    ds_read_b128 a[48:51], v230 offset:0
    v_fmac_f32 v222, v243, v243
    v_sub_f32 v242, v168, v220
    v_sub_f32 v243, v169, v220
    v_mfma_f32_32x32x16_bf16 v[112:127], v[156:159], a[28:31], v[112:127]
    buffer_load_dwordx4 v194, s[8:11], s32 offen offset:2048 lds
    v_fmac_f32 v221, v242, v242
    v_fmac_f32 v222, v243, v243
    v_mfma_f32_16x16x32_bf16 a[144:147], a[132:135], a[136:139], a[144:147]
    ds_read_b128 a[52:55], v230 offset:4096
    v_sub_f32 v242, v170, v220
    v_sub_f32 v243, v171, v220
    s_waitcnt lgkmcnt(5)
    v_mfma_f32_32x32x16_bf16 v[0:15], v[128:131], a[32:35], v[0:15]
    ds_read_b64_tr_b16 v[144:145], v197 offset:53248
    ds_read_b64_tr_b16 v[146:147], v197 offset:54272
    ds_read_b128 a[56:59], v231 offset:0
    v_fmac_f32 v221, v242, v242
    v_fmac_f32 v222, v243, v243
    v_sub_f32 v242, v172, v220
    v_mfma_f32_32x32x16_bf16 v[16:31], v[128:131], a[36:39], v[16:31]
    ds_read_b128 a[60:63], v231 offset:4096
    buffer_load_dwordx4 v195, s[8:11], s32 offen offset:3072 lds
    v_sub_f32 v243, v173, v220
    v_fmac_f32 v221, v242, v242
    v_mfma_f32_32x32x16_bf16 v[32:47], v[132:135], a[32:35], v[32:47]
    ds_read_b64_tr_b16 v[148:149], v198 offset:53248
    ds_read_b64_tr_b16 v[150:151], v198 offset:54272
    v_fmac_f32 v222, v243, v243
    v_sub_f32 v242, v174, v220
    v_sub_f32 v243, v175, v220
    v_mfma_f32_32x32x16_bf16 v[48:63], v[132:135], a[36:39], v[48:63]
    ds_read_b64_tr_b16 v[152:153], v199 offset:53248
    ds_read_b64_tr_b16 v[154:155], v199 offset:54272
    s_add_u32 s44, s44, 128
    s_and_b32 s44, s44, 0x7ff
    s_add_u32 s33, s45, s44
    s_add_u32 s34, s33, 0x10000
    s_add_u32 m0, s40, 0x0
    v_fmac_f32 v221, v242, v242
    v_fmac_f32 v222, v243, v243
    v_mfma_f32_32x32x16_bf16 v[64:79], v[136:139], a[32:35], v[64:79]
    s_waitcnt lgkmcnt(4)
    buffer_load_dwordx4 v224, s[12:15], s33 offen offset:0 lds
    v_sub_f32 v242, v176, v220
    v_sub_f32 v243, v177, v220
    v_fmac_f32 v221, v242, v242
    v_mfma_f32_32x32x16_bf16 v[80:95], v[136:139], a[36:39], v[80:95]
    ds_read_b64_tr_b16 v[156:157], v200 offset:53248
    ds_read_b64_tr_b16 v[158:159], v200 offset:54272
    v_fmac_f32 v222, v243, v243
    v_sub_f32 v242, v178, v220
    v_mfma_f32_32x32x16_bf16 v[96:111], v[140:143], a[32:35], v[96:111]
    ds_read_b64_tr_b16 a[132:133], v232 offset:53248
    ds_read_b64_tr_b16 a[134:135], v232 offset:54272
    v_sub_f32 v243, v179, v220
    v_fmac_f32 v221, v242, v242
    v_fmac_f32 v222, v243, v243
    v_mfma_f32_32x32x16_bf16 v[112:127], v[140:143], a[36:39], v[112:127]
    buffer_load_dwordx4 v225, s[12:15], s33 offen offset:1024 lds
    v_sub_f32 v242, v180, v220
    v_sub_f32 v243, v181, v220
    v_mfma_f32_16x16x32_bf16 a[144:147], a[128:131], a[136:139], a[144:147]
    v_fmac_f32 v221, v242, v242
    v_fmac_f32 v222, v243, v243
    s_waitcnt lgkmcnt(2)
    v_mfma_f32_32x32x16_bf16 v[0:15], v[144:147], a[40:43], v[0:15]
    ds_read_b64_tr_b16 v[128:129], v197 offset:57344
    ds_read_b64_tr_b16 v[130:131], v197 offset:58368
    v_sub_f32 v242, v182, v220
    v_sub_f32 v243, v183, v220
    v_fmac_f32 v221, v242, v242
    v_mfma_f32_32x32x16_bf16 v[16:31], v[144:147], a[44:47], v[16:31]
    buffer_load_dwordx4 v226, s[12:15], s33 offen offset:2048 lds
    v_fmac_f32 v222, v243, v243
    v_sub_f32 v242, v184, v220
    v_mfma_f32_32x32x16_bf16 v[32:47], v[148:151], a[40:43], v[32:47]
    ds_read_b64_tr_b16 v[132:133], v198 offset:57344
    ds_read_b64_tr_b16 v[134:135], v198 offset:58368
    v_sub_f32 v243, v185, v220
    v_fmac_f32 v221, v242, v242
    v_fmac_f32 v222, v243, v243
    v_mfma_f32_32x32x16_bf16 v[48:63], v[148:151], a[44:47], v[48:63]
    ds_read_b64_tr_b16 v[136:137], v199 offset:57344
    ds_read_b64_tr_b16 v[138:139], v199 offset:58368
    v_sub_f32 v242, v186, v220
    v_sub_f32 v243, v187, v220
    v_mfma_f32_32x32x16_bf16 v[64:79], v[152:155], a[40:43], v[64:79]
    buffer_load_dwordx4 v227, s[12:15], s33 offen offset:3072 lds
    v_fmac_f32 v221, v242, v242
    v_fmac_f32 v222, v243, v243
    v_sub_f32 v242, v188, v220
    v_mfma_f32_32x32x16_bf16 v[80:95], v[152:155], a[44:47], v[80:95]
    ds_read_b64_tr_b16 v[140:141], v200 offset:57344
    ds_read_b64_tr_b16 v[142:143], v200 offset:58368
    v_sub_f32 v243, v189, v220
    v_fmac_f32 v221, v242, v242
    v_mfma_f32_32x32x16_bf16 v[96:111], v[156:159], a[40:43], v[96:111]
    ds_read_b64_tr_b16 a[128:129], v232 offset:57344
    ds_read_b64_tr_b16 a[130:131], v232 offset:58368
    s_add_u32 m0, s40, 0x1000
    v_fmac_f32 v222, v243, v243
    v_sub_f32 v242, v190, v220
    v_sub_f32 v243, v191, v220
    v_mfma_f32_32x32x16_bf16 v[112:127], v[156:159], a[44:47], v[112:127]
    buffer_load_dwordx4 v224, s[12:15], s34 offen offset:0 lds
    v_fmac_f32 v221, v242, v242
    v_fmac_f32 v222, v243, v243
    s_waitcnt lgkmcnt(10)
    v_mfma_f32_16x16x32_bf16 a[144:147], a[132:135], a[136:139], a[144:147]
    v_add_f32 v221, v221, v222
    s_nop 1
    v_add_f32_dpp v221, v221, v221 quad_perm:[1,0,3,2] row_mask:0xf bank_mask:0xf
    s_waitcnt lgkmcnt(2)
    v_mfma_f32_32x32x16_bf16 v[0:15], v[128:131], a[48:51], v[0:15]
    ds_read_b64_tr_b16 v[144:145], v197 offset:61440
    ds_read_b64_tr_b16 v[146:147], v197 offset:62464
    v_add_f32_dpp v221, v221, v221 quad_perm:[2,3,0,1] row_mask:0xf bank_mask:0xf
    s_nop 1
    v_add_f32_dpp v221, v221, v221 row_half_mirror row_mask:0xf bank_mask:0xf
    s_nop 1
    v_add_f32_dpp v221, v221, v221 row_mirror row_mask:0xf bank_mask:0xf
    v_mfma_f32_32x32x16_bf16 v[16:31], v[128:131], a[52:55], v[16:31]
    buffer_load_dwordx4 v225, s[12:15], s34 offen offset:1024 lds
    v_mov_b32 v222, v221
    s_nop 1
    v_permlane16_swap_b32 v221, v222
    v_mfma_f32_32x32x16_bf16 v[32:47], v[132:135], a[48:51], v[32:47]
    ds_read_b64_tr_b16 v[148:149], v198 offset:61440
    ds_read_b64_tr_b16 v[150:151], v198 offset:62464
    v_add_f32 v221, v221, v222
    v_mul_f32 v221, 0x3a800000, v221
    v_cvt_pk_bf16_f32 v222, v220, v221
    v_mfma_f32_32x32x16_bf16 v[48:63], v[132:135], a[52:55], v[48:63]
    ds_read_b64_tr_b16 v[152:153], v199 offset:61440
    ds_read_b64_tr_b16 v[154:155], v199 offset:62464
    v_lshlrev_b32 v220, 16, v222
    v_and_b32 v221, s49, v222
    v_mfma_f32_32x32x16_bf16 v[64:79], v[136:139], a[48:51], v[64:79]
    buffer_load_dwordx4 v226, s[12:15], s34 offen offset:2048 lds
    v_add_f32 v221, 0x3727c5ac, v221
    v_cvt_pk_bf16_f32 v221, v221, v221
    v_and_b32 v221, s49, v221
    v_mfma_f32_32x32x16_bf16 v[80:95], v[136:139], a[52:55], v[80:95]
    ds_read_b64_tr_b16 v[156:157], v200 offset:61440
    ds_read_b64_tr_b16 v[158:159], v200 offset:62464
    v_sqrt_f32 v221, v221
    s_nop 0
    v_cvt_pk_bf16_f32 v221, v221, v221
    v_mfma_f32_32x32x16_bf16 v[96:111], v[140:143], a[48:51], v[96:111]
    ds_read_b64_tr_b16 a[132:133], v232 offset:61440
    ds_read_b64_tr_b16 a[134:135], v232 offset:62464
    v_and_b32 v222, s49, v221
    v_rcp_f32 v221, v222
    s_nop 0
    v_fma_f32 v223, -v222, v221, 1.0
    v_mfma_f32_32x32x16_bf16 v[112:127], v[140:143], a[52:55], v[112:127]
    buffer_load_dwordx4 v227, s[12:15], s34 offen offset:3072 lds
    v_fma_f32 v221, v223, v221, v221
    v_mov_b32 v222, 0
    s_waitcnt lgkmcnt(10)
    v_mfma_f32_16x16x32_bf16 a[144:147], a[128:131], a[136:139], a[144:147]
    v_mov_b32 v223, 0
    v_sub_f32 v160, v160, v220
    s_waitcnt vmcnt(24)
    s_waitcnt lgkmcnt(0)
    s_barrier
    v_mfma_f32_32x32x16_bf16 v[0:15], v[144:147], a[56:59], v[0:15]
    ds_read_b64_tr_b16 v[128:129], v197 offset:0
    ds_read_b64_tr_b16 v[130:131], v197 offset:1024
    ds_read_b128 a[0:3], v228 offset:8192
    s_add_u32 s32, s32, 0x80000
    s_and_b32 s32, s32, 0x7fffff
    s_add_u32 m0, s37, 0xc000
    v_sub_f32 v161, v161, v220
    v_cvt_pk_bf16_f32 v242, v160, v161
    v_accvgpr_read_b32 v243, a80
    v_mfma_f32_32x32x16_bf16 v[16:31], v[144:147], a[60:63], v[16:31]
    buffer_load_dwordx4 v192, s[8:11], s32 offen offset:0 lds
    v_lshlrev_b32 v160, 16, v242
    v_and_b32 v161, s49, v242
    v_mfma_f32_32x32x16_bf16 v[32:47], v[148:151], a[56:59], v[32:47]
    ds_read_b64_tr_b16 v[132:133], v198 offset:0
    ds_read_b64_tr_b16 v[134:135], v198 offset:1024
    ds_read_b128 a[4:7], v228 offset:12288
    v_mul_f32 v160, v160, v221
    v_mul_f32 v161, v161, v221
    v_cvt_pk_bf16_f32 v242, v160, v161
    v_mfma_f32_32x32x16_bf16 v[48:63], v[148:151], a[60:63], v[48:63]
    ds_read_b64_tr_b16 v[136:137], v199 offset:0
    ds_read_b64_tr_b16 v[138:139], v199 offset:1024
    ds_read_b128 a[8:11], v229 offset:8192
    v_lshlrev_b32 v245, 16, v243
    v_and_b32 v243, s49, v243
    v_mfma_f32_32x32x16_bf16 v[64:79], v[152:155], a[56:59], v[64:79]
    buffer_load_dwordx4 v193, s[8:11], s32 offen offset:1024 lds
    v_lshlrev_b32 v160, 16, v242
    v_and_b32 v161, s49, v242
    v_fmac_f32 v222, v160, v245
    v_mfma_f32_32x32x16_bf16 v[80:95], v[152:155], a[60:63], v[80:95]
    ds_read_b64_tr_b16 v[140:141], v200 offset:0
    ds_read_b64_tr_b16 v[142:143], v200 offset:1024
    ds_read_b128 a[12:15], v229 offset:12288
    v_fmac_f32 v223, v161, v243
    v_sub_f32 v162, v162, v220
    v_mfma_f32_32x32x16_bf16 v[96:111], v[156:159], a[56:59], v[96:111]
    ds_read_b64_tr_b16 a[128:129], v232 offset:0
    ds_read_b64_tr_b16 a[130:131], v232 offset:1024
    ds_read_b128 a[16:19], v230 offset:8192
    v_sub_f32 v163, v163, v220
    v_cvt_pk_bf16_f32 v242, v162, v163
    v_accvgpr_read_b32 v243, a81
    v_mfma_f32_32x32x16_bf16 v[112:127], v[156:159], a[60:63], v[112:127]
    buffer_load_dwordx4 v194, s[8:11], s32 offen offset:2048 lds
    v_lshlrev_b32 v162, 16, v242
    v_and_b32 v163, s49, v242
    v_mfma_f32_16x16x32_bf16 a[144:147], a[132:135], a[136:139], a[144:147]
    ds_read_b128 a[20:23], v230 offset:12288
    v_mul_f32 v162, v162, v221
    v_mul_f32 v163, v163, v221
    s_waitcnt lgkmcnt(5)
    v_mfma_f32_32x32x16_bf16 v[0:15], v[128:131], a[0:3], v[0:15]
    ds_read_b64_tr_b16 v[144:145], v197 offset:4096
    ds_read_b64_tr_b16 v[146:147], v197 offset:5120
    ds_read_b128 a[24:27], v231 offset:8192
    v_cvt_pk_bf16_f32 v242, v162, v163
    v_lshlrev_b32 v245, 16, v243
    v_and_b32 v243, s49, v243
    v_mfma_f32_32x32x16_bf16 v[16:31], v[128:131], a[4:7], v[16:31]
    ds_read_b128 a[28:31], v231 offset:12288
    buffer_load_dwordx4 v195, s[8:11], s32 offen offset:3072 lds
    v_lshlrev_b32 v162, 16, v242
    v_and_b32 v163, s49, v242
    v_mfma_f32_32x32x16_bf16 v[32:47], v[132:135], a[0:3], v[32:47]
    ds_read_b64_tr_b16 v[148:149], v198 offset:4096
    ds_read_b64_tr_b16 v[150:151], v198 offset:5120
    v_fmac_f32 v222, v162, v245
    v_fmac_f32 v223, v163, v243
    v_sub_f32 v164, v164, v220
    v_mfma_f32_32x32x16_bf16 v[48:63], v[132:135], a[4:7], v[48:63]
    ds_read_b64_tr_b16 v[152:153], v199 offset:4096
    ds_read_b64_tr_b16 v[154:155], v199 offset:5120
    s_add_u32 s44, s44, 128
    s_and_b32 s44, s44, 0x7ff
    s_add_u32 s33, s45, s44
    s_add_u32 s34, s33, 0x10000
    s_add_u32 m0, s40, 0x2000
    v_sub_f32 v165, v165, v220
    v_cvt_pk_bf16_f32 v242, v164, v165
    v_mfma_f32_32x32x16_bf16 v[64:79], v[136:139], a[0:3], v[64:79]
    s_waitcnt lgkmcnt(4)
    buffer_load_dwordx4 v224, s[12:15], s33 offen offset:0 lds
    v_accvgpr_read_b32 v243, a82
    v_lshlrev_b32 v164, 16, v242
    v_and_b32 v165, s49, v242
    v_mfma_f32_32x32x16_bf16 v[80:95], v[136:139], a[4:7], v[80:95]
    ds_read_b64_tr_b16 v[156:157], v200 offset:4096
    ds_read_b64_tr_b16 v[158:159], v200 offset:5120
    v_mul_f32 v164, v164, v221
    v_mul_f32 v165, v165, v221
    v_mfma_f32_32x32x16_bf16 v[96:111], v[140:143], a[0:3], v[96:111]
    ds_read_b64_tr_b16 a[132:133], v232 offset:4096
    ds_read_b64_tr_b16 a[134:135], v232 offset:5120
    v_cvt_pk_bf16_f32 v242, v164, v165
    v_lshlrev_b32 v245, 16, v243
    v_and_b32 v243, s49, v243
    v_mfma_f32_32x32x16_bf16 v[112:127], v[140:143], a[4:7], v[112:127]
    buffer_load_dwordx4 v225, s[12:15], s33 offen offset:1024 lds
    v_lshlrev_b32 v164, 16, v242
    v_and_b32 v165, s49, v242
    v_mfma_f32_16x16x32_bf16 a[144:147], a[128:131], a[136:139], a[144:147]
    v_fmac_f32 v222, v164, v245
    v_fmac_f32 v223, v165, v243
    s_waitcnt lgkmcnt(2)
    v_mfma_f32_32x32x16_bf16 v[0:15], v[144:147], a[8:11], v[0:15]
    ds_read_b64_tr_b16 v[128:129], v197 offset:8192
    ds_read_b64_tr_b16 v[130:131], v197 offset:9216
    v_sub_f32 v166, v166, v220
    v_sub_f32 v167, v167, v220
    v_cvt_pk_bf16_f32 v242, v166, v167
    v_mfma_f32_32x32x16_bf16 v[16:31], v[144:147], a[12:15], v[16:31]
    buffer_load_dwordx4 v226, s[12:15], s33 offen offset:2048 lds
    v_accvgpr_read_b32 v243, a83
    v_lshlrev_b32 v166, 16, v242
    v_mfma_f32_32x32x16_bf16 v[32:47], v[148:151], a[8:11], v[32:47]
    ds_read_b64_tr_b16 v[132:133], v198 offset:8192
    ds_read_b64_tr_b16 v[134:135], v198 offset:9216
    v_and_b32 v167, s49, v242
    v_mul_f32 v166, v166, v221
    v_mul_f32 v167, v167, v221
    v_mfma_f32_32x32x16_bf16 v[48:63], v[148:151], a[12:15], v[48:63]
    ds_read_b64_tr_b16 v[136:137], v199 offset:8192
    ds_read_b64_tr_b16 v[138:139], v199 offset:9216
    v_cvt_pk_bf16_f32 v242, v166, v167
    v_lshlrev_b32 v245, 16, v243
    v_mfma_f32_32x32x16_bf16 v[64:79], v[152:155], a[8:11], v[64:79]
    buffer_load_dwordx4 v227, s[12:15], s33 offen offset:3072 lds
    v_and_b32 v243, s49, v243
    v_lshlrev_b32 v166, 16, v242
    v_and_b32 v167, s49, v242
    v_mfma_f32_32x32x16_bf16 v[80:95], v[152:155], a[12:15], v[80:95]
    ds_read_b64_tr_b16 v[140:141], v200 offset:8192
    ds_read_b64_tr_b16 v[142:143], v200 offset:9216
    v_fmac_f32 v222, v166, v245
    v_fmac_f32 v223, v167, v243
    v_mfma_f32_32x32x16_bf16 v[96:111], v[156:159], a[8:11], v[96:111]
    ds_read_b64_tr_b16 a[128:129], v232 offset:8192
    ds_read_b64_tr_b16 a[130:131], v232 offset:9216
    s_add_u32 m0, s40, 0x3000
    v_sub_f32 v168, v168, v220
    v_sub_f32 v169, v169, v220
    v_cvt_pk_bf16_f32 v242, v168, v169
    v_mfma_f32_32x32x16_bf16 v[112:127], v[156:159], a[12:15], v[112:127]
    buffer_load_dwordx4 v224, s[12:15], s34 offen offset:0 lds
    v_accvgpr_read_b32 v243, a84
    v_lshlrev_b32 v168, 16, v242
    s_waitcnt lgkmcnt(10)
    v_mfma_f32_16x16x32_bf16 a[144:147], a[132:135], a[136:139], a[144:147]
    v_and_b32 v169, s49, v242
    v_mul_f32 v168, v168, v221
    s_waitcnt lgkmcnt(2)
    v_mfma_f32_32x32x16_bf16 v[0:15], v[128:131], a[16:19], v[0:15]
    ds_read_b64_tr_b16 v[144:145], v197 offset:12288
    ds_read_b64_tr_b16 v[146:147], v197 offset:13312
    v_mul_f32 v169, v169, v221
    v_cvt_pk_bf16_f32 v242, v168, v169
    v_lshlrev_b32 v245, 16, v243
    v_mfma_f32_32x32x16_bf16 v[16:31], v[128:131], a[20:23], v[16:31]
    buffer_load_dwordx4 v225, s[12:15], s34 offen offset:1024 lds
    v_and_b32 v243, s49, v243
    v_lshlrev_b32 v168, 16, v242
    v_mfma_f32_32x32x16_bf16 v[32:47], v[132:135], a[16:19], v[32:47]
    ds_read_b64_tr_b16 v[148:149], v198 offset:12288
    ds_read_b64_tr_b16 v[150:151], v198 offset:13312
    v_and_b32 v169, s49, v242
    v_fmac_f32 v222, v168, v245
    v_fmac_f32 v223, v169, v243
    v_mfma_f32_32x32x16_bf16 v[48:63], v[132:135], a[20:23], v[48:63]
    ds_read_b64_tr_b16 v[152:153], v199 offset:12288
    ds_read_b64_tr_b16 v[154:155], v199 offset:13312
    v_sub_f32 v170, v170, v220
    v_sub_f32 v171, v171, v220
    v_mfma_f32_32x32x16_bf16 v[64:79], v[136:139], a[16:19], v[64:79]
    buffer_load_dwordx4 v226, s[12:15], s34 offen offset:2048 lds
    v_cvt_pk_bf16_f32 v242, v170, v171
    v_accvgpr_read_b32 v243, a85
    v_lshlrev_b32 v170, 16, v242
    v_mfma_f32_32x32x16_bf16 v[80:95], v[136:139], a[20:23], v[80:95]
    ds_read_b64_tr_b16 v[156:157], v200 offset:12288
    ds_read_b64_tr_b16 v[158:159], v200 offset:13312
    v_and_b32 v171, s49, v242
    v_mul_f32 v170, v170, v221
    v_mfma_f32_32x32x16_bf16 v[96:111], v[140:143], a[16:19], v[96:111]
    ds_read_b64_tr_b16 a[132:133], v232 offset:12288
    ds_read_b64_tr_b16 a[134:135], v232 offset:13312
    v_mul_f32 v171, v171, v221
    v_cvt_pk_bf16_f32 v242, v170, v171
    v_lshlrev_b32 v245, 16, v243
    v_mfma_f32_32x32x16_bf16 v[112:127], v[140:143], a[20:23], v[112:127]
    buffer_load_dwordx4 v227, s[12:15], s34 offen offset:3072 lds
    v_and_b32 v243, s49, v243
    v_lshlrev_b32 v170, 16, v242
    s_waitcnt lgkmcnt(10)
    v_mfma_f32_16x16x32_bf16 a[144:147], a[128:131], a[136:139], a[144:147]
    v_and_b32 v171, s49, v242
    v_fmac_f32 v222, v170, v245
    s_waitcnt vmcnt(24)
    s_waitcnt lgkmcnt(0)
    s_barrier
    v_mfma_f32_32x32x16_bf16 v[0:15], v[144:147], a[24:27], v[0:15]
    ds_read_b64_tr_b16 v[128:129], v197 offset:16384
    ds_read_b64_tr_b16 v[130:131], v197 offset:17408
    ds_read_b128 a[32:35], v228 offset:16384
    s_add_u32 s32, s32, 0x80000
    s_and_b32 s32, s32, 0x7fffff
    s_add_u32 m0, s37, 0x0
    v_fmac_f32 v223, v171, v243
    v_sub_f32 v172, v172, v220
    v_sub_f32 v173, v173, v220
    v_mfma_f32_32x32x16_bf16 v[16:31], v[144:147], a[28:31], v[16:31]
    buffer_load_dwordx4 v192, s[8:11], s32 offen offset:0 lds
    v_cvt_pk_bf16_f32 v242, v172, v173
    v_accvgpr_read_b32 v243, a86
    v_mfma_f32_32x32x16_bf16 v[32:47], v[148:151], a[24:27], v[32:47]
    ds_read_b64_tr_b16 v[132:133], v198 offset:16384
    ds_read_b64_tr_b16 v[134:135], v198 offset:17408
    ds_read_b128 a[36:39], v228 offset:20480
    v_lshlrev_b32 v172, 16, v242
    v_and_b32 v173, s49, v242
    v_mul_f32 v172, v172, v221
    v_mfma_f32_32x32x16_bf16 v[48:63], v[148:151], a[28:31], v[48:63]
    ds_read_b64_tr_b16 v[136:137], v199 offset:16384
    ds_read_b64_tr_b16 v[138:139], v199 offset:17408
    ds_read_b128 a[40:43], v229 offset:16384
    v_mul_f32 v173, v173, v221
    v_cvt_pk_bf16_f32 v242, v172, v173
    v_mfma_f32_32x32x16_bf16 v[64:79], v[152:155], a[24:27], v[64:79]
    buffer_load_dwordx4 v193, s[8:11], s32 offen offset:1024 lds
    v_lshlrev_b32 v245, 16, v243
    v_and_b32 v243, s49, v243
    v_lshlrev_b32 v172, 16, v242
    v_mfma_f32_32x32x16_bf16 v[80:95], v[152:155], a[28:31], v[80:95]
    ds_read_b64_tr_b16 v[140:141], v200 offset:16384
    ds_read_b64_tr_b16 v[142:143], v200 offset:17408
    ds_read_b128 a[44:47], v229 offset:20480
    v_and_b32 v173, s49, v242
    v_fmac_f32 v222, v172, v245
    v_mfma_f32_32x32x16_bf16 v[96:111], v[156:159], a[24:27], v[96:111]
    ds_read_b64_tr_b16 a[128:129], v232 offset:16384
    ds_read_b64_tr_b16 a[130:131], v232 offset:17408
    ds_read_b128 a[48:51], v230 offset:16384
    v_fmac_f32 v223, v173, v243
    v_sub_f32 v174, v174, v220
    v_sub_f32 v175, v175, v220
    v_mfma_f32_32x32x16_bf16 v[112:127], v[156:159], a[28:31], v[112:127]
    buffer_load_dwordx4 v194, s[8:11], s32 offen offset:2048 lds
    v_cvt_pk_bf16_f32 v242, v174, v175
    v_accvgpr_read_b32 v243, a87
    v_mfma_f32_16x16x32_bf16 a[144:147], a[132:135], a[136:139], a[144:147]
    ds_read_b128 a[52:55], v230 offset:20480
    v_lshlrev_b32 v174, 16, v242
    v_and_b32 v175, s49, v242
    s_waitcnt lgkmcnt(5)
    v_mfma_f32_32x32x16_bf16 v[0:15], v[128:131], a[32:35], v[0:15]
    ds_read_b64_tr_b16 v[144:145], v197 offset:20480
    ds_read_b64_tr_b16 v[146:147], v197 offset:21504
    ds_read_b128 a[56:59], v231 offset:16384
    v_mul_f32 v174, v174, v221
    v_mul_f32 v175, v175, v221
    v_cvt_pk_bf16_f32 v242, v174, v175
    v_mfma_f32_32x32x16_bf16 v[16:31], v[128:131], a[36:39], v[16:31]
    ds_read_b128 a[60:63], v231 offset:20480
    buffer_load_dwordx4 v195, s[8:11], s32 offen offset:3072 lds
    v_lshlrev_b32 v245, 16, v243
    v_and_b32 v243, s49, v243
    v_mfma_f32_32x32x16_bf16 v[32:47], v[132:135], a[32:35], v[32:47]
    ds_read_b64_tr_b16 v[148:149], v198 offset:20480
    ds_read_b64_tr_b16 v[150:151], v198 offset:21504
    v_lshlrev_b32 v174, 16, v242
    v_and_b32 v175, s49, v242
    v_fmac_f32 v222, v174, v245
    v_mfma_f32_32x32x16_bf16 v[48:63], v[132:135], a[36:39], v[48:63]
    ds_read_b64_tr_b16 v[152:153], v199 offset:20480
    ds_read_b64_tr_b16 v[154:155], v199 offset:21504
    s_add_u32 s44, s44, 128
    s_and_b32 s44, s44, 0x7ff
    s_add_u32 s33, s45, s44
    s_add_u32 s34, s33, 0x10000
    s_add_u32 m0, s40, 0x4000
    v_fmac_f32 v223, v175, v243
    v_sub_f32 v176, v176, v220
    v_mfma_f32_32x32x16_bf16 v[64:79], v[136:139], a[32:35], v[64:79]
    s_waitcnt lgkmcnt(4)
    buffer_load_dwordx4 v224, s[12:15], s33 offen offset:0 lds
    v_sub_f32 v177, v177, v220
    v_cvt_pk_bf16_f32 v242, v176, v177
    v_accvgpr_read_b32 v243, a88
    v_mfma_f32_32x32x16_bf16 v[80:95], v[136:139], a[36:39], v[80:95]
    ds_read_b64_tr_b16 v[156:157], v200 offset:20480
    ds_read_b64_tr_b16 v[158:159], v200 offset:21504
    v_lshlrev_b32 v176, 16, v242
    v_and_b32 v177, s49, v242
    v_mfma_f32_32x32x16_bf16 v[96:111], v[140:143], a[32:35], v[96:111]
    ds_read_b64_tr_b16 a[132:133], v232 offset:20480
    ds_read_b64_tr_b16 a[134:135], v232 offset:21504
    v_mul_f32 v176, v176, v221
    v_mul_f32 v177, v177, v221
    v_cvt_pk_bf16_f32 v242, v176, v177
    v_mfma_f32_32x32x16_bf16 v[112:127], v[140:143], a[36:39], v[112:127]
    buffer_load_dwordx4 v225, s[12:15], s33 offen offset:1024 lds
    v_lshlrev_b32 v245, 16, v243
    v_and_b32 v243, s49, v243
    v_mfma_f32_16x16x32_bf16 a[144:147], a[128:131], a[136:139], a[144:147]
    v_lshlrev_b32 v176, 16, v242
    v_and_b32 v177, s49, v242
    s_waitcnt lgkmcnt(2)
    v_mfma_f32_32x32x16_bf16 v[0:15], v[144:147], a[40:43], v[0:15]
    ds_read_b64_tr_b16 v[128:129], v197 offset:24576
    ds_read_b64_tr_b16 v[130:131], v197 offset:25600
    v_fmac_f32 v222, v176, v245
    v_fmac_f32 v223, v177, v243
    v_sub_f32 v178, v178, v220
    v_mfma_f32_32x32x16_bf16 v[16:31], v[144:147], a[44:47], v[16:31]
    buffer_load_dwordx4 v226, s[12:15], s33 offen offset:2048 lds
    v_sub_f32 v179, v179, v220
    v_cvt_pk_bf16_f32 v242, v178, v179
    v_mfma_f32_32x32x16_bf16 v[32:47], v[148:151], a[40:43], v[32:47]
    ds_read_b64_tr_b16 v[132:133], v198 offset:24576
    ds_read_b64_tr_b16 v[134:135], v198 offset:25600
    v_accvgpr_read_b32 v243, a89
    v_lshlrev_b32 v178, 16, v242
    v_and_b32 v179, s49, v242
    v_mfma_f32_32x32x16_bf16 v[48:63], v[148:151], a[44:47], v[48:63]
    ds_read_b64_tr_b16 v[136:137], v199 offset:24576
    ds_read_b64_tr_b16 v[138:139], v199 offset:25600
    v_mul_f32 v178, v178, v221
    v_mul_f32 v179, v179, v221
    v_mfma_f32_32x32x16_bf16 v[64:79], v[152:155], a[40:43], v[64:79]
    buffer_load_dwordx4 v227, s[12:15], s33 offen offset:3072 lds
    v_cvt_pk_bf16_f32 v242, v178, v179
    v_lshlrev_b32 v245, 16, v243
    v_and_b32 v243, s49, v243
    v_mfma_f32_32x32x16_bf16 v[80:95], v[152:155], a[44:47], v[80:95]
    ds_read_b64_tr_b16 v[140:141], v200 offset:24576
    ds_read_b64_tr_b16 v[142:143], v200 offset:25600
    v_lshlrev_b32 v178, 16, v242
    v_and_b32 v179, s49, v242
    v_mfma_f32_32x32x16_bf16 v[96:111], v[156:159], a[40:43], v[96:111]
    ds_read_b64_tr_b16 a[128:129], v232 offset:24576
    ds_read_b64_tr_b16 a[130:131], v232 offset:25600
    s_add_u32 m0, s40, 0x5000
    v_fmac_f32 v222, v178, v245
    v_fmac_f32 v223, v179, v243
    v_sub_f32 v180, v180, v220
    v_mfma_f32_32x32x16_bf16 v[112:127], v[156:159], a[44:47], v[112:127]
    buffer_load_dwordx4 v224, s[12:15], s34 offen offset:0 lds
    v_sub_f32 v181, v181, v220
    v_cvt_pk_bf16_f32 v242, v180, v181
    s_waitcnt lgkmcnt(10)
    v_mfma_f32_16x16x32_bf16 a[144:147], a[132:135], a[136:139], a[144:147]
    v_accvgpr_read_b32 v243, a90
    v_lshlrev_b32 v180, 16, v242
    s_waitcnt lgkmcnt(2)
    v_mfma_f32_32x32x16_bf16 v[0:15], v[128:131], a[48:51], v[0:15]
    ds_read_b64_tr_b16 v[144:145], v197 offset:28672
    ds_read_b64_tr_b16 v[146:147], v197 offset:29696
    v_and_b32 v181, s49, v242
    v_mul_f32 v180, v180, v221
    v_mul_f32 v181, v181, v221
    v_mfma_f32_32x32x16_bf16 v[16:31], v[128:131], a[52:55], v[16:31]
    buffer_load_dwordx4 v225, s[12:15], s34 offen offset:1024 lds
    v_cvt_pk_bf16_f32 v242, v180, v181
    v_lshlrev_b32 v245, 16, v243
    v_mfma_f32_32x32x16_bf16 v[32:47], v[132:135], a[48:51], v[32:47]
    ds_read_b64_tr_b16 v[148:149], v198 offset:28672
    ds_read_b64_tr_b16 v[150:151], v198 offset:29696
    v_and_b32 v243, s49, v243
    v_lshlrev_b32 v180, 16, v242
    v_and_b32 v181, s49, v242
    v_mfma_f32_32x32x16_bf16 v[48:63], v[132:135], a[52:55], v[48:63]
    ds_read_b64_tr_b16 v[152:153], v199 offset:28672
    ds_read_b64_tr_b16 v[154:155], v199 offset:29696
    v_fmac_f32 v222, v180, v245
    v_fmac_f32 v223, v181, v243
    v_mfma_f32_32x32x16_bf16 v[64:79], v[136:139], a[48:51], v[64:79]
    buffer_load_dwordx4 v226, s[12:15], s34 offen offset:2048 lds
    v_sub_f32 v182, v182, v220
    v_sub_f32 v183, v183, v220
    v_cvt_pk_bf16_f32 v242, v182, v183
    v_mfma_f32_32x32x16_bf16 v[80:95], v[136:139], a[52:55], v[80:95]
    ds_read_b64_tr_b16 v[156:157], v200 offset:28672
    ds_read_b64_tr_b16 v[158:159], v200 offset:29696
    v_accvgpr_read_b32 v243, a91
    v_lshlrev_b32 v182, 16, v242
    v_mfma_f32_32x32x16_bf16 v[96:111], v[140:143], a[48:51], v[96:111]
    ds_read_b64_tr_b16 a[132:133], v232 offset:28672
    ds_read_b64_tr_b16 a[134:135], v232 offset:29696
    v_and_b32 v183, s49, v242
    v_mul_f32 v182, v182, v221
    v_mul_f32 v183, v183, v221
    v_mfma_f32_32x32x16_bf16 v[112:127], v[140:143], a[52:55], v[112:127]
    buffer_load_dwordx4 v227, s[12:15], s34 offen offset:3072 lds
    v_cvt_pk_bf16_f32 v242, v182, v183
    v_lshlrev_b32 v245, 16, v243
    s_waitcnt lgkmcnt(10)
    v_mfma_f32_16x16x32_bf16 a[144:147], a[128:131], a[136:139], a[144:147]
    v_and_b32 v243, s49, v243
    v_lshlrev_b32 v182, 16, v242
    s_waitcnt vmcnt(24)
    s_waitcnt lgkmcnt(0)
    s_barrier
    v_mfma_f32_32x32x16_bf16 v[0:15], v[144:147], a[56:59], v[0:15]
    ds_read_b64_tr_b16 v[128:129], v197 offset:32768
    ds_read_b64_tr_b16 v[130:131], v197 offset:33792
    ds_read_b128 a[0:3], v228 offset:0
    s_add_u32 s32, s32, 0x80000
    s_and_b32 s32, s32, 0x7fffff
    s_add_u32 m0, s37, 0x4000
    v_and_b32 v183, s49, v242
    v_fmac_f32 v222, v182, v245
    v_fmac_f32 v223, v183, v243
    v_mfma_f32_32x32x16_bf16 v[16:31], v[144:147], a[60:63], v[16:31]
    buffer_load_dwordx4 v192, s[8:11], s32 offen offset:0 lds
    v_sub_f32 v184, v184, v220
    v_sub_f32 v185, v185, v220
    v_mfma_f32_32x32x16_bf16 v[32:47], v[148:151], a[56:59], v[32:47]
    ds_read_b64_tr_b16 v[132:133], v198 offset:32768
    ds_read_b64_tr_b16 v[134:135], v198 offset:33792
    ds_read_b128 a[4:7], v228 offset:4096
    v_cvt_pk_bf16_f32 v242, v184, v185
    v_accvgpr_read_b32 v243, a92
    v_lshlrev_b32 v184, 16, v242
    v_mfma_f32_32x32x16_bf16 v[48:63], v[148:151], a[60:63], v[48:63]
    ds_read_b64_tr_b16 v[136:137], v199 offset:32768
    ds_read_b64_tr_b16 v[138:139], v199 offset:33792
    ds_read_b128 a[8:11], v229 offset:0
    v_and_b32 v185, s49, v242
    v_mul_f32 v184, v184, v221
    v_mfma_f32_32x32x16_bf16 v[64:79], v[152:155], a[56:59], v[64:79]
    buffer_load_dwordx4 v193, s[8:11], s32 offen offset:1024 lds
    v_mul_f32 v185, v185, v221
    v_cvt_pk_bf16_f32 v242, v184, v185
    v_lshlrev_b32 v245, 16, v243
    v_mfma_f32_32x32x16_bf16 v[80:95], v[152:155], a[60:63], v[80:95]
    ds_read_b64_tr_b16 v[140:141], v200 offset:32768
    ds_read_b64_tr_b16 v[142:143], v200 offset:33792
    ds_read_b128 a[12:15], v229 offset:4096
    v_and_b32 v243, s49, v243
    v_lshlrev_b32 v184, 16, v242
    v_mfma_f32_32x32x16_bf16 v[96:111], v[156:159], a[56:59], v[96:111]
    ds_read_b64_tr_b16 a[128:129], v232 offset:32768
    ds_read_b64_tr_b16 a[130:131], v232 offset:33792
    ds_read_b128 a[16:19], v230 offset:0
    v_and_b32 v185, s49, v242
    v_fmac_f32 v222, v184, v245
    v_fmac_f32 v223, v185, v243
    v_mfma_f32_32x32x16_bf16 v[112:127], v[156:159], a[60:63], v[112:127]
    buffer_load_dwordx4 v194, s[8:11], s32 offen offset:2048 lds
    v_sub_f32 v186, v186, v220
    v_sub_f32 v187, v187, v220
    v_mfma_f32_16x16x32_bf16 a[144:147], a[132:135], a[136:139], a[144:147]
    ds_read_b128 a[20:23], v230 offset:4096
    v_cvt_pk_bf16_f32 v242, v186, v187
    v_accvgpr_read_b32 v243, a93
    s_waitcnt lgkmcnt(5)
    v_mfma_f32_32x32x16_bf16 v[0:15], v[128:131], a[0:3], v[0:15]
    ds_read_b64_tr_b16 v[144:145], v197 offset:36864
    ds_read_b64_tr_b16 v[146:147], v197 offset:37888
    ds_read_b128 a[24:27], v231 offset:0
    v_lshlrev_b32 v186, 16, v242
    v_and_b32 v187, s49, v242
    v_mul_f32 v186, v186, v221
    v_mfma_f32_32x32x16_bf16 v[16:31], v[128:131], a[4:7], v[16:31]
    ds_read_b128 a[28:31], v231 offset:4096
    buffer_load_dwordx4 v195, s[8:11], s32 offen offset:3072 lds
    v_mul_f32 v187, v187, v221
    v_cvt_pk_bf16_f32 v242, v186, v187
    v_lshlrev_b32 v245, 16, v243
    v_mfma_f32_32x32x16_bf16 v[32:47], v[132:135], a[0:3], v[32:47]
    ds_read_b64_tr_b16 v[148:149], v198 offset:36864
    ds_read_b64_tr_b16 v[150:151], v198 offset:37888
    v_and_b32 v243, s49, v243
    v_lshlrev_b32 v186, 16, v242
    v_mfma_f32_32x32x16_bf16 v[48:63], v[132:135], a[4:7], v[48:63]
    ds_read_b64_tr_b16 v[152:153], v199 offset:36864
    ds_read_b64_tr_b16 v[154:155], v199 offset:37888
    s_add_u32 s44, s44, 128
    s_and_b32 s44, s44, 0x7ff
    s_add_u32 s33, s45, s44
    s_add_u32 s34, s33, 0x10000
    s_add_u32 m0, s40, 0x0
    v_and_b32 v187, s49, v242
    v_fmac_f32 v222, v186, v245
    v_fmac_f32 v223, v187, v243
    v_mfma_f32_32x32x16_bf16 v[64:79], v[136:139], a[0:3], v[64:79]
    s_waitcnt lgkmcnt(4)
    buffer_load_dwordx4 v224, s[12:15], s33 offen offset:0 lds
    v_sub_f32 v188, v188, v220
    v_sub_f32 v189, v189, v220
    v_mfma_f32_32x32x16_bf16 v[80:95], v[136:139], a[4:7], v[80:95]
    ds_read_b64_tr_b16 v[156:157], v200 offset:36864
    ds_read_b64_tr_b16 v[158:159], v200 offset:37888
    v_cvt_pk_bf16_f32 v242, v188, v189
    v_accvgpr_read_b32 v243, a94
    v_lshlrev_b32 v188, 16, v242
    v_mfma_f32_32x32x16_bf16 v[96:111], v[140:143], a[0:3], v[96:111]
    ds_read_b64_tr_b16 a[132:133], v232 offset:36864
    ds_read_b64_tr_b16 a[134:135], v232 offset:37888
    v_and_b32 v189, s49, v242
    v_mul_f32 v188, v188, v221
    v_mfma_f32_32x32x16_bf16 v[112:127], v[140:143], a[4:7], v[112:127]
    buffer_load_dwordx4 v225, s[12:15], s33 offen offset:1024 lds
    v_mul_f32 v189, v189, v221
    v_cvt_pk_bf16_f32 v242, v188, v189
    v_lshlrev_b32 v245, 16, v243
    v_mfma_f32_16x16x32_bf16 a[144:147], a[128:131], a[136:139], a[144:147]
    v_and_b32 v243, s49, v243
    s_cmp_eq_u32 s48, 0
    s_cbranch_scc1 L_ka_o_do0
L_ka_o_rt0:
    s_waitcnt lgkmcnt(2)
    v_mfma_f32_32x32x16_bf16 v[0:15], v[144:147], a[8:11], v[0:15]
    ds_read_b64_tr_b16 v[128:129], v197 offset:40960
    ds_read_b64_tr_b16 v[130:131], v197 offset:41984
    v_lshlrev_b32 v188, 16, v242
    v_and_b32 v189, s49, v242
    v_fmac_f32 v222, v188, v245
    v_mfma_f32_32x32x16_bf16 v[16:31], v[144:147], a[12:15], v[16:31]
    buffer_load_dwordx4 v226, s[12:15], s33 offen offset:2048 lds
    v_fmac_f32 v223, v189, v243
    v_sub_f32 v190, v190, v220
    v_mfma_f32_32x32x16_bf16 v[32:47], v[148:151], a[8:11], v[32:47]
    ds_read_b64_tr_b16 v[132:133], v198 offset:40960
    ds_read_b64_tr_b16 v[134:135], v198 offset:41984
    v_sub_f32 v191, v191, v220
    v_cvt_pk_bf16_f32 v242, v190, v191
    v_accvgpr_read_b32 v243, a95
    v_mfma_f32_32x32x16_bf16 v[48:63], v[148:151], a[12:15], v[48:63]
    ds_read_b64_tr_b16 v[136:137], v199 offset:40960
    ds_read_b64_tr_b16 v[138:139], v199 offset:41984
    v_lshlrev_b32 v190, 16, v242
    v_and_b32 v191, s49, v242
    v_mfma_f32_32x32x16_bf16 v[64:79], v[152:155], a[8:11], v[64:79]
    buffer_load_dwordx4 v227, s[12:15], s33 offen offset:3072 lds
    v_mul_f32 v190, v190, v221
    v_mul_f32 v191, v191, v221
    v_cvt_pk_bf16_f32 v242, v190, v191
    v_mfma_f32_32x32x16_bf16 v[80:95], v[152:155], a[12:15], v[80:95]
    ds_read_b64_tr_b16 v[140:141], v200 offset:40960
    ds_read_b64_tr_b16 v[142:143], v200 offset:41984
    v_lshlrev_b32 v245, 16, v243
    v_and_b32 v243, s49, v243
    v_mfma_f32_32x32x16_bf16 v[96:111], v[156:159], a[8:11], v[96:111]
    ds_read_b64_tr_b16 a[128:129], v232 offset:40960
    ds_read_b64_tr_b16 a[130:131], v232 offset:41984
    s_add_u32 m0, s40, 0x1000
    v_lshlrev_b32 v190, 16, v242
    v_and_b32 v191, s49, v242
    v_fmac_f32 v222, v190, v245
    v_mfma_f32_32x32x16_bf16 v[112:127], v[156:159], a[12:15], v[112:127]
    buffer_load_dwordx4 v224, s[12:15], s34 offen offset:0 lds
    v_fmac_f32 v223, v191, v243
    v_add_f32 v222, v222, v223
    s_waitcnt lgkmcnt(10)
    v_mfma_f32_16x16x32_bf16 a[144:147], a[132:135], a[136:139], a[144:147]
    v_add_f32_dpp v222, v222, v222 quad_perm:[1,0,3,2] row_mask:0xf bank_mask:0xf
    s_nop 1
    v_add_f32_dpp v222, v222, v222 quad_perm:[2,3,0,1] row_mask:0xf bank_mask:0xf
    s_waitcnt lgkmcnt(2)
    v_mfma_f32_32x32x16_bf16 v[0:15], v[128:131], a[16:19], v[0:15]
    ds_read_b64_tr_b16 v[144:145], v197 offset:45056
    ds_read_b64_tr_b16 v[146:147], v197 offset:46080
    v_add_f32_dpp v222, v222, v222 row_half_mirror row_mask:0xf bank_mask:0xf
    s_nop 1
    v_add_f32_dpp v222, v222, v222 row_mirror row_mask:0xf bank_mask:0xf
    v_mov_b32 v223, v222
    v_mfma_f32_32x32x16_bf16 v[16:31], v[128:131], a[20:23], v[16:31]
    buffer_load_dwordx4 v225, s[12:15], s34 offen offset:1024 lds
    v_permlane16_swap_b32 v222, v223
    v_add_f32 v222, v222, v223
    v_mfma_f32_32x32x16_bf16 v[32:47], v[132:135], a[16:19], v[32:47]
    ds_read_b64_tr_b16 v[148:149], v198 offset:45056
    ds_read_b64_tr_b16 v[150:151], v198 offset:46080
    v_cvt_pk_bf16_f32 v160, v222, v222
    v_ashrrev_i32 v161, 31, v160
    v_mfma_f32_32x32x16_bf16 v[48:63], v[132:135], a[20:23], v[48:63]
    ds_read_b64_tr_b16 v[152:153], v199 offset:45056
    ds_read_b64_tr_b16 v[154:155], v199 offset:46080
    v_or_b32 v161, 0x80000000, v161
    v_xor_b32 v160, v160, v161
    v_mfma_f32_32x32x16_bf16 v[64:79], v[136:139], a[16:19], v[64:79]
    buffer_load_dwordx4 v226, s[12:15], s34 offen offset:2048 lds
    v_and_b32 v160, s49, v160
    v_sub_u32 v161, 0xffff, v240
    v_mfma_f32_32x32x16_bf16 v[80:95], v[136:139], a[20:23], v[80:95]
    ds_read_b64_tr_b16 v[156:157], v200 offset:45056
    ds_read_b64_tr_b16 v[158:159], v200 offset:46080
    v_or_b32 v160, v160, v161
    v_cmp_u_f32 vcc, v222, v222
    s_nop 1
    v_cndmask_b32 v160, v160, 0, vcc
    v_mfma_f32_32x32x16_bf16 v[96:111], v[140:143], a[16:19], v[96:111]
    ds_read_b64_tr_b16 a[132:133], v232 offset:45056
    ds_read_b64_tr_b16 a[134:135], v232 offset:46080
    v_mov_b32 v161, v160
    s_nop 1
    v_permlane32_swap_b32 v160, v161
    v_mfma_f32_32x32x16_bf16 v[112:127], v[140:143], a[20:23], v[112:127]
    buffer_load_dwordx4 v227, s[12:15], s34 offen offset:3072 lds
    v_max_u32 v160, v160, v161
    v_lshlrev_b32 v161, 3, v240
    s_waitcnt lgkmcnt(10)
    v_mfma_f32_16x16x32_bf16 a[144:147], a[128:131], a[136:139], a[144:147]
    v_lshlrev_b32 v162, 1, v240
    s_movk_i32 s3, 0x4000
    s_mov_b32 exec_lo, 1
    s_mov_b32 exec_hi, 1
    buffer_store_dwordx2 v[220:221], v161, s[52:55], 0 offen sc1
    s_mov_b32 exec_hi, 0
    buffer_store_dword v160, v162, s[52:55], s3 offen sc1
    v_mov_b32 v222, 0
    s_mov_b32 s3, 0x8000
    buffer_store_dword v222, v162, s[52:55], s3 offen sc1
    s_add_u32 s3, s3, 4096
    buffer_store_dword v222, v162, s[52:55], s3 offen sc1
    s_mov_b64 exec, -1
    s_waitcnt vmcnt(28)
    s_waitcnt lgkmcnt(0)
    s_barrier
    v_mfma_f32_32x32x16_bf16 v[0:15], v[144:147], a[24:27], v[0:15]
    ds_read_b64_tr_b16 v[128:129], v197 offset:49152
    ds_read_b64_tr_b16 v[130:131], v197 offset:50176
    ds_read_b128 a[32:35], v228 offset:8192
    s_add_u32 s32, s32, 0x80000
    s_and_b32 s32, s32, 0x7fffff
    s_add_u32 m0, s37, 0x8000
    v_mfma_f32_32x32x16_bf16 v[16:31], v[144:147], a[28:31], v[16:31]
    buffer_load_dwordx4 v192, s[8:11], s32 offen offset:0 lds
    v_mfma_f32_32x32x16_bf16 v[32:47], v[148:151], a[24:27], v[32:47]
    ds_read_b64_tr_b16 v[132:133], v198 offset:49152
    ds_read_b64_tr_b16 v[134:135], v198 offset:50176
    ds_read_b128 a[36:39], v228 offset:12288
    v_mfma_f32_32x32x16_bf16 v[48:63], v[148:151], a[28:31], v[48:63]
    ds_read_b64_tr_b16 v[136:137], v199 offset:49152
    ds_read_b64_tr_b16 v[138:139], v199 offset:50176
    ds_read_b128 a[40:43], v229 offset:8192
    v_mfma_f32_32x32x16_bf16 v[64:79], v[152:155], a[24:27], v[64:79]
    buffer_load_dwordx4 v193, s[8:11], s32 offen offset:1024 lds
    v_mfma_f32_32x32x16_bf16 v[80:95], v[152:155], a[28:31], v[80:95]
    ds_read_b64_tr_b16 v[140:141], v200 offset:49152
    ds_read_b64_tr_b16 v[142:143], v200 offset:50176
    ds_read_b128 a[44:47], v229 offset:12288
    v_mfma_f32_32x32x16_bf16 v[96:111], v[156:159], a[24:27], v[96:111]
    ds_read_b64_tr_b16 a[128:129], v232 offset:49152
    ds_read_b64_tr_b16 a[130:131], v232 offset:50176
    ds_read_b128 a[48:51], v230 offset:8192
    v_mfma_f32_32x32x16_bf16 v[112:127], v[156:159], a[28:31], v[112:127]
    buffer_load_dwordx4 v194, s[8:11], s32 offen offset:2048 lds
    v_mfma_f32_16x16x32_bf16 a[144:147], a[132:135], a[136:139], a[144:147]
    ds_read_b128 a[52:55], v230 offset:12288
    s_waitcnt lgkmcnt(5)
    v_mfma_f32_32x32x16_bf16 v[0:15], v[128:131], a[32:35], v[0:15]
    ds_read_b64_tr_b16 v[144:145], v197 offset:53248
    ds_read_b64_tr_b16 v[146:147], v197 offset:54272
    ds_read_b128 a[56:59], v231 offset:8192
    v_mfma_f32_32x32x16_bf16 v[16:31], v[128:131], a[36:39], v[16:31]
    ds_read_b128 a[60:63], v231 offset:12288
    buffer_load_dwordx4 v195, s[8:11], s32 offen offset:3072 lds
    v_mfma_f32_32x32x16_bf16 v[32:47], v[132:135], a[32:35], v[32:47]
    ds_read_b64_tr_b16 v[148:149], v198 offset:53248
    ds_read_b64_tr_b16 v[150:151], v198 offset:54272
    v_mfma_f32_32x32x16_bf16 v[48:63], v[132:135], a[36:39], v[48:63]
    ds_read_b64_tr_b16 v[152:153], v199 offset:53248
    ds_read_b64_tr_b16 v[154:155], v199 offset:54272
    s_add_u32 s44, s44, 128
    s_and_b32 s44, s44, 0x7ff
    s_add_u32 s33, s45, s44
    s_add_u32 s34, s33, 0x10000
    s_add_u32 m0, s40, 0x2000
    v_mfma_f32_32x32x16_bf16 v[64:79], v[136:139], a[32:35], v[64:79]
    s_waitcnt lgkmcnt(4)
    buffer_load_dwordx4 v224, s[12:15], s33 offen offset:0 lds
    v_mfma_f32_32x32x16_bf16 v[80:95], v[136:139], a[36:39], v[80:95]
    ds_read_b64_tr_b16 v[156:157], v200 offset:53248
    ds_read_b64_tr_b16 v[158:159], v200 offset:54272
    v_mfma_f32_32x32x16_bf16 v[96:111], v[140:143], a[32:35], v[96:111]
    ds_read_b64_tr_b16 a[132:133], v232 offset:53248
    ds_read_b64_tr_b16 a[134:135], v232 offset:54272
    v_mfma_f32_32x32x16_bf16 v[112:127], v[140:143], a[36:39], v[112:127]
    buffer_load_dwordx4 v225, s[12:15], s33 offen offset:1024 lds
    v_mfma_f32_16x16x32_bf16 a[144:147], a[128:131], a[136:139], a[144:147]
    s_cmp_eq_u32 s48, 1
    s_cbranch_scc1 L_ka_o_do1
L_ka_o_rt1:
    s_waitcnt lgkmcnt(2)
    v_mfma_f32_32x32x16_bf16 v[0:15], v[144:147], a[40:43], v[0:15]
    ds_read_b64_tr_b16 v[128:129], v197 offset:57344
    ds_read_b64_tr_b16 v[130:131], v197 offset:58368
    v_mfma_f32_32x32x16_bf16 v[16:31], v[144:147], a[44:47], v[16:31]
    buffer_load_dwordx4 v226, s[12:15], s33 offen offset:2048 lds
    v_mfma_f32_32x32x16_bf16 v[32:47], v[148:151], a[40:43], v[32:47]
    ds_read_b64_tr_b16 v[132:133], v198 offset:57344
    ds_read_b64_tr_b16 v[134:135], v198 offset:58368
    v_mfma_f32_32x32x16_bf16 v[48:63], v[148:151], a[44:47], v[48:63]
    ds_read_b64_tr_b16 v[136:137], v199 offset:57344
    ds_read_b64_tr_b16 v[138:139], v199 offset:58368
    v_mfma_f32_32x32x16_bf16 v[64:79], v[152:155], a[40:43], v[64:79]
    buffer_load_dwordx4 v227, s[12:15], s33 offen offset:3072 lds
    v_mfma_f32_32x32x16_bf16 v[80:95], v[152:155], a[44:47], v[80:95]
    ds_read_b64_tr_b16 v[140:141], v200 offset:57344
    ds_read_b64_tr_b16 v[142:143], v200 offset:58368
    v_mfma_f32_32x32x16_bf16 v[96:111], v[156:159], a[40:43], v[96:111]
    ds_read_b64_tr_b16 a[128:129], v232 offset:57344
    ds_read_b64_tr_b16 a[130:131], v232 offset:58368
    s_add_u32 m0, s40, 0x3000
    v_mfma_f32_32x32x16_bf16 v[112:127], v[156:159], a[44:47], v[112:127]
    buffer_load_dwordx4 v224, s[12:15], s34 offen offset:0 lds
    s_waitcnt lgkmcnt(10)
    v_mfma_f32_16x16x32_bf16 a[144:147], a[132:135], a[136:139], a[144:147]
    s_waitcnt lgkmcnt(2)
    v_mfma_f32_32x32x16_bf16 v[0:15], v[128:131], a[48:51], v[0:15]
    ds_read_b64_tr_b16 v[144:145], v197 offset:61440
    ds_read_b64_tr_b16 v[146:147], v197 offset:62464
    v_mfma_f32_32x32x16_bf16 v[16:31], v[128:131], a[52:55], v[16:31]
    buffer_load_dwordx4 v225, s[12:15], s34 offen offset:1024 lds
    v_mfma_f32_32x32x16_bf16 v[32:47], v[132:135], a[48:51], v[32:47]
    ds_read_b64_tr_b16 v[148:149], v198 offset:61440
    ds_read_b64_tr_b16 v[150:151], v198 offset:62464
    v_mfma_f32_32x32x16_bf16 v[48:63], v[132:135], a[52:55], v[48:63]
    ds_read_b64_tr_b16 v[152:153], v199 offset:61440
    ds_read_b64_tr_b16 v[154:155], v199 offset:62464
    v_mfma_f32_32x32x16_bf16 v[64:79], v[136:139], a[48:51], v[64:79]
    buffer_load_dwordx4 v226, s[12:15], s34 offen offset:2048 lds
    v_mfma_f32_32x32x16_bf16 v[80:95], v[136:139], a[52:55], v[80:95]
    ds_read_b64_tr_b16 v[156:157], v200 offset:61440
    ds_read_b64_tr_b16 v[158:159], v200 offset:62464
    v_mfma_f32_32x32x16_bf16 v[96:111], v[140:143], a[48:51], v[96:111]
    ds_read_b64_tr_b16 a[132:133], v232 offset:61440
    ds_read_b64_tr_b16 a[134:135], v232 offset:62464
    v_mfma_f32_32x32x16_bf16 v[112:127], v[140:143], a[52:55], v[112:127]
    buffer_load_dwordx4 v227, s[12:15], s34 offen offset:3072 lds
    s_waitcnt lgkmcnt(10)
    v_mfma_f32_16x16x32_bf16 a[144:147], a[128:131], a[136:139], a[144:147]
    s_bfe_u32 s42, s2, 0x40003
    s_cmp_eq_u32 s28, 0
    s_cselect_b32 s42, s42, 99
    v_mov_b32 v220, 1
    s_and_b32 s3, s2, 1
    s_lshl_b32 s3, s3, 7
    v_mov_b32 v221, s3
    s_waitcnt vmcnt(12)
    s_waitcnt lgkmcnt(0)
    s_barrier
    v_mfma_f32_32x32x16_bf16 v[0:15], v[144:147], a[56:59], v[0:15]
    ds_read_b64_tr_b16 v[128:129], v197 offset:0
    ds_read_b64_tr_b16 v[130:131], v197 offset:1024
    ds_read_b128 a[0:3], v228 offset:16384
    s_add_u32 s32, s32, 0x80000
    s_and_b32 s32, s32, 0x7fffff
    s_add_u32 m0, s37, 0xc000
    v_mfma_f32_32x32x16_bf16 v[16:31], v[144:147], a[60:63], v[16:31]
    buffer_load_dwordx4 v192, s[8:11], s32 offen offset:0 lds
    v_mfma_f32_32x32x16_bf16 v[32:47], v[148:151], a[56:59], v[32:47]
    ds_read_b64_tr_b16 v[132:133], v198 offset:0
    ds_read_b64_tr_b16 v[134:135], v198 offset:1024
    ds_read_b128 a[4:7], v228 offset:20480
    v_mfma_f32_32x32x16_bf16 v[48:63], v[148:151], a[60:63], v[48:63]
    ds_read_b64_tr_b16 v[136:137], v199 offset:0
    ds_read_b64_tr_b16 v[138:139], v199 offset:1024
    ds_read_b128 a[8:11], v229 offset:16384
    v_mfma_f32_32x32x16_bf16 v[64:79], v[152:155], a[56:59], v[64:79]
    buffer_load_dwordx4 v193, s[8:11], s32 offen offset:1024 lds
    v_mfma_f32_32x32x16_bf16 v[80:95], v[152:155], a[60:63], v[80:95]
    ds_read_b64_tr_b16 v[140:141], v200 offset:0
    ds_read_b64_tr_b16 v[142:143], v200 offset:1024
    ds_read_b128 a[12:15], v229 offset:20480
    v_mfma_f32_32x32x16_bf16 v[96:111], v[156:159], a[56:59], v[96:111]
    ds_read_b64_tr_b16 a[128:129], v232 offset:0
    ds_read_b64_tr_b16 a[130:131], v232 offset:1024
    ds_read_b128 a[16:19], v230 offset:16384
    v_mfma_f32_32x32x16_bf16 v[112:127], v[156:159], a[60:63], v[112:127]
    buffer_load_dwordx4 v194, s[8:11], s32 offen offset:2048 lds
    v_mfma_f32_16x16x32_bf16 a[144:147], a[132:135], a[136:139], a[144:147]
    ds_read_b128 a[20:23], v230 offset:20480
    s_cmp_eq_u32 s42, 0
    s_cbranch_scc1 L_ka_o_do2
L_ka_o_rt2:
    s_waitcnt lgkmcnt(5)
    v_mfma_f32_32x32x16_bf16 v[0:15], v[128:131], a[0:3], v[0:15]
    ds_read_b64_tr_b16 v[144:145], v197 offset:4096
    ds_read_b64_tr_b16 v[146:147], v197 offset:5120
    ds_read_b128 a[24:27], v231 offset:16384
    v_mfma_f32_32x32x16_bf16 v[16:31], v[128:131], a[4:7], v[16:31]
    ds_read_b128 a[28:31], v231 offset:20480
    buffer_load_dwordx4 v195, s[8:11], s32 offen offset:3072 lds
    v_mfma_f32_32x32x16_bf16 v[32:47], v[132:135], a[0:3], v[32:47]
    ds_read_b64_tr_b16 v[148:149], v198 offset:4096
    ds_read_b64_tr_b16 v[150:151], v198 offset:5120
    v_mfma_f32_32x32x16_bf16 v[48:63], v[132:135], a[4:7], v[48:63]
    ds_read_b64_tr_b16 v[152:153], v199 offset:4096
    ds_read_b64_tr_b16 v[154:155], v199 offset:5120
    s_add_u32 s44, s44, 128
    s_and_b32 s44, s44, 0x7ff
    s_add_u32 s33, s45, s44
    s_add_u32 s34, s33, 0x10000
    s_add_u32 m0, s40, 0x4000
    v_mfma_f32_32x32x16_bf16 v[64:79], v[136:139], a[0:3], v[64:79]
    s_waitcnt lgkmcnt(4)
    buffer_load_dwordx4 v224, s[12:15], s33 offen offset:0 lds
    v_mfma_f32_32x32x16_bf16 v[80:95], v[136:139], a[4:7], v[80:95]
    ds_read_b64_tr_b16 v[156:157], v200 offset:4096
    ds_read_b64_tr_b16 v[158:159], v200 offset:5120
    v_mfma_f32_32x32x16_bf16 v[96:111], v[140:143], a[0:3], v[96:111]
    ds_read_b64_tr_b16 a[132:133], v232 offset:4096
    ds_read_b64_tr_b16 a[134:135], v232 offset:5120
    v_mfma_f32_32x32x16_bf16 v[112:127], v[140:143], a[4:7], v[112:127]
    buffer_load_dwordx4 v225, s[12:15], s33 offen offset:1024 lds
    v_mfma_f32_16x16x32_bf16 a[144:147], a[128:131], a[136:139], a[144:147]
    s_cmp_eq_u32 s42, 1
    s_cbranch_scc1 L_ka_o_do3
L_ka_o_rt3:
    s_cmp_eq_u32 s48, 2
    s_cbranch_scc1 L_ka_o_do4
L_ka_o_rt4:
    s_waitcnt lgkmcnt(2)
    v_mfma_f32_32x32x16_bf16 v[0:15], v[144:147], a[8:11], v[0:15]
    ds_read_b64_tr_b16 v[128:129], v197 offset:8192
    ds_read_b64_tr_b16 v[130:131], v197 offset:9216
    v_mfma_f32_32x32x16_bf16 v[16:31], v[144:147], a[12:15], v[16:31]
    buffer_load_dwordx4 v226, s[12:15], s33 offen offset:2048 lds
    v_mfma_f32_32x32x16_bf16 v[32:47], v[148:151], a[8:11], v[32:47]
    ds_read_b64_tr_b16 v[132:133], v198 offset:8192
    ds_read_b64_tr_b16 v[134:135], v198 offset:9216
    v_mfma_f32_32x32x16_bf16 v[48:63], v[148:151], a[12:15], v[48:63]
    ds_read_b64_tr_b16 v[136:137], v199 offset:8192
    ds_read_b64_tr_b16 v[138:139], v199 offset:9216
    v_mfma_f32_32x32x16_bf16 v[64:79], v[152:155], a[8:11], v[64:79]
    buffer_load_dwordx4 v227, s[12:15], s33 offen offset:3072 lds
    v_mfma_f32_32x32x16_bf16 v[80:95], v[152:155], a[12:15], v[80:95]
    ds_read_b64_tr_b16 v[140:141], v200 offset:8192
    ds_read_b64_tr_b16 v[142:143], v200 offset:9216
    v_mfma_f32_32x32x16_bf16 v[96:111], v[156:159], a[8:11], v[96:111]
    ds_read_b64_tr_b16 a[128:129], v232 offset:8192
    ds_read_b64_tr_b16 a[130:131], v232 offset:9216
    s_add_u32 m0, s40, 0x5000
    v_mfma_f32_32x32x16_bf16 v[112:127], v[156:159], a[12:15], v[112:127]
    buffer_load_dwordx4 v224, s[12:15], s34 offen offset:0 lds
    s_waitcnt lgkmcnt(10)
    v_mfma_f32_16x16x32_bf16 a[144:147], a[132:135], a[136:139], a[144:147]
    s_cmp_eq_u32 s42, 2
    s_cbranch_scc1 L_ka_o_do5
L_ka_o_rt5:
    s_waitcnt lgkmcnt(2)
    v_mfma_f32_32x32x16_bf16 v[0:15], v[128:131], a[16:19], v[0:15]
    ds_read_b64_tr_b16 v[144:145], v197 offset:12288
    ds_read_b64_tr_b16 v[146:147], v197 offset:13312
    v_mfma_f32_32x32x16_bf16 v[16:31], v[128:131], a[20:23], v[16:31]
    buffer_load_dwordx4 v225, s[12:15], s34 offen offset:1024 lds
    v_mfma_f32_32x32x16_bf16 v[32:47], v[132:135], a[16:19], v[32:47]
    ds_read_b64_tr_b16 v[148:149], v198 offset:12288
    ds_read_b64_tr_b16 v[150:151], v198 offset:13312
    v_mfma_f32_32x32x16_bf16 v[48:63], v[132:135], a[20:23], v[48:63]
    ds_read_b64_tr_b16 v[152:153], v199 offset:12288
    ds_read_b64_tr_b16 v[154:155], v199 offset:13312
    v_mfma_f32_32x32x16_bf16 v[64:79], v[136:139], a[16:19], v[64:79]
    buffer_load_dwordx4 v226, s[12:15], s34 offen offset:2048 lds
    v_mfma_f32_32x32x16_bf16 v[80:95], v[136:139], a[20:23], v[80:95]
    ds_read_b64_tr_b16 v[156:157], v200 offset:12288
    ds_read_b64_tr_b16 v[158:159], v200 offset:13312
    v_mfma_f32_32x32x16_bf16 v[96:111], v[140:143], a[16:19], v[96:111]
    ds_read_b64_tr_b16 a[132:133], v232 offset:12288
    ds_read_b64_tr_b16 a[134:135], v232 offset:13312
    v_mfma_f32_32x32x16_bf16 v[112:127], v[140:143], a[20:23], v[112:127]
    buffer_load_dwordx4 v227, s[12:15], s34 offen offset:3072 lds
    s_waitcnt lgkmcnt(10)
    v_mfma_f32_16x16x32_bf16 a[144:147], a[128:131], a[136:139], a[144:147]
    s_cmp_eq_u32 s42, 3
    s_cbranch_scc1 L_ka_o_do6
L_ka_o_rt6:
    s_waitcnt lgkmcnt(0)
    s_barrier
    v_mfma_f32_32x32x16_bf16 v[0:15], v[144:147], a[24:27], v[0:15]
    ds_read_b64_tr_b16 v[128:129], v197 offset:16384
    ds_read_b64_tr_b16 v[130:131], v197 offset:17408
    ds_read_b128 a[32:35], v228 offset:0
    s_add_u32 s32, s32, 0x80000
    s_and_b32 s32, s32, 0x7fffff
    s_add_u32 m0, s37, 0x0
    v_mfma_f32_32x32x16_bf16 v[16:31], v[144:147], a[28:31], v[16:31]
    buffer_load_dwordx4 v192, s[8:11], s32 offen offset:0 lds
    v_mfma_f32_32x32x16_bf16 v[32:47], v[148:151], a[24:27], v[32:47]
    ds_read_b64_tr_b16 v[132:133], v198 offset:16384
    ds_read_b64_tr_b16 v[134:135], v198 offset:17408
    ds_read_b128 a[36:39], v228 offset:4096
    v_mfma_f32_32x32x16_bf16 v[48:63], v[148:151], a[28:31], v[48:63]
    ds_read_b64_tr_b16 v[136:137], v199 offset:16384
    ds_read_b64_tr_b16 v[138:139], v199 offset:17408
    ds_read_b128 a[40:43], v229 offset:0
    v_mfma_f32_32x32x16_bf16 v[64:79], v[152:155], a[24:27], v[64:79]
    buffer_load_dwordx4 v193, s[8:11], s32 offen offset:1024 lds
    v_mfma_f32_32x32x16_bf16 v[80:95], v[152:155], a[28:31], v[80:95]
    ds_read_b64_tr_b16 v[140:141], v200 offset:16384
    ds_read_b64_tr_b16 v[142:143], v200 offset:17408
    ds_read_b128 a[44:47], v229 offset:4096
    v_mfma_f32_32x32x16_bf16 v[96:111], v[156:159], a[24:27], v[96:111]
    ds_read_b64_tr_b16 a[128:129], v232 offset:16384
    ds_read_b64_tr_b16 a[130:131], v232 offset:17408
    ds_read_b128 a[48:51], v230 offset:0
    v_mfma_f32_32x32x16_bf16 v[112:127], v[156:159], a[28:31], v[112:127]
    buffer_load_dwordx4 v194, s[8:11], s32 offen offset:2048 lds
    v_mfma_f32_16x16x32_bf16 a[144:147], a[132:135], a[136:139], a[144:147]
    ds_read_b128 a[52:55], v230 offset:4096
    s_cmp_eq_u32 s42, 4
    s_cbranch_scc1 L_ka_o_do7
L_ka_o_rt7:
    s_waitcnt lgkmcnt(5)
    v_mfma_f32_32x32x16_bf16 v[0:15], v[128:131], a[32:35], v[0:15]
    ds_read_b64_tr_b16 v[144:145], v197 offset:20480
    ds_read_b64_tr_b16 v[146:147], v197 offset:21504
    ds_read_b128 a[56:59], v231 offset:0
    v_mfma_f32_32x32x16_bf16 v[16:31], v[128:131], a[36:39], v[16:31]
    ds_read_b128 a[60:63], v231 offset:4096
    buffer_load_dwordx4 v195, s[8:11], s32 offen offset:3072 lds
    v_mfma_f32_32x32x16_bf16 v[32:47], v[132:135], a[32:35], v[32:47]
    ds_read_b64_tr_b16 v[148:149], v198 offset:20480
    ds_read_b64_tr_b16 v[150:151], v198 offset:21504
    v_mfma_f32_32x32x16_bf16 v[48:63], v[132:135], a[36:39], v[48:63]
    ds_read_b64_tr_b16 v[152:153], v199 offset:20480
    ds_read_b64_tr_b16 v[154:155], v199 offset:21504
    s_add_u32 s44, s44, 128
    s_and_b32 s44, s44, 0x7ff
    s_add_u32 s33, s45, s44
    s_add_u32 s34, s33, 0x10000
    s_add_u32 m0, s40, 0x0
    v_mfma_f32_32x32x16_bf16 v[64:79], v[136:139], a[32:35], v[64:79]
    s_waitcnt lgkmcnt(4)
    buffer_load_dwordx4 v224, s[12:15], s33 offen offset:0 lds
    v_mfma_f32_32x32x16_bf16 v[80:95], v[136:139], a[36:39], v[80:95]
    ds_read_b64_tr_b16 v[156:157], v200 offset:20480
    ds_read_b64_tr_b16 v[158:159], v200 offset:21504
    v_mfma_f32_32x32x16_bf16 v[96:111], v[140:143], a[32:35], v[96:111]
    ds_read_b64_tr_b16 a[132:133], v232 offset:20480
    ds_read_b64_tr_b16 a[134:135], v232 offset:21504
    v_mfma_f32_32x32x16_bf16 v[112:127], v[140:143], a[36:39], v[112:127]
    buffer_load_dwordx4 v225, s[12:15], s33 offen offset:1024 lds
    v_mfma_f32_16x16x32_bf16 a[144:147], a[128:131], a[136:139], a[144:147]
    s_cmp_eq_u32 s42, 5
    s_cbranch_scc1 L_ka_o_do8
L_ka_o_rt8:
    s_cmp_eq_u32 s48, 3
    s_cbranch_scc1 L_ka_o_do9
L_ka_o_rt9:
    s_waitcnt lgkmcnt(2)
    v_mfma_f32_32x32x16_bf16 v[0:15], v[144:147], a[40:43], v[0:15]
    ds_read_b64_tr_b16 v[128:129], v197 offset:24576
    ds_read_b64_tr_b16 v[130:131], v197 offset:25600
    v_mfma_f32_32x32x16_bf16 v[16:31], v[144:147], a[44:47], v[16:31]
    buffer_load_dwordx4 v226, s[12:15], s33 offen offset:2048 lds
    v_mfma_f32_32x32x16_bf16 v[32:47], v[148:151], a[40:43], v[32:47]
    ds_read_b64_tr_b16 v[132:133], v198 offset:24576
    ds_read_b64_tr_b16 v[134:135], v198 offset:25600
    v_mfma_f32_32x32x16_bf16 v[48:63], v[148:151], a[44:47], v[48:63]
    ds_read_b64_tr_b16 v[136:137], v199 offset:24576
    ds_read_b64_tr_b16 v[138:139], v199 offset:25600
    v_mfma_f32_32x32x16_bf16 v[64:79], v[152:155], a[40:43], v[64:79]
    buffer_load_dwordx4 v227, s[12:15], s33 offen offset:3072 lds
    v_mfma_f32_32x32x16_bf16 v[80:95], v[152:155], a[44:47], v[80:95]
    ds_read_b64_tr_b16 v[140:141], v200 offset:24576
    ds_read_b64_tr_b16 v[142:143], v200 offset:25600
    v_mfma_f32_32x32x16_bf16 v[96:111], v[156:159], a[40:43], v[96:111]
    ds_read_b64_tr_b16 a[128:129], v232 offset:24576
    ds_read_b64_tr_b16 a[130:131], v232 offset:25600
    s_add_u32 m0, s40, 0x1000
    v_mfma_f32_32x32x16_bf16 v[112:127], v[156:159], a[44:47], v[112:127]
    buffer_load_dwordx4 v224, s[12:15], s34 offen offset:0 lds
    s_waitcnt lgkmcnt(10)
    v_mfma_f32_16x16x32_bf16 a[144:147], a[132:135], a[136:139], a[144:147]
    s_cmp_eq_u32 s42, 6
    s_cbranch_scc1 L_ka_o_do10
L_ka_o_rt10:
    s_waitcnt lgkmcnt(2)
    v_mfma_f32_32x32x16_bf16 v[0:15], v[128:131], a[48:51], v[0:15]
    ds_read_b64_tr_b16 v[144:145], v197 offset:28672
    ds_read_b64_tr_b16 v[146:147], v197 offset:29696
    v_mfma_f32_32x32x16_bf16 v[16:31], v[128:131], a[52:55], v[16:31]
    buffer_load_dwordx4 v225, s[12:15], s34 offen offset:1024 lds
    v_mfma_f32_32x32x16_bf16 v[32:47], v[132:135], a[48:51], v[32:47]
    ds_read_b64_tr_b16 v[148:149], v198 offset:28672
    ds_read_b64_tr_b16 v[150:151], v198 offset:29696
    v_mfma_f32_32x32x16_bf16 v[48:63], v[132:135], a[52:55], v[48:63]
    ds_read_b64_tr_b16 v[152:153], v199 offset:28672
    ds_read_b64_tr_b16 v[154:155], v199 offset:29696
    v_mfma_f32_32x32x16_bf16 v[64:79], v[136:139], a[48:51], v[64:79]
    buffer_load_dwordx4 v226, s[12:15], s34 offen offset:2048 lds
    v_mfma_f32_32x32x16_bf16 v[80:95], v[136:139], a[52:55], v[80:95]
    ds_read_b64_tr_b16 v[156:157], v200 offset:28672
    ds_read_b64_tr_b16 v[158:159], v200 offset:29696
    v_mfma_f32_32x32x16_bf16 v[96:111], v[140:143], a[48:51], v[96:111]
    ds_read_b64_tr_b16 a[132:133], v232 offset:28672
    ds_read_b64_tr_b16 a[134:135], v232 offset:29696
    v_mfma_f32_32x32x16_bf16 v[112:127], v[140:143], a[52:55], v[112:127]
    buffer_load_dwordx4 v227, s[12:15], s34 offen offset:3072 lds
    s_waitcnt lgkmcnt(10)
    v_mfma_f32_16x16x32_bf16 a[144:147], a[128:131], a[136:139], a[144:147]
    s_cmp_eq_u32 s42, 7
    s_cbranch_scc1 L_ka_o_do11
L_ka_o_rt11:
    s_waitcnt vmcnt(24)
    s_waitcnt lgkmcnt(0)
    s_barrier
    v_mfma_f32_32x32x16_bf16 v[0:15], v[144:147], a[56:59], v[0:15]
    ds_read_b64_tr_b16 v[128:129], v197 offset:32768
    ds_read_b64_tr_b16 v[130:131], v197 offset:33792
    ds_read_b128 a[0:3], v228 offset:8192
    s_add_u32 s32, s32, 0x80000
    s_and_b32 s32, s32, 0x7fffff
    s_add_u32 m0, s37, 0x4000
    v_mfma_f32_32x32x16_bf16 v[16:31], v[144:147], a[60:63], v[16:31]
    buffer_load_dwordx4 v192, s[8:11], s32 offen offset:0 lds
    v_mfma_f32_32x32x16_bf16 v[32:47], v[148:151], a[56:59], v[32:47]
    ds_read_b64_tr_b16 v[132:133], v198 offset:32768
    ds_read_b64_tr_b16 v[134:135], v198 offset:33792
    ds_read_b128 a[4:7], v228 offset:12288
    v_mfma_f32_32x32x16_bf16 v[48:63], v[148:151], a[60:63], v[48:63]
    ds_read_b64_tr_b16 v[136:137], v199 offset:32768
    ds_read_b64_tr_b16 v[138:139], v199 offset:33792
    ds_read_b128 a[8:11], v229 offset:8192
    v_mfma_f32_32x32x16_bf16 v[64:79], v[152:155], a[56:59], v[64:79]
    buffer_load_dwordx4 v193, s[8:11], s32 offen offset:1024 lds
    v_mfma_f32_32x32x16_bf16 v[80:95], v[152:155], a[60:63], v[80:95]
    ds_read_b64_tr_b16 v[140:141], v200 offset:32768
    ds_read_b64_tr_b16 v[142:143], v200 offset:33792
    ds_read_b128 a[12:15], v229 offset:12288
    v_mfma_f32_32x32x16_bf16 v[96:111], v[156:159], a[56:59], v[96:111]
    ds_read_b64_tr_b16 a[128:129], v232 offset:32768
    ds_read_b64_tr_b16 a[130:131], v232 offset:33792
    ds_read_b128 a[16:19], v230 offset:8192
    v_mfma_f32_32x32x16_bf16 v[112:127], v[156:159], a[60:63], v[112:127]
    buffer_load_dwordx4 v194, s[8:11], s32 offen offset:2048 lds
    v_mfma_f32_16x16x32_bf16 a[144:147], a[132:135], a[136:139], a[144:147]
    ds_read_b128 a[20:23], v230 offset:12288
    s_cmp_eq_u32 s42, 8
    s_cbranch_scc1 L_ka_o_do12
L_ka_o_rt12:
    s_waitcnt lgkmcnt(5)
    v_mfma_f32_32x32x16_bf16 v[0:15], v[128:131], a[0:3], v[0:15]
    ds_read_b64_tr_b16 v[144:145], v197 offset:36864
    ds_read_b64_tr_b16 v[146:147], v197 offset:37888
    ds_read_b128 a[24:27], v231 offset:8192
    v_mfma_f32_32x32x16_bf16 v[16:31], v[128:131], a[4:7], v[16:31]
    ds_read_b128 a[28:31], v231 offset:12288
    buffer_load_dwordx4 v195, s[8:11], s32 offen offset:3072 lds
    v_mfma_f32_32x32x16_bf16 v[32:47], v[132:135], a[0:3], v[32:47]
    ds_read_b64_tr_b16 v[148:149], v198 offset:36864
    ds_read_b64_tr_b16 v[150:151], v198 offset:37888
    v_mfma_f32_32x32x16_bf16 v[48:63], v[132:135], a[4:7], v[48:63]
    ds_read_b64_tr_b16 v[152:153], v199 offset:36864
    ds_read_b64_tr_b16 v[154:155], v199 offset:37888
    s_add_u32 s44, s44, 128
    s_and_b32 s44, s44, 0x7ff
    s_add_u32 s33, s45, s44
    s_add_u32 s34, s33, 0x10000
    s_add_u32 m0, s40, 0x2000
    v_mfma_f32_32x32x16_bf16 v[64:79], v[136:139], a[0:3], v[64:79]
    s_waitcnt lgkmcnt(4)
    buffer_load_dwordx4 v224, s[12:15], s33 offen offset:0 lds
    v_mfma_f32_32x32x16_bf16 v[80:95], v[136:139], a[4:7], v[80:95]
    ds_read_b64_tr_b16 v[156:157], v200 offset:36864
    ds_read_b64_tr_b16 v[158:159], v200 offset:37888
    v_mfma_f32_32x32x16_bf16 v[96:111], v[140:143], a[0:3], v[96:111]
    ds_read_b64_tr_b16 a[132:133], v232 offset:36864
    ds_read_b64_tr_b16 a[134:135], v232 offset:37888
    v_mfma_f32_32x32x16_bf16 v[112:127], v[140:143], a[4:7], v[112:127]
    buffer_load_dwordx4 v225, s[12:15], s33 offen offset:1024 lds
    v_mfma_f32_16x16x32_bf16 a[144:147], a[128:131], a[136:139], a[144:147]
    s_cmp_eq_u32 s42, 9
    s_cbranch_scc1 L_ka_o_do13
L_ka_o_rt13:
    s_cmp_eq_u32 s48, 4
    s_cbranch_scc1 L_ka_o_do14
L_ka_o_rt14:
    s_waitcnt lgkmcnt(2)
    v_mfma_f32_32x32x16_bf16 v[0:15], v[144:147], a[8:11], v[0:15]
    ds_read_b64_tr_b16 v[128:129], v197 offset:40960
    ds_read_b64_tr_b16 v[130:131], v197 offset:41984
    v_mfma_f32_32x32x16_bf16 v[16:31], v[144:147], a[12:15], v[16:31]
    buffer_load_dwordx4 v226, s[12:15], s33 offen offset:2048 lds
    v_mfma_f32_32x32x16_bf16 v[32:47], v[148:151], a[8:11], v[32:47]
    ds_read_b64_tr_b16 v[132:133], v198 offset:40960
    ds_read_b64_tr_b16 v[134:135], v198 offset:41984
    v_mfma_f32_32x32x16_bf16 v[48:63], v[148:151], a[12:15], v[48:63]
    ds_read_b64_tr_b16 v[136:137], v199 offset:40960
    ds_read_b64_tr_b16 v[138:139], v199 offset:41984
    v_mfma_f32_32x32x16_bf16 v[64:79], v[152:155], a[8:11], v[64:79]
    buffer_load_dwordx4 v227, s[12:15], s33 offen offset:3072 lds
    v_mfma_f32_32x32x16_bf16 v[80:95], v[152:155], a[12:15], v[80:95]
    ds_read_b64_tr_b16 v[140:141], v200 offset:40960
    ds_read_b64_tr_b16 v[142:143], v200 offset:41984
    v_mfma_f32_32x32x16_bf16 v[96:111], v[156:159], a[8:11], v[96:111]
    ds_read_b64_tr_b16 a[128:129], v232 offset:40960
    ds_read_b64_tr_b16 a[130:131], v232 offset:41984
    s_add_u32 m0, s40, 0x3000
    v_mfma_f32_32x32x16_bf16 v[112:127], v[156:159], a[12:15], v[112:127]
    buffer_load_dwordx4 v224, s[12:15], s34 offen offset:0 lds
    s_waitcnt lgkmcnt(10)
    v_mfma_f32_16x16x32_bf16 a[144:147], a[132:135], a[136:139], a[144:147]
    s_cmp_eq_u32 s42, 10
    s_cbranch_scc1 L_ka_o_do15
L_ka_o_rt15:
    s_waitcnt lgkmcnt(2)
    v_mfma_f32_32x32x16_bf16 v[0:15], v[128:131], a[16:19], v[0:15]
    ds_read_b64_tr_b16 v[144:145], v197 offset:45056
    ds_read_b64_tr_b16 v[146:147], v197 offset:46080
    v_mfma_f32_32x32x16_bf16 v[16:31], v[128:131], a[20:23], v[16:31]
    buffer_load_dwordx4 v225, s[12:15], s34 offen offset:1024 lds
    v_mfma_f32_32x32x16_bf16 v[32:47], v[132:135], a[16:19], v[32:47]
    ds_read_b64_tr_b16 v[148:149], v198 offset:45056
    ds_read_b64_tr_b16 v[150:151], v198 offset:46080
    v_mfma_f32_32x32x16_bf16 v[48:63], v[132:135], a[20:23], v[48:63]
    ds_read_b64_tr_b16 v[152:153], v199 offset:45056
    ds_read_b64_tr_b16 v[154:155], v199 offset:46080
    v_mfma_f32_32x32x16_bf16 v[64:79], v[136:139], a[16:19], v[64:79]
    buffer_load_dwordx4 v226, s[12:15], s34 offen offset:2048 lds
    v_mfma_f32_32x32x16_bf16 v[80:95], v[136:139], a[20:23], v[80:95]
    ds_read_b64_tr_b16 v[156:157], v200 offset:45056
    ds_read_b64_tr_b16 v[158:159], v200 offset:46080
    v_mfma_f32_32x32x16_bf16 v[96:111], v[140:143], a[16:19], v[96:111]
    ds_read_b64_tr_b16 a[132:133], v232 offset:45056
    ds_read_b64_tr_b16 a[134:135], v232 offset:46080
    v_mfma_f32_32x32x16_bf16 v[112:127], v[140:143], a[20:23], v[112:127]
    buffer_load_dwordx4 v227, s[12:15], s34 offen offset:3072 lds
    s_waitcnt lgkmcnt(10)
    v_mfma_f32_16x16x32_bf16 a[144:147], a[128:131], a[136:139], a[144:147]
    s_cmp_eq_u32 s42, 11
    s_cbranch_scc1 L_ka_o_do16
L_ka_o_rt16:
    s_waitcnt vmcnt(24)
    s_waitcnt lgkmcnt(0)
    s_barrier
    v_mfma_f32_32x32x16_bf16 v[0:15], v[144:147], a[24:27], v[0:15]
    ds_read_b64_tr_b16 v[128:129], v197 offset:49152
    ds_read_b64_tr_b16 v[130:131], v197 offset:50176
    ds_read_b128 a[32:35], v228 offset:16384
    s_add_u32 s32, s32, 0x80000
    s_and_b32 s32, s32, 0x7fffff
    s_add_u32 m0, s37, 0x8000
    v_mfma_f32_32x32x16_bf16 v[16:31], v[144:147], a[28:31], v[16:31]
    buffer_load_dwordx4 v192, s[8:11], s32 offen offset:0 lds
    v_mfma_f32_32x32x16_bf16 v[32:47], v[148:151], a[24:27], v[32:47]
    ds_read_b64_tr_b16 v[132:133], v198 offset:49152
    ds_read_b64_tr_b16 v[134:135], v198 offset:50176
    ds_read_b128 a[36:39], v228 offset:20480
    v_mfma_f32_32x32x16_bf16 v[48:63], v[148:151], a[28:31], v[48:63]
    ds_read_b64_tr_b16 v[136:137], v199 offset:49152
    ds_read_b64_tr_b16 v[138:139], v199 offset:50176
    ds_read_b128 a[40:43], v229 offset:16384
    v_mfma_f32_32x32x16_bf16 v[64:79], v[152:155], a[24:27], v[64:79]
    buffer_load_dwordx4 v193, s[8:11], s32 offen offset:1024 lds
    v_mfma_f32_32x32x16_bf16 v[80:95], v[152:155], a[28:31], v[80:95]
    ds_read_b64_tr_b16 v[140:141], v200 offset:49152
    ds_read_b64_tr_b16 v[142:143], v200 offset:50176
    ds_read_b128 a[44:47], v229 offset:20480
    v_mfma_f32_32x32x16_bf16 v[96:111], v[156:159], a[24:27], v[96:111]
    ds_read_b64_tr_b16 a[128:129], v232 offset:49152
    ds_read_b64_tr_b16 a[130:131], v232 offset:50176
    ds_read_b128 a[48:51], v230 offset:16384
    v_mfma_f32_32x32x16_bf16 v[112:127], v[156:159], a[28:31], v[112:127]
    buffer_load_dwordx4 v194, s[8:11], s32 offen offset:2048 lds
    v_mfma_f32_16x16x32_bf16 a[144:147], a[132:135], a[136:139], a[144:147]
    ds_read_b128 a[52:55], v230 offset:20480
    s_cmp_eq_u32 s42, 12
    s_cbranch_scc1 L_ka_o_do17
L_ka_o_rt17:
    s_waitcnt lgkmcnt(5)
    v_mfma_f32_32x32x16_bf16 v[0:15], v[128:131], a[32:35], v[0:15]
    ds_read_b64_tr_b16 v[144:145], v197 offset:53248
    ds_read_b64_tr_b16 v[146:147], v197 offset:54272
    ds_read_b128 a[56:59], v231 offset:16384
    v_mfma_f32_32x32x16_bf16 v[16:31], v[128:131], a[36:39], v[16:31]
    ds_read_b128 a[60:63], v231 offset:20480
    buffer_load_dwordx4 v195, s[8:11], s32 offen offset:3072 lds
    v_mfma_f32_32x32x16_bf16 v[32:47], v[132:135], a[32:35], v[32:47]
    ds_read_b64_tr_b16 v[148:149], v198 offset:53248
    ds_read_b64_tr_b16 v[150:151], v198 offset:54272
    v_mfma_f32_32x32x16_bf16 v[48:63], v[132:135], a[36:39], v[48:63]
    ds_read_b64_tr_b16 v[152:153], v199 offset:53248
    ds_read_b64_tr_b16 v[154:155], v199 offset:54272
    s_add_u32 s44, s44, 128
    s_and_b32 s44, s44, 0x7ff
    s_add_u32 s33, s45, s44
    s_add_u32 s34, s33, 0x10000
    s_add_u32 m0, s40, 0x4000
    v_mfma_f32_32x32x16_bf16 v[64:79], v[136:139], a[32:35], v[64:79]
    s_waitcnt lgkmcnt(4)
    buffer_load_dwordx4 v224, s[12:15], s33 offen offset:0 lds
    v_mfma_f32_32x32x16_bf16 v[80:95], v[136:139], a[36:39], v[80:95]
    ds_read_b64_tr_b16 v[156:157], v200 offset:53248
    ds_read_b64_tr_b16 v[158:159], v200 offset:54272
    v_mfma_f32_32x32x16_bf16 v[96:111], v[140:143], a[32:35], v[96:111]
    ds_read_b64_tr_b16 a[132:133], v232 offset:53248
    ds_read_b64_tr_b16 a[134:135], v232 offset:54272
    v_mfma_f32_32x32x16_bf16 v[112:127], v[140:143], a[36:39], v[112:127]
    buffer_load_dwordx4 v225, s[12:15], s33 offen offset:1024 lds
    v_mfma_f32_16x16x32_bf16 a[144:147], a[128:131], a[136:139], a[144:147]
    s_cmp_eq_u32 s42, 13
    s_cbranch_scc1 L_ka_o_do18
L_ka_o_rt18:
    s_cmp_eq_u32 s48, 5
    s_cbranch_scc1 L_ka_o_do19
L_ka_o_rt19:
    s_waitcnt lgkmcnt(2)
    v_mfma_f32_32x32x16_bf16 v[0:15], v[144:147], a[40:43], v[0:15]
    ds_read_b64_tr_b16 v[128:129], v197 offset:57344
    ds_read_b64_tr_b16 v[130:131], v197 offset:58368
    v_mfma_f32_32x32x16_bf16 v[16:31], v[144:147], a[44:47], v[16:31]
    buffer_load_dwordx4 v226, s[12:15], s33 offen offset:2048 lds
    v_mfma_f32_32x32x16_bf16 v[32:47], v[148:151], a[40:43], v[32:47]
    ds_read_b64_tr_b16 v[132:133], v198 offset:57344
    ds_read_b64_tr_b16 v[134:135], v198 offset:58368
    v_mfma_f32_32x32x16_bf16 v[48:63], v[148:151], a[44:47], v[48:63]
    ds_read_b64_tr_b16 v[136:137], v199 offset:57344
    ds_read_b64_tr_b16 v[138:139], v199 offset:58368
    v_mfma_f32_32x32x16_bf16 v[64:79], v[152:155], a[40:43], v[64:79]
    buffer_load_dwordx4 v227, s[12:15], s33 offen offset:3072 lds
    v_mfma_f32_32x32x16_bf16 v[80:95], v[152:155], a[44:47], v[80:95]
    ds_read_b64_tr_b16 v[140:141], v200 offset:57344
    ds_read_b64_tr_b16 v[142:143], v200 offset:58368
    v_mfma_f32_32x32x16_bf16 v[96:111], v[156:159], a[40:43], v[96:111]
    ds_read_b64_tr_b16 a[128:129], v232 offset:57344
    ds_read_b64_tr_b16 a[130:131], v232 offset:58368
    s_add_u32 m0, s40, 0x5000
    v_mfma_f32_32x32x16_bf16 v[112:127], v[156:159], a[44:47], v[112:127]
    buffer_load_dwordx4 v224, s[12:15], s34 offen offset:0 lds
    s_waitcnt lgkmcnt(10)
    v_mfma_f32_16x16x32_bf16 a[144:147], a[132:135], a[136:139], a[144:147]
    s_cmp_eq_u32 s42, 14
    s_cbranch_scc1 L_ka_o_do20
L_ka_o_rt20:
    s_waitcnt lgkmcnt(2)
    v_mfma_f32_32x32x16_bf16 v[0:15], v[128:131], a[48:51], v[0:15]
    ds_read_b64_tr_b16 v[144:145], v197 offset:61440
    ds_read_b64_tr_b16 v[146:147], v197 offset:62464
    v_mfma_f32_32x32x16_bf16 v[16:31], v[128:131], a[52:55], v[16:31]
    buffer_load_dwordx4 v225, s[12:15], s34 offen offset:1024 lds
    v_mfma_f32_32x32x16_bf16 v[32:47], v[132:135], a[48:51], v[32:47]
    ds_read_b64_tr_b16 v[148:149], v198 offset:61440
    ds_read_b64_tr_b16 v[150:151], v198 offset:62464
    v_mfma_f32_32x32x16_bf16 v[48:63], v[132:135], a[52:55], v[48:63]
    ds_read_b64_tr_b16 v[152:153], v199 offset:61440
    ds_read_b64_tr_b16 v[154:155], v199 offset:62464
    v_mfma_f32_32x32x16_bf16 v[64:79], v[136:139], a[48:51], v[64:79]
    buffer_load_dwordx4 v226, s[12:15], s34 offen offset:2048 lds
    v_mfma_f32_32x32x16_bf16 v[80:95], v[136:139], a[52:55], v[80:95]
    ds_read_b64_tr_b16 v[156:157], v200 offset:61440
    ds_read_b64_tr_b16 v[158:159], v200 offset:62464
    v_mfma_f32_32x32x16_bf16 v[96:111], v[140:143], a[48:51], v[96:111]
    ds_read_b64_tr_b16 a[132:133], v232 offset:61440
    ds_read_b64_tr_b16 a[134:135], v232 offset:62464
    v_mfma_f32_32x32x16_bf16 v[112:127], v[140:143], a[52:55], v[112:127]
    buffer_load_dwordx4 v227, s[12:15], s34 offen offset:3072 lds
    s_waitcnt lgkmcnt(10)
    v_mfma_f32_16x16x32_bf16 a[144:147], a[128:131], a[136:139], a[144:147]
    s_cmp_eq_u32 s42, 15
    s_cbranch_scc1 L_ka_o_do21
L_ka_o_rt21:
    s_waitcnt vmcnt(24)
    s_waitcnt lgkmcnt(0)
    s_barrier
    v_mfma_f32_32x32x16_bf16 v[0:15], v[144:147], a[56:59], v[0:15]
    ds_read_b64_tr_b16 v[128:129], v197 offset:0
    ds_read_b64_tr_b16 v[130:131], v197 offset:1024
    ds_read_b128 a[0:3], v228 offset:0
    s_add_u32 s32, s32, 0x80000
    s_and_b32 s32, s32, 0x7fffff
    s_add_u32 m0, s37, 0xc000
    v_mfma_f32_32x32x16_bf16 v[16:31], v[144:147], a[60:63], v[16:31]
    buffer_load_dwordx4 v192, s[8:11], s32 offen offset:0 lds
    v_mfma_f32_32x32x16_bf16 v[32:47], v[148:151], a[56:59], v[32:47]
    ds_read_b64_tr_b16 v[132:133], v198 offset:0
    ds_read_b64_tr_b16 v[134:135], v198 offset:1024
    ds_read_b128 a[4:7], v228 offset:4096
    v_mfma_f32_32x32x16_bf16 v[48:63], v[148:151], a[60:63], v[48:63]
    ds_read_b64_tr_b16 v[136:137], v199 offset:0
    ds_read_b64_tr_b16 v[138:139], v199 offset:1024
    ds_read_b128 a[8:11], v229 offset:0
    v_mfma_f32_32x32x16_bf16 v[64:79], v[152:155], a[56:59], v[64:79]
    buffer_load_dwordx4 v193, s[8:11], s32 offen offset:1024 lds
    v_mfma_f32_32x32x16_bf16 v[80:95], v[152:155], a[60:63], v[80:95]
    ds_read_b64_tr_b16 v[140:141], v200 offset:0
    ds_read_b64_tr_b16 v[142:143], v200 offset:1024
    ds_read_b128 a[12:15], v229 offset:4096
    v_mfma_f32_32x32x16_bf16 v[96:111], v[156:159], a[56:59], v[96:111]
    ds_read_b64_tr_b16 a[128:129], v232 offset:0
    ds_read_b64_tr_b16 a[130:131], v232 offset:1024
    ds_read_b128 a[16:19], v230 offset:0
    v_mfma_f32_32x32x16_bf16 v[112:127], v[156:159], a[60:63], v[112:127]
    buffer_load_dwordx4 v194, s[8:11], s32 offen offset:2048 lds
    v_mfma_f32_16x16x32_bf16 a[144:147], a[132:135], a[136:139], a[144:147]
    ds_read_b128 a[20:23], v230 offset:4096
    s_waitcnt lgkmcnt(5)
    v_mfma_f32_32x32x16_bf16 v[0:15], v[128:131], a[0:3], v[0:15]
    ds_read_b64_tr_b16 v[144:145], v197 offset:4096
    ds_read_b64_tr_b16 v[146:147], v197 offset:5120
    ds_read_b128 a[24:27], v231 offset:0
    v_mfma_f32_32x32x16_bf16 v[16:31], v[128:131], a[4:7], v[16:31]
    ds_read_b128 a[28:31], v231 offset:4096
    buffer_load_dwordx4 v195, s[8:11], s32 offen offset:3072 lds
    v_mfma_f32_32x32x16_bf16 v[32:47], v[132:135], a[0:3], v[32:47]
    ds_read_b64_tr_b16 v[148:149], v198 offset:4096
    ds_read_b64_tr_b16 v[150:151], v198 offset:5120
    v_mfma_f32_32x32x16_bf16 v[48:63], v[132:135], a[4:7], v[48:63]
    ds_read_b64_tr_b16 v[152:153], v199 offset:4096
    ds_read_b64_tr_b16 v[154:155], v199 offset:5120
    s_add_u32 s44, s44, 128
    s_and_b32 s44, s44, 0x7ff
    s_add_u32 s33, s45, s44
    s_add_u32 s34, s33, 0x10000
    s_add_u32 m0, s40, 0x0
    v_mfma_f32_32x32x16_bf16 v[64:79], v[136:139], a[0:3], v[64:79]
    s_waitcnt lgkmcnt(4)
    buffer_load_dwordx4 v224, s[12:15], s33 offen offset:0 lds
    v_mfma_f32_32x32x16_bf16 v[80:95], v[136:139], a[4:7], v[80:95]
    ds_read_b64_tr_b16 v[156:157], v200 offset:4096
    ds_read_b64_tr_b16 v[158:159], v200 offset:5120
    v_mfma_f32_32x32x16_bf16 v[96:111], v[140:143], a[0:3], v[96:111]
    ds_read_b64_tr_b16 a[132:133], v232 offset:4096
    ds_read_b64_tr_b16 a[134:135], v232 offset:5120
    v_mfma_f32_32x32x16_bf16 v[112:127], v[140:143], a[4:7], v[112:127]
    buffer_load_dwordx4 v225, s[12:15], s33 offen offset:1024 lds
    v_mfma_f32_16x16x32_bf16 a[144:147], a[128:131], a[136:139], a[144:147]
    s_cmp_eq_u32 s48, 6
    s_cbranch_scc1 L_ka_o_do22
L_ka_o_rt22:
    s_waitcnt lgkmcnt(2)
    v_mfma_f32_32x32x16_bf16 v[0:15], v[144:147], a[8:11], v[0:15]
    ds_read_b64_tr_b16 v[128:129], v197 offset:8192
    ds_read_b64_tr_b16 v[130:131], v197 offset:9216
    v_mfma_f32_32x32x16_bf16 v[16:31], v[144:147], a[12:15], v[16:31]
    buffer_load_dwordx4 v226, s[12:15], s33 offen offset:2048 lds
    v_mfma_f32_32x32x16_bf16 v[32:47], v[148:151], a[8:11], v[32:47]
    ds_read_b64_tr_b16 v[132:133], v198 offset:8192
    ds_read_b64_tr_b16 v[134:135], v198 offset:9216
    v_mfma_f32_32x32x16_bf16 v[48:63], v[148:151], a[12:15], v[48:63]
    ds_read_b64_tr_b16 v[136:137], v199 offset:8192
    ds_read_b64_tr_b16 v[138:139], v199 offset:9216
    v_mfma_f32_32x32x16_bf16 v[64:79], v[152:155], a[8:11], v[64:79]
    buffer_load_dwordx4 v227, s[12:15], s33 offen offset:3072 lds
    v_mfma_f32_32x32x16_bf16 v[80:95], v[152:155], a[12:15], v[80:95]
    ds_read_b64_tr_b16 v[140:141], v200 offset:8192
    ds_read_b64_tr_b16 v[142:143], v200 offset:9216
    v_mfma_f32_32x32x16_bf16 v[96:111], v[156:159], a[8:11], v[96:111]
    ds_read_b64_tr_b16 a[128:129], v232 offset:8192
    ds_read_b64_tr_b16 a[130:131], v232 offset:9216
    s_add_u32 m0, s40, 0x1000
    v_mfma_f32_32x32x16_bf16 v[112:127], v[156:159], a[12:15], v[112:127]
    buffer_load_dwordx4 v224, s[12:15], s34 offen offset:0 lds
    s_waitcnt lgkmcnt(10)
    v_mfma_f32_16x16x32_bf16 a[144:147], a[132:135], a[136:139], a[144:147]
    s_waitcnt lgkmcnt(2)
    v_mfma_f32_32x32x16_bf16 v[0:15], v[128:131], a[16:19], v[0:15]
    ds_read_b64_tr_b16 v[144:145], v197 offset:12288
    ds_read_b64_tr_b16 v[146:147], v197 offset:13312
    v_mfma_f32_32x32x16_bf16 v[16:31], v[128:131], a[20:23], v[16:31]
    buffer_load_dwordx4 v225, s[12:15], s34 offen offset:1024 lds
    v_mfma_f32_32x32x16_bf16 v[32:47], v[132:135], a[16:19], v[32:47]
    ds_read_b64_tr_b16 v[148:149], v198 offset:12288
    ds_read_b64_tr_b16 v[150:151], v198 offset:13312
    v_mfma_f32_32x32x16_bf16 v[48:63], v[132:135], a[20:23], v[48:63]
    ds_read_b64_tr_b16 v[152:153], v199 offset:12288
    ds_read_b64_tr_b16 v[154:155], v199 offset:13312
    v_mfma_f32_32x32x16_bf16 v[64:79], v[136:139], a[16:19], v[64:79]
    buffer_load_dwordx4 v226, s[12:15], s34 offen offset:2048 lds
    v_mfma_f32_32x32x16_bf16 v[80:95], v[136:139], a[20:23], v[80:95]
    ds_read_b64_tr_b16 v[156:157], v200 offset:12288
    ds_read_b64_tr_b16 v[158:159], v200 offset:13312
    v_mfma_f32_32x32x16_bf16 v[96:111], v[140:143], a[16:19], v[96:111]
    ds_read_b64_tr_b16 a[132:133], v232 offset:12288
    ds_read_b64_tr_b16 a[134:135], v232 offset:13312
    v_mfma_f32_32x32x16_bf16 v[112:127], v[140:143], a[20:23], v[112:127]
    buffer_load_dwordx4 v227, s[12:15], s34 offen offset:3072 lds
    s_waitcnt lgkmcnt(10)
    v_mfma_f32_16x16x32_bf16 a[144:147], a[128:131], a[136:139], a[144:147]
    s_waitcnt vmcnt(24)
    s_waitcnt lgkmcnt(0)
    s_barrier
    v_mfma_f32_32x32x16_bf16 v[0:15], v[144:147], a[24:27], v[0:15]
    ds_read_b64_tr_b16 v[128:129], v197 offset:16384
    ds_read_b64_tr_b16 v[130:131], v197 offset:17408
    ds_read_b128 a[32:35], v228 offset:8192
    v_mfma_f32_32x32x16_bf16 v[16:31], v[144:147], a[28:31], v[16:31]
    v_mfma_f32_32x32x16_bf16 v[32:47], v[148:151], a[24:27], v[32:47]
    ds_read_b64_tr_b16 v[132:133], v198 offset:16384
    ds_read_b64_tr_b16 v[134:135], v198 offset:17408
    ds_read_b128 a[36:39], v228 offset:12288
    v_mfma_f32_32x32x16_bf16 v[48:63], v[148:151], a[28:31], v[48:63]
    ds_read_b64_tr_b16 v[136:137], v199 offset:16384
    ds_read_b64_tr_b16 v[138:139], v199 offset:17408
    ds_read_b128 a[40:43], v229 offset:8192
    v_mfma_f32_32x32x16_bf16 v[64:79], v[152:155], a[24:27], v[64:79]
    s_add_u32 m0, s38, 0x0
    s_nop 0
    buffer_load_dwordx4 v213, s[16:19], s35 offen offset:0 lds
    v_mfma_f32_32x32x16_bf16 v[80:95], v[152:155], a[28:31], v[80:95]
    ds_read_b64_tr_b16 v[140:141], v200 offset:16384
    ds_read_b64_tr_b16 v[142:143], v200 offset:17408
    ds_read_b128 a[44:47], v229 offset:12288
    buffer_load_dwordx4 v214, s[16:19], s35 offen offset:1024 lds
    v_mfma_f32_32x32x16_bf16 v[96:111], v[156:159], a[24:27], v[96:111]
    ds_read_b64_tr_b16 a[128:129], v232 offset:16384
    ds_read_b64_tr_b16 a[130:131], v232 offset:17408
    ds_read_b128 a[48:51], v230 offset:8192
    v_mfma_f32_32x32x16_bf16 v[112:127], v[156:159], a[28:31], v[112:127]
    v_mfma_f32_16x16x32_bf16 a[144:147], a[132:135], a[136:139], a[144:147]
    ds_read_b128 a[52:55], v230 offset:12288
    s_waitcnt lgkmcnt(5)
    v_mfma_f32_32x32x16_bf16 v[0:15], v[128:131], a[32:35], v[0:15]
    ds_read_b64_tr_b16 v[144:145], v197 offset:20480
    ds_read_b64_tr_b16 v[146:147], v197 offset:21504
    ds_read_b128 a[56:59], v231 offset:8192
    v_mfma_f32_32x32x16_bf16 v[16:31], v[128:131], a[36:39], v[16:31]
    ds_read_b128 a[60:63], v231 offset:12288
    s_add_u32 s35, s35, 8192
    s_add_u32 m0, s38, 0x2000
    s_nop 0
    buffer_load_dwordx4 v213, s[16:19], s35 offen offset:0 lds
    v_mfma_f32_32x32x16_bf16 v[32:47], v[132:135], a[32:35], v[32:47]
    ds_read_b64_tr_b16 v[148:149], v198 offset:20480
    ds_read_b64_tr_b16 v[150:151], v198 offset:21504
    buffer_load_dwordx4 v214, s[16:19], s35 offen offset:1024 lds
    v_mfma_f32_32x32x16_bf16 v[48:63], v[132:135], a[36:39], v[48:63]
    ds_read_b64_tr_b16 v[152:153], v199 offset:20480
    ds_read_b64_tr_b16 v[154:155], v199 offset:21504
    v_mfma_f32_32x32x16_bf16 v[64:79], v[136:139], a[32:35], v[64:79]
    v_mfma_f32_32x32x16_bf16 v[80:95], v[136:139], a[36:39], v[80:95]
    ds_read_b64_tr_b16 v[156:157], v200 offset:20480
    ds_read_b64_tr_b16 v[158:159], v200 offset:21504
    v_mfma_f32_32x32x16_bf16 v[96:111], v[140:143], a[32:35], v[96:111]
    ds_read_b64_tr_b16 a[132:133], v232 offset:20480
    ds_read_b64_tr_b16 a[134:135], v232 offset:21504
    v_mfma_f32_32x32x16_bf16 v[112:127], v[140:143], a[36:39], v[112:127]
    s_waitcnt lgkmcnt(14)
    v_mfma_f32_16x16x32_bf16 a[144:147], a[128:131], a[136:139], a[144:147]
    s_cmp_eq_u32 s48, 7
    s_cbranch_scc1 L_ka_o_do23
L_ka_o_rt23:
    s_waitcnt lgkmcnt(2)
    v_mfma_f32_32x32x16_bf16 v[0:15], v[144:147], a[40:43], v[0:15]
    ds_read_b64_tr_b16 v[128:129], v197 offset:24576
    ds_read_b64_tr_b16 v[130:131], v197 offset:25600
    v_mfma_f32_32x32x16_bf16 v[16:31], v[144:147], a[44:47], v[16:31]
    v_mfma_f32_32x32x16_bf16 v[32:47], v[148:151], a[40:43], v[32:47]
    ds_read_b64_tr_b16 v[132:133], v198 offset:24576
    ds_read_b64_tr_b16 v[134:135], v198 offset:25600
    v_mfma_f32_32x32x16_bf16 v[48:63], v[148:151], a[44:47], v[48:63]
    ds_read_b64_tr_b16 v[136:137], v199 offset:24576
    ds_read_b64_tr_b16 v[138:139], v199 offset:25600
    v_mfma_f32_32x32x16_bf16 v[64:79], v[152:155], a[40:43], v[64:79]
    v_mfma_f32_32x32x16_bf16 v[80:95], v[152:155], a[44:47], v[80:95]
    ds_read_b64_tr_b16 v[140:141], v200 offset:24576
    ds_read_b64_tr_b16 v[142:143], v200 offset:25600
    v_mfma_f32_32x32x16_bf16 v[96:111], v[156:159], a[40:43], v[96:111]
    ds_read_b64_tr_b16 a[128:129], v232 offset:24576
    ds_read_b64_tr_b16 a[130:131], v232 offset:25600
    v_mfma_f32_32x32x16_bf16 v[112:127], v[156:159], a[44:47], v[112:127]
    s_waitcnt lgkmcnt(10)
    v_mfma_f32_16x16x32_bf16 a[144:147], a[132:135], a[136:139], a[144:147]
    s_waitcnt lgkmcnt(2)
    v_mfma_f32_32x32x16_bf16 v[0:15], v[128:131], a[48:51], v[0:15]
    ds_read_b64_tr_b16 v[144:145], v197 offset:28672
    ds_read_b64_tr_b16 v[146:147], v197 offset:29696
    v_mfma_f32_32x32x16_bf16 v[16:31], v[128:131], a[52:55], v[16:31]
    v_mfma_f32_32x32x16_bf16 v[32:47], v[132:135], a[48:51], v[32:47]
    ds_read_b64_tr_b16 v[148:149], v198 offset:28672
    ds_read_b64_tr_b16 v[150:151], v198 offset:29696
    v_mfma_f32_32x32x16_bf16 v[48:63], v[132:135], a[52:55], v[48:63]
    ds_read_b64_tr_b16 v[152:153], v199 offset:28672
    ds_read_b64_tr_b16 v[154:155], v199 offset:29696
    v_mfma_f32_32x32x16_bf16 v[64:79], v[136:139], a[48:51], v[64:79]
    v_and_b32 v237, 1, v233
    v_lshlrev_b32 v237, 7, v237
    buffer_load_dword v250, v237, s[56:59], 0 offen sc1
    v_mfma_f32_32x32x16_bf16 v[80:95], v[136:139], a[52:55], v[80:95]
    ds_read_b64_tr_b16 v[156:157], v200 offset:28672
    ds_read_b64_tr_b16 v[158:159], v200 offset:29696
    v_mfma_f32_32x32x16_bf16 v[96:111], v[140:143], a[48:51], v[96:111]
    ds_read_b64_tr_b16 a[132:133], v232 offset:28672
    ds_read_b64_tr_b16 a[134:135], v232 offset:29696
    v_mfma_f32_32x32x16_bf16 v[112:127], v[140:143], a[52:55], v[112:127]
    s_waitcnt lgkmcnt(10)
    v_mfma_f32_16x16x32_bf16 a[144:147], a[128:131], a[136:139], a[144:147]
    s_waitcnt vmcnt(17)
    s_waitcnt lgkmcnt(0)
    s_barrier
    v_mfma_f32_32x32x16_bf16 v[0:15], v[144:147], a[56:59], v[0:15]
    ds_read_b64_tr_b16 v[128:129], v197 offset:32768
    ds_read_b64_tr_b16 v[130:131], v197 offset:33792
    ds_read_b128 a[0:3], v228 offset:16384
    v_mfma_f32_32x32x16_bf16 v[16:31], v[144:147], a[60:63], v[16:31]
    v_mfma_f32_32x32x16_bf16 v[32:47], v[148:151], a[56:59], v[32:47]
    ds_read_b64_tr_b16 v[132:133], v198 offset:32768
    ds_read_b64_tr_b16 v[134:135], v198 offset:33792
    ds_read_b128 a[4:7], v228 offset:20480
    v_mfma_f32_32x32x16_bf16 v[48:63], v[148:151], a[60:63], v[48:63]
    ds_read_b64_tr_b16 v[136:137], v199 offset:32768
    ds_read_b64_tr_b16 v[138:139], v199 offset:33792
    ds_read_b128 a[8:11], v229 offset:16384
    v_mfma_f32_32x32x16_bf16 v[64:79], v[152:155], a[56:59], v[64:79]
    s_add_u32 s35, s35, 8192
    s_add_u32 m0, s38, 0x4000
    s_nop 0
    buffer_load_dwordx4 v213, s[16:19], s35 offen offset:0 lds
    v_mfma_f32_32x32x16_bf16 v[80:95], v[152:155], a[60:63], v[80:95]
    ds_read_b64_tr_b16 v[140:141], v200 offset:32768
    ds_read_b64_tr_b16 v[142:143], v200 offset:33792
    ds_read_b128 a[12:15], v229 offset:20480
    buffer_load_dwordx4 v214, s[16:19], s35 offen offset:1024 lds
    v_mfma_f32_32x32x16_bf16 v[96:111], v[156:159], a[56:59], v[96:111]
    ds_read_b64_tr_b16 a[128:129], v232 offset:32768
    ds_read_b64_tr_b16 a[130:131], v232 offset:33792
    ds_read_b128 a[16:19], v230 offset:16384
    v_mfma_f32_32x32x16_bf16 v[112:127], v[156:159], a[60:63], v[112:127]
    v_mfma_f32_16x16x32_bf16 a[144:147], a[132:135], a[136:139], a[144:147]
    ds_read_b128 a[20:23], v230 offset:20480
    s_waitcnt lgkmcnt(5)
    v_mfma_f32_32x32x16_bf16 v[0:15], v[128:131], a[0:3], v[0:15]
    ds_read_b64_tr_b16 v[144:145], v197 offset:36864
    ds_read_b64_tr_b16 v[146:147], v197 offset:37888
    ds_read_b128 a[24:27], v231 offset:16384
    v_mfma_f32_32x32x16_bf16 v[16:31], v[128:131], a[4:7], v[16:31]
    ds_read_b128 a[28:31], v231 offset:20480
    s_add_u32 m0, s39, 0x2000
    s_nop 0
    buffer_load_dwordx4 v215, s[20:23], s36 offen offset:0 lds
    v_mfma_f32_32x32x16_bf16 v[32:47], v[132:135], a[0:3], v[32:47]
    ds_read_b64_tr_b16 v[148:149], v198 offset:36864
    ds_read_b64_tr_b16 v[150:151], v198 offset:37888
    buffer_load_dwordx4 v215, s[20:23], s36 offen offset:1024 lds
    v_mfma_f32_32x32x16_bf16 v[48:63], v[132:135], a[4:7], v[48:63]
    ds_read_b64_tr_b16 v[152:153], v199 offset:36864
    ds_read_b64_tr_b16 v[154:155], v199 offset:37888
    v_mfma_f32_32x32x16_bf16 v[64:79], v[136:139], a[0:3], v[64:79]
    s_add_u32 s35, s35, 8192
    s_add_u32 m0, s38, 0x6000
    s_nop 0
    buffer_load_dwordx4 v213, s[16:19], s35 offen offset:0 lds
    v_mfma_f32_32x32x16_bf16 v[80:95], v[136:139], a[4:7], v[80:95]
    ds_read_b64_tr_b16 v[156:157], v200 offset:36864
    ds_read_b64_tr_b16 v[158:159], v200 offset:37888
    buffer_load_dwordx4 v214, s[16:19], s35 offen offset:1024 lds
    v_mfma_f32_32x32x16_bf16 v[96:111], v[140:143], a[0:3], v[96:111]
    ds_read_b64_tr_b16 a[132:133], v232 offset:36864
    ds_read_b64_tr_b16 a[134:135], v232 offset:37888
    v_mfma_f32_32x32x16_bf16 v[112:127], v[140:143], a[4:7], v[112:127]
    s_waitcnt lgkmcnt(14)
    v_mfma_f32_16x16x32_bf16 a[144:147], a[128:131], a[136:139], a[144:147]
    s_waitcnt lgkmcnt(2)
    v_mfma_f32_32x32x16_bf16 v[0:15], v[144:147], a[8:11], v[0:15]
    ds_read_b64_tr_b16 v[128:129], v197 offset:40960
    ds_read_b64_tr_b16 v[130:131], v197 offset:41984
    v_mfma_f32_32x32x16_bf16 v[16:31], v[144:147], a[12:15], v[16:31]
    s_add_u32 s36, s36, 8192
    s_add_u32 m0, s39, 0x8000
    s_nop 0
    buffer_load_dwordx4 v215, s[20:23], s36 offen offset:0 lds
    v_mfma_f32_32x32x16_bf16 v[32:47], v[148:151], a[8:11], v[32:47]
    ds_read_b64_tr_b16 v[132:133], v198 offset:40960
    ds_read_b64_tr_b16 v[134:135], v198 offset:41984
    buffer_load_dwordx4 v215, s[20:23], s36 offen offset:1024 lds
    v_mfma_f32_32x32x16_bf16 v[48:63], v[148:151], a[12:15], v[48:63]
    ds_read_b64_tr_b16 v[136:137], v199 offset:40960
    ds_read_b64_tr_b16 v[138:139], v199 offset:41984
    v_mfma_f32_32x32x16_bf16 v[64:79], v[152:155], a[8:11], v[64:79]
    s_add_u32 s36, s36, 8192
    s_add_u32 m0, s39, 0xe000
    s_nop 0
    buffer_load_dwordx4 v215, s[20:23], s36 offen offset:0 lds
    v_mfma_f32_32x32x16_bf16 v[80:95], v[152:155], a[12:15], v[80:95]
    ds_read_b64_tr_b16 v[140:141], v200 offset:40960
    ds_read_b64_tr_b16 v[142:143], v200 offset:41984
    buffer_load_dwordx4 v215, s[20:23], s36 offen offset:1024 lds
    v_mfma_f32_32x32x16_bf16 v[96:111], v[156:159], a[8:11], v[96:111]
    ds_read_b64_tr_b16 a[128:129], v232 offset:40960
    ds_read_b64_tr_b16 a[130:131], v232 offset:41984
    v_mfma_f32_32x32x16_bf16 v[112:127], v[156:159], a[12:15], v[112:127]
    s_waitcnt lgkmcnt(10)
    v_mfma_f32_16x16x32_bf16 a[144:147], a[132:135], a[136:139], a[144:147]
    s_waitcnt lgkmcnt(2)
    v_mfma_f32_32x32x16_bf16 v[0:15], v[128:131], a[16:19], v[0:15]
    ds_read_b64_tr_b16 v[144:145], v197 offset:45056
    ds_read_b64_tr_b16 v[146:147], v197 offset:46080
    v_mfma_f32_32x32x16_bf16 v[16:31], v[128:131], a[20:23], v[16:31]
    v_mfma_f32_32x32x16_bf16 v[32:47], v[132:135], a[16:19], v[32:47]
    ds_read_b64_tr_b16 v[148:149], v198 offset:45056
    ds_read_b64_tr_b16 v[150:151], v198 offset:46080
    v_mfma_f32_32x32x16_bf16 v[48:63], v[132:135], a[20:23], v[48:63]
    ds_read_b64_tr_b16 v[152:153], v199 offset:45056
    ds_read_b64_tr_b16 v[154:155], v199 offset:46080
    v_mfma_f32_32x32x16_bf16 v[64:79], v[136:139], a[16:19], v[64:79]
    v_mfma_f32_32x32x16_bf16 v[80:95], v[136:139], a[20:23], v[80:95]
    ds_read_b64_tr_b16 v[156:157], v200 offset:45056
    ds_read_b64_tr_b16 v[158:159], v200 offset:46080
    v_mfma_f32_32x32x16_bf16 v[96:111], v[140:143], a[16:19], v[96:111]
    ds_read_b64_tr_b16 a[132:133], v232 offset:45056
    ds_read_b64_tr_b16 a[134:135], v232 offset:46080
    v_mfma_f32_32x32x16_bf16 v[112:127], v[140:143], a[20:23], v[112:127]
    s_waitcnt lgkmcnt(10)
    v_mfma_f32_16x16x32_bf16 a[144:147], a[128:131], a[136:139], a[144:147]
    s_waitcnt vmcnt(10)
    v_cmp_gt_u32 vcc, 0x80, v250
    s_or_b32 s50, vcc_lo, vcc_hi
    v_and_b32 v237, 31, v233
    v_lshlrev_b32 v237, 3, v237
    buffer_load_dwordx2 v[246:247], v237, s[52:55], s51 offen offset:0 sc1
    buffer_load_dwordx2 v[248:249], v237, s[52:55], s51 offen offset:256 sc1
    s_movk_i32 s3, 0x4000
    buffer_load_dwordx4 v[172:175], v196, s[52:55], s3 offen offset:0 sc1
    buffer_load_dwordx4 v[176:179], v196, s[52:55], s3 offen offset:1024 sc1
    buffer_load_dwordx4 v[180:183], v196, s[52:55], s3 offen offset:2048 sc1
    buffer_load_dwordx4 v[184:187], v196, s[52:55], s3 offen offset:3072 sc1
    s_waitcnt lgkmcnt(0)
    s_barrier
    v_mfma_f32_32x32x16_bf16 v[0:15], v[144:147], a[24:27], v[0:15]
    ds_read_b64_tr_b16 v[128:129], v197 offset:49152
    ds_read_b64_tr_b16 v[130:131], v197 offset:50176
    ds_read_b128 a[32:35], v228 offset:0
    v_mfma_f32_32x32x16_bf16 v[16:31], v[144:147], a[28:31], v[16:31]
    v_mfma_f32_32x32x16_bf16 v[32:47], v[148:151], a[24:27], v[32:47]
    ds_read_b64_tr_b16 v[132:133], v198 offset:49152
    ds_read_b64_tr_b16 v[134:135], v198 offset:50176
    ds_read_b128 a[36:39], v228 offset:4096
    v_mfma_f32_32x32x16_bf16 v[48:63], v[148:151], a[28:31], v[48:63]
    ds_read_b64_tr_b16 v[136:137], v199 offset:49152
    ds_read_b64_tr_b16 v[138:139], v199 offset:50176
    ds_read_b128 a[40:43], v229 offset:0
    v_mfma_f32_32x32x16_bf16 v[64:79], v[152:155], a[24:27], v[64:79]
    s_add_u32 s35, s35, 8192
    s_add_u32 m0, s38, 0x8000
    s_nop 0
    buffer_load_dwordx4 v213, s[16:19], s35 offen offset:0 lds
    v_mfma_f32_32x32x16_bf16 v[80:95], v[152:155], a[28:31], v[80:95]
    ds_read_b64_tr_b16 v[140:141], v200 offset:49152
    ds_read_b64_tr_b16 v[142:143], v200 offset:50176
    ds_read_b128 a[44:47], v229 offset:4096
    buffer_load_dwordx4 v214, s[16:19], s35 offen offset:1024 lds
    v_mfma_f32_32x32x16_bf16 v[96:111], v[156:159], a[24:27], v[96:111]
    ds_read_b64_tr_b16 a[128:129], v232 offset:49152
    ds_read_b64_tr_b16 a[130:131], v232 offset:50176
    ds_read_b128 a[48:51], v230 offset:0
    v_mfma_f32_32x32x16_bf16 v[112:127], v[156:159], a[28:31], v[112:127]
    v_mfma_f32_16x16x32_bf16 a[144:147], a[132:135], a[136:139], a[144:147]
    ds_read_b128 a[52:55], v230 offset:4096
    s_waitcnt lgkmcnt(5)
    v_mfma_f32_32x32x16_bf16 v[0:15], v[128:131], a[32:35], v[0:15]
    ds_read_b64_tr_b16 v[144:145], v197 offset:53248
    ds_read_b64_tr_b16 v[146:147], v197 offset:54272
    ds_read_b128 a[56:59], v231 offset:0
    v_mfma_f32_32x32x16_bf16 v[16:31], v[128:131], a[36:39], v[16:31]
    ds_read_b128 a[60:63], v231 offset:4096
    s_add_u32 s36, s36, 8192
    s_add_u32 m0, s39, 0x4000
    s_nop 0
    buffer_load_dwordx4 v215, s[20:23], s36 offen offset:0 lds
    v_mfma_f32_32x32x16_bf16 v[32:47], v[132:135], a[32:35], v[32:47]
    ds_read_b64_tr_b16 v[148:149], v198 offset:53248
    ds_read_b64_tr_b16 v[150:151], v198 offset:54272
    buffer_load_dwordx4 v215, s[20:23], s36 offen offset:1024 lds
    v_mfma_f32_32x32x16_bf16 v[48:63], v[132:135], a[36:39], v[48:63]
    ds_read_b64_tr_b16 v[152:153], v199 offset:53248
    ds_read_b64_tr_b16 v[154:155], v199 offset:54272
    v_mfma_f32_32x32x16_bf16 v[64:79], v[136:139], a[32:35], v[64:79]
    s_add_u32 s35, s35, 8192
    s_add_u32 m0, s38, 0xa000
    s_nop 0
    buffer_load_dwordx4 v213, s[16:19], s35 offen offset:0 lds
    v_mfma_f32_32x32x16_bf16 v[80:95], v[136:139], a[36:39], v[80:95]
    ds_read_b64_tr_b16 v[156:157], v200 offset:53248
    ds_read_b64_tr_b16 v[158:159], v200 offset:54272
    buffer_load_dwordx4 v214, s[16:19], s35 offen offset:1024 lds
    v_mfma_f32_32x32x16_bf16 v[96:111], v[140:143], a[32:35], v[96:111]
    ds_read_b64_tr_b16 a[132:133], v232 offset:53248
    ds_read_b64_tr_b16 a[134:135], v232 offset:54272
    v_mfma_f32_32x32x16_bf16 v[112:127], v[140:143], a[36:39], v[112:127]
    s_waitcnt lgkmcnt(14)
    v_mfma_f32_16x16x32_bf16 a[144:147], a[128:131], a[136:139], a[144:147]
    s_cmp_eq_u32 s48, 0
    s_cbranch_scc1 L_ka_o_do24
L_ka_o_rt24:
    s_waitcnt lgkmcnt(2)
    v_mfma_f32_32x32x16_bf16 v[0:15], v[144:147], a[40:43], v[0:15]
    ds_read_b64_tr_b16 v[128:129], v197 offset:57344
    ds_read_b64_tr_b16 v[130:131], v197 offset:58368
    v_mfma_f32_32x32x16_bf16 v[16:31], v[144:147], a[44:47], v[16:31]
    s_add_u32 s36, s36, 8192
    s_add_u32 m0, s39, 0xa000
    s_nop 0
    buffer_load_dwordx4 v215, s[20:23], s36 offen offset:0 lds
    v_mfma_f32_32x32x16_bf16 v[32:47], v[148:151], a[40:43], v[32:47]
    ds_read_b64_tr_b16 v[132:133], v198 offset:57344
    ds_read_b64_tr_b16 v[134:135], v198 offset:58368
    buffer_load_dwordx4 v215, s[20:23], s36 offen offset:1024 lds
    v_mfma_f32_32x32x16_bf16 v[48:63], v[148:151], a[44:47], v[48:63]
    ds_read_b64_tr_b16 v[136:137], v199 offset:57344
    ds_read_b64_tr_b16 v[138:139], v199 offset:58368
    v_mfma_f32_32x32x16_bf16 v[64:79], v[152:155], a[40:43], v[64:79]
    v_mfma_f32_32x32x16_bf16 v[80:95], v[152:155], a[44:47], v[80:95]
    ds_read_b64_tr_b16 v[140:141], v200 offset:57344
    ds_read_b64_tr_b16 v[142:143], v200 offset:58368
    v_mfma_f32_32x32x16_bf16 v[96:111], v[156:159], a[40:43], v[96:111]
    ds_read_b64_tr_b16 a[128:129], v232 offset:57344
    ds_read_b64_tr_b16 a[130:131], v232 offset:58368
    v_mfma_f32_32x32x16_bf16 v[112:127], v[156:159], a[44:47], v[112:127]
    s_waitcnt lgkmcnt(10)
    v_mfma_f32_16x16x32_bf16 a[144:147], a[132:135], a[136:139], a[144:147]
    s_waitcnt lgkmcnt(2)
    v_mfma_f32_32x32x16_bf16 v[0:15], v[128:131], a[48:51], v[0:15]
    ds_read_b64_tr_b16 v[144:145], v197 offset:61440
    ds_read_b64_tr_b16 v[146:147], v197 offset:62464
    v_mfma_f32_32x32x16_bf16 v[16:31], v[128:131], a[52:55], v[16:31]
    v_mfma_f32_32x32x16_bf16 v[32:47], v[132:135], a[48:51], v[32:47]
    ds_read_b64_tr_b16 v[148:149], v198 offset:61440
    ds_read_b64_tr_b16 v[150:151], v198 offset:62464
    v_mfma_f32_32x32x16_bf16 v[48:63], v[132:135], a[52:55], v[48:63]
    ds_read_b64_tr_b16 v[152:153], v199 offset:61440
    ds_read_b64_tr_b16 v[154:155], v199 offset:62464
    v_mfma_f32_32x32x16_bf16 v[64:79], v[136:139], a[48:51], v[64:79]
    v_mfma_f32_32x32x16_bf16 v[80:95], v[136:139], a[52:55], v[80:95]
    ds_read_b64_tr_b16 v[156:157], v200 offset:61440
    ds_read_b64_tr_b16 v[158:159], v200 offset:62464
    v_mfma_f32_32x32x16_bf16 v[96:111], v[140:143], a[48:51], v[96:111]
    ds_read_b64_tr_b16 a[132:133], v232 offset:61440
    ds_read_b64_tr_b16 a[134:135], v232 offset:62464
    v_mfma_f32_32x32x16_bf16 v[112:127], v[140:143], a[52:55], v[112:127]
    s_waitcnt lgkmcnt(10)
    v_mfma_f32_16x16x32_bf16 a[144:147], a[128:131], a[136:139], a[144:147]
    s_cmp_eq_u32 s48, 1
    s_cbranch_scc1 L_ka_o_do25
L_ka_o_rt25:
    s_waitcnt lgkmcnt(0)
    v_mfma_f32_32x32x16_bf16 v[0:15], v[144:147], a[56:59], v[0:15]
    v_mfma_f32_32x32x16_bf16 v[16:31], v[144:147], a[60:63], v[16:31]
    v_mfma_f32_32x32x16_bf16 v[32:47], v[148:151], a[56:59], v[32:47]
    v_mfma_f32_32x32x16_bf16 v[48:63], v[148:151], a[60:63], v[48:63]
    v_mfma_f32_32x32x16_bf16 v[64:79], v[152:155], a[56:59], v[64:79]
    v_mfma_f32_32x32x16_bf16 v[80:95], v[152:155], a[60:63], v[80:95]
    v_mfma_f32_32x32x16_bf16 v[96:111], v[156:159], a[56:59], v[96:111]
    v_mfma_f32_32x32x16_bf16 v[112:127], v[156:159], a[60:63], v[112:127]
    v_mfma_f32_16x16x32_bf16 a[144:147], a[132:135], a[136:139], a[144:147]
    s_cmp_lg_u32 s50, 0
    s_cbranch_scc1 L_ka_slow
L_ka_slowret:
    v_and_b32 v220, 1, v233
    v_lshlrev_b32 v220, 6, v220
    v_bfe_u32 v221, v233, 4, 1
    v_lshl_add_u32 v220, v221, 5, v220
    v_lshrrev_b32 v221, 5, v233
    v_lshl_add_u32 v220, v221, 4, v220
    s_lshl_b32 s3, s28, 7
    s_add_u32 s3, s3, 0x14000
    v_add_u32 v220, s3, v220
    s_mov_b32 exec_lo, 0x00030003
    s_mov_b32 exec_hi, 0x00030003
    ds_write_b128 v220, a[144:147]
    s_mov_b64 exec, -1
    v_lshrrev_b32 v221, 5, v233
    v_lshlrev_b32 v221, 5, v221
    v_add_u32 v221, 0x14000, v221
    s_waitcnt vmcnt(8)
    s_waitcnt lgkmcnt(0)
    s_barrier
    ds_read_b128 v[224:227], v221 offset:0
    ds_read_b128 v[228:231], v221 offset:16
    ds_read_b128 v[238:241], v221 offset:64
    ds_read_b128 v[242:245], v221 offset:80
    ds_read_b128 a[128:131], v205 offset:0
    ds_read_b128 a[132:135], v206 offset:0
    ds_read_b128 a[136:139], v207 offset:0
    ds_read_b128 a[140:143], v208 offset:0
    ds_read_b128 a[144:147], v209 offset:0
    ds_read_b128 a[148:151], v210 offset:0
    ds_read_b128 a[152:155], v211 offset:0
    ds_read_b128 a[156:159], v212 offset:0
    v_mul_f32 v247, 0x3e0293ee, v247
    v_mul_f32 v249, 0x3e0293ee, v249
    v_max3_u32 v250, v172, v173, v174
    v_max3_u32 v250, v250, v175, v176
    v_max3_u32 v250, v250, v177, v178
    v_max3_u32 v250, v250, v179, v180
    v_max3_u32 v250, v250, v181, v182
    v_max3_u32 v250, v250, v183, v184
    v_max3_u32 v250, v250, v185, v186
    v_max_u32 v250, v250, v187
    s_nop 1
    v_max_u32_dpp v250, v250, v250 row_shr:1 row_mask:0xf bank_mask:0xf
    s_nop 1
    v_max_u32_dpp v250, v250, v250 row_shr:2 row_mask:0xf bank_mask:0xf
    s_nop 1
    v_max_u32_dpp v250, v250, v250 row_shr:4 row_mask:0xf bank_mask:0xf
    s_nop 1
    v_max_u32_dpp v250, v250, v250 row_shr:8 row_mask:0xf bank_mask:0xf
    s_nop 1
    v_max_u32_dpp v250, v250, v250 row_bcast:15 row_mask:0xa bank_mask:0xf
    s_nop 1
    v_max_u32_dpp v250, v250, v250 row_bcast:31 row_mask:0xc bank_mask:0xf
    s_nop 0
    v_readlane_b32 s50, v250, 63
    s_and_b32 s43, s50, 0xffff
    s_sub_u32 s43, 0xffff, s43
    s_and_b32 s43, s43, 2047
    s_add_u32 s35, s35, 8192
    s_add_u32 m0, s38, 0xc000
    s_nop 0
    buffer_load_dwordx4 v213, s[16:19], s35 offen offset:0 lds
    buffer_load_dwordx4 v214, s[16:19], s35 offen offset:1024 lds
    s_add_u32 s36, s36, 8192
    s_add_u32 m0, s39, 0x0
    s_nop 0
    buffer_load_dwordx4 v215, s[20:23], s36 offen offset:0 lds
    buffer_load_dwordx4 v215, s[20:23], s36 offen offset:1024 lds
    s_waitcnt lgkmcnt(10)
    v_pk_fma_f32 v[0:1], v[246:247], v[224:225], v[0:1] op_sel:[0,0,0] op_sel_hi:[0,1,1] neg_lo:[1,0,0] neg_hi:[1,0,0]
    v_pk_mul_f32 v[0:1], v[246:247], v[0:1] op_sel:[1,0] op_sel_hi:[1,1]
    v_cvt_pk_bf16_f32 v128, v0, v1
    v_pk_fma_f32 v[2:3], v[246:247], v[226:227], v[2:3] op_sel:[0,0,0] op_sel_hi:[0,1,1] neg_lo:[1,0,0] neg_hi:[1,0,0]
    v_pk_mul_f32 v[2:3], v[246:247], v[2:3] op_sel:[1,0] op_sel_hi:[1,1]
    v_cvt_pk_bf16_f32 v129, v2, v3
    v_pk_fma_f32 v[4:5], v[246:247], v[228:229], v[4:5] op_sel:[0,0,0] op_sel_hi:[0,1,1] neg_lo:[1,0,0] neg_hi:[1,0,0]
    v_pk_mul_f32 v[4:5], v[246:247], v[4:5] op_sel:[1,0] op_sel_hi:[1,1]
    v_cvt_pk_bf16_f32 v130, v4, v5
    v_pk_fma_f32 v[6:7], v[246:247], v[230:231], v[6:7] op_sel:[0,0,0] op_sel_hi:[0,1,1] neg_lo:[1,0,0] neg_hi:[1,0,0]
    v_pk_mul_f32 v[6:7], v[246:247], v[6:7] op_sel:[1,0] op_sel_hi:[1,1]
    v_cvt_pk_bf16_f32 v131, v6, v7
    v_pk_fma_f32 v[16:17], v[248:249], v[224:225], v[16:17] op_sel:[0,0,0] op_sel_hi:[0,1,1] neg_lo:[1,0,0] neg_hi:[1,0,0]
    v_pk_mul_f32 v[16:17], v[248:249], v[16:17] op_sel:[1,0] op_sel_hi:[1,1]
    v_cvt_pk_bf16_f32 v160, v16, v17
    v_pk_fma_f32 v[18:19], v[248:249], v[226:227], v[18:19] op_sel:[0,0,0] op_sel_hi:[0,1,1] neg_lo:[1,0,0] neg_hi:[1,0,0]
    v_pk_mul_f32 v[18:19], v[248:249], v[18:19] op_sel:[1,0] op_sel_hi:[1,1]
    v_cvt_pk_bf16_f32 v161, v18, v19
    v_pk_fma_f32 v[20:21], v[248:249], v[228:229], v[20:21] op_sel:[0,0,0] op_sel_hi:[0,1,1] neg_lo:[1,0,0] neg_hi:[1,0,0]
    v_pk_mul_f32 v[20:21], v[248:249], v[20:21] op_sel:[1,0] op_sel_hi:[1,1]
    v_cvt_pk_bf16_f32 v162, v20, v21
    v_pk_fma_f32 v[22:23], v[248:249], v[230:231], v[22:23] op_sel:[0,0,0] op_sel_hi:[0,1,1] neg_lo:[1,0,0] neg_hi:[1,0,0]
    v_pk_mul_f32 v[22:23], v[248:249], v[22:23] op_sel:[1,0] op_sel_hi:[1,1]
    v_cvt_pk_bf16_f32 v163, v22, v23
    ds_read_b128 v[224:227], v221 offset:128
    ds_read_b128 v[228:231], v221 offset:144
    s_waitcnt lgkmcnt(10)
    v_pk_fma_f32 v[8:9], v[246:247], v[238:239], v[8:9] op_sel:[0,0,0] op_sel_hi:[0,1,1] neg_lo:[1,0,0] neg_hi:[1,0,0]
    v_pk_mul_f32 v[8:9], v[246:247], v[8:9] op_sel:[1,0] op_sel_hi:[1,1]
    v_cvt_pk_bf16_f32 v132, v8, v9
    v_pk_fma_f32 v[10:11], v[246:247], v[240:241], v[10:11] op_sel:[0,0,0] op_sel_hi:[0,1,1] neg_lo:[1,0,0] neg_hi:[1,0,0]
    v_pk_mul_f32 v[10:11], v[246:247], v[10:11] op_sel:[1,0] op_sel_hi:[1,1]
    v_cvt_pk_bf16_f32 v133, v10, v11
    v_pk_fma_f32 v[12:13], v[246:247], v[242:243], v[12:13] op_sel:[0,0,0] op_sel_hi:[0,1,1] neg_lo:[1,0,0] neg_hi:[1,0,0]
    v_pk_mul_f32 v[12:13], v[246:247], v[12:13] op_sel:[1,0] op_sel_hi:[1,1]
    v_cvt_pk_bf16_f32 v134, v12, v13
    v_pk_fma_f32 v[14:15], v[246:247], v[244:245], v[14:15] op_sel:[0,0,0] op_sel_hi:[0,1,1] neg_lo:[1,0,0] neg_hi:[1,0,0]
    v_pk_mul_f32 v[14:15], v[246:247], v[14:15] op_sel:[1,0] op_sel_hi:[1,1]
    v_cvt_pk_bf16_f32 v135, v14, v15
    v_pk_fma_f32 v[24:25], v[248:249], v[238:239], v[24:25] op_sel:[0,0,0] op_sel_hi:[0,1,1] neg_lo:[1,0,0] neg_hi:[1,0,0]
    v_pk_mul_f32 v[24:25], v[248:249], v[24:25] op_sel:[1,0] op_sel_hi:[1,1]
    v_cvt_pk_bf16_f32 v164, v24, v25
    v_pk_fma_f32 v[26:27], v[248:249], v[240:241], v[26:27] op_sel:[0,0,0] op_sel_hi:[0,1,1] neg_lo:[1,0,0] neg_hi:[1,0,0]
    v_pk_mul_f32 v[26:27], v[248:249], v[26:27] op_sel:[1,0] op_sel_hi:[1,1]
    v_cvt_pk_bf16_f32 v165, v26, v27
    v_pk_fma_f32 v[28:29], v[248:249], v[242:243], v[28:29] op_sel:[0,0,0] op_sel_hi:[0,1,1] neg_lo:[1,0,0] neg_hi:[1,0,0]
    v_pk_mul_f32 v[28:29], v[248:249], v[28:29] op_sel:[1,0] op_sel_hi:[1,1]
    v_cvt_pk_bf16_f32 v166, v28, v29
    v_pk_fma_f32 v[30:31], v[248:249], v[244:245], v[30:31] op_sel:[0,0,0] op_sel_hi:[0,1,1] neg_lo:[1,0,0] neg_hi:[1,0,0]
    v_pk_mul_f32 v[30:31], v[248:249], v[30:31] op_sel:[1,0] op_sel_hi:[1,1]
    v_cvt_pk_bf16_f32 v167, v30, v31
    ds_read_b128 v[238:241], v221 offset:192
    ds_read_b128 v[242:245], v221 offset:208
    s_waitcnt lgkmcnt(11)
    s_waitcnt lgkmcnt(2)
    v_mfma_f32_32x32x16_bf16 v[0:15], a[128:131], v[128:131], 0
    v_pk_fma_f32 v[32:33], v[246:247], v[224:225], v[32:33] op_sel:[0,0,0] op_sel_hi:[0,1,1] neg_lo:[1,0,0] neg_hi:[1,0,0]
    v_pk_mul_f32 v[32:33], v[246:247], v[32:33] op_sel:[1,0] op_sel_hi:[1,1]
    v_cvt_pk_bf16_f32 v136, v32, v33
    v_pk_fma_f32 v[34:35], v[246:247], v[226:227], v[34:35] op_sel:[0,0,0] op_sel_hi:[0,1,1] neg_lo:[1,0,0] neg_hi:[1,0,0]
    v_pk_mul_f32 v[34:35], v[246:247], v[34:35] op_sel:[1,0] op_sel_hi:[1,1]
    v_cvt_pk_bf16_f32 v137, v34, v35
    v_pk_fma_f32 v[36:37], v[246:247], v[228:229], v[36:37] op_sel:[0,0,0] op_sel_hi:[0,1,1] neg_lo:[1,0,0] neg_hi:[1,0,0]
    v_pk_mul_f32 v[36:37], v[246:247], v[36:37] op_sel:[1,0] op_sel_hi:[1,1]
    v_cvt_pk_bf16_f32 v138, v36, v37
    v_pk_fma_f32 v[38:39], v[246:247], v[230:231], v[38:39] op_sel:[0,0,0] op_sel_hi:[0,1,1] neg_lo:[1,0,0] neg_hi:[1,0,0]
    v_pk_mul_f32 v[38:39], v[246:247], v[38:39] op_sel:[1,0] op_sel_hi:[1,1]
    v_cvt_pk_bf16_f32 v139, v38, v39
    v_mfma_f32_32x32x16_bf16 v[16:31], a[128:131], v[160:163], 0
    v_pk_fma_f32 v[48:49], v[248:249], v[224:225], v[48:49] op_sel:[0,0,0] op_sel_hi:[0,1,1] neg_lo:[1,0,0] neg_hi:[1,0,0]
    v_pk_mul_f32 v[48:49], v[248:249], v[48:49] op_sel:[1,0] op_sel_hi:[1,1]
    v_cvt_pk_bf16_f32 v168, v48, v49
    v_pk_fma_f32 v[50:51], v[248:249], v[226:227], v[50:51] op_sel:[0,0,0] op_sel_hi:[0,1,1] neg_lo:[1,0,0] neg_hi:[1,0,0]
    v_pk_mul_f32 v[50:51], v[248:249], v[50:51] op_sel:[1,0] op_sel_hi:[1,1]
    v_cvt_pk_bf16_f32 v169, v50, v51
    v_pk_fma_f32 v[52:53], v[248:249], v[228:229], v[52:53] op_sel:[0,0,0] op_sel_hi:[0,1,1] neg_lo:[1,0,0] neg_hi:[1,0,0]
    v_pk_mul_f32 v[52:53], v[248:249], v[52:53] op_sel:[1,0] op_sel_hi:[1,1]
    v_cvt_pk_bf16_f32 v170, v52, v53
    v_pk_fma_f32 v[54:55], v[248:249], v[230:231], v[54:55] op_sel:[0,0,0] op_sel_hi:[0,1,1] neg_lo:[1,0,0] neg_hi:[1,0,0]
    v_pk_mul_f32 v[54:55], v[248:249], v[54:55] op_sel:[1,0] op_sel_hi:[1,1]
    v_cvt_pk_bf16_f32 v171, v54, v55
    ds_read_b128 v[224:227], v221 offset:256
    ds_read_b128 v[228:231], v221 offset:272
    ds_read_b128 a[128:131], v205 offset:8192
    s_waitcnt lgkmcnt(3)
    v_mfma_f32_32x32x16_bf16 v[0:15], a[132:135], v[132:135], v[0:15]
    v_pk_fma_f32 v[40:41], v[246:247], v[238:239], v[40:41] op_sel:[0,0,0] op_sel_hi:[0,1,1] neg_lo:[1,0,0] neg_hi:[1,0,0]
    v_pk_mul_f32 v[40:41], v[246:247], v[40:41] op_sel:[1,0] op_sel_hi:[1,1]
    v_cvt_pk_bf16_f32 v140, v40, v41
    v_pk_fma_f32 v[42:43], v[246:247], v[240:241], v[42:43] op_sel:[0,0,0] op_sel_hi:[0,1,1] neg_lo:[1,0,0] neg_hi:[1,0,0]
    v_pk_mul_f32 v[42:43], v[246:247], v[42:43] op_sel:[1,0] op_sel_hi:[1,1]
    v_cvt_pk_bf16_f32 v141, v42, v43
    v_pk_fma_f32 v[44:45], v[246:247], v[242:243], v[44:45] op_sel:[0,0,0] op_sel_hi:[0,1,1] neg_lo:[1,0,0] neg_hi:[1,0,0]
    v_pk_mul_f32 v[44:45], v[246:247], v[44:45] op_sel:[1,0] op_sel_hi:[1,1]
    v_cvt_pk_bf16_f32 v142, v44, v45
    v_pk_fma_f32 v[46:47], v[246:247], v[244:245], v[46:47] op_sel:[0,0,0] op_sel_hi:[0,1,1] neg_lo:[1,0,0] neg_hi:[1,0,0]
    v_pk_mul_f32 v[46:47], v[246:247], v[46:47] op_sel:[1,0] op_sel_hi:[1,1]
    v_cvt_pk_bf16_f32 v143, v46, v47
    v_mfma_f32_32x32x16_bf16 v[16:31], a[132:135], v[164:167], v[16:31]
    v_pk_fma_f32 v[56:57], v[248:249], v[238:239], v[56:57] op_sel:[0,0,0] op_sel_hi:[0,1,1] neg_lo:[1,0,0] neg_hi:[1,0,0]
    v_pk_mul_f32 v[56:57], v[248:249], v[56:57] op_sel:[1,0] op_sel_hi:[1,1]
    v_cvt_pk_bf16_f32 v172, v56, v57
    v_pk_fma_f32 v[58:59], v[248:249], v[240:241], v[58:59] op_sel:[0,0,0] op_sel_hi:[0,1,1] neg_lo:[1,0,0] neg_hi:[1,0,0]
    v_pk_mul_f32 v[58:59], v[248:249], v[58:59] op_sel:[1,0] op_sel_hi:[1,1]
    v_cvt_pk_bf16_f32 v173, v58, v59
    v_pk_fma_f32 v[60:61], v[248:249], v[242:243], v[60:61] op_sel:[0,0,0] op_sel_hi:[0,1,1] neg_lo:[1,0,0] neg_hi:[1,0,0]
    v_pk_mul_f32 v[60:61], v[248:249], v[60:61] op_sel:[1,0] op_sel_hi:[1,1]
    v_cvt_pk_bf16_f32 v174, v60, v61
    v_pk_fma_f32 v[62:63], v[248:249], v[244:245], v[62:63] op_sel:[0,0,0] op_sel_hi:[0,1,1] neg_lo:[1,0,0] neg_hi:[1,0,0]
    v_pk_mul_f32 v[62:63], v[248:249], v[62:63] op_sel:[1,0] op_sel_hi:[1,1]
    v_cvt_pk_bf16_f32 v175, v62, v63
    ds_read_b128 v[238:241], v221 offset:320
    ds_read_b128 v[242:245], v221 offset:336
    ds_read_b128 a[132:135], v206 offset:8192
    s_cmp_eq_u32 s48, 2
    s_cbranch_scc1 L_ka_o_do26
L_ka_o_rt26:
    s_waitcnt lgkmcnt(4)
    v_mfma_f32_32x32x16_bf16 v[0:15], a[136:139], v[136:139], v[0:15]
    v_pk_fma_f32 v[64:65], v[246:247], v[224:225], v[64:65] op_sel:[0,0,0] op_sel_hi:[0,1,1] neg_lo:[1,0,0] neg_hi:[1,0,0]
    v_pk_mul_f32 v[64:65], v[246:247], v[64:65] op_sel:[1,0] op_sel_hi:[1,1]
    v_cvt_pk_bf16_f32 v144, v64, v65
    v_pk_fma_f32 v[66:67], v[246:247], v[226:227], v[66:67] op_sel:[0,0,0] op_sel_hi:[0,1,1] neg_lo:[1,0,0] neg_hi:[1,0,0]
    v_pk_mul_f32 v[66:67], v[246:247], v[66:67] op_sel:[1,0] op_sel_hi:[1,1]
    v_cvt_pk_bf16_f32 v145, v66, v67
    v_pk_fma_f32 v[68:69], v[246:247], v[228:229], v[68:69] op_sel:[0,0,0] op_sel_hi:[0,1,1] neg_lo:[1,0,0] neg_hi:[1,0,0]
    v_pk_mul_f32 v[68:69], v[246:247], v[68:69] op_sel:[1,0] op_sel_hi:[1,1]
    v_cvt_pk_bf16_f32 v146, v68, v69
    v_pk_fma_f32 v[70:71], v[246:247], v[230:231], v[70:71] op_sel:[0,0,0] op_sel_hi:[0,1,1] neg_lo:[1,0,0] neg_hi:[1,0,0]
    v_pk_mul_f32 v[70:71], v[246:247], v[70:71] op_sel:[1,0] op_sel_hi:[1,1]
    v_cvt_pk_bf16_f32 v147, v70, v71
    v_mfma_f32_32x32x16_bf16 v[16:31], a[136:139], v[168:171], v[16:31]
    v_pk_fma_f32 v[80:81], v[248:249], v[224:225], v[80:81] op_sel:[0,0,0] op_sel_hi:[0,1,1] neg_lo:[1,0,0] neg_hi:[1,0,0]
    v_pk_mul_f32 v[80:81], v[248:249], v[80:81] op_sel:[1,0] op_sel_hi:[1,1]
    v_cvt_pk_bf16_f32 v176, v80, v81
    v_pk_fma_f32 v[82:83], v[248:249], v[226:227], v[82:83] op_sel:[0,0,0] op_sel_hi:[0,1,1] neg_lo:[1,0,0] neg_hi:[1,0,0]
    v_pk_mul_f32 v[82:83], v[248:249], v[82:83] op_sel:[1,0] op_sel_hi:[1,1]
    v_cvt_pk_bf16_f32 v177, v82, v83
    v_pk_fma_f32 v[84:85], v[248:249], v[228:229], v[84:85] op_sel:[0,0,0] op_sel_hi:[0,1,1] neg_lo:[1,0,0] neg_hi:[1,0,0]
    v_pk_mul_f32 v[84:85], v[248:249], v[84:85] op_sel:[1,0] op_sel_hi:[1,1]
    v_cvt_pk_bf16_f32 v178, v84, v85
    v_pk_fma_f32 v[86:87], v[248:249], v[230:231], v[86:87] op_sel:[0,0,0] op_sel_hi:[0,1,1] neg_lo:[1,0,0] neg_hi:[1,0,0]
    v_pk_mul_f32 v[86:87], v[248:249], v[86:87] op_sel:[1,0] op_sel_hi:[1,1]
    v_cvt_pk_bf16_f32 v179, v86, v87
    ds_read_b128 v[224:227], v221 offset:384
    ds_read_b128 v[228:231], v221 offset:400
    ds_read_b128 a[136:139], v207 offset:8192
    s_waitcnt lgkmcnt(4)
    v_mfma_f32_32x32x16_bf16 v[0:15], a[140:143], v[140:143], v[0:15]
    v_pk_fma_f32 v[72:73], v[246:247], v[238:239], v[72:73] op_sel:[0,0,0] op_sel_hi:[0,1,1] neg_lo:[1,0,0] neg_hi:[1,0,0]
    v_pk_mul_f32 v[72:73], v[246:247], v[72:73] op_sel:[1,0] op_sel_hi:[1,1]
    v_cvt_pk_bf16_f32 v148, v72, v73
    v_pk_fma_f32 v[74:75], v[246:247], v[240:241], v[74:75] op_sel:[0,0,0] op_sel_hi:[0,1,1] neg_lo:[1,0,0] neg_hi:[1,0,0]
    v_pk_mul_f32 v[74:75], v[246:247], v[74:75] op_sel:[1,0] op_sel_hi:[1,1]
    v_cvt_pk_bf16_f32 v149, v74, v75
    v_pk_fma_f32 v[76:77], v[246:247], v[242:243], v[76:77] op_sel:[0,0,0] op_sel_hi:[0,1,1] neg_lo:[1,0,0] neg_hi:[1,0,0]
    v_pk_mul_f32 v[76:77], v[246:247], v[76:77] op_sel:[1,0] op_sel_hi:[1,1]
    v_cvt_pk_bf16_f32 v150, v76, v77
    v_pk_fma_f32 v[78:79], v[246:247], v[244:245], v[78:79] op_sel:[0,0,0] op_sel_hi:[0,1,1] neg_lo:[1,0,0] neg_hi:[1,0,0]
    v_pk_mul_f32 v[78:79], v[246:247], v[78:79] op_sel:[1,0] op_sel_hi:[1,1]
    v_cvt_pk_bf16_f32 v151, v78, v79
    v_mfma_f32_32x32x16_bf16 v[16:31], a[140:143], v[172:175], v[16:31]
    v_pk_fma_f32 v[88:89], v[248:249], v[238:239], v[88:89] op_sel:[0,0,0] op_sel_hi:[0,1,1] neg_lo:[1,0,0] neg_hi:[1,0,0]
    v_pk_mul_f32 v[88:89], v[248:249], v[88:89] op_sel:[1,0] op_sel_hi:[1,1]
    v_cvt_pk_bf16_f32 v180, v88, v89
    v_pk_fma_f32 v[90:91], v[248:249], v[240:241], v[90:91] op_sel:[0,0,0] op_sel_hi:[0,1,1] neg_lo:[1,0,0] neg_hi:[1,0,0]
    v_pk_mul_f32 v[90:91], v[248:249], v[90:91] op_sel:[1,0] op_sel_hi:[1,1]
    v_cvt_pk_bf16_f32 v181, v90, v91
    v_pk_fma_f32 v[92:93], v[248:249], v[242:243], v[92:93] op_sel:[0,0,0] op_sel_hi:[0,1,1] neg_lo:[1,0,0] neg_hi:[1,0,0]
    v_pk_mul_f32 v[92:93], v[248:249], v[92:93] op_sel:[1,0] op_sel_hi:[1,1]
    v_cvt_pk_bf16_f32 v182, v92, v93
    v_pk_fma_f32 v[94:95], v[248:249], v[244:245], v[94:95] op_sel:[0,0,0] op_sel_hi:[0,1,1] neg_lo:[1,0,0] neg_hi:[1,0,0]
    v_pk_mul_f32 v[94:95], v[248:249], v[94:95] op_sel:[1,0] op_sel_hi:[1,1]
    v_cvt_pk_bf16_f32 v183, v94, v95
    ds_read_b128 v[238:241], v221 offset:448
    ds_read_b128 v[242:245], v221 offset:464
    ds_read_b128 a[140:143], v208 offset:8192
    s_waitcnt lgkmcnt(4)
    v_mfma_f32_32x32x16_bf16 v[0:15], a[144:147], v[144:147], v[0:15]
    v_pk_fma_f32 v[96:97], v[246:247], v[224:225], v[96:97] op_sel:[0,0,0] op_sel_hi:[0,1,1] neg_lo:[1,0,0] neg_hi:[1,0,0]
    v_pk_mul_f32 v[96:97], v[246:247], v[96:97] op_sel:[1,0] op_sel_hi:[1,1]
    v_cvt_pk_bf16_f32 v152, v96, v97
    v_pk_fma_f32 v[98:99], v[246:247], v[226:227], v[98:99] op_sel:[0,0,0] op_sel_hi:[0,1,1] neg_lo:[1,0,0] neg_hi:[1,0,0]
    v_pk_mul_f32 v[98:99], v[246:247], v[98:99] op_sel:[1,0] op_sel_hi:[1,1]
    v_cvt_pk_bf16_f32 v153, v98, v99
    v_pk_fma_f32 v[100:101], v[246:247], v[228:229], v[100:101] op_sel:[0,0,0] op_sel_hi:[0,1,1] neg_lo:[1,0,0] neg_hi:[1,0,0]
    v_pk_mul_f32 v[100:101], v[246:247], v[100:101] op_sel:[1,0] op_sel_hi:[1,1]
    v_cvt_pk_bf16_f32 v154, v100, v101
    v_pk_fma_f32 v[102:103], v[246:247], v[230:231], v[102:103] op_sel:[0,0,0] op_sel_hi:[0,1,1] neg_lo:[1,0,0] neg_hi:[1,0,0]
    v_pk_mul_f32 v[102:103], v[246:247], v[102:103] op_sel:[1,0] op_sel_hi:[1,1]
    v_cvt_pk_bf16_f32 v155, v102, v103
    v_mfma_f32_32x32x16_bf16 v[16:31], a[144:147], v[176:179], v[16:31]
    v_pk_fma_f32 v[112:113], v[248:249], v[224:225], v[112:113] op_sel:[0,0,0] op_sel_hi:[0,1,1] neg_lo:[1,0,0] neg_hi:[1,0,0]
    v_pk_mul_f32 v[112:113], v[248:249], v[112:113] op_sel:[1,0] op_sel_hi:[1,1]
    v_cvt_pk_bf16_f32 v184, v112, v113
    v_pk_fma_f32 v[114:115], v[248:249], v[226:227], v[114:115] op_sel:[0,0,0] op_sel_hi:[0,1,1] neg_lo:[1,0,0] neg_hi:[1,0,0]
    v_pk_mul_f32 v[114:115], v[248:249], v[114:115] op_sel:[1,0] op_sel_hi:[1,1]
    v_cvt_pk_bf16_f32 v185, v114, v115
    v_pk_fma_f32 v[116:117], v[248:249], v[228:229], v[116:117] op_sel:[0,0,0] op_sel_hi:[0,1,1] neg_lo:[1,0,0] neg_hi:[1,0,0]
    v_pk_mul_f32 v[116:117], v[248:249], v[116:117] op_sel:[1,0] op_sel_hi:[1,1]
    v_cvt_pk_bf16_f32 v186, v116, v117
    v_pk_fma_f32 v[118:119], v[248:249], v[230:231], v[118:119] op_sel:[0,0,0] op_sel_hi:[0,1,1] neg_lo:[1,0,0] neg_hi:[1,0,0]
    v_pk_mul_f32 v[118:119], v[248:249], v[118:119] op_sel:[1,0] op_sel_hi:[1,1]
    v_cvt_pk_bf16_f32 v187, v118, v119
    ds_read_b128 a[144:147], v209 offset:8192
    s_waitcnt lgkmcnt(2)
    v_mfma_f32_32x32x16_bf16 v[0:15], a[148:151], v[148:151], v[0:15]
    v_pk_fma_f32 v[104:105], v[246:247], v[238:239], v[104:105] op_sel:[0,0,0] op_sel_hi:[0,1,1] neg_lo:[1,0,0] neg_hi:[1,0,0]
    v_pk_mul_f32 v[104:105], v[246:247], v[104:105] op_sel:[1,0] op_sel_hi:[1,1]
    v_cvt_pk_bf16_f32 v156, v104, v105
    v_pk_fma_f32 v[106:107], v[246:247], v[240:241], v[106:107] op_sel:[0,0,0] op_sel_hi:[0,1,1] neg_lo:[1,0,0] neg_hi:[1,0,0]
    v_pk_mul_f32 v[106:107], v[246:247], v[106:107] op_sel:[1,0] op_sel_hi:[1,1]
    v_cvt_pk_bf16_f32 v157, v106, v107
    v_pk_fma_f32 v[108:109], v[246:247], v[242:243], v[108:109] op_sel:[0,0,0] op_sel_hi:[0,1,1] neg_lo:[1,0,0] neg_hi:[1,0,0]
    v_pk_mul_f32 v[108:109], v[246:247], v[108:109] op_sel:[1,0] op_sel_hi:[1,1]
    v_cvt_pk_bf16_f32 v158, v108, v109
    v_pk_fma_f32 v[110:111], v[246:247], v[244:245], v[110:111] op_sel:[0,0,0] op_sel_hi:[0,1,1] neg_lo:[1,0,0] neg_hi:[1,0,0]
    v_pk_mul_f32 v[110:111], v[246:247], v[110:111] op_sel:[1,0] op_sel_hi:[1,1]
    v_cvt_pk_bf16_f32 v159, v110, v111
    v_mfma_f32_32x32x16_bf16 v[16:31], a[148:151], v[180:183], v[16:31]
    v_pk_fma_f32 v[120:121], v[248:249], v[238:239], v[120:121] op_sel:[0,0,0] op_sel_hi:[0,1,1] neg_lo:[1,0,0] neg_hi:[1,0,0]
    v_pk_mul_f32 v[120:121], v[248:249], v[120:121] op_sel:[1,0] op_sel_hi:[1,1]
    v_cvt_pk_bf16_f32 v188, v120, v121
    v_pk_fma_f32 v[122:123], v[248:249], v[240:241], v[122:123] op_sel:[0,0,0] op_sel_hi:[0,1,1] neg_lo:[1,0,0] neg_hi:[1,0,0]
    v_pk_mul_f32 v[122:123], v[248:249], v[122:123] op_sel:[1,0] op_sel_hi:[1,1]
    v_cvt_pk_bf16_f32 v189, v122, v123
    v_pk_fma_f32 v[124:125], v[248:249], v[242:243], v[124:125] op_sel:[0,0,0] op_sel_hi:[0,1,1] neg_lo:[1,0,0] neg_hi:[1,0,0]
    v_pk_mul_f32 v[124:125], v[248:249], v[124:125] op_sel:[1,0] op_sel_hi:[1,1]
    v_cvt_pk_bf16_f32 v190, v124, v125
    v_pk_fma_f32 v[126:127], v[248:249], v[244:245], v[126:127] op_sel:[0,0,0] op_sel_hi:[0,1,1] neg_lo:[1,0,0] neg_hi:[1,0,0]
    v_pk_mul_f32 v[126:127], v[248:249], v[126:127] op_sel:[1,0] op_sel_hi:[1,1]
    v_cvt_pk_bf16_f32 v191, v126, v127
    ds_read_b128 a[148:151], v210 offset:8192
    s_cmp_eq_u32 s48, 3
    s_cbranch_scc1 L_ka_o_do27
L_ka_o_rt27:
    v_mfma_f32_32x32x16_bf16 v[0:15], a[152:155], v[152:155], v[0:15]
    v_mfma_f32_32x32x16_bf16 v[16:31], a[152:155], v[184:187], v[16:31]
    ds_read_b128 a[152:155], v211 offset:8192
    s_add_u32 s35, s35, 8192
    s_add_u32 m0, s38, 0xe000
    s_nop 0
    buffer_load_dwordx4 v213, s[16:19], s35 offen offset:0 lds
    buffer_load_dwordx4 v214, s[16:19], s35 offen offset:1024 lds
    v_mfma_f32_32x32x16_bf16 v[0:15], a[156:159], v[156:159], v[0:15]
    v_mfma_f32_32x32x16_bf16 v[16:31], a[156:159], v[188:191], v[16:31]
    ds_read_b128 a[156:159], v212 offset:8192
    s_add_u32 s36, s36, 8192
    s_add_u32 m0, s39, 0x6000
    s_nop 0
    buffer_load_dwordx4 v215, s[20:23], s36 offen offset:0 lds
    buffer_load_dwordx4 v215, s[20:23], s36 offen offset:1024 lds
    s_nop 4
    v_max3_f32 v220, v0, v1, v2
    v_max3_f32 v220, v220, v3, v4
    v_max3_f32 v220, v220, v5, v6
    v_max3_f32 v220, v220, v7, v8
    v_max3_f32 v220, v220, v9, v10
    v_max3_f32 v220, v220, v11, v12
    v_max3_f32 v220, v220, v13, v14
    v_max_f32 v220, v220, v15
    v_mov_b32 v222, v220
    v_max3_f32 v221, v16, v17, v18
    v_max3_f32 v221, v221, v19, v20
    v_max3_f32 v221, v221, v21, v22
    v_max3_f32 v221, v221, v23, v24
    v_max3_f32 v221, v221, v25, v26
    v_max3_f32 v221, v221, v27, v28
    v_max3_f32 v221, v221, v29, v30
    v_max_f32 v221, v221, v31
    v_mov_b32 v223, v221
    v_permlane32_swap_b32 v220, v222
    s_nop 0
    v_permlane32_swap_b32 v221, v223
    v_max_f32 v220, v220, v222
    v_mov_b32 v216, 0
    v_max_f32 v221, v221, v223
    v_mov_b32 v217, 0
    v_pk_mul_f32 v[96:97], v[220:221], -1.0 op_sel:[0,0] op_sel_hi:[0,0]
    v_pk_mul_f32 v[98:99], v[220:221], -1.0 op_sel:[0,0] op_sel_hi:[0,0]
    v_pk_mul_f32 v[100:101], v[220:221], -1.0 op_sel:[0,0] op_sel_hi:[0,0]
    v_pk_mul_f32 v[102:103], v[220:221], -1.0 op_sel:[0,0] op_sel_hi:[0,0]
    v_pk_mul_f32 v[104:105], v[220:221], -1.0 op_sel:[0,0] op_sel_hi:[0,0]
    v_pk_mul_f32 v[106:107], v[220:221], -1.0 op_sel:[0,0] op_sel_hi:[0,0]
    v_pk_mul_f32 v[108:109], v[220:221], -1.0 op_sel:[0,0] op_sel_hi:[0,0]
    v_pk_mul_f32 v[110:111], v[220:221], -1.0 op_sel:[0,0] op_sel_hi:[0,0]
    v_pk_mul_f32 v[112:113], v[220:221], -1.0 op_sel:[1,0] op_sel_hi:[1,0]
    v_pk_mul_f32 v[114:115], v[220:221], -1.0 op_sel:[1,0] op_sel_hi:[1,0]
    v_pk_mul_f32 v[116:117], v[220:221], -1.0 op_sel:[1,0] op_sel_hi:[1,0]
    v_pk_mul_f32 v[118:119], v[220:221], -1.0 op_sel:[1,0] op_sel_hi:[1,0]
    v_pk_mul_f32 v[120:121], v[220:221], -1.0 op_sel:[1,0] op_sel_hi:[1,0]
    v_pk_mul_f32 v[122:123], v[220:221], -1.0 op_sel:[1,0] op_sel_hi:[1,0]
    v_pk_mul_f32 v[124:125], v[220:221], -1.0 op_sel:[1,0] op_sel_hi:[1,0]
    v_pk_mul_f32 v[126:127], v[220:221], -1.0 op_sel:[1,0] op_sel_hi:[1,0]
    v_pk_add_f32 v[0:1], v[0:1], v[96:97]
    v_pk_add_f32 v[2:3], v[2:3], v[96:97]
    v_pk_add_f32 v[4:5], v[4:5], v[96:97]
    v_pk_add_f32 v[6:7], v[6:7], v[96:97]
    v_pk_add_f32 v[8:9], v[8:9], v[96:97]
    v_pk_add_f32 v[10:11], v[10:11], v[96:97]
    v_pk_add_f32 v[12:13], v[12:13], v[96:97]
    v_pk_add_f32 v[14:15], v[14:15], v[96:97]
    v_pk_add_f32 v[16:17], v[16:17], v[112:113]
    v_pk_add_f32 v[18:19], v[18:19], v[112:113]
    v_pk_add_f32 v[20:21], v[20:21], v[112:113]
    v_pk_add_f32 v[22:23], v[22:23], v[112:113]
    v_pk_add_f32 v[24:25], v[24:25], v[112:113]
    v_pk_add_f32 v[26:27], v[26:27], v[112:113]
    v_pk_add_f32 v[28:29], v[28:29], v[112:113]
    v_pk_add_f32 v[30:31], v[30:31], v[112:113]
    s_barrier
    s_waitcnt lgkmcnt(3)
    v_mfma_f32_32x32x16_bf16 v[32:47], a[128:131], v[128:131], v[96:111]
    v_lshrrev_b32 v251, 1, v233
    v_and_b32 v252, 1, v233
    v_lshlrev_b32 v252, 4, v252
    s_movk_i32 s3, 7168
    v_mad_u32_u24 v192, v251, s3, v252
    v_xor_b32 v251, 4, v251
    v_mad_u32_u24 v193, v251, s3, v252
    v_lshrrev_b32 v251, 5, v233
    v_and_b32 v252, 31, v233
    v_lshlrev_b32 v253, 2, v251
    v_xor_b32 v252, v252, v253
    v_lshlrev_b32 v252, 4, v252
    v_lshl_add_u32 v194, v251, 11, v252
    v_xor_b32 v225, 0x80, v194
    s_and_b32 s3, s2, 7
    s_mul_i32 s37, s3, 28
    s_lshr_b32 s3, s2, 3
    s_add_u32 s37, s37, s3
    s_cmp_lt_u32 s3, 28
    s_cselect_b32 s37, s37, 0x4000
    s_mul_i32 s32, s28, 1835008
    s_lshl_b32 s3, s37, 5
    s_add_u32 s32, s32, s3
    s_lshl_b32 s33, s37, 15
    s_lshl_b32 s3, s28, 9
    s_add_u32 s33, s33, s3
    s_cmp_lt_u32 s37, 224
    s_cselect_b32 s32, s32, 0x40000000
    s_lshl_b32 s34, s28, 13
    s_add_u32 s34, s34, 0x10000
    v_lshrrev_b32 v251, 5, v233
    v_bfe_u32 v252, v233, 2, 2
    v_lshl_add_u32 v253, v251, 3, v252
    v_bfe_u32 v254, v233, 4, 1
    v_lshlrev_b32 v195, 5, v253
    v_mul_u32_u24 v254, 4224, v254
    v_add_u32 v195, v195, v254
    v_and_b32 v254, 3, v233
    v_lshl_add_u32 v195, v254, 3, v195
    v_add_u32 v195, s34, v195
    v_lshlrev_b32 v253, 9, v253
    v_bfe_u32 v254, v233, 4, 1
    v_lshl_add_u32 v253, v254, 5, v253
    v_and_b32 v254, 3, v233
    v_lshl_add_u32 v253, v254, 3, v253
    v_add_u32 v253, s34, v253
    v_xor_b32 v254, 0, v252
    v_lshl_add_u32 v197, v254, 6, v253
    v_xor_b32 v254, 1, v252
    v_lshl_add_u32 v198, v254, 6, v253
    v_xor_b32 v254, 2, v252
    v_lshl_add_u32 v199, v254, 6, v253
    v_xor_b32 v254, 3, v252
    v_lshl_add_u32 v200, v254, 6, v253
    s_lshl_b32 s3, s28, 9
    s_add_u32 s3, s3, 0xc000
    v_lshl_add_u32 v224, v251, 4, s3
    v_lshl_add_u32 v232, v233, 3, s3
    s_lshl_b32 s3, s43, 11
    s_lshl_b32 s31, s28, 9
    s_add_u32 s3, s3, s31
    v_lshlrev_b32 v251, 3, v233
    buffer_load_dwordx2 v[226:227], v251, s[12:15], s3 offen
    s_lshl_b32 s3, s43, 3
    v_mov_b32 v252, s3
    buffer_load_dwordx2 v[228:229], v252, s[52:55], 0 offen sc1
    v_exp_f32 v220, v0
    v_exp_f32 v221, v1
    v_exp_f32 v222, v2
    v_add_f32 v218, v220, v221
    v_cvt_pk_bf16_f32 v64, v220, v221
    v_exp_f32 v223, v3
    v_mfma_f32_32x32x16_bf16 v[48:63], a[128:131], v[160:163], v[112:127]
    ds_read_b128 a[128:131], v205 offset:16384
    v_add_f32 v218, v218, v222
    v_exp_f32 v220, v4
    v_add_f32 v218, v218, v223
    v_cvt_pk_bf16_f32 v65, v222, v223
    v_exp_f32 v221, v5
    v_add_f32 v218, v218, v220
    v_exp_f32 v222, v6
    v_add_f32 v218, v218, v221
    v_cvt_pk_bf16_f32 v66, v220, v221
    v_mfma_f32_32x32x16_bf16 v[32:47], a[132:135], v[132:135], v[32:47]
    ds_read_b64_tr_b16 a[160:161], v201 offset:8192
    ds_read_b64_tr_b16 a[162:163], v201 offset:9216
    v_exp_f32 v223, v7
    v_add_f32 v218, v218, v222
    v_exp_f32 v220, v8
    v_add_f32 v218, v218, v223
    v_cvt_pk_bf16_f32 v67, v222, v223
    v_exp_f32 v221, v9
    v_add_f32 v218, v218, v220
    v_mfma_f32_32x32x16_bf16 v[48:63], a[132:135], v[164:167], v[48:63]
    ds_read_b128 a[132:135], v206 offset:16384
    v_exp_f32 v222, v10
    v_add_f32 v218, v218, v221
    v_cvt_pk_bf16_f32 v68, v220, v221
    v_exp_f32 v223, v11
    v_add_f32 v218, v218, v222
    v_exp_f32 v220, v12
    v_add_f32 v218, v218, v223
    v_cvt_pk_bf16_f32 v69, v222, v223
    v_mfma_f32_32x32x16_bf16 v[32:47], a[136:139], v[136:139], v[32:47]
    ds_read_b64_tr_b16 a[164:165], v201 offset:12288
    ds_read_b64_tr_b16 a[166:167], v201 offset:13312
    s_mov_b32 s60, s4
    s_mov_b32 s61, s5
    s_mov_b32 s62, 0x800000
    s_mov_b32 s63, 0x00020000
    v_exp_f32 v221, v13
    v_add_f32 v218, v218, v220
    v_exp_f32 v222, v14
    v_add_f32 v218, v218, v221
    v_cvt_pk_bf16_f32 v70, v220, v221
    v_mfma_f32_32x32x16_bf16 v[48:63], a[136:139], v[168:171], v[48:63]
    ds_read_b128 a[136:139], v207 offset:16384
    v_exp_f32 v223, v15
    v_add_f32 v218, v218, v222
    v_exp_f32 v220, v16
    v_add_f32 v218, v218, v223
    v_cvt_pk_bf16_f32 v71, v222, v223
    v_exp_f32 v221, v17
    v_exp_f32 v222, v18
    v_add_f32 v219, v220, v221
    v_mfma_f32_32x32x16_bf16 v[32:47], a[140:143], v[140:143], v[32:47]
    ds_read_b64_tr_b16 a[168:169], v202 offset:8192
    ds_read_b64_tr_b16 a[170:171], v202 offset:9216
    v_cvt_pk_bf16_f32 v72, v220, v221
    v_exp_f32 v223, v19
    v_add_f32 v219, v219, v222
    v_exp_f32 v220, v20
    v_add_f32 v219, v219, v223
    v_cvt_pk_bf16_f32 v73, v222, v223
    v_exp_f32 v221, v21
    v_add_f32 v219, v219, v220
    v_mfma_f32_32x32x16_bf16 v[48:63], a[140:143], v[172:175], v[48:63]
    ds_read_b128 a[140:143], v208 offset:16384
    v_exp_f32 v222, v22
    v_add_f32 v219, v219, v221
    v_cvt_pk_bf16_f32 v74, v220, v221
    v_exp_f32 v223, v23
    v_add_f32 v219, v219, v222
    v_exp_f32 v220, v24
    v_add_f32 v219, v219, v223
    v_cvt_pk_bf16_f32 v75, v222, v223
    s_waitcnt lgkmcnt(3)
    v_mfma_f32_32x32x16_bf16 v[32:47], a[144:147], v[144:147], v[32:47]
    ds_read_b64_tr_b16 a[172:173], v202 offset:12288
    ds_read_b64_tr_b16 a[174:175], v202 offset:13312
    s_mov_b32 s40, s32
    v_exp_f32 v221, v25
    v_add_f32 v219, v219, v220
    v_exp_f32 v222, v26
    v_add_f32 v219, v219, v221
    v_cvt_pk_bf16_f32 v76, v220, v221
    v_exp_f32 v223, v27
    v_add_f32 v219, v219, v222
    v_mfma_f32_32x32x16_bf16 v[48:63], a[144:147], v[176:179], v[48:63]
    ds_read_b128 a[144:147], v209 offset:16384
    v_exp_f32 v220, v28
    v_add_f32 v219, v219, v223
    v_cvt_pk_bf16_f32 v77, v222, v223
    v_exp_f32 v221, v29
    v_add_f32 v219, v219, v220
    v_exp_f32 v222, v30
    v_add_f32 v219, v219, v221
    v_cvt_pk_bf16_f32 v78, v220, v221
    v_mfma_f32_32x32x16_bf16 v[32:47], a[148:151], v[148:151], v[32:47]
    ds_read_b64_tr_b16 a[176:177], v203 offset:8192
    ds_read_b64_tr_b16 a[178:179], v203 offset:9216
    v_exp_f32 v223, v31
    v_add_f32 v219, v219, v222
    v_add_f32 v219, v219, v223
    v_cvt_pk_bf16_f32 v79, v222, v223
    v_mfma_f32_32x32x16_bf16 v[48:63], a[148:151], v[180:183], v[48:63]
    ds_read_b128 a[148:151], v210 offset:16384
    v_mfma_f32_32x32x16_bf16 v[32:47], a[152:155], v[152:155], v[32:47]
    ds_read_b64_tr_b16 a[180:181], v203 offset:12288
    ds_read_b64_tr_b16 a[182:183], v203 offset:13312
    s_cmp_eq_u32 s48, 4
    s_cbranch_scc1 L_ka_o_do28
L_ka_o_rt28:
    v_mfma_f32_32x32x16_bf16 v[48:63], a[152:155], v[184:187], v[48:63]
    ds_read_b128 a[152:155], v211 offset:16384
    v_mfma_f32_32x32x16_bf16 v[32:47], a[156:159], v[156:159], v[32:47]
    ds_read_b64_tr_b16 a[184:185], v204 offset:8192
    ds_read_b64_tr_b16 a[186:187], v204 offset:9216
    v_mfma_f32_32x32x16_bf16 v[48:63], a[156:159], v[188:191], v[48:63]
    ds_read_b128 a[156:159], v212 offset:16384
    ds_read_b64_tr_b16 a[188:189], v204 offset:12288
    ds_read_b64_tr_b16 a[190:191], v204 offset:13312
    v_add_f32 v216, v216, v218
    v_add_f32 v217, v217, v219
    s_waitcnt lgkmcnt(3)
    v_mfma_f32_32x32x16_bf16 v[0:15], a[128:131], v[128:131], v[96:111]
    s_cmp_eq_u32 s48, 5
    s_cbranch_scc1 L_ka_o_do29
L_ka_o_rt29:
    v_exp_f32 v220, v32
    v_mfma_f32_32x32x16_bf16 v[16:31], a[128:131], v[160:163], v[112:127]
    ds_read_b128 a[128:131], v205 offset:24576
    v_exp_f32 v221, v33
    v_exp_f32 v222, v34
    v_mfma_f32_32x32x16_bf16 a[0:15], a[160:163], v[64:67], 0
    s_add_u32 s35, s35, 8192
    s_add_u32 m0, s38, 0x0
    s_nop 0
    buffer_load_dwordx4 v213, s[16:19], s35 offen offset:0 lds
    v_add_f32 v218, v220, v221
    v_cvt_pk_bf16_f32 v80, v220, v221
    v_mfma_f32_32x32x16_bf16 a[16:31], a[160:163], v[72:75], 0
    ds_read_b64_tr_b16 a[160:161], v201 offset:32768
    ds_read_b64_tr_b16 a[162:163], v201 offset:33792
    v_exp_f32 v223, v35
    v_add_f32 v218, v218, v222
    v_mfma_f32_32x32x16_bf16 v[0:15], a[132:135], v[132:135], v[0:15]
    v_exp_f32 v220, v36
    v_add_f32 v218, v218, v223
    v_cvt_pk_bf16_f32 v81, v222, v223
    v_exp_f32 v221, v37
    v_mfma_f32_32x32x16_bf16 v[16:31], a[132:135], v[164:167], v[16:31]
    ds_read_b128 a[132:135], v206 offset:24576
    v_add_f32 v218, v218, v220
    v_exp_f32 v222, v38
    v_add_f32 v218, v218, v221
    v_mfma_f32_32x32x16_bf16 a[0:15], a[164:167], v[68:71], a[0:15]
    v_cvt_pk_bf16_f32 v82, v220, v221
    v_exp_f32 v223, v39
    v_add_f32 v218, v218, v222
    v_exp_f32 v220, v40
    v_mfma_f32_32x32x16_bf16 a[16:31], a[164:167], v[76:79], a[16:31]
    ds_read_b64_tr_b16 a[164:165], v201 offset:36864
    ds_read_b64_tr_b16 a[166:167], v201 offset:37888
    v_add_f32 v218, v218, v223
    v_cvt_pk_bf16_f32 v83, v222, v223
    v_mfma_f32_32x32x16_bf16 v[0:15], a[136:139], v[136:139], v[0:15]
    s_add_u32 m0, s38, 0x0
    s_nop 0
    buffer_load_dwordx4 v214, s[16:19], s35 offen offset:1024 lds
    v_exp_f32 v221, v41
    v_add_f32 v218, v218, v220
    v_mfma_f32_32x32x16_bf16 v[16:31], a[136:139], v[168:171], v[16:31]
    ds_read_b128 a[136:139], v207 offset:24576
    v_exp_f32 v222, v42
    v_add_f32 v218, v218, v221
    v_cvt_pk_bf16_f32 v84, v220, v221
    v_mfma_f32_32x32x16_bf16 a[32:47], a[168:171], v[64:67], 0
    s_add_u32 m0, s34, 0
    s_nop 0
    buffer_load_dwordx4 v192, s[64:67], s32 offen lds
    s_add_u32 s32, s32, 229376
    v_exp_f32 v223, v43
    v_add_f32 v218, v218, v222
    v_mfma_f32_32x32x16_bf16 a[48:63], a[168:171], v[72:75], 0
    ds_read_b64_tr_b16 a[168:169], v202 offset:32768
    ds_read_b64_tr_b16 a[170:171], v202 offset:33792
    v_exp_f32 v220, v44
    v_add_f32 v218, v218, v223
    v_mfma_f32_32x32x16_bf16 v[0:15], a[140:143], v[140:143], v[0:15]
    v_cvt_pk_bf16_f32 v85, v222, v223
    v_exp_f32 v221, v45
    v_add_f32 v218, v218, v220
    v_exp_f32 v222, v46
    v_mfma_f32_32x32x16_bf16 v[16:31], a[140:143], v[172:175], v[16:31]
    ds_read_b128 a[140:143], v208 offset:24576
    v_add_f32 v218, v218, v221
    v_cvt_pk_bf16_f32 v86, v220, v221
    v_exp_f32 v223, v47
    v_mfma_f32_32x32x16_bf16 a[32:47], a[172:175], v[68:71], a[32:47]
    v_add_f32 v218, v218, v222
    v_exp_f32 v220, v48
    v_add_f32 v218, v218, v223
    v_cvt_pk_bf16_f32 v87, v222, v223
    v_mfma_f32_32x32x16_bf16 a[48:63], a[172:175], v[76:79], a[48:63]
    ds_read_b64_tr_b16 a[172:173], v202 offset:36864
    ds_read_b64_tr_b16 a[174:175], v202 offset:37888
    v_exp_f32 v221, v49
    s_waitcnt lgkmcnt(3)
    v_mfma_f32_32x32x16_bf16 v[0:15], a[144:147], v[144:147], v[0:15]
    v_exp_f32 v222, v50
    v_add_f32 v219, v220, v221
    v_cvt_pk_bf16_f32 v88, v220, v221
    v_exp_f32 v223, v51
    v_mfma_f32_32x32x16_bf16 v[16:31], a[144:147], v[176:179], v[16:31]
    ds_read_b128 a[144:147], v209 offset:24576
    v_add_f32 v219, v219, v222
    v_exp_f32 v220, v52
    v_add_f32 v219, v219, v223
    v_mfma_f32_32x32x16_bf16 a[64:79], a[176:179], v[64:67], 0
    v_cvt_pk_bf16_f32 v89, v222, v223
    v_exp_f32 v221, v53
    v_add_f32 v219, v219, v220
    v_exp_f32 v222, v54
    v_mfma_f32_32x32x16_bf16 a[80:95], a[176:179], v[72:75], 0
    ds_read_b64_tr_b16 a[176:177], v203 offset:32768
    ds_read_b64_tr_b16 a[178:179], v203 offset:33792
    v_add_f32 v219, v219, v221
    v_cvt_pk_bf16_f32 v90, v220, v221
    v_mfma_f32_32x32x16_bf16 v[0:15], a[148:151], v[148:151], v[0:15]
    v_exp_f32 v223, v55
    v_add_f32 v219, v219, v222
    v_exp_f32 v220, v56
    v_add_f32 v219, v219, v223
    v_mfma_f32_32x32x16_bf16 v[16:31], a[148:151], v[180:183], v[16:31]
    ds_read_b128 a[148:151], v210 offset:24576
    s_add_u32 m0, s34, 1024
    s_nop 0
    buffer_load_dwordx4 v192, s[64:67], s32 offen lds
    s_add_u32 s32, s32, 229376
    v_cvt_pk_bf16_f32 v91, v222, v223
    v_mfma_f32_32x32x16_bf16 a[64:79], a[180:183], v[68:71], a[64:79]
    v_exp_f32 v221, v57
    v_add_f32 v219, v219, v220
    v_exp_f32 v222, v58
    v_add_f32 v219, v219, v221
    v_mfma_f32_32x32x16_bf16 a[80:95], a[180:183], v[76:79], a[80:95]
    ds_read_b64_tr_b16 a[180:181], v203 offset:36864
    ds_read_b64_tr_b16 a[182:183], v203 offset:37888
    v_cvt_pk_bf16_f32 v92, v220, v221
    v_exp_f32 v223, v59
    v_mfma_f32_32x32x16_bf16 v[0:15], a[152:155], v[152:155], v[0:15]
    v_add_f32 v219, v219, v222
    v_exp_f32 v220, v60
    v_add_f32 v219, v219, v223
    v_cvt_pk_bf16_f32 v93, v222, v223
    v_mfma_f32_32x32x16_bf16 v[16:31], a[152:155], v[184:187], v[16:31]
    ds_read_b128 a[152:155], v211 offset:24576
    v_exp_f32 v221, v61
    v_add_f32 v219, v219, v220
    v_mfma_f32_32x32x16_bf16 a[96:111], a[184:187], v[64:67], 0
    v_exp_f32 v222, v62
    v_add_f32 v219, v219, v221
    v_cvt_pk_bf16_f32 v94, v220, v221
    v_exp_f32 v223, v63
    v_mfma_f32_32x32x16_bf16 a[112:127], a[184:187], v[72:75], 0
    ds_read_b64_tr_b16 a[184:185], v204 offset:32768
    ds_read_b64_tr_b16 a[186:187], v204 offset:33792
    v_add_f32 v219, v219, v222
    v_add_f32 v219, v219, v223
    v_cvt_pk_bf16_f32 v95, v222, v223
    v_mfma_f32_32x32x16_bf16 v[0:15], a[156:159], v[156:159], v[0:15]
    v_add_f32 v220, v218, v219
    v_cmp_nge_f32 s[94:95], s41, v220
    v_mfma_f32_32x32x16_bf16 v[16:31], a[156:159], v[188:191], v[16:31]
    ds_read_b128 a[156:159], v212 offset:24576
    v_mfma_f32_32x32x16_bf16 a[96:111], a[188:191], v[68:71], a[96:111]
    v_mfma_f32_32x32x16_bf16 a[112:127], a[188:191], v[76:79], a[112:127]
    ds_read_b64_tr_b16 a[188:189], v204 offset:36864
    ds_read_b64_tr_b16 a[190:191], v204 offset:37888
    s_cmp_lg_u64 s[94:95], 0
    s_cbranch_scc1 L_ka_trp1
L_ka_retp1:
    v_add_f32 v216, v216, v218
    v_add_f32 v217, v217, v219
    s_waitcnt vmcnt(16)
    s_barrier
    s_waitcnt lgkmcnt(3)
    v_mfma_f32_32x32x16_bf16 v[32:47], a[128:131], v[128:131], v[96:111]
    s_cmp_eq_u32 s48, 6
    s_cbranch_scc1 L_ka_o_do30
L_ka_o_rt30:
    v_exp_f32 v220, v0
    v_mfma_f32_32x32x16_bf16 v[48:63], a[128:131], v[160:163], v[112:127]
    ds_read_b128 a[128:131], v205 offset:32768
    v_exp_f32 v221, v1
    v_exp_f32 v222, v2
    v_mfma_f32_32x32x16_bf16 a[0:15], a[160:163], v[80:83], a[0:15]
    s_add_u32 s35, s35, 8192
    s_add_u32 m0, s38, 0x2000
    s_nop 0
    buffer_load_dwordx4 v213, s[16:19], s35 offen offset:0 lds
    v_add_f32 v218, v220, v221
    v_cvt_pk_bf16_f32 v64, v220, v221
    v_mfma_f32_32x32x16_bf16 a[16:31], a[160:163], v[88:91], a[16:31]
    ds_read_b64_tr_b16 a[160:161], v201 offset:57344
    ds_read_b64_tr_b16 a[162:163], v201 offset:58368
    v_exp_f32 v223, v3
    v_add_f32 v218, v218, v222
    v_mfma_f32_32x32x16_bf16 v[32:47], a[132:135], v[132:135], v[32:47]
    v_exp_f32 v220, v4
    v_add_f32 v218, v218, v223
    v_cvt_pk_bf16_f32 v65, v222, v223
    v_exp_f32 v221, v5
    v_mfma_f32_32x32x16_bf16 v[48:63], a[132:135], v[164:167], v[48:63]
    ds_read_b128 a[132:135], v206 offset:32768
    v_add_f32 v218, v218, v220
    v_exp_f32 v222, v6
    v_add_f32 v218, v218, v221
    v_mfma_f32_32x32x16_bf16 a[0:15], a[164:167], v[84:87], a[0:15]
    v_cvt_pk_bf16_f32 v66, v220, v221
    v_exp_f32 v223, v7
    v_add_f32 v218, v218, v222
    v_exp_f32 v220, v8
    v_mfma_f32_32x32x16_bf16 a[16:31], a[164:167], v[92:95], a[16:31]
    ds_read_b64_tr_b16 a[164:165], v201 offset:61440
    ds_read_b64_tr_b16 a[166:167], v201 offset:62464
    v_add_f32 v218, v218, v223
    v_cvt_pk_bf16_f32 v67, v222, v223
    v_mfma_f32_32x32x16_bf16 v[32:47], a[136:139], v[136:139], v[32:47]
    s_add_u32 m0, s38, 0x2000
    s_nop 0
    buffer_load_dwordx4 v214, s[16:19], s35 offen offset:1024 lds
    v_exp_f32 v221, v9
    v_add_f32 v218, v218, v220
    v_mfma_f32_32x32x16_bf16 v[48:63], a[136:139], v[168:171], v[48:63]
    ds_read_b128 a[136:139], v207 offset:32768
    v_exp_f32 v222, v10
    v_add_f32 v218, v218, v221
    v_cvt_pk_bf16_f32 v68, v220, v221
    v_mfma_f32_32x32x16_bf16 a[32:47], a[168:171], v[80:83], a[32:47]
    s_add_u32 m0, s34, 2048
    s_nop 0
    buffer_load_dwordx4 v192, s[64:67], s32 offen lds
    s_add_u32 s32, s32, 229376
    v_exp_f32 v223, v11
    v_add_f32 v218, v218, v222
    v_mfma_f32_32x32x16_bf16 a[48:63], a[168:171], v[88:91], a[48:63]
    ds_read_b64_tr_b16 a[168:169], v202 offset:57344
    ds_read_b64_tr_b16 a[170:171], v202 offset:58368
    v_exp_f32 v220, v12
    v_add_f32 v218, v218, v223
    v_mfma_f32_32x32x16_bf16 v[32:47], a[140:143], v[140:143], v[32:47]
    v_cvt_pk_bf16_f32 v69, v222, v223
    v_exp_f32 v221, v13
    v_add_f32 v218, v218, v220
    v_exp_f32 v222, v14
    v_mfma_f32_32x32x16_bf16 v[48:63], a[140:143], v[172:175], v[48:63]
    ds_read_b128 a[140:143], v208 offset:32768
    v_add_f32 v218, v218, v221
    v_cvt_pk_bf16_f32 v70, v220, v221
    v_exp_f32 v223, v15
    v_mfma_f32_32x32x16_bf16 a[32:47], a[172:175], v[84:87], a[32:47]
    v_add_f32 v218, v218, v222
    v_exp_f32 v220, v16
    v_add_f32 v218, v218, v223
    v_cvt_pk_bf16_f32 v71, v222, v223
    v_mfma_f32_32x32x16_bf16 a[48:63], a[172:175], v[92:95], a[48:63]
    ds_read_b64_tr_b16 a[172:173], v202 offset:61440
    ds_read_b64_tr_b16 a[174:175], v202 offset:62464
    v_exp_f32 v221, v17
    s_waitcnt lgkmcnt(3)
    v_mfma_f32_32x32x16_bf16 v[32:47], a[144:147], v[144:147], v[32:47]
    v_exp_f32 v222, v18
    v_add_f32 v219, v220, v221
    v_cvt_pk_bf16_f32 v72, v220, v221
    v_exp_f32 v223, v19
    v_mfma_f32_32x32x16_bf16 v[48:63], a[144:147], v[176:179], v[48:63]
    ds_read_b128 a[144:147], v209 offset:32768
    v_add_f32 v219, v219, v222
    v_exp_f32 v220, v20
    v_add_f32 v219, v219, v223
    v_mfma_f32_32x32x16_bf16 a[64:79], a[176:179], v[80:83], a[64:79]
    v_cvt_pk_bf16_f32 v73, v222, v223
    v_exp_f32 v221, v21
    v_add_f32 v219, v219, v220
    v_exp_f32 v222, v22
    v_mfma_f32_32x32x16_bf16 a[80:95], a[176:179], v[88:91], a[80:95]
    ds_read_b64_tr_b16 a[176:177], v203 offset:57344
    ds_read_b64_tr_b16 a[178:179], v203 offset:58368
    v_add_f32 v219, v219, v221
    v_cvt_pk_bf16_f32 v74, v220, v221
    v_mfma_f32_32x32x16_bf16 v[32:47], a[148:151], v[148:151], v[32:47]
    v_exp_f32 v223, v23
    v_add_f32 v219, v219, v222
    v_exp_f32 v220, v24
    v_add_f32 v219, v219, v223
    v_mfma_f32_32x32x16_bf16 v[48:63], a[148:151], v[180:183], v[48:63]
    ds_read_b128 a[148:151], v210 offset:32768
    s_add_u32 m0, s34, 3072
    s_nop 0
    buffer_load_dwordx4 v192, s[64:67], s32 offen lds
    s_add_u32 s32, s32, 229376
    v_cvt_pk_bf16_f32 v75, v222, v223
    v_mfma_f32_32x32x16_bf16 a[64:79], a[180:183], v[84:87], a[64:79]
    v_exp_f32 v221, v25
    v_add_f32 v219, v219, v220
    v_exp_f32 v222, v26
    v_add_f32 v219, v219, v221
    v_mfma_f32_32x32x16_bf16 a[80:95], a[180:183], v[92:95], a[80:95]
    ds_read_b64_tr_b16 a[180:181], v203 offset:61440
    ds_read_b64_tr_b16 a[182:183], v203 offset:62464
    v_cvt_pk_bf16_f32 v76, v220, v221
    v_exp_f32 v223, v27
    v_mfma_f32_32x32x16_bf16 v[32:47], a[152:155], v[152:155], v[32:47]
    v_add_f32 v219, v219, v222
    v_exp_f32 v220, v28
    v_add_f32 v219, v219, v223
    v_cvt_pk_bf16_f32 v77, v222, v223
    v_mfma_f32_32x32x16_bf16 v[48:63], a[152:155], v[184:187], v[48:63]
    ds_read_b128 a[152:155], v211 offset:32768
    v_exp_f32 v221, v29
    v_add_f32 v219, v219, v220
    v_mfma_f32_32x32x16_bf16 a[96:111], a[184:187], v[80:83], a[96:111]
    v_exp_f32 v222, v30
    v_add_f32 v219, v219, v221
    v_cvt_pk_bf16_f32 v78, v220, v221
    v_exp_f32 v223, v31
    v_mfma_f32_32x32x16_bf16 a[112:127], a[184:187], v[88:91], a[112:127]
    ds_read_b64_tr_b16 a[184:185], v204 offset:57344
    ds_read_b64_tr_b16 a[186:187], v204 offset:58368
    v_add_f32 v219, v219, v222
    v_add_f32 v219, v219, v223
    v_cvt_pk_bf16_f32 v79, v222, v223
    v_mfma_f32_32x32x16_bf16 v[32:47], a[156:159], v[156:159], v[32:47]
    v_add_f32 v220, v218, v219
    v_cmp_nge_f32 s[94:95], s41, v220
    v_mfma_f32_32x32x16_bf16 v[48:63], a[156:159], v[188:191], v[48:63]
    ds_read_b128 a[156:159], v212 offset:32768
    v_mfma_f32_32x32x16_bf16 a[96:111], a[188:191], v[84:87], a[96:111]
    v_mfma_f32_32x32x16_bf16 a[112:127], a[188:191], v[92:95], a[112:127]
    ds_read_b64_tr_b16 a[188:189], v204 offset:61440
    ds_read_b64_tr_b16 a[190:191], v204 offset:62464
    s_cmp_lg_u64 s[94:95], 0
    s_cbranch_scc1 L_ka_trp2
L_ka_retp2:
    v_add_f32 v216, v216, v218
    v_add_f32 v217, v217, v219
    s_waitcnt lgkmcnt(3)
    v_mfma_f32_32x32x16_bf16 v[0:15], a[128:131], v[128:131], v[96:111]
    s_cmp_eq_u32 s48, 7
    s_cbranch_scc1 L_ka_o_do31
L_ka_o_rt31:
    v_exp_f32 v220, v32
    v_mfma_f32_32x32x16_bf16 v[16:31], a[128:131], v[160:163], v[112:127]
    ds_read_b128 a[128:131], v205 offset:40960
    s_waitcnt vmcnt(8)
    v_mfma_f32_32x32x16_bf16 a[0:15], a[160:163], v[64:67], a[0:15]
    s_add_u32 s35, s35, 8192
    s_add_u32 m0, s38, 0x4000
    s_nop 0
    buffer_load_dwordx4 v213, s[16:19], s35 offen offset:0 lds
    v_lshlrev_b32 v251, 16, v226
    v_exp_f32 v221, v33
    v_mfma_f32_32x32x16_bf16 a[16:31], a[160:163], v[72:75], a[16:31]
    ds_read_b64_tr_b16 a[160:161], v201 offset:16384
    ds_read_b64_tr_b16 a[162:163], v201 offset:17408
    v_exp_f32 v222, v34
    v_add_f32 v218, v220, v221
    v_mfma_f32_32x32x16_bf16 v[0:15], a[132:135], v[132:135], v[0:15]
    v_and_b32 v252, s49, v226
    v_cvt_pk_bf16_f32 v80, v220, v221
    v_exp_f32 v223, v35
    v_add_f32 v218, v218, v222
    v_mfma_f32_32x32x16_bf16 v[16:31], a[132:135], v[164:167], v[16:31]
    ds_read_b128 a[132:135], v206 offset:40960
    v_sub_f32 v251, v251, v228
    v_exp_f32 v220, v36
    v_add_f32 v218, v218, v223
    v_mfma_f32_32x32x16_bf16 a[0:15], a[164:167], v[68:71], a[0:15]
    v_sub_f32 v252, v252, v228
    v_cvt_pk_bf16_f32 v81, v222, v223
    v_exp_f32 v221, v37
    v_add_f32 v218, v218, v220
    v_mfma_f32_32x32x16_bf16 a[16:31], a[164:167], v[76:79], a[16:31]
    ds_read_b64_tr_b16 a[164:165], v201 offset:20480
    ds_read_b64_tr_b16 a[166:167], v201 offset:21504
    v_exp_f32 v222, v38
    v_add_f32 v218, v218, v221
    v_mfma_f32_32x32x16_bf16 v[0:15], a[136:139], v[136:139], v[0:15]
    s_add_u32 m0, s38, 0x4000
    s_nop 0
    buffer_load_dwordx4 v214, s[16:19], s35 offen offset:1024 lds
    v_cvt_pk_bf16_f32 v253, v251, v252
    v_cvt_pk_bf16_f32 v82, v220, v221
    v_mfma_f32_32x32x16_bf16 v[16:31], a[136:139], v[168:171], v[16:31]
    ds_read_b128 a[136:139], v207 offset:40960
    v_lshlrev_b32 v251, 16, v253
    v_exp_f32 v223, v39
    v_add_f32 v218, v218, v222
    v_mfma_f32_32x32x16_bf16 a[32:47], a[168:171], v[64:67], a[32:47]
    v_and_b32 v252, s49, v253
    v_exp_f32 v220, v40
    v_add_f32 v218, v218, v223
    v_cvt_pk_bf16_f32 v83, v222, v223
    v_mfma_f32_32x32x16_bf16 a[48:63], a[168:171], v[72:75], a[48:63]
    ds_read_b64_tr_b16 a[168:169], v202 offset:16384
    ds_read_b64_tr_b16 a[170:171], v202 offset:17408
    v_exp_f32 v221, v41
    v_add_f32 v218, v218, v220
    v_mfma_f32_32x32x16_bf16 v[0:15], a[140:143], v[140:143], v[0:15]
    v_mul_f32 v251, v251, v229
    v_exp_f32 v222, v42
    v_add_f32 v218, v218, v221
    v_cvt_pk_bf16_f32 v84, v220, v221
    v_mfma_f32_32x32x16_bf16 v[16:31], a[140:143], v[172:175], v[16:31]
    ds_read_b128 a[140:143], v208 offset:40960
    v_mul_f32 v252, v252, v229
    v_exp_f32 v223, v43
    v_add_f32 v218, v218, v222
    v_mfma_f32_32x32x16_bf16 a[32:47], a[172:175], v[68:71], a[32:47]
    s_add_u32 s36, s36, 8192
    s_add_u32 m0, s39, 0x2000
    s_nop 0
    buffer_load_dwordx4 v215, s[20:23], s36 offen offset:0 lds
    v_cvt_pk_bf16_f32 v230, v251, v252
    v_exp_f32 v220, v44
    v_mfma_f32_32x32x16_bf16 a[48:63], a[172:175], v[76:79], a[48:63]
    ds_read_b64_tr_b16 a[172:173], v202 offset:20480
    ds_read_b64_tr_b16 a[174:175], v202 offset:21504
    v_add_f32 v218, v218, v223
    v_cvt_pk_bf16_f32 v85, v222, v223
    s_waitcnt lgkmcnt(3)
    v_mfma_f32_32x32x16_bf16 v[0:15], a[144:147], v[144:147], v[0:15]
    v_lshlrev_b32 v251, 16, v227
    v_exp_f32 v221, v45
    v_add_f32 v218, v218, v220
    v_exp_f32 v222, v46
    v_mfma_f32_32x32x16_bf16 v[16:31], a[144:147], v[176:179], v[16:31]
    ds_read_b128 a[144:147], v209 offset:40960
    v_and_b32 v252, s49, v227
    v_add_f32 v218, v218, v221
    v_cvt_pk_bf16_f32 v86, v220, v221
    v_mfma_f32_32x32x16_bf16 a[64:79], a[176:179], v[64:67], a[64:79]
    v_sub_f32 v251, v251, v228
    v_exp_f32 v223, v47
    v_add_f32 v218, v218, v222
    v_exp_f32 v220, v48
    v_mfma_f32_32x32x16_bf16 a[80:95], a[176:179], v[72:75], a[80:95]
    ds_read_b64_tr_b16 a[176:177], v203 offset:16384
    ds_read_b64_tr_b16 a[178:179], v203 offset:17408
    v_add_f32 v218, v218, v223
    v_cvt_pk_bf16_f32 v87, v222, v223
    v_mfma_f32_32x32x16_bf16 v[0:15], a[148:151], v[148:151], v[0:15]
    s_add_u32 m0, s39, 0x2000
    s_nop 0
    buffer_load_dwordx4 v215, s[20:23], s36 offen offset:1024 lds
    v_sub_f32 v252, v252, v228
    v_exp_f32 v221, v49
    v_mfma_f32_32x32x16_bf16 v[16:31], a[148:151], v[180:183], v[16:31]
    ds_read_b128 a[148:151], v210 offset:40960
    v_cvt_pk_bf16_f32 v253, v251, v252
    v_exp_f32 v222, v50
    v_add_f32 v219, v220, v221
    v_mfma_f32_32x32x16_bf16 a[64:79], a[180:183], v[68:71], a[64:79]
    v_lshlrev_b32 v251, 16, v253
    v_cvt_pk_bf16_f32 v88, v220, v221
    v_exp_f32 v223, v51
    v_add_f32 v219, v219, v222
    v_mfma_f32_32x32x16_bf16 a[80:95], a[180:183], v[76:79], a[80:95]
    ds_read_b64_tr_b16 a[180:181], v203 offset:20480
    ds_read_b64_tr_b16 a[182:183], v203 offset:21504
    v_exp_f32 v220, v52
    v_add_f32 v219, v219, v223
    v_mfma_f32_32x32x16_bf16 v[0:15], a[152:155], v[152:155], v[0:15]
    v_and_b32 v252, s49, v253
    v_cvt_pk_bf16_f32 v89, v222, v223
    v_exp_f32 v221, v53
    v_add_f32 v219, v219, v220
    v_mfma_f32_32x32x16_bf16 v[16:31], a[152:155], v[184:187], v[16:31]
    ds_read_b128 a[152:155], v211 offset:40960
    v_mul_f32 v251, v251, v229
    v_exp_f32 v222, v54
    v_add_f32 v219, v219, v221
    v_mfma_f32_32x32x16_bf16 a[96:111], a[184:187], v[64:67], a[96:111]
    v_mul_f32 v252, v252, v229
    v_cvt_pk_bf16_f32 v90, v220, v221
    v_exp_f32 v223, v55
    v_add_f32 v219, v219, v222
    v_mfma_f32_32x32x16_bf16 a[112:127], a[184:187], v[72:75], a[112:127]
    ds_read_b64_tr_b16 a[184:185], v204 offset:16384
    ds_read_b64_tr_b16 a[186:187], v204 offset:17408
    v_exp_f32 v220, v56
    v_add_f32 v219, v219, v223
    v_mfma_f32_32x32x16_bf16 v[0:15], a[156:159], v[156:159], v[0:15]
    v_cvt_pk_bf16_f32 v231, v251, v252
    v_cvt_pk_bf16_f32 v91, v222, v223
    v_exp_f32 v221, v57
    v_add_f32 v219, v219, v220
    v_mfma_f32_32x32x16_bf16 v[16:31], a[156:159], v[188:191], v[16:31]
    ds_read_b128 a[156:159], v212 offset:40960
    ds_write_b64 v232, v[230:231]
    v_exp_f32 v222, v58
    v_add_f32 v219, v219, v221
    v_mfma_f32_32x32x16_bf16 a[96:111], a[188:191], v[68:71], a[96:111]
    v_xor_b32 v230, 0x80, v195
    v_cvt_pk_bf16_f32 v92, v220, v221
    v_exp_f32 v223, v59
    v_add_f32 v219, v219, v222
    v_mfma_f32_32x32x16_bf16 a[112:127], a[188:191], v[76:79], a[112:127]
    ds_read_b64_tr_b16 a[188:189], v204 offset:20480
    ds_read_b64_tr_b16 a[190:191], v204 offset:21504
    v_exp_f32 v220, v60
    v_add_f32 v219, v219, v223
    v_cvt_pk_bf16_f32 v93, v222, v223
    v_exp_f32 v221, v61
    v_add_f32 v219, v219, v220
    v_exp_f32 v222, v62
    v_add_f32 v219, v219, v221
    v_cvt_pk_bf16_f32 v94, v220, v221
    v_exp_f32 v223, v63
    v_add_f32 v219, v219, v222
    v_add_f32 v219, v219, v223
    v_cvt_pk_bf16_f32 v95, v222, v223
    v_add_f32 v220, v218, v219
    v_cmp_nge_f32 s[94:95], s41, v220
    s_cmp_lg_u64 s[94:95], 0
    s_cbranch_scc1 L_ka_trp3
L_ka_retp3:
    v_add_f32 v216, v216, v218
    v_add_f32 v217, v217, v219
    s_barrier
    s_waitcnt lgkmcnt(3)
    v_mfma_f32_32x32x16_bf16 v[32:47], a[128:131], v[128:131], v[96:111]
    s_cmp_eq_u32 s48, 0
    s_cbranch_scc1 L_ka_o_do32
L_ka_o_rt32:
    v_exp_f32 v220, v0
    v_mfma_f32_32x32x16_bf16 v[48:63], a[128:131], v[160:163], v[112:127]
    ds_read_b128 a[128:131], v205 offset:49152
    v_exp_f32 v221, v1
    v_exp_f32 v222, v2
    v_mfma_f32_32x32x16_bf16 a[0:15], a[160:163], v[80:83], a[0:15]
    s_add_u32 s35, s35, 8192
    s_add_u32 m0, s38, 0x6000
    s_nop 0
    buffer_load_dwordx4 v213, s[16:19], s35 offen offset:0 lds
    v_add_f32 v218, v220, v221
    v_cvt_pk_bf16_f32 v64, v220, v221
    v_mfma_f32_32x32x16_bf16 a[16:31], a[160:163], v[88:91], a[16:31]
    ds_read_b64_tr_b16 a[160:161], v201 offset:40960
    ds_read_b64_tr_b16 a[162:163], v201 offset:41984
    v_exp_f32 v223, v3
    v_add_f32 v218, v218, v222
    v_mfma_f32_32x32x16_bf16 v[32:47], a[132:135], v[132:135], v[32:47]
    v_exp_f32 v220, v4
    v_add_f32 v218, v218, v223
    v_cvt_pk_bf16_f32 v65, v222, v223
    v_exp_f32 v221, v5
    v_mfma_f32_32x32x16_bf16 v[48:63], a[132:135], v[164:167], v[48:63]
    ds_read_b128 a[132:135], v206 offset:49152
    v_add_f32 v218, v218, v220
    v_exp_f32 v222, v6
    v_add_f32 v218, v218, v221
    v_mfma_f32_32x32x16_bf16 a[0:15], a[164:167], v[84:87], a[0:15]
    v_cvt_pk_bf16_f32 v66, v220, v221
    v_exp_f32 v223, v7
    v_add_f32 v218, v218, v222
    v_exp_f32 v220, v8
    v_mfma_f32_32x32x16_bf16 a[16:31], a[164:167], v[92:95], a[16:31]
    ds_read_b64_tr_b16 a[164:165], v201 offset:45056
    ds_read_b64_tr_b16 a[166:167], v201 offset:46080
    v_add_f32 v218, v218, v223
    v_cvt_pk_bf16_f32 v67, v222, v223
    v_mfma_f32_32x32x16_bf16 v[32:47], a[136:139], v[136:139], v[32:47]
    s_add_u32 m0, s38, 0x6000
    s_nop 0
    buffer_load_dwordx4 v214, s[16:19], s35 offen offset:1024 lds
    s_cmp_eq_u32 s48, 1
    s_cbranch_scc1 L_ka_o_do33
L_ka_o_rt33:
    v_mfma_f32_32x32x16_bf16 v[48:63], a[136:139], v[168:171], v[48:63]
    ds_read_b128 a[136:139], v207 offset:49152
    v_exp_f32 v221, v9
    v_add_f32 v218, v218, v220
    v_mfma_f32_32x32x16_bf16 a[32:47], a[168:171], v[80:83], a[32:47]
    v_exp_f32 v222, v10
    v_add_f32 v218, v218, v221
    v_cvt_pk_bf16_f32 v68, v220, v221
    v_exp_f32 v223, v11
    v_mfma_f32_32x32x16_bf16 a[48:63], a[168:171], v[88:91], a[48:63]
    ds_read_b64_tr_b16 a[168:169], v202 offset:40960
    ds_read_b64_tr_b16 a[170:171], v202 offset:41984
    v_add_f32 v218, v218, v222
    v_exp_f32 v220, v12
    v_mfma_f32_32x32x16_bf16 v[32:47], a[140:143], v[140:143], v[32:47]
    v_add_f32 v218, v218, v223
    v_cvt_pk_bf16_f32 v69, v222, v223
    v_exp_f32 v221, v13
    v_add_f32 v218, v218, v220
    v_mfma_f32_32x32x16_bf16 v[48:63], a[140:143], v[172:175], v[48:63]
    ds_read_b128 a[140:143], v208 offset:49152
    v_exp_f32 v222, v14
    v_add_f32 v218, v218, v221
    v_cvt_pk_bf16_f32 v70, v220, v221
    v_mfma_f32_32x32x16_bf16 a[32:47], a[172:175], v[84:87], a[32:47]
    s_add_u32 s36, s36, 8192
    s_add_u32 m0, s39, 0x8000
    s_nop 0
    buffer_load_dwordx4 v215, s[20:23], s36 offen offset:0 lds
    v_exp_f32 v223, v15
    v_add_f32 v218, v218, v222
    v_mfma_f32_32x32x16_bf16 a[48:63], a[172:175], v[92:95], a[48:63]
    ds_read_b64_tr_b16 a[172:173], v202 offset:45056
    ds_read_b64_tr_b16 a[174:175], v202 offset:46080
    v_exp_f32 v220, v16
    v_add_f32 v218, v218, v223
    s_waitcnt lgkmcnt(3)
    v_mfma_f32_32x32x16_bf16 v[32:47], a[144:147], v[144:147], v[32:47]
    s_add_u32 m0, s34, 4096
    s_nop 0
    buffer_load_dwordx4 v193, s[68:71], s40 offen lds
    s_add_u32 s40, s40, 229376
    v_cvt_pk_bf16_f32 v71, v222, v223
    v_exp_f32 v221, v17
    v_mfma_f32_32x32x16_bf16 v[48:63], a[144:147], v[176:179], v[48:63]
    ds_read_b128 a[144:147], v209 offset:49152
    v_exp_f32 v222, v18
    v_add_f32 v219, v220, v221
    v_cvt_pk_bf16_f32 v72, v220, v221
    v_mfma_f32_32x32x16_bf16 a[64:79], a[176:179], v[80:83], a[64:79]
    v_exp_f32 v223, v19
    v_add_f32 v219, v219, v222
    v_exp_f32 v220, v20
    v_add_f32 v219, v219, v223
    v_mfma_f32_32x32x16_bf16 a[80:95], a[176:179], v[88:91], a[80:95]
    ds_read_b64_tr_b16 a[176:177], v203 offset:40960
    ds_read_b64_tr_b16 a[178:179], v203 offset:41984
    v_cvt_pk_bf16_f32 v73, v222, v223
    v_exp_f32 v221, v21
    v_mfma_f32_32x32x16_bf16 v[32:47], a[148:151], v[148:151], v[32:47]
    s_add_u32 m0, s39, 0x8000
    s_nop 0
    buffer_load_dwordx4 v215, s[20:23], s36 offen offset:1024 lds
    v_add_f32 v219, v219, v220
    v_exp_f32 v222, v22
    v_mfma_f32_32x32x16_bf16 v[48:63], a[148:151], v[180:183], v[48:63]
    ds_read_b128 a[148:151], v210 offset:49152
    v_add_f32 v219, v219, v221
    v_cvt_pk_bf16_f32 v74, v220, v221
    v_exp_f32 v223, v23
    v_mfma_f32_32x32x16_bf16 a[64:79], a[180:183], v[84:87], a[64:79]
    v_add_f32 v219, v219, v222
    v_exp_f32 v220, v24
    v_add_f32 v219, v219, v223
    v_cvt_pk_bf16_f32 v75, v222, v223
    v_mfma_f32_32x32x16_bf16 a[80:95], a[180:183], v[92:95], a[80:95]
    ds_read_b64_tr_b16 a[180:181], v203 offset:45056
    ds_read_b64_tr_b16 a[182:183], v203 offset:46080
    v_exp_f32 v221, v25
    v_add_f32 v219, v219, v220
    v_mfma_f32_32x32x16_bf16 v[32:47], a[152:155], v[152:155], v[32:47]
    s_add_u32 m0, s34, 5120
    s_nop 0
    buffer_load_dwordx4 v193, s[68:71], s40 offen lds
    s_add_u32 s40, s40, 229376
    v_exp_f32 v222, v26
    v_add_f32 v219, v219, v221
    v_mfma_f32_32x32x16_bf16 v[48:63], a[152:155], v[184:187], v[48:63]
    ds_read_b128 a[152:155], v211 offset:49152
    v_cvt_pk_bf16_f32 v76, v220, v221
    v_exp_f32 v223, v27
    v_add_f32 v219, v219, v222
    v_mfma_f32_32x32x16_bf16 a[96:111], a[184:187], v[80:83], a[96:111]
    v_exp_f32 v220, v28
    v_add_f32 v219, v219, v223
    v_cvt_pk_bf16_f32 v77, v222, v223
    v_exp_f32 v221, v29
    v_mfma_f32_32x32x16_bf16 a[112:127], a[184:187], v[88:91], a[112:127]
    ds_read_b64_tr_b16 a[184:185], v204 offset:40960
    ds_read_b64_tr_b16 a[186:187], v204 offset:41984
    v_add_f32 v219, v219, v220
    v_exp_f32 v222, v30
    v_mfma_f32_32x32x16_bf16 v[32:47], a[156:159], v[156:159], v[32:47]
    v_add_f32 v219, v219, v221
    v_cvt_pk_bf16_f32 v78, v220, v221
    v_exp_f32 v223, v31
    v_add_f32 v219, v219, v222
    v_add_f32 v219, v219, v223
    v_mfma_f32_32x32x16_bf16 v[48:63], a[156:159], v[188:191], v[48:63]
    ds_read_b128 a[156:159], v212 offset:49152
    v_cvt_pk_bf16_f32 v79, v222, v223
    v_add_f32 v220, v218, v219
    v_cmp_nge_f32 s[94:95], s41, v220
    v_mfma_f32_32x32x16_bf16 a[96:111], a[188:191], v[84:87], a[96:111]
    v_mfma_f32_32x32x16_bf16 a[112:127], a[188:191], v[92:95], a[112:127]
    ds_read_b64_tr_b16 a[188:189], v204 offset:45056
    ds_read_b64_tr_b16 a[190:191], v204 offset:46080
    s_cmp_lg_u64 s[94:95], 0
    s_cbranch_scc1 L_ka_trp4
L_ka_retp4:
    v_add_f32 v216, v216, v218
    v_add_f32 v217, v217, v219
    s_waitcnt lgkmcnt(3)
    v_mfma_f32_32x32x16_bf16 v[0:15], a[128:131], v[128:131], v[96:111]
    s_cmp_eq_u32 s48, 2
    s_cbranch_scc1 L_ka_o_do34
L_ka_o_rt34:
    v_exp_f32 v220, v32
    v_mfma_f32_32x32x16_bf16 v[16:31], a[128:131], v[160:163], v[112:127]
    ds_read_b128 a[128:131], v205 offset:57344
    v_exp_f32 v221, v33
    v_exp_f32 v222, v34
    v_mfma_f32_32x32x16_bf16 a[0:15], a[160:163], v[64:67], a[0:15]
    s_add_u32 s35, s35, 8192
    s_add_u32 m0, s38, 0x8000
    s_nop 0
    buffer_load_dwordx4 v213, s[16:19], s35 offen offset:0 lds
    v_add_f32 v218, v220, v221
    v_cvt_pk_bf16_f32 v80, v220, v221
    v_mfma_f32_32x32x16_bf16 a[16:31], a[160:163], v[72:75], a[16:31]
    ds_read_b64_tr_b16 a[160:161], v201 offset:0
    ds_read_b64_tr_b16 a[162:163], v201 offset:1024
    v_exp_f32 v223, v35
    v_add_f32 v218, v218, v222
    v_mfma_f32_32x32x16_bf16 v[0:15], a[132:135], v[132:135], v[0:15]
    v_exp_f32 v220, v36
    v_add_f32 v218, v218, v223
    v_cvt_pk_bf16_f32 v81, v222, v223
    v_exp_f32 v221, v37
    v_mfma_f32_32x32x16_bf16 v[16:31], a[132:135], v[164:167], v[16:31]
    ds_read_b128 a[132:135], v206 offset:57344
    v_add_f32 v218, v218, v220
    v_exp_f32 v222, v38
    v_add_f32 v218, v218, v221
    v_mfma_f32_32x32x16_bf16 a[0:15], a[164:167], v[68:71], a[0:15]
    v_cvt_pk_bf16_f32 v82, v220, v221
    v_exp_f32 v223, v39
    v_add_f32 v218, v218, v222
    v_exp_f32 v220, v40
    v_mfma_f32_32x32x16_bf16 a[16:31], a[164:167], v[76:79], a[16:31]
    ds_read_b64_tr_b16 a[164:165], v201 offset:4096
    ds_read_b64_tr_b16 a[166:167], v201 offset:5120
    v_add_f32 v218, v218, v223
    v_cvt_pk_bf16_f32 v83, v222, v223
    v_mfma_f32_32x32x16_bf16 v[0:15], a[136:139], v[136:139], v[0:15]
    s_add_u32 m0, s38, 0x8000
    s_nop 0
    buffer_load_dwordx4 v214, s[16:19], s35 offen offset:1024 lds
    s_cmp_eq_u32 s48, 3
    s_cbranch_scc1 L_ka_o_do35
L_ka_o_rt35:
    v_mfma_f32_32x32x16_bf16 v[16:31], a[136:139], v[168:171], v[16:31]
    ds_read_b128 a[136:139], v207 offset:57344
    v_exp_f32 v221, v41
    v_add_f32 v218, v218, v220
    v_mfma_f32_32x32x16_bf16 a[32:47], a[168:171], v[64:67], a[32:47]
    v_exp_f32 v222, v42
    v_add_f32 v218, v218, v221
    v_cvt_pk_bf16_f32 v84, v220, v221
    v_exp_f32 v223, v43
    v_mfma_f32_32x32x16_bf16 a[48:63], a[168:171], v[72:75], a[48:63]
    ds_read_b64_tr_b16 a[168:169], v202 offset:0
    ds_read_b64_tr_b16 a[170:171], v202 offset:1024
    v_add_f32 v218, v218, v222
    v_exp_f32 v220, v44
    v_mfma_f32_32x32x16_bf16 v[0:15], a[140:143], v[140:143], v[0:15]
    v_add_f32 v218, v218, v223
    v_cvt_pk_bf16_f32 v85, v222, v223
    v_exp_f32 v221, v45
    v_add_f32 v218, v218, v220
    v_mfma_f32_32x32x16_bf16 v[16:31], a[140:143], v[172:175], v[16:31]
    ds_read_b128 a[140:143], v208 offset:57344
    v_exp_f32 v222, v46
    v_add_f32 v218, v218, v221
    v_cvt_pk_bf16_f32 v86, v220, v221
    v_mfma_f32_32x32x16_bf16 a[32:47], a[172:175], v[68:71], a[32:47]
    s_add_u32 s36, s36, 8192
    s_add_u32 m0, s39, 0xe000
    s_nop 0
    buffer_load_dwordx4 v215, s[20:23], s36 offen offset:0 lds
    v_exp_f32 v223, v47
    v_add_f32 v218, v218, v222
    v_mfma_f32_32x32x16_bf16 a[48:63], a[172:175], v[76:79], a[48:63]
    ds_read_b64_tr_b16 a[172:173], v202 offset:4096
    ds_read_b64_tr_b16 a[174:175], v202 offset:5120
    v_exp_f32 v220, v48
    v_add_f32 v218, v218, v223
    s_waitcnt lgkmcnt(3)
    v_mfma_f32_32x32x16_bf16 v[0:15], a[144:147], v[144:147], v[0:15]
    s_add_u32 m0, s34, 6144
    s_nop 0
    buffer_load_dwordx4 v193, s[68:71], s40 offen lds
    s_add_u32 s40, s40, 229376
    v_cvt_pk_bf16_f32 v87, v222, v223
    v_exp_f32 v221, v49
    v_mfma_f32_32x32x16_bf16 v[16:31], a[144:147], v[176:179], v[16:31]
    ds_read_b128 a[144:147], v209 offset:57344
    v_exp_f32 v222, v50
    v_add_f32 v219, v220, v221
    v_cvt_pk_bf16_f32 v88, v220, v221
    v_mfma_f32_32x32x16_bf16 a[64:79], a[176:179], v[64:67], a[64:79]
    v_exp_f32 v223, v51
    v_add_f32 v219, v219, v222
    v_exp_f32 v220, v52
    v_add_f32 v219, v219, v223
    v_mfma_f32_32x32x16_bf16 a[80:95], a[176:179], v[72:75], a[80:95]
    ds_read_b64_tr_b16 a[176:177], v203 offset:0
    ds_read_b64_tr_b16 a[178:179], v203 offset:1024
    v_cvt_pk_bf16_f32 v89, v222, v223
    v_exp_f32 v221, v53
    v_mfma_f32_32x32x16_bf16 v[0:15], a[148:151], v[148:151], v[0:15]
    s_add_u32 m0, s39, 0xe000
    s_nop 0
    buffer_load_dwordx4 v215, s[20:23], s36 offen offset:1024 lds
    v_add_f32 v219, v219, v220
    v_exp_f32 v222, v54
    v_mfma_f32_32x32x16_bf16 v[16:31], a[148:151], v[180:183], v[16:31]
    ds_read_b128 a[148:151], v210 offset:57344
    v_add_f32 v219, v219, v221
    v_cvt_pk_bf16_f32 v90, v220, v221
    v_exp_f32 v223, v55
    v_mfma_f32_32x32x16_bf16 a[64:79], a[180:183], v[68:71], a[64:79]
    v_add_f32 v219, v219, v222
    v_exp_f32 v220, v56
    v_add_f32 v219, v219, v223
    v_cvt_pk_bf16_f32 v91, v222, v223
    v_mfma_f32_32x32x16_bf16 a[80:95], a[180:183], v[76:79], a[80:95]
    ds_read_b64_tr_b16 a[180:181], v203 offset:4096
    ds_read_b64_tr_b16 a[182:183], v203 offset:5120
    v_exp_f32 v221, v57
    v_add_f32 v219, v219, v220
    v_mfma_f32_32x32x16_bf16 v[0:15], a[152:155], v[152:155], v[0:15]
    s_add_u32 m0, s34, 7168
    s_nop 0
    buffer_load_dwordx4 v193, s[68:71], s40 offen lds
    s_add_u32 s40, s40, 229376
    v_exp_f32 v222, v58
    v_add_f32 v219, v219, v221
    v_mfma_f32_32x32x16_bf16 v[16:31], a[152:155], v[184:187], v[16:31]
    ds_read_b128 a[152:155], v211 offset:57344
    v_cvt_pk_bf16_f32 v92, v220, v221
    v_exp_f32 v223, v59
    v_add_f32 v219, v219, v222
    v_mfma_f32_32x32x16_bf16 a[96:111], a[184:187], v[64:67], a[96:111]
    v_exp_f32 v220, v60
    v_add_f32 v219, v219, v223
    v_cvt_pk_bf16_f32 v93, v222, v223
    v_exp_f32 v221, v61
    v_mfma_f32_32x32x16_bf16 a[112:127], a[184:187], v[72:75], a[112:127]
    ds_read_b64_tr_b16 a[184:185], v204 offset:0
    ds_read_b64_tr_b16 a[186:187], v204 offset:1024
    v_add_f32 v219, v219, v220
    v_exp_f32 v222, v62
    v_mfma_f32_32x32x16_bf16 v[0:15], a[156:159], v[156:159], v[0:15]
    v_add_f32 v219, v219, v221
    v_cvt_pk_bf16_f32 v94, v220, v221
    v_exp_f32 v223, v63
    v_add_f32 v219, v219, v222
    v_add_f32 v219, v219, v223
    v_mfma_f32_32x32x16_bf16 v[16:31], a[156:159], v[188:191], v[16:31]
    ds_read_b128 a[156:159], v212 offset:57344
    v_cvt_pk_bf16_f32 v95, v222, v223
    v_add_f32 v220, v218, v219
    v_cmp_nge_f32 s[94:95], s41, v220
    v_mfma_f32_32x32x16_bf16 a[96:111], a[188:191], v[68:71], a[96:111]
    v_mfma_f32_32x32x16_bf16 a[112:127], a[188:191], v[76:79], a[112:127]
    ds_read_b64_tr_b16 a[188:189], v204 offset:4096
    ds_read_b64_tr_b16 a[190:191], v204 offset:5120
    s_cmp_lg_u64 s[94:95], 0
    s_cbranch_scc1 L_ka_trp5
L_ka_retp5:
    v_add_f32 v216, v216, v218
    v_add_f32 v217, v217, v219
    s_waitcnt vmcnt(12)
    s_barrier
    s_waitcnt lgkmcnt(3)
    v_mfma_f32_32x32x16_bf16 v[32:47], a[128:131], v[128:131], v[96:111]
    s_cmp_eq_u32 s48, 4
    s_cbranch_scc1 L_ka_o_do36
L_ka_o_rt36:
    v_exp_f32 v220, v0
    v_mfma_f32_32x32x16_bf16 v[48:63], a[128:131], v[160:163], v[112:127]
    ds_read_b128 a[128:131], v205 offset:0
    s_waitcnt vmcnt(6)
    v_mfma_f32_32x32x16_bf16 a[0:15], a[160:163], v[80:83], a[0:15]
    s_add_u32 s35, s35, 8192
    s_add_u32 m0, s38, 0xa000
    s_nop 0
    buffer_load_dwordx4 v213, s[16:19], s35 offen offset:0 lds
    v_exp_f32 v221, v1
    v_mfma_f32_32x32x16_bf16 a[16:31], a[160:163], v[88:91], a[16:31]
    ds_read_b64_tr_b16 a[160:161], v201 offset:24576
    ds_read_b64_tr_b16 a[162:163], v201 offset:25600
    ds_read_b64_tr_b16 a[232:233], v195 offset:0
    v_exp_f32 v222, v2
    v_mfma_f32_32x32x16_bf16 v[32:47], a[132:135], v[132:135], v[32:47]
    v_add_f32 v218, v220, v221
    v_cvt_pk_bf16_f32 v64, v220, v221
    v_exp_f32 v223, v3
    v_add_f32 v218, v218, v222
    v_mfma_f32_32x32x16_bf16 v[48:63], a[132:135], v[164:167], v[48:63]
    ds_read_b128 a[132:135], v206 offset:0
    ds_read_b64_tr_b16 a[234:235], v230 offset:0
    v_exp_f32 v220, v4
    v_add_f32 v218, v218, v223
    v_mfma_f32_32x32x16_bf16 a[0:15], a[164:167], v[84:87], a[0:15]
    v_cvt_pk_bf16_f32 v65, v222, v223
    v_exp_f32 v221, v5
    v_add_f32 v218, v218, v220
    v_exp_f32 v222, v6
    v_mfma_f32_32x32x16_bf16 a[16:31], a[164:167], v[92:95], a[16:31]
    ds_read_b64_tr_b16 a[164:165], v201 offset:28672
    ds_read_b64_tr_b16 a[166:167], v201 offset:29696
    ds_read_b128 a[224:227], v224 offset:0
    v_add_f32 v218, v218, v221
    v_cvt_pk_bf16_f32 v66, v220, v221
    v_mfma_f32_32x32x16_bf16 v[32:47], a[136:139], v[136:139], v[32:47]
    s_add_u32 m0, s38, 0xa000
    s_nop 0
    buffer_load_dwordx4 v214, s[16:19], s35 offen offset:1024 lds
    ds_read_b64_tr_b16 a[236:237], v195 offset:512
    v_mfma_f32_32x32x16_bf16 v[48:63], a[136:139], v[168:171], v[48:63]
    ds_read_b128 a[136:139], v207 offset:0
    v_exp_f32 v223, v7
    v_add_f32 v218, v218, v222
    v_mfma_f32_32x32x16_bf16 a[32:47], a[168:171], v[80:83], a[32:47]
    ds_read_b64_tr_b16 a[238:239], v230 offset:512
    v_exp_f32 v220, v8
    v_add_f32 v218, v218, v223
    v_cvt_pk_bf16_f32 v67, v222, v223
    v_mfma_f32_32x32x16_bf16 a[48:63], a[168:171], v[88:91], a[48:63]
    ds_read_b64_tr_b16 a[168:169], v202 offset:24576
    ds_read_b64_tr_b16 a[170:171], v202 offset:25600
    v_exp_f32 v221, v9
    v_add_f32 v218, v218, v220
    v_mfma_f32_32x32x16_bf16 v[32:47], a[140:143], v[140:143], v[32:47]
    ds_read_b128 a[228:231], v224 offset:32
    v_exp_f32 v222, v10
    v_add_f32 v218, v218, v221
    v_cvt_pk_bf16_f32 v68, v220, v221
    v_mfma_f32_32x32x16_bf16 v[48:63], a[140:143], v[172:175], v[48:63]
    ds_read_b128 a[140:143], v208 offset:0
    v_exp_f32 v223, v11
    v_add_f32 v218, v218, v222
    v_mfma_f32_32x32x16_bf16 a[32:47], a[172:175], v[84:87], a[32:47]
    s_add_u32 s36, s36, 8192
    s_add_u32 m0, s39, 0x4000
    s_nop 0
    buffer_load_dwordx4 v215, s[20:23], s36 offen offset:0 lds
    s_waitcnt lgkmcnt(7)
    v_mfma_f32_32x32x16_bf16 a[192:207], a[224:227], a[232:235], 0
    v_mfma_f32_32x32x16_bf16 a[48:63], a[172:175], v[92:95], a[48:63]
    ds_read_b64_tr_b16 a[172:173], v202 offset:28672
    ds_read_b64_tr_b16 a[174:175], v202 offset:29696
    v_exp_f32 v220, v12
    v_add_f32 v218, v218, v223
    s_waitcnt lgkmcnt(3)
    v_mfma_f32_32x32x16_bf16 v[32:47], a[144:147], v[144:147], v[32:47]
    ds_read_b64_tr_b16 a[232:233], v195 offset:1024
    v_cvt_pk_bf16_f32 v69, v222, v223
    v_exp_f32 v221, v13
    v_add_f32 v218, v218, v220
    v_mfma_f32_32x32x16_bf16 v[48:63], a[144:147], v[176:179], v[48:63]
    ds_read_b128 a[144:147], v209 offset:0
    ds_read_b64_tr_b16 a[234:235], v230 offset:1024
    v_exp_f32 v222, v14
    v_add_f32 v218, v218, v221
    v_mfma_f32_32x32x16_bf16 a[64:79], a[176:179], v[80:83], a[64:79]
    v_cvt_pk_bf16_f32 v70, v220, v221
    v_exp_f32 v223, v15
    v_add_f32 v218, v218, v222
    v_exp_f32 v220, v16
    v_mfma_f32_32x32x16_bf16 a[80:95], a[176:179], v[88:91], a[80:95]
    ds_read_b64_tr_b16 a[176:177], v203 offset:24576
    ds_read_b64_tr_b16 a[178:179], v203 offset:25600
    ds_read_b128 a[224:227], v224 offset:64
    v_add_f32 v218, v218, v223
    v_cvt_pk_bf16_f32 v71, v222, v223
    v_mfma_f32_32x32x16_bf16 v[32:47], a[148:151], v[148:151], v[32:47]
    s_add_u32 m0, s39, 0x4000
    s_nop 0
    buffer_load_dwordx4 v215, s[20:23], s36 offen offset:1024 lds
    v_exp_f32 v221, v17
    v_mfma_f32_32x32x16_bf16 v[48:63], a[148:151], v[180:183], v[48:63]
    ds_read_b128 a[148:151], v210 offset:0
    v_mfma_f32_32x32x16_bf16 a[192:207], a[228:231], a[236:239], a[192:207]
    v_mfma_f32_32x32x16_bf16 a[64:79], a[180:183], v[84:87], a[64:79]
    v_exp_f32 v222, v18
    v_add_f32 v219, v220, v221
    v_cvt_pk_bf16_f32 v72, v220, v221
    v_exp_f32 v223, v19
    v_mfma_f32_32x32x16_bf16 a[80:95], a[180:183], v[92:95], a[80:95]
    ds_read_b64_tr_b16 a[180:181], v203 offset:28672
    ds_read_b64_tr_b16 a[182:183], v203 offset:29696
    ds_read_b64_tr_b16 a[236:237], v195 offset:1536
    v_add_f32 v219, v219, v222
    v_mfma_f32_32x32x16_bf16 v[32:47], a[152:155], v[152:155], v[32:47]
    ds_read_b64_tr_b16 a[238:239], v230 offset:1536
    v_exp_f32 v220, v20
    v_add_f32 v219, v219, v223
    v_cvt_pk_bf16_f32 v73, v222, v223
    v_mfma_f32_32x32x16_bf16 v[48:63], a[152:155], v[184:187], v[48:63]
    ds_read_b128 a[152:155], v211 offset:0
    v_exp_f32 v221, v21
    v_add_f32 v219, v219, v220
    v_mfma_f32_32x32x16_bf16 a[96:111], a[184:187], v[80:83], a[96:111]
    ds_read_b128 a[228:231], v224 offset:96
    v_exp_f32 v222, v22
    v_add_f32 v219, v219, v221
    v_cvt_pk_bf16_f32 v74, v220, v221
    v_mfma_f32_32x32x16_bf16 a[112:127], a[184:187], v[88:91], a[112:127]
    ds_read_b64_tr_b16 a[184:185], v204 offset:24576
    ds_read_b64_tr_b16 a[186:187], v204 offset:25600
    v_exp_f32 v223, v23
    v_add_f32 v219, v219, v222
    v_mfma_f32_32x32x16_bf16 v[32:47], a[156:159], v[156:159], v[32:47]
    s_waitcnt lgkmcnt(9)
    v_mfma_f32_32x32x16_bf16 a[192:207], a[224:227], a[232:235], a[192:207]
    v_exp_f32 v220, v24
    v_add_f32 v219, v219, v223
    v_mfma_f32_32x32x16_bf16 v[48:63], a[156:159], v[188:191], v[48:63]
    ds_read_b128 a[156:159], v212 offset:0
    v_cvt_pk_bf16_f32 v75, v222, v223
    v_exp_f32 v221, v25
    v_add_f32 v219, v219, v220
    v_mfma_f32_32x32x16_bf16 a[96:111], a[188:191], v[84:87], a[96:111]
    s_waitcnt lgkmcnt(3)
    v_mfma_f32_32x32x16_bf16 a[192:207], a[228:231], a[236:239], a[192:207]
    v_exp_f32 v222, v26
    v_add_f32 v219, v219, v221
    v_mfma_f32_32x32x16_bf16 a[112:127], a[188:191], v[92:95], a[112:127]
    ds_read_b64_tr_b16 a[188:189], v204 offset:28672
    ds_read_b64_tr_b16 a[190:191], v204 offset:29696
    v_cvt_pk_bf16_f32 v76, v220, v221
    v_exp_f32 v223, v27
    v_add_f32 v219, v219, v222
    v_exp_f32 v220, v28
    v_add_f32 v219, v219, v223
    v_cvt_pk_bf16_f32 v77, v222, v223
    v_exp_f32 v221, v29
    v_add_f32 v219, v219, v220
    v_exp_f32 v222, v30
    v_add_f32 v219, v219, v221
    v_cvt_pk_bf16_f32 v78, v220, v221
    v_exp_f32 v223, v31
    v_add_f32 v219, v219, v222
    v_add_f32 v219, v219, v223
    v_cvt_pk_bf16_f32 v79, v222, v223
    v_add_f32 v220, v218, v219
    v_cmp_nge_f32 s[94:95], s41, v220
    s_cmp_lg_u64 s[94:95], 0
    s_cbranch_scc1 L_ka_trp6
L_ka_retp6:
    v_add_f32 v216, v216, v218
    v_add_f32 v217, v217, v219
    s_waitcnt lgkmcnt(3)
    v_mfma_f32_32x32x16_bf16 v[0:15], a[128:131], v[128:131], v[96:111]
    s_cmp_eq_u32 s48, 0
    s_cbranch_scc1 L_ka_o_do37
L_ka_o_rt37:
    v_exp_f32 v220, v32
    v_mfma_f32_32x32x16_bf16 v[16:31], a[128:131], v[160:163], v[112:127]
    ds_read_b128 a[128:131], v205 offset:8192
    s_cmp_eq_u32 s48, 1
    s_cbranch_scc1 L_ka_o_do38
L_ka_o_rt38:
    v_mfma_f32_32x32x16_bf16 a[0:15], a[160:163], v[64:67], a[0:15]
    s_add_u32 s35, s35, 8192
    s_add_u32 m0, s38, 0xc000
    s_nop 0
    buffer_load_dwordx4 v213, s[16:19], s35 offen offset:0 lds
    s_cmp_eq_u32 s48, 5
    s_cbranch_scc1 L_ka_o_do39
L_ka_o_rt39:
    v_mfma_f32_32x32x16_bf16 a[16:31], a[160:163], v[72:75], a[16:31]
    ds_read_b64_tr_b16 a[160:161], v201 offset:8192
    ds_read_b64_tr_b16 a[162:163], v201 offset:9216
    s_cmp_eq_u32 s48, 6
    s_cbranch_scc1 L_ka_o_do40
L_ka_o_rt40:
    v_mfma_f32_32x32x16_bf16 v[0:15], a[132:135], v[132:135], v[0:15]
    v_exp_f32 v221, v33
    v_exp_f32 v222, v34
    v_add_f32 v218, v220, v221
    v_cvt_pk_bf16_f32 v80, v220, v221
    v_mfma_f32_32x32x16_bf16 v[16:31], a[132:135], v[164:167], v[16:31]
    ds_read_b128 a[132:135], v206 offset:8192
    s_waitcnt vmcnt(5)
    v_mfma_f32_32x32x16_bf16 a[0:15], a[164:167], v[68:71], a[0:15]
    ds_read_b64_tr_b16 a[232:233], v195 offset:2048
    v_exp_f32 v223, v35
    v_add_f32 v218, v218, v222
    v_mfma_f32_32x32x16_bf16 a[16:31], a[164:167], v[76:79], a[16:31]
    ds_read_b64_tr_b16 a[164:165], v201 offset:12288
    ds_read_b64_tr_b16 a[166:167], v201 offset:13312
    ds_read_b64_tr_b16 a[234:235], v230 offset:2048
    v_exp_f32 v220, v36
    v_mfma_f32_32x32x16_bf16 v[0:15], a[136:139], v[136:139], v[0:15]
    s_add_u32 m0, s38, 0xc000
    s_nop 0
    buffer_load_dwordx4 v214, s[16:19], s35 offen offset:1024 lds
    ds_read_b128 a[224:227], v224 offset:128
    v_add_f32 v218, v218, v223
    v_mfma_f32_32x32x16_bf16 v[16:31], a[136:139], v[168:171], v[16:31]
    ds_read_b128 a[136:139], v207 offset:8192
    v_cvt_pk_bf16_f32 v81, v222, v223
    v_exp_f32 v221, v37
    v_add_f32 v218, v218, v220
    v_mfma_f32_32x32x16_bf16 a[32:47], a[168:171], v[64:67], a[32:47]
    ds_read_b64_tr_b16 a[236:237], v195 offset:2560
    v_exp_f32 v222, v38
    v_add_f32 v218, v218, v221
    v_cvt_pk_bf16_f32 v82, v220, v221
    v_mfma_f32_32x32x16_bf16 a[48:63], a[168:171], v[72:75], a[48:63]
    ds_read_b64_tr_b16 a[168:169], v202 offset:8192
    ds_read_b64_tr_b16 a[170:171], v202 offset:9216
    s_add_u32 m0, s34, 0
    s_nop 0
    buffer_load_dwordx4 v192, s[64:67], s32 offen lds
    s_add_u32 s32, s32, 229376
    v_mfma_f32_32x32x16_bf16 v[0:15], a[140:143], v[140:143], v[0:15]
    ds_read_b64_tr_b16 a[238:239], v230 offset:2560
    v_exp_f32 v223, v39
    v_add_f32 v218, v218, v222
    v_mfma_f32_32x32x16_bf16 v[16:31], a[140:143], v[172:175], v[16:31]
    ds_read_b128 a[140:143], v208 offset:8192
    v_exp_f32 v220, v40
    v_add_f32 v218, v218, v223
    v_cvt_pk_bf16_f32 v83, v222, v223
    v_mfma_f32_32x32x16_bf16 a[32:47], a[172:175], v[68:71], a[32:47]
    s_add_u32 s36, s36, 8192
    s_add_u32 m0, s39, 0xa000
    s_nop 0
    buffer_load_dwordx4 v215, s[20:23], s36 offen offset:0 lds
    ds_read_b128 a[228:231], v224 offset:160
    v_mfma_f32_32x32x16_bf16 a[48:63], a[172:175], v[76:79], a[48:63]
    ds_read_b64_tr_b16 a[172:173], v202 offset:12288
    ds_read_b64_tr_b16 a[174:175], v202 offset:13312
    s_waitcnt lgkmcnt(9)
    v_mfma_f32_32x32x16_bf16 a[192:207], a[224:227], a[232:235], a[192:207]
    s_waitcnt lgkmcnt(3)
    v_mfma_f32_32x32x16_bf16 v[0:15], a[144:147], v[144:147], v[0:15]
    ds_read_b64_tr_b16 a[232:233], v195 offset:3072
    v_exp_f32 v221, v41
    v_add_f32 v218, v218, v220
    v_mfma_f32_32x32x16_bf16 v[16:31], a[144:147], v[176:179], v[16:31]
    ds_read_b128 a[144:147], v209 offset:8192
    s_add_u32 m0, s34, 1024
    s_nop 0
    buffer_load_dwordx4 v192, s[64:67], s32 offen lds
    s_add_u32 s32, s32, 229376
    v_mfma_f32_32x32x16_bf16 a[64:79], a[176:179], v[64:67], a[64:79]
    v_exp_f32 v222, v42
    v_add_f32 v218, v218, v221
    v_cvt_pk_bf16_f32 v84, v220, v221
    v_exp_f32 v223, v43
    v_mfma_f32_32x32x16_bf16 a[80:95], a[176:179], v[72:75], a[80:95]
    ds_read_b64_tr_b16 a[176:177], v203 offset:8192
    ds_read_b64_tr_b16 a[178:179], v203 offset:9216
    ds_read_b64_tr_b16 a[234:235], v230 offset:3072
    v_add_f32 v218, v218, v222
    v_mfma_f32_32x32x16_bf16 v[0:15], a[148:151], v[148:151], v[0:15]
    s_add_u32 m0, s39, 0xa000
    s_nop 0
    buffer_load_dwordx4 v215, s[20:23], s36 offen offset:1024 lds
    ds_read_b128 a[224:227], v224 offset:192
    v_mfma_f32_32x32x16_bf16 v[16:31], a[148:151], v[180:183], v[16:31]
    ds_read_b128 a[148:151], v210 offset:8192
    s_waitcnt lgkmcnt(9)
    v_mfma_f32_32x32x16_bf16 a[192:207], a[228:231], a[236:239], a[192:207]
    v_mfma_f32_32x32x16_bf16 a[64:79], a[180:183], v[68:71], a[64:79]
    v_exp_f32 v220, v44
    v_add_f32 v218, v218, v223
    v_cvt_pk_bf16_f32 v85, v222, v223
    v_exp_f32 v221, v45
    v_mfma_f32_32x32x16_bf16 a[80:95], a[180:183], v[76:79], a[80:95]
    ds_read_b64_tr_b16 a[180:181], v203 offset:12288
    ds_read_b64_tr_b16 a[182:183], v203 offset:13312
    ds_read_b64_tr_b16 a[236:237], v195 offset:3584
    v_add_f32 v218, v218, v220
    v_mfma_f32_32x32x16_bf16 v[0:15], a[152:155], v[152:155], v[0:15]
    s_add_u32 m0, s34, 4096
    s_nop 0
    buffer_load_dwordx4 v193, s[68:71], s40 offen lds
    s_add_u32 s40, s40, 229376
    v_exp_f32 v222, v46
    v_add_f32 v218, v218, v221
    v_mfma_f32_32x32x16_bf16 v[16:31], a[152:155], v[184:187], v[16:31]
    ds_read_b128 a[152:155], v211 offset:8192
    ds_read_b64_tr_b16 a[238:239], v230 offset:3584
    v_cvt_pk_bf16_f32 v86, v220, v221
    v_exp_f32 v223, v47
    v_mfma_f32_32x32x16_bf16 a[96:111], a[184:187], v[64:67], a[96:111]
    ds_read_b128 a[228:231], v224 offset:224
    v_add_f32 v218, v218, v222
    v_exp_f32 v220, v48
    v_add_f32 v218, v218, v223
    v_mfma_f32_32x32x16_bf16 a[112:127], a[184:187], v[72:75], a[112:127]
    ds_read_b64_tr_b16 a[184:185], v204 offset:8192
    ds_read_b64_tr_b16 a[186:187], v204 offset:9216
    v_cvt_pk_bf16_f32 v87, v222, v223
    v_exp_f32 v221, v49
    v_mfma_f32_32x32x16_bf16 v[0:15], a[156:159], v[156:159], v[0:15]
    s_waitcnt lgkmcnt(9)
    v_mfma_f32_32x32x16_bf16 a[192:207], a[224:227], a[232:235], a[192:207]
    v_exp_f32 v222, v50
    v_add_f32 v219, v220, v221
    v_mfma_f32_32x32x16_bf16 v[16:31], a[156:159], v[188:191], v[16:31]
    ds_read_b128 a[156:159], v212 offset:8192
    s_waitcnt lgkmcnt(3)
    v_mfma_f32_32x32x16_bf16 a[192:207], a[228:231], a[236:239], a[192:207]
    v_cvt_pk_bf16_f32 v88, v220, v221
    v_mfma_f32_32x32x16_bf16 a[96:111], a[188:191], v[68:71], a[96:111]
    s_add_u32 m0, s34, 5120
    s_nop 0
    buffer_load_dwordx4 v193, s[68:71], s40 offen lds
    s_add_u32 s40, s40, 229376
    v_exp_f32 v223, v51
    v_add_f32 v219, v219, v222
    v_mfma_f32_32x32x16_bf16 a[112:127], a[188:191], v[76:79], a[112:127]
    ds_read_b64_tr_b16 a[188:189], v204 offset:12288
    ds_read_b64_tr_b16 a[190:191], v204 offset:13312
    v_exp_f32 v220, v52
    v_add_f32 v219, v219, v223
    v_cvt_pk_bf16_f32 v89, v222, v223
    v_exp_f32 v221, v53
    v_add_f32 v219, v219, v220
    v_exp_f32 v222, v54
    v_add_f32 v219, v219, v221
    v_cvt_pk_bf16_f32 v90, v220, v221
    v_exp_f32 v223, v55
    v_add_f32 v219, v219, v222
    v_exp_f32 v220, v56
    v_add_f32 v219, v219, v223
    v_cvt_pk_bf16_f32 v91, v222, v223
    v_exp_f32 v221, v57
    v_add_f32 v219, v219, v220
    v_exp_f32 v222, v58
    v_add_f32 v219, v219, v221
    v_cvt_pk_bf16_f32 v92, v220, v221
    v_exp_f32 v223, v59
    v_add_f32 v219, v219, v222
    v_exp_f32 v220, v60
    v_add_f32 v219, v219, v223
    v_cvt_pk_bf16_f32 v93, v222, v223
    v_exp_f32 v221, v61
    v_add_f32 v219, v219, v220
    v_exp_f32 v222, v62
    v_add_f32 v219, v219, v221
    v_cvt_pk_bf16_f32 v94, v220, v221
    v_exp_f32 v223, v63
    v_add_f32 v219, v219, v222
    v_add_f32 v219, v219, v223
    v_cvt_pk_bf16_f32 v95, v222, v223
    v_add_f32 v220, v218, v219
    v_cmp_nge_f32 s[94:95], s41, v220
    s_cmp_lg_u64 s[94:95], 0
    s_cbranch_scc1 L_ka_trp7
L_ka_retp7:
    v_add_f32 v216, v216, v218
    v_add_f32 v217, v217, v219
    s_barrier
    s_waitcnt lgkmcnt(3)
    v_mfma_f32_32x32x16_bf16 v[32:47], a[128:131], v[128:131], v[96:111]
    s_cmp_eq_u32 s48, 2
    s_cbranch_scc1 L_ka_o_do41
L_ka_o_rt41:
    v_exp_f32 v220, v0
    v_mfma_f32_32x32x16_bf16 v[48:63], a[128:131], v[160:163], v[112:127]
    ds_read_b128 a[128:131], v205 offset:16384
    v_exp_f32 v221, v1
    v_exp_f32 v222, v2
    v_mfma_f32_32x32x16_bf16 a[0:15], a[160:163], v[80:83], a[0:15]
    s_add_u32 s35, s35, 8192
    s_add_u32 m0, s38, 0xe000
    s_nop 0
    buffer_load_dwordx4 v213, s[16:19], s35 offen offset:0 lds
    v_add_f32 v218, v220, v221
    v_cvt_pk_bf16_f32 v64, v220, v221
    v_mfma_f32_32x32x16_bf16 a[16:31], a[160:163], v[88:91], a[16:31]
    ds_read_b64_tr_b16 a[160:161], v201 offset:32768
    ds_read_b64_tr_b16 a[162:163], v201 offset:33792
    v_exp_f32 v223, v3
    v_add_f32 v218, v218, v222
    v_mfma_f32_32x32x16_bf16 v[32:47], a[132:135], v[132:135], v[32:47]
    v_exp_f32 v220, v4
    v_add_f32 v218, v218, v223
    v_cvt_pk_bf16_f32 v65, v222, v223
    v_exp_f32 v221, v5
    v_mfma_f32_32x32x16_bf16 v[48:63], a[132:135], v[164:167], v[48:63]
    ds_read_b128 a[132:135], v206 offset:16384
    s_cmp_eq_u32 s48, 7
    s_cbranch_scc1 L_ka_o_do42
L_ka_o_rt42:
    v_add_f32 v218, v218, v220
    v_mfma_f32_32x32x16_bf16 a[0:15], a[164:167], v[84:87], a[0:15]
    v_exp_f32 v222, v6
    v_add_f32 v218, v218, v221
    v_cvt_pk_bf16_f32 v66, v220, v221
    v_exp_f32 v223, v7
    v_mfma_f32_32x32x16_bf16 a[16:31], a[164:167], v[92:95], a[16:31]
    ds_read_b64_tr_b16 a[164:165], v201 offset:36864
    ds_read_b64_tr_b16 a[166:167], v201 offset:37888
    v_add_f32 v218, v218, v222
    v_exp_f32 v220, v8
    v_mfma_f32_32x32x16_bf16 v[32:47], a[136:139], v[136:139], v[32:47]
    s_add_u32 m0, s38, 0xe000
    s_nop 0
    buffer_load_dwordx4 v214, s[16:19], s35 offen offset:1024 lds
    v_add_f32 v218, v218, v223
    v_cvt_pk_bf16_f32 v67, v222, v223
    v_mfma_f32_32x32x16_bf16 v[48:63], a[136:139], v[168:171], v[48:63]
    ds_read_b128 a[136:139], v207 offset:16384
    v_exp_f32 v221, v9
    v_add_f32 v218, v218, v220
    v_mfma_f32_32x32x16_bf16 a[32:47], a[168:171], v[80:83], a[32:47]
    s_add_u32 m0, s34, 2048
    s_nop 0
    buffer_load_dwordx4 v192, s[64:67], s32 offen lds
    s_add_u32 s32, s32, 229376
    v_exp_f32 v222, v10
    v_add_f32 v218, v218, v221
    v_mfma_f32_32x32x16_bf16 a[48:63], a[168:171], v[88:91], a[48:63]
    ds_read_b64_tr_b16 a[168:169], v202 offset:32768
    ds_read_b64_tr_b16 a[170:171], v202 offset:33792
    v_cvt_pk_bf16_f32 v68, v220, v221
    v_exp_f32 v223, v11
    v_mfma_f32_32x32x16_bf16 v[32:47], a[140:143], v[140:143], v[32:47]
    v_add_f32 v218, v218, v222
    v_exp_f32 v220, v12
    v_add_f32 v218, v218, v223
    v_cvt_pk_bf16_f32 v69, v222, v223
    v_mfma_f32_32x32x16_bf16 v[48:63], a[140:143], v[172:175], v[48:63]
    ds_read_b128 a[140:143], v208 offset:16384
    v_exp_f32 v221, v13
    v_add_f32 v218, v218, v220
    v_mfma_f32_32x32x16_bf16 a[32:47], a[172:175], v[84:87], a[32:47]
    s_add_u32 s36, s36, 8192
    s_add_u32 m0, s39, 0x0
    s_nop 0
    buffer_load_dwordx4 v215, s[20:23], s36 offen offset:0 lds
    v_exp_f32 v222, v14
    v_add_f32 v218, v218, v221
    v_mfma_f32_32x32x16_bf16 a[48:63], a[172:175], v[92:95], a[48:63]
    ds_read_b64_tr_b16 a[172:173], v202 offset:36864
    ds_read_b64_tr_b16 a[174:175], v202 offset:37888
    v_cvt_pk_bf16_f32 v70, v220, v221
    v_exp_f32 v223, v15
    s_waitcnt lgkmcnt(3)
    v_mfma_f32_32x32x16_bf16 v[32:47], a[144:147], v[144:147], v[32:47]
    s_add_u32 m0, s34, 3072
    s_nop 0
    buffer_load_dwordx4 v192, s[64:67], s32 offen lds
    s_add_u32 s32, s32, 229376
    v_add_f32 v218, v218, v222
    v_exp_f32 v220, v16
    v_mfma_f32_32x32x16_bf16 v[48:63], a[144:147], v[176:179], v[48:63]
    ds_read_b128 a[144:147], v209 offset:16384
    v_add_f32 v218, v218, v223
    v_cvt_pk_bf16_f32 v71, v222, v223
    v_exp_f32 v221, v17
    v_mfma_f32_32x32x16_bf16 a[64:79], a[176:179], v[80:83], a[64:79]
    v_exp_f32 v222, v18
    v_add_f32 v219, v220, v221
    v_cvt_pk_bf16_f32 v72, v220, v221
    v_exp_f32 v223, v19
    v_mfma_f32_32x32x16_bf16 a[80:95], a[176:179], v[88:91], a[80:95]
    ds_read_b64_tr_b16 a[176:177], v203 offset:32768
    ds_read_b64_tr_b16 a[178:179], v203 offset:33792
    v_add_f32 v219, v219, v222
    v_exp_f32 v220, v20
    v_mfma_f32_32x32x16_bf16 v[32:47], a[148:151], v[148:151], v[32:47]
    s_add_u32 m0, s39, 0x0
    s_nop 0
    buffer_load_dwordx4 v215, s[20:23], s36 offen offset:1024 lds
    v_add_f32 v219, v219, v223
    v_cvt_pk_bf16_f32 v73, v222, v223
    v_mfma_f32_32x32x16_bf16 v[48:63], a[148:151], v[180:183], v[48:63]
    ds_read_b128 a[148:151], v210 offset:16384
    s_add_u32 m0, s34, 6144
    s_nop 0
    buffer_load_dwordx4 v193, s[68:71], s40 offen lds
    s_add_u32 s40, s40, 229376
    v_mfma_f32_32x32x16_bf16 a[64:79], a[180:183], v[84:87], a[64:79]
    v_exp_f32 v221, v21
    v_add_f32 v219, v219, v220
    v_exp_f32 v222, v22
    v_add_f32 v219, v219, v221
    v_mfma_f32_32x32x16_bf16 a[80:95], a[180:183], v[92:95], a[80:95]
    ds_read_b64_tr_b16 a[180:181], v203 offset:36864
    ds_read_b64_tr_b16 a[182:183], v203 offset:37888
    v_cvt_pk_bf16_f32 v74, v220, v221
    v_exp_f32 v223, v23
    v_mfma_f32_32x32x16_bf16 v[32:47], a[152:155], v[152:155], v[32:47]
    v_add_f32 v219, v219, v222
    v_exp_f32 v220, v24
    v_add_f32 v219, v219, v223
    v_cvt_pk_bf16_f32 v75, v222, v223
    v_mfma_f32_32x32x16_bf16 v[48:63], a[152:155], v[184:187], v[48:63]
    ds_read_b128 a[152:155], v211 offset:16384
    v_exp_f32 v221, v25
    v_add_f32 v219, v219, v220
    v_mfma_f32_32x32x16_bf16 a[96:111], a[184:187], v[80:83], a[96:111]
    s_add_u32 m0, s34, 7168
    s_nop 0
    buffer_load_dwordx4 v193, s[68:71], s40 offen lds
    s_add_u32 s40, s40, 229376
    v_exp_f32 v222, v26
    v_add_f32 v219, v219, v221
    v_mfma_f32_32x32x16_bf16 a[112:127], a[184:187], v[88:91], a[112:127]
    ds_read_b64_tr_b16 a[184:185], v204 offset:32768
    ds_read_b64_tr_b16 a[186:187], v204 offset:33792
    v_cvt_pk_bf16_f32 v76, v220, v221
    v_exp_f32 v223, v27
    v_mfma_f32_32x32x16_bf16 v[32:47], a[156:159], v[156:159], v[32:47]
    v_add_f32 v219, v219, v222
    v_exp_f32 v220, v28
    v_add_f32 v219, v219, v223
    v_cvt_pk_bf16_f32 v77, v222, v223
    v_mfma_f32_32x32x16_bf16 v[48:63], a[156:159], v[188:191], v[48:63]
    ds_read_b128 a[156:159], v212 offset:16384
    v_exp_f32 v221, v29
    v_add_f32 v219, v219, v220
    v_mfma_f32_32x32x16_bf16 a[96:111], a[188:191], v[84:87], a[96:111]
    v_exp_f32 v222, v30
    v_add_f32 v219, v219, v221
    v_cvt_pk_bf16_f32 v78, v220, v221
    v_exp_f32 v223, v31
    v_mfma_f32_32x32x16_bf16 a[112:127], a[188:191], v[92:95], a[112:127]
    ds_read_b64_tr_b16 a[188:189], v204 offset:36864
    ds_read_b64_tr_b16 a[190:191], v204 offset:37888
    v_add_f32 v219, v219, v222
    v_add_f32 v219, v219, v223
    v_cvt_pk_bf16_f32 v79, v222, v223
    v_add_f32 v220, v218, v219
    v_cmp_nge_f32 s[94:95], s41, v220
    s_cmp_lg_u64 s[94:95], 0
    s_cbranch_scc1 L_ka_trp8
L_ka_retp8:
    v_add_f32 v216, v216, v218
    v_add_f32 v217, v217, v219
    s_waitcnt lgkmcnt(3)
    v_mfma_f32_32x32x16_bf16 v[0:15], a[128:131], v[128:131], v[96:111]
    s_cmp_eq_u32 s48, 3
    s_cbranch_scc1 L_ka_o_do43
L_ka_o_rt43:
    v_exp_f32 v220, v32
    v_mfma_f32_32x32x16_bf16 v[16:31], a[128:131], v[160:163], v[112:127]
    ds_read_b128 a[128:131], v205 offset:24576
    s_waitcnt vmcnt(8)
    v_mfma_f32_32x32x16_bf16 a[0:15], a[160:163], v[64:67], a[0:15]
    s_add_u32 s36, s36, 8192
    s_add_u32 m0, s39, 0x6000
    s_nop 0
    buffer_load_dwordx4 v215, s[20:23], s36 offen offset:0 lds
    v_exp_f32 v221, v33
    v_mfma_f32_32x32x16_bf16 a[16:31], a[160:163], v[72:75], a[16:31]
    ds_read_b64_tr_b16 a[160:161], v201 offset:57344
    ds_read_b64_tr_b16 a[162:163], v201 offset:58368
    ds_read_b64_tr_b16 a[232:233], v195 offset:0
    v_exp_f32 v222, v34
    v_mfma_f32_32x32x16_bf16 v[0:15], a[132:135], v[132:135], v[0:15]
    v_add_f32 v218, v220, v221
    v_cvt_pk_bf16_f32 v80, v220, v221
    v_exp_f32 v223, v35
    v_add_f32 v218, v218, v222
    v_mfma_f32_32x32x16_bf16 v[16:31], a[132:135], v[164:167], v[16:31]
    ds_read_b128 a[132:135], v206 offset:24576
    ds_read_b64_tr_b16 a[234:235], v230 offset:0
    v_exp_f32 v220, v36
    v_add_f32 v218, v218, v223
    v_mfma_f32_32x32x16_bf16 a[0:15], a[164:167], v[68:71], a[0:15]
    v_cvt_pk_bf16_f32 v81, v222, v223
    v_exp_f32 v221, v37
    v_add_f32 v218, v218, v220
    v_exp_f32 v222, v38
    v_mfma_f32_32x32x16_bf16 a[16:31], a[164:167], v[76:79], a[16:31]
    ds_read_b64_tr_b16 a[164:165], v201 offset:61440
    ds_read_b64_tr_b16 a[166:167], v201 offset:62464
    ds_read_b128 a[224:227], v224 offset:256
    v_add_f32 v218, v218, v221
    v_cvt_pk_bf16_f32 v82, v220, v221
    v_mfma_f32_32x32x16_bf16 v[0:15], a[136:139], v[136:139], v[0:15]
    s_add_u32 m0, s39, 0x6000
    s_nop 0
    buffer_load_dwordx4 v215, s[20:23], s36 offen offset:1024 lds
    ds_read_b64_tr_b16 a[236:237], v195 offset:512
    v_mfma_f32_32x32x16_bf16 v[16:31], a[136:139], v[168:171], v[16:31]
    ds_read_b128 a[136:139], v207 offset:24576
    v_exp_f32 v223, v39
    v_add_f32 v218, v218, v222
    v_mfma_f32_32x32x16_bf16 a[32:47], a[168:171], v[64:67], a[32:47]
    ds_read_b64_tr_b16 a[238:239], v230 offset:512
    v_exp_f32 v220, v40
    v_add_f32 v218, v218, v223
    v_cvt_pk_bf16_f32 v83, v222, v223
    v_mfma_f32_32x32x16_bf16 a[48:63], a[168:171], v[72:75], a[48:63]
    ds_read_b64_tr_b16 a[168:169], v202 offset:57344
    ds_read_b64_tr_b16 a[170:171], v202 offset:58368
    v_exp_f32 v221, v41
    v_add_f32 v218, v218, v220
    v_mfma_f32_32x32x16_bf16 v[0:15], a[140:143], v[140:143], v[0:15]
    ds_read_b128 a[228:231], v224 offset:288
    v_exp_f32 v222, v42
    v_add_f32 v218, v218, v221
    v_cvt_pk_bf16_f32 v84, v220, v221
    v_mfma_f32_32x32x16_bf16 v[16:31], a[140:143], v[172:175], v[16:31]
    ds_read_b128 a[140:143], v208 offset:24576
    v_exp_f32 v223, v43
    v_add_f32 v218, v218, v222
    v_mfma_f32_32x32x16_bf16 a[32:47], a[172:175], v[68:71], a[32:47]
    s_waitcnt lgkmcnt(7)
    v_mfma_f32_32x32x16_bf16 a[192:207], a[224:227], a[232:235], a[192:207]
    v_exp_f32 v220, v44
    v_add_f32 v218, v218, v223
    v_mfma_f32_32x32x16_bf16 a[48:63], a[172:175], v[76:79], a[48:63]
    ds_read_b64_tr_b16 a[172:173], v202 offset:61440
    ds_read_b64_tr_b16 a[174:175], v202 offset:62464
    v_cvt_pk_bf16_f32 v85, v222, v223
    v_exp_f32 v221, v45
    s_waitcnt lgkmcnt(3)
    v_mfma_f32_32x32x16_bf16 v[0:15], a[144:147], v[144:147], v[0:15]
    ds_read_b64_tr_b16 a[232:233], v195 offset:1024
    v_add_f32 v218, v218, v220
    v_exp_f32 v222, v46
    v_add_f32 v218, v218, v221
    v_mfma_f32_32x32x16_bf16 v[16:31], a[144:147], v[176:179], v[16:31]
    ds_read_b128 a[144:147], v209 offset:24576
    ds_read_b64_tr_b16 a[234:235], v230 offset:1024
    v_cvt_pk_bf16_f32 v86, v220, v221
    v_exp_f32 v223, v47
    v_mfma_f32_32x32x16_bf16 a[64:79], a[176:179], v[64:67], a[64:79]
    v_add_f32 v218, v218, v222
    v_exp_f32 v220, v48
    v_add_f32 v218, v218, v223
    v_cvt_pk_bf16_f32 v87, v222, v223
    v_mfma_f32_32x32x16_bf16 a[80:95], a[176:179], v[72:75], a[80:95]
    ds_read_b64_tr_b16 a[176:177], v203 offset:57344
    ds_read_b64_tr_b16 a[178:179], v203 offset:58368
    ds_read_b128 a[224:227], v224 offset:320
    v_exp_f32 v221, v49
    v_mfma_f32_32x32x16_bf16 v[0:15], a[148:151], v[148:151], v[0:15]
    v_exp_f32 v222, v50
    v_add_f32 v219, v220, v221
    v_cvt_pk_bf16_f32 v88, v220, v221
    v_exp_f32 v223, v51
    v_mfma_f32_32x32x16_bf16 v[16:31], a[148:151], v[180:183], v[16:31]
    ds_read_b128 a[148:151], v210 offset:24576
    v_mfma_f32_32x32x16_bf16 a[192:207], a[228:231], a[236:239], a[192:207]
    v_add_f32 v219, v219, v222
    v_mfma_f32_32x32x16_bf16 a[64:79], a[180:183], v[68:71], a[64:79]
    v_exp_f32 v220, v52
    v_add_f32 v219, v219, v223
    v_cvt_pk_bf16_f32 v89, v222, v223
    v_exp_f32 v221, v53
    v_mfma_f32_32x32x16_bf16 a[80:95], a[180:183], v[76:79], a[80:95]
    ds_read_b64_tr_b16 a[180:181], v203 offset:61440
    ds_read_b64_tr_b16 a[182:183], v203 offset:62464
    ds_read_b64_tr_b16 a[236:237], v195 offset:1536
    v_add_f32 v219, v219, v220
    v_mfma_f32_32x32x16_bf16 v[0:15], a[152:155], v[152:155], v[0:15]
    ds_read_b64_tr_b16 a[238:239], v230 offset:1536
    v_exp_f32 v222, v54
    v_add_f32 v219, v219, v221
    v_cvt_pk_bf16_f32 v90, v220, v221
    v_mfma_f32_32x32x16_bf16 v[16:31], a[152:155], v[184:187], v[16:31]
    ds_read_b128 a[152:155], v211 offset:24576
    v_exp_f32 v223, v55
    v_add_f32 v219, v219, v222
    v_mfma_f32_32x32x16_bf16 a[96:111], a[184:187], v[64:67], a[96:111]
    ds_read_b128 a[228:231], v224 offset:352
    v_exp_f32 v220, v56
    v_add_f32 v219, v219, v223
    v_cvt_pk_bf16_f32 v91, v222, v223
    v_mfma_f32_32x32x16_bf16 a[112:127], a[184:187], v[72:75], a[112:127]
    ds_read_b64_tr_b16 a[184:185], v204 offset:57344
    ds_read_b64_tr_b16 a[186:187], v204 offset:58368
    v_exp_f32 v221, v57
    v_add_f32 v219, v219, v220
    v_mfma_f32_32x32x16_bf16 v[0:15], a[156:159], v[156:159], v[0:15]
    s_waitcnt lgkmcnt(9)
    v_mfma_f32_32x32x16_bf16 a[192:207], a[224:227], a[232:235], a[192:207]
    v_exp_f32 v222, v58
    v_add_f32 v219, v219, v221
    v_mfma_f32_32x32x16_bf16 v[16:31], a[156:159], v[188:191], v[16:31]
    ds_read_b128 a[156:159], v212 offset:24576
    v_cvt_pk_bf16_f32 v92, v220, v221
    v_exp_f32 v223, v59
    v_add_f32 v219, v219, v222
    v_mfma_f32_32x32x16_bf16 a[96:111], a[188:191], v[68:71], a[96:111]
    s_waitcnt lgkmcnt(3)
    v_mfma_f32_32x32x16_bf16 a[192:207], a[228:231], a[236:239], a[192:207]
    v_exp_f32 v220, v60
    v_add_f32 v219, v219, v223
    v_mfma_f32_32x32x16_bf16 a[112:127], a[188:191], v[76:79], a[112:127]
    ds_read_b64_tr_b16 a[188:189], v204 offset:61440
    ds_read_b64_tr_b16 a[190:191], v204 offset:62464
    v_cvt_pk_bf16_f32 v93, v222, v223
    v_exp_f32 v221, v61
    v_add_f32 v219, v219, v220
    v_exp_f32 v222, v62
    v_add_f32 v219, v219, v221
    v_cvt_pk_bf16_f32 v94, v220, v221
    v_exp_f32 v223, v63
    v_add_f32 v219, v219, v222
    v_add_f32 v219, v219, v223
    v_cvt_pk_bf16_f32 v95, v222, v223
    v_add_f32 v220, v218, v219
    v_cmp_nge_f32 s[94:95], s41, v220
    s_cmp_lg_u64 s[94:95], 0
    s_cbranch_scc1 L_ka_trp9
L_ka_retp9:
    v_add_f32 v216, v216, v218
    v_add_f32 v217, v217, v219
    s_barrier
    s_waitcnt lgkmcnt(3)
    v_mfma_f32_32x32x16_bf16 v[32:47], a[128:131], v[128:131], v[96:111]
    s_cmp_eq_u32 s48, 4
    s_cbranch_scc1 L_ka_o_do44
L_ka_o_rt44:
    v_exp_f32 v220, v0
    v_mfma_f32_32x32x16_bf16 v[48:63], a[128:131], v[160:163], v[112:127]
    ds_read_b128 a[128:131], v205 offset:32768
    s_waitcnt vmcnt(2)
    v_mfma_f32_32x32x16_bf16 a[0:15], a[160:163], v[80:83], a[0:15]
    s_add_u32 s36, s36, 8192
    s_add_u32 m0, s39, 0x2000
    s_nop 0
    buffer_load_dwordx4 v215, s[20:23], s36 offen offset:0 lds
    v_exp_f32 v221, v1
    v_mfma_f32_32x32x16_bf16 a[16:31], a[160:163], v[88:91], a[16:31]
    ds_read_b64_tr_b16 a[160:161], v201 offset:16384
    ds_read_b64_tr_b16 a[162:163], v201 offset:17408
    ds_read_b64_tr_b16 a[232:233], v195 offset:2048
    v_exp_f32 v222, v2
    v_mfma_f32_32x32x16_bf16 v[32:47], a[132:135], v[132:135], v[32:47]
    v_add_f32 v218, v220, v221
    v_cvt_pk_bf16_f32 v64, v220, v221
    v_exp_f32 v223, v3
    v_add_f32 v218, v218, v222
    v_mfma_f32_32x32x16_bf16 v[48:63], a[132:135], v[164:167], v[48:63]
    ds_read_b128 a[132:135], v206 offset:32768
    ds_read_b64_tr_b16 a[234:235], v230 offset:2048
    v_exp_f32 v220, v4
    v_add_f32 v218, v218, v223
    v_mfma_f32_32x32x16_bf16 a[0:15], a[164:167], v[84:87], a[0:15]
    ds_read_b128 a[224:227], v224 offset:384
    v_cvt_pk_bf16_f32 v65, v222, v223
    v_exp_f32 v221, v5
    v_add_f32 v218, v218, v220
    v_mfma_f32_32x32x16_bf16 a[16:31], a[164:167], v[92:95], a[16:31]
    ds_read_b64_tr_b16 a[164:165], v201 offset:20480
    ds_read_b64_tr_b16 a[166:167], v201 offset:21504
    v_exp_f32 v222, v6
    v_add_f32 v218, v218, v221
    v_mfma_f32_32x32x16_bf16 v[32:47], a[136:139], v[136:139], v[32:47]
    s_add_u32 m0, s39, 0x2000
    s_nop 0
    buffer_load_dwordx4 v215, s[20:23], s36 offen offset:1024 lds
    ds_read_b64_tr_b16 a[236:237], v195 offset:2560
    v_cvt_pk_bf16_f32 v66, v220, v221
    v_mfma_f32_32x32x16_bf16 v[48:63], a[136:139], v[168:171], v[48:63]
    ds_read_b128 a[136:139], v207 offset:32768
    v_exp_f32 v223, v7
    v_add_f32 v218, v218, v222
    v_mfma_f32_32x32x16_bf16 a[32:47], a[168:171], v[80:83], a[32:47]
    ds_read_b64_tr_b16 a[238:239], v230 offset:2560
    v_exp_f32 v220, v8
    v_add_f32 v218, v218, v223
    v_cvt_pk_bf16_f32 v67, v222, v223
    v_mfma_f32_32x32x16_bf16 a[48:63], a[168:171], v[88:91], a[48:63]
    ds_read_b64_tr_b16 a[168:169], v202 offset:16384
    ds_read_b64_tr_b16 a[170:171], v202 offset:17408
    ds_read_b128 a[228:231], v224 offset:416
    v_exp_f32 v221, v9
    v_mfma_f32_32x32x16_bf16 v[32:47], a[140:143], v[140:143], v[32:47]
    v_add_f32 v218, v218, v220
    v_exp_f32 v222, v10
    v_add_f32 v218, v218, v221
    v_cvt_pk_bf16_f32 v68, v220, v221
    v_mfma_f32_32x32x16_bf16 v[48:63], a[140:143], v[172:175], v[48:63]
    ds_read_b128 a[140:143], v208 offset:32768
    s_waitcnt lgkmcnt(9)
    v_mfma_f32_32x32x16_bf16 a[192:207], a[224:227], a[232:235], a[192:207]
    v_mfma_f32_32x32x16_bf16 a[32:47], a[172:175], v[84:87], a[32:47]
    v_exp_f32 v223, v11
    v_add_f32 v218, v218, v222
    v_exp_f32 v220, v12
    v_add_f32 v218, v218, v223
    v_mfma_f32_32x32x16_bf16 a[48:63], a[172:175], v[92:95], a[48:63]
    ds_read_b64_tr_b16 a[172:173], v202 offset:20480
    ds_read_b64_tr_b16 a[174:175], v202 offset:21504
    ds_read_b64_tr_b16 a[232:233], v195 offset:3072
    v_cvt_pk_bf16_f32 v69, v222, v223
    s_waitcnt lgkmcnt(3)
    v_mfma_f32_32x32x16_bf16 v[32:47], a[144:147], v[144:147], v[32:47]
    ds_read_b64_tr_b16 a[234:235], v230 offset:3072
    v_exp_f32 v221, v13
    v_add_f32 v218, v218, v220
    v_mfma_f32_32x32x16_bf16 v[48:63], a[144:147], v[176:179], v[48:63]
    ds_read_b128 a[144:147], v209 offset:32768
    v_exp_f32 v222, v14
    v_add_f32 v218, v218, v221
    v_cvt_pk_bf16_f32 v70, v220, v221
    v_mfma_f32_32x32x16_bf16 a[64:79], a[176:179], v[80:83], a[64:79]
    ds_read_b128 a[224:227], v224 offset:448
    v_exp_f32 v223, v15
    v_add_f32 v218, v218, v222
    v_mfma_f32_32x32x16_bf16 a[80:95], a[176:179], v[88:91], a[80:95]
    ds_read_b64_tr_b16 a[176:177], v203 offset:16384
    ds_read_b64_tr_b16 a[178:179], v203 offset:17408
    v_exp_f32 v220, v16
    v_add_f32 v218, v218, v223
    v_mfma_f32_32x32x16_bf16 v[32:47], a[148:151], v[148:151], v[32:47]
    v_mfma_f32_32x32x16_bf16 a[192:207], a[228:231], a[236:239], a[192:207]
    v_cvt_pk_bf16_f32 v71, v222, v223
    v_exp_f32 v221, v17
    v_mfma_f32_32x32x16_bf16 v[48:63], a[148:151], v[180:183], v[48:63]
    ds_read_b128 a[148:151], v210 offset:32768
    ds_read_b64_tr_b16 a[236:237], v195 offset:3584
    v_exp_f32 v222, v18
    v_add_f32 v219, v220, v221
    v_mfma_f32_32x32x16_bf16 a[64:79], a[180:183], v[84:87], a[64:79]
    v_cvt_pk_bf16_f32 v72, v220, v221
    v_exp_f32 v223, v19
    v_add_f32 v219, v219, v222
    v_exp_f32 v220, v20
    v_mfma_f32_32x32x16_bf16 a[80:95], a[180:183], v[92:95], a[80:95]
    ds_read_b64_tr_b16 a[180:181], v203 offset:20480
    ds_read_b64_tr_b16 a[182:183], v203 offset:21504
    ds_read_b64_tr_b16 a[238:239], v230 offset:3584
    v_add_f32 v219, v219, v223
    v_cvt_pk_bf16_f32 v73, v222, v223
    v_mfma_f32_32x32x16_bf16 v[32:47], a[152:155], v[152:155], v[32:47]
    v_exp_f32 v221, v21
    v_add_f32 v219, v219, v220
    v_exp_f32 v222, v22
    v_add_f32 v219, v219, v221
    v_mfma_f32_32x32x16_bf16 v[48:63], a[152:155], v[184:187], v[48:63]
    ds_read_b128 a[152:155], v211 offset:32768
    ds_read_b128 a[228:231], v224 offset:480
    v_cvt_pk_bf16_f32 v74, v220, v221
    v_exp_f32 v223, v23
    v_mfma_f32_32x32x16_bf16 a[96:111], a[184:187], v[80:83], a[96:111]
    s_waitcnt lgkmcnt(9)
    v_mfma_f32_32x32x16_bf16 a[192:207], a[224:227], a[232:235], a[192:207]
    v_add_f32 v219, v219, v222
    v_exp_f32 v220, v24
    v_mfma_f32_32x32x16_bf16 a[112:127], a[184:187], v[88:91], a[112:127]
    ds_read_b64_tr_b16 a[184:185], v204 offset:16384
    ds_read_b64_tr_b16 a[186:187], v204 offset:17408
    v_add_f32 v219, v219, v223
    v_cvt_pk_bf16_f32 v75, v222, v223
    v_mfma_f32_32x32x16_bf16 v[32:47], a[156:159], v[156:159], v[32:47]
    s_waitcnt lgkmcnt(2)
    v_mfma_f32_32x32x16_bf16 a[192:207], a[228:231], a[236:239], a[192:207]
    v_exp_f32 v221, v25
    v_add_f32 v219, v219, v220
    v_mfma_f32_32x32x16_bf16 v[48:63], a[156:159], v[188:191], v[48:63]
    ds_read_b128 a[156:159], v212 offset:32768
    v_exp_f32 v222, v26
    v_add_f32 v219, v219, v221
    v_cvt_pk_bf16_f32 v76, v220, v221
    v_mfma_f32_32x32x16_bf16 a[96:111], a[188:191], v[84:87], a[96:111]
    s_cmp_eq_u32 s28, 3
    s_cbranch_scc1 L_ka_o_do45
L_ka_o_rt45:
    v_exp_f32 v223, v27
    v_add_f32 v219, v219, v222
    v_mfma_f32_32x32x16_bf16 a[112:127], a[188:191], v[92:95], a[112:127]
    ds_read_b64_tr_b16 a[188:189], v204 offset:20480
    ds_read_b64_tr_b16 a[190:191], v204 offset:21504
    v_exp_f32 v220, v28
    v_add_f32 v219, v219, v223
    v_cvt_pk_bf16_f32 v77, v222, v223
    v_exp_f32 v221, v29
    v_add_f32 v219, v219, v220
    v_exp_f32 v222, v30
    v_add_f32 v219, v219, v221
    v_cvt_pk_bf16_f32 v78, v220, v221
    v_exp_f32 v223, v31
    v_add_f32 v219, v219, v222
    v_add_f32 v219, v219, v223
    v_cvt_pk_bf16_f32 v79, v222, v223
    v_add_f32 v220, v218, v219
    v_cmp_nge_f32 s[94:95], s41, v220
    s_cmp_lg_u64 s[94:95], 0
    s_cbranch_scc1 L_ka_trp10
L_ka_retp10:
    v_add_f32 v216, v216, v218
    v_add_f32 v217, v217, v219
    s_waitcnt lgkmcnt(3)
    v_mfma_f32_32x32x16_bf16 v[0:15], a[128:131], v[128:131], v[96:111]
    s_cmp_eq_u32 s48, 5
    s_cbranch_scc1 L_ka_o_do46
L_ka_o_rt46:
    v_exp_f32 v220, v32
    v_mfma_f32_32x32x16_bf16 v[16:31], a[128:131], v[160:163], v[112:127]
    ds_read_b128 a[128:131], v205 offset:40960
    v_exp_f32 v221, v33
    v_exp_f32 v222, v34
    v_mfma_f32_32x32x16_bf16 a[0:15], a[160:163], v[64:67], a[0:15]
    s_add_u32 s36, s36, 8192
    s_add_u32 m0, s39, 0x8000
    s_nop 0
    buffer_load_dwordx4 v215, s[20:23], s36 offen offset:0 lds
    s_add_u32 m0, s34, 0
    s_nop 0
    buffer_load_dwordx4 v194, s[72:75], s33 offen lds
    s_add_u32 s33, s33, 4096
    v_mfma_f32_32x32x16_bf16 a[16:31], a[160:163], v[72:75], a[16:31]
    ds_read_b64_tr_b16 a[160:161], v201 offset:40960
    ds_read_b64_tr_b16 a[162:163], v201 offset:41984
    v_add_f32 v218, v220, v221
    v_cvt_pk_bf16_f32 v80, v220, v221
    v_mfma_f32_32x32x16_bf16 v[0:15], a[132:135], v[132:135], v[0:15]
    v_exp_f32 v223, v35
    v_add_f32 v218, v218, v222
    v_exp_f32 v220, v36
    v_add_f32 v218, v218, v223
    v_mfma_f32_32x32x16_bf16 v[16:31], a[132:135], v[164:167], v[16:31]
    ds_read_b128 a[132:135], v206 offset:40960
    s_add_u32 m0, s34, 1024
    s_nop 0
    buffer_load_dwordx4 v225, s[72:75], s33 offen lds
    s_add_u32 s33, s33, 4096
    v_cvt_pk_bf16_f32 v81, v222, v223
    v_mfma_f32_32x32x16_bf16 a[0:15], a[164:167], v[68:71], a[0:15]
    v_exp_f32 v221, v37
    v_add_f32 v218, v218, v220
    v_exp_f32 v222, v38
    v_add_f32 v218, v218, v221
    v_mfma_f32_32x32x16_bf16 a[16:31], a[164:167], v[76:79], a[16:31]
    ds_read_b64_tr_b16 a[164:165], v201 offset:45056
    ds_read_b64_tr_b16 a[166:167], v201 offset:46080
    v_cvt_pk_bf16_f32 v82, v220, v221
    v_exp_f32 v223, v39
    v_mfma_f32_32x32x16_bf16 v[0:15], a[136:139], v[136:139], v[0:15]
    s_add_u32 m0, s39, 0x8000
    s_nop 0
    buffer_load_dwordx4 v215, s[20:23], s36 offen offset:1024 lds
    s_add_u32 m0, s34, 2048
    s_nop 0
    buffer_load_dwordx4 v194, s[72:75], s33 offen lds
    s_add_u32 s33, s33, 4096
    v_mfma_f32_32x32x16_bf16 v[16:31], a[136:139], v[168:171], v[16:31]
    ds_read_b128 a[136:139], v207 offset:40960
    v_add_f32 v218, v218, v222
    v_exp_f32 v220, v40
    v_add_f32 v218, v218, v223
    v_mfma_f32_32x32x16_bf16 a[32:47], a[168:171], v[64:67], a[32:47]
    v_cvt_pk_bf16_f32 v83, v222, v223
    v_exp_f32 v221, v41
    v_add_f32 v218, v218, v220
    v_exp_f32 v222, v42
    v_mfma_f32_32x32x16_bf16 a[48:63], a[168:171], v[72:75], a[48:63]
    ds_read_b64_tr_b16 a[168:169], v202 offset:40960
    ds_read_b64_tr_b16 a[170:171], v202 offset:41984
    s_add_u32 m0, s34, 3072
    s_nop 0
    buffer_load_dwordx4 v225, s[72:75], s33 offen lds
    s_add_u32 s33, s33, 4096
    v_mfma_f32_32x32x16_bf16 v[0:15], a[140:143], v[140:143], v[0:15]
    v_add_f32 v218, v218, v221
    v_cvt_pk_bf16_f32 v84, v220, v221
    v_exp_f32 v223, v43
    v_add_f32 v218, v218, v222
    v_mfma_f32_32x32x16_bf16 v[16:31], a[140:143], v[172:175], v[16:31]
    ds_read_b128 a[140:143], v208 offset:40960
    v_exp_f32 v220, v44
    v_add_f32 v218, v218, v223
    v_cvt_pk_bf16_f32 v85, v222, v223
    v_mfma_f32_32x32x16_bf16 a[32:47], a[172:175], v[68:71], a[32:47]
    v_accvgpr_read_b32 v251, a192
    s_lshl_b32 s3, s28, 7
    s_add_u32 s3, s3, 0xc800
    v_and_b32 v252, 31, v233
    v_lshl_add_u32 v252, v252, 2, s3
    ds_write_b32 v252, v251
    v_exp_f32 v221, v45
    v_add_f32 v218, v218, v220
    v_mfma_f32_32x32x16_bf16 a[48:63], a[172:175], v[76:79], a[48:63]
    ds_read_b64_tr_b16 a[172:173], v202 offset:45056
    ds_read_b64_tr_b16 a[174:175], v202 offset:46080
    v_exp_f32 v222, v46
    v_add_f32 v218, v218, v221
    s_waitcnt lgkmcnt(3)
    v_mfma_f32_32x32x16_bf16 v[0:15], a[144:147], v[144:147], v[0:15]
    v_cvt_pk_bf16_f32 v86, v220, v221
    v_exp_f32 v223, v47
    v_add_f32 v218, v218, v222
    v_exp_f32 v220, v48
    v_mfma_f32_32x32x16_bf16 v[16:31], a[144:147], v[176:179], v[16:31]
    ds_read_b128 a[144:147], v209 offset:40960
    s_add_u32 m0, s34, 4096
    s_nop 0
    buffer_load_dwordx4 v194, s[72:75], s33 offen lds
    s_add_u32 s33, s33, 4096
    v_add_f32 v218, v218, v223
    v_mfma_f32_32x32x16_bf16 a[64:79], a[176:179], v[64:67], a[64:79]
    v_cvt_pk_bf16_f32 v87, v222, v223
    v_exp_f32 v221, v49
    v_exp_f32 v222, v50
    v_add_f32 v219, v220, v221
    v_mfma_f32_32x32x16_bf16 a[80:95], a[176:179], v[72:75], a[80:95]
    ds_read_b64_tr_b16 a[176:177], v203 offset:40960
    ds_read_b64_tr_b16 a[178:179], v203 offset:41984
    v_cvt_pk_bf16_f32 v88, v220, v221
    v_exp_f32 v223, v51
    v_mfma_f32_32x32x16_bf16 v[0:15], a[148:151], v[148:151], v[0:15]
    s_add_u32 m0, s34, 5120
    s_nop 0
    buffer_load_dwordx4 v225, s[72:75], s33 offen lds
    s_add_u32 s33, s33, 4096
    v_add_f32 v219, v219, v222
    v_exp_f32 v220, v52
    v_mfma_f32_32x32x16_bf16 v[16:31], a[148:151], v[180:183], v[16:31]
    ds_read_b128 a[148:151], v210 offset:40960
    v_add_f32 v219, v219, v223
    v_cvt_pk_bf16_f32 v89, v222, v223
    v_exp_f32 v221, v53
    v_mfma_f32_32x32x16_bf16 a[64:79], a[180:183], v[68:71], a[64:79]
    v_add_f32 v219, v219, v220
    v_exp_f32 v222, v54
    v_add_f32 v219, v219, v221
    v_cvt_pk_bf16_f32 v90, v220, v221
    v_mfma_f32_32x32x16_bf16 a[80:95], a[180:183], v[76:79], a[80:95]
    ds_read_b64_tr_b16 a[180:181], v203 offset:45056
    ds_read_b64_tr_b16 a[182:183], v203 offset:46080
    s_add_u32 m0, s34, 6144
    s_nop 0
    buffer_load_dwordx4 v194, s[72:75], s33 offen lds
    s_add_u32 s33, s33, 4096
    v_mfma_f32_32x32x16_bf16 v[0:15], a[152:155], v[152:155], v[0:15]
    v_exp_f32 v223, v55
    v_add_f32 v219, v219, v222
    v_exp_f32 v220, v56
    v_add_f32 v219, v219, v223
    v_mfma_f32_32x32x16_bf16 v[16:31], a[152:155], v[184:187], v[16:31]
    ds_read_b128 a[152:155], v211 offset:40960
    v_cvt_pk_bf16_f32 v91, v222, v223
    v_exp_f32 v221, v57
    v_add_f32 v219, v219, v220
    v_mfma_f32_32x32x16_bf16 a[96:111], a[184:187], v[64:67], a[96:111]
    s_add_u32 m0, s34, 7168
    s_nop 0
    buffer_load_dwordx4 v225, s[72:75], s33 offen lds
    s_add_u32 s33, s33, 4096
    v_exp_f32 v222, v58
    v_add_f32 v219, v219, v221
    v_mfma_f32_32x32x16_bf16 a[112:127], a[184:187], v[72:75], a[112:127]
    ds_read_b64_tr_b16 a[184:185], v204 offset:40960
    ds_read_b64_tr_b16 a[186:187], v204 offset:41984
    v_cvt_pk_bf16_f32 v92, v220, v221
    v_exp_f32 v223, v59
    v_mfma_f32_32x32x16_bf16 v[0:15], a[156:159], v[156:159], v[0:15]
    v_add_f32 v219, v219, v222
    v_exp_f32 v220, v60
    v_add_f32 v219, v219, v223
    v_cvt_pk_bf16_f32 v93, v222, v223
    v_mfma_f32_32x32x16_bf16 v[16:31], a[156:159], v[188:191], v[16:31]
    ds_read_b128 a[156:159], v212 offset:40960
    s_waitcnt lgkmcnt(12)
    v_mfma_f32_32x32x16_bf16 a[96:111], a[188:191], v[68:71], a[96:111]
    v_exp_f32 v221, v61
    v_add_f32 v219, v219, v220
    v_exp_f32 v222, v62
    v_add_f32 v219, v219, v221
    v_mfma_f32_32x32x16_bf16 a[112:127], a[188:191], v[76:79], a[112:127]
    ds_read_b64_tr_b16 a[188:189], v204 offset:45056
    ds_read_b64_tr_b16 a[190:191], v204 offset:46080
    v_cvt_pk_bf16_f32 v94, v220, v221
    v_exp_f32 v223, v63
    v_add_f32 v219, v219, v222
    v_add_f32 v219, v219, v223
    v_cvt_pk_bf16_f32 v95, v222, v223
    v_add_f32 v220, v218, v219
    v_cmp_nge_f32 s[94:95], s41, v220
    s_cmp_lg_u64 s[94:95], 0
    s_cbranch_scc1 L_ka_trp11
L_ka_retp11:
    v_add_f32 v216, v216, v218
    v_add_f32 v217, v217, v219
    s_waitcnt vmcnt(12)
    s_barrier
    s_waitcnt lgkmcnt(3)
    v_mfma_f32_32x32x16_bf16 v[32:47], a[128:131], v[128:131], v[96:111]
    s_cmp_eq_u32 s48, 6
    s_cbranch_scc1 L_ka_o_do47
L_ka_o_rt47:
    v_and_b32 v251, 15, v233
    v_exp_f32 v220, v0
    v_mfma_f32_32x32x16_bf16 v[48:63], a[128:131], v[160:163], v[112:127]
    ds_read_b128 a[128:131], v205 offset:49152
    v_lshlrev_b32 v252, 2, v251
    v_exp_f32 v221, v1
    v_mfma_f32_32x32x16_bf16 a[0:15], a[160:163], v[80:83], a[0:15]
    v_add_u32 v252, 0xc800, v252
    v_exp_f32 v222, v2
    v_add_f32 v218, v220, v221
    v_cvt_pk_bf16_f32 v64, v220, v221
    v_mfma_f32_32x32x16_bf16 a[16:31], a[160:163], v[88:91], a[16:31]
    ds_read_b64_tr_b16 a[160:161], v201 offset:0
    ds_read_b64_tr_b16 a[162:163], v201 offset:1024
    ds_read_b32 v226, v252 offset:0
    v_exp_f32 v223, v3
    v_mfma_f32_32x32x16_bf16 v[32:47], a[132:135], v[132:135], v[32:47]
    ds_read_b32 v246, v252 offset:64
    v_add_f32 v218, v218, v222
    v_exp_f32 v220, v4
    v_add_f32 v218, v218, v223
    v_mfma_f32_32x32x16_bf16 v[48:63], a[132:135], v[164:167], v[48:63]
    ds_read_b128 a[132:135], v206 offset:49152
    ds_read_b32 v227, v252 offset:128
    v_cvt_pk_bf16_f32 v65, v222, v223
    v_exp_f32 v221, v5
    v_mfma_f32_32x32x16_bf16 a[0:15], a[164:167], v[84:87], a[0:15]
    ds_read_b32 v247, v252 offset:192
    v_add_f32 v218, v218, v220
    v_exp_f32 v222, v6
    v_add_f32 v218, v218, v221
    v_mfma_f32_32x32x16_bf16 a[16:31], a[164:167], v[92:95], a[16:31]
    ds_read_b64_tr_b16 a[164:165], v201 offset:4096
    ds_read_b64_tr_b16 a[166:167], v201 offset:5120
    ds_read_b32 v228, v252 offset:256
    v_cvt_pk_bf16_f32 v66, v220, v221
    v_mfma_f32_32x32x16_bf16 v[32:47], a[136:139], v[136:139], v[32:47]
    ds_read_b32 v248, v252 offset:320
    v_exp_f32 v223, v7
    v_add_f32 v218, v218, v222
    v_mfma_f32_32x32x16_bf16 v[48:63], a[136:139], v[168:171], v[48:63]
    ds_read_b128 a[136:139], v207 offset:49152
    ds_read_b32 v229, v252 offset:384
    v_exp_f32 v220, v8
    v_add_f32 v218, v218, v223
    v_mfma_f32_32x32x16_bf16 a[32:47], a[168:171], v[80:83], a[32:47]
    ds_read_b32 v249, v252 offset:448
    s_waitcnt lgkmcnt(0)
    v_cvt_pk_bf16_f32 v67, v222, v223
    v_mfma_f32_32x32x16_bf16 a[48:63], a[168:171], v[88:91], a[48:63]
    ds_read_b64_tr_b16 a[168:169], v202 offset:0
    ds_read_b64_tr_b16 a[170:171], v202 offset:1024
    v_add_f32 v226, v226, v227
    v_exp_f32 v221, v9
    v_mfma_f32_32x32x16_bf16 v[32:47], a[140:143], v[140:143], v[32:47]
    v_add_f32 v228, v228, v229
    v_add_f32 v218, v218, v220
    v_exp_f32 v222, v10
    v_add_f32 v218, v218, v221
    v_cvt_pk_bf16_f32 v68, v220, v221
    v_mfma_f32_32x32x16_bf16 v[48:63], a[140:143], v[172:175], v[48:63]
    ds_read_b128 a[140:143], v208 offset:49152
    v_add_f32 v246, v246, v247
    v_exp_f32 v223, v11
    v_add_f32 v218, v218, v222
    v_mfma_f32_32x32x16_bf16 a[32:47], a[172:175], v[84:87], a[32:47]
    v_add_f32 v248, v248, v249
    v_exp_f32 v220, v12
    v_add_f32 v218, v218, v223
    v_cvt_pk_bf16_f32 v69, v222, v223
    v_mfma_f32_32x32x16_bf16 a[48:63], a[172:175], v[92:95], a[48:63]
    ds_read_b64_tr_b16 a[172:173], v202 offset:4096
    ds_read_b64_tr_b16 a[174:175], v202 offset:5120
    v_add_f32 v226, v226, v228
    v_exp_f32 v221, v13
    s_waitcnt lgkmcnt(3)
    v_mfma_f32_32x32x16_bf16 v[32:47], a[144:147], v[144:147], v[32:47]
    v_add_f32 v246, v246, v248
    v_add_f32 v218, v218, v220
    v_exp_f32 v222, v14
    v_add_f32 v218, v218, v221
    v_cvt_pk_bf16_f32 v70, v220, v221
    v_mfma_f32_32x32x16_bf16 v[48:63], a[144:147], v[176:179], v[48:63]
    ds_read_b128 a[144:147], v209 offset:49152
    v_cvt_pk_bf16_f32 v253, v226, v246
    v_exp_f32 v223, v15
    v_add_f32 v218, v218, v222
    v_mfma_f32_32x32x16_bf16 a[64:79], a[176:179], v[80:83], a[64:79]
    v_lshlrev_b32 v226, 16, v253
    v_exp_f32 v220, v16
    v_add_f32 v218, v218, v223
    v_cvt_pk_bf16_f32 v71, v222, v223
    v_mfma_f32_32x32x16_bf16 a[80:95], a[176:179], v[88:91], a[80:95]
    ds_read_b64_tr_b16 a[176:177], v203 offset:0
    ds_read_b64_tr_b16 a[178:179], v203 offset:1024
    v_and_b32 v227, s49, v253
    v_exp_f32 v221, v17
    v_mfma_f32_32x32x16_bf16 v[32:47], a[148:151], v[148:151], v[32:47]
    v_mul_f32 v253, 0xbfb8aa3b, v226
    v_exp_f32 v222, v18
    v_add_f32 v219, v220, v221
    v_cvt_pk_bf16_f32 v72, v220, v221
    v_mfma_f32_32x32x16_bf16 v[48:63], a[148:151], v[180:183], v[48:63]
    ds_read_b128 a[148:151], v210 offset:49152
    v_exp_f32 v253, v253
    s_nop 0
    v_add_f32 v253, 1.0, v253
    v_mfma_f32_32x32x16_bf16 a[64:79], a[180:183], v[84:87], a[64:79]
    v_rcp_f32 v253, v253
    v_exp_f32 v223, v19
    v_add_f32 v219, v219, v222
    v_mfma_f32_32x32x16_bf16 a[80:95], a[180:183], v[92:95], a[80:95]
    ds_read_b64_tr_b16 a[180:181], v203 offset:4096
    ds_read_b64_tr_b16 a[182:183], v203 offset:5120
    v_mul_f32 v253, v253, v226
    v_exp_f32 v220, v20
    v_mfma_f32_32x32x16_bf16 v[32:47], a[152:155], v[152:155], v[32:47]
    v_cvt_pk_bf16_f32 v253, v253, v253
    v_add_f32 v219, v219, v223
    v_cvt_pk_bf16_f32 v73, v222, v223
    v_exp_f32 v221, v21
    v_add_f32 v219, v219, v220
    v_mfma_f32_32x32x16_bf16 v[48:63], a[152:155], v[184:187], v[48:63]
    ds_read_b128 a[152:155], v211 offset:49152
    v_and_b32 v253, s49, v253
    v_exp_f32 v222, v22
    v_add_f32 v219, v219, v221
    v_mfma_f32_32x32x16_bf16 a[96:111], a[184:187], v[80:83], a[96:111]
    v_mul_f32 v253, v253, v227
    v_cvt_pk_bf16_f32 v74, v220, v221
    v_exp_f32 v223, v23
    v_add_f32 v219, v219, v222
    v_mfma_f32_32x32x16_bf16 a[112:127], a[184:187], v[88:91], a[112:127]
    ds_read_b64_tr_b16 a[184:185], v204 offset:0
    ds_read_b64_tr_b16 a[186:187], v204 offset:1024
    v_cvt_pk_bf16_f32 v253, v253, v253
    v_exp_f32 v220, v24
    v_mfma_f32_32x32x16_bf16 v[32:47], a[156:159], v[156:159], v[32:47]
    v_lshlrev_b32 v254, 3, v233
    v_add_f32 v219, v219, v223
    v_cvt_pk_bf16_f32 v75, v222, v223
    v_exp_f32 v221, v25
    v_add_f32 v219, v219, v220
    v_mfma_f32_32x32x16_bf16 v[48:63], a[156:159], v[188:191], v[48:63]
    ds_read_b128 a[156:159], v212 offset:49152
    v_sub_u32 v254, v232, v254
    v_exp_f32 v222, v26
    v_add_f32 v219, v219, v221
    v_mfma_f32_32x32x16_bf16 a[96:111], a[188:191], v[84:87], a[96:111]
    v_lshl_add_u32 v254, v251, 1, v254
    v_cvt_pk_bf16_f32 v76, v220, v221
    v_exp_f32 v223, v27
    v_add_f32 v219, v219, v222
    v_mfma_f32_32x32x16_bf16 a[112:127], a[188:191], v[92:95], a[112:127]
    ds_read_b64_tr_b16 a[188:189], v204 offset:4096
    ds_read_b64_tr_b16 a[190:191], v204 offset:5120
    ds_write_b16 v254, v253
    v_exp_f32 v220, v28
    v_add_f32 v219, v219, v223
    v_cvt_pk_bf16_f32 v77, v222, v223
    v_exp_f32 v221, v29
    v_add_f32 v219, v219, v220
    v_exp_f32 v222, v30
    v_add_f32 v219, v219, v221
    v_cvt_pk_bf16_f32 v78, v220, v221
    v_exp_f32 v223, v31
    v_add_f32 v219, v219, v222
    v_add_f32 v219, v219, v223
    v_cvt_pk_bf16_f32 v79, v222, v223
    v_add_f32 v220, v218, v219
    v_cmp_nge_f32 s[94:95], s41, v220
    s_cmp_lg_u64 s[94:95], 0
    s_cbranch_scc1 L_ka_trp12
L_ka_retp12:
    v_add_f32 v216, v216, v218
    v_add_f32 v217, v217, v219
    s_waitcnt lgkmcnt(3)
    v_mfma_f32_32x32x16_bf16 v[0:15], a[128:131], v[128:131], v[96:111]
    s_cmp_eq_u32 s48, 7
    s_cbranch_scc1 L_ka_o_do48
L_ka_o_rt48:
    v_exp_f32 v220, v32
    v_mfma_f32_32x32x16_bf16 v[16:31], a[128:131], v[160:163], v[112:127]
    ds_read_b128 a[128:131], v205 offset:57344
    v_exp_f32 v221, v33
    v_exp_f32 v222, v34
    v_mfma_f32_32x32x16_bf16 a[0:15], a[160:163], v[64:67], a[0:15]
    v_add_f32 v218, v220, v221
    v_cvt_pk_bf16_f32 v80, v220, v221
    v_exp_f32 v223, v35
    v_add_f32 v218, v218, v222
    v_mfma_f32_32x32x16_bf16 a[16:31], a[160:163], v[72:75], a[16:31]
    ds_read_b64_tr_b16 a[160:161], v201 offset:24576
    ds_read_b64_tr_b16 a[162:163], v201 offset:25600
    v_exp_f32 v220, v36
    v_add_f32 v218, v218, v223
    v_mfma_f32_32x32x16_bf16 v[0:15], a[132:135], v[132:135], v[0:15]
    v_cvt_pk_bf16_f32 v81, v222, v223
    v_exp_f32 v221, v37
    v_add_f32 v218, v218, v220
    v_exp_f32 v222, v38
    v_mfma_f32_32x32x16_bf16 v[16:31], a[132:135], v[164:167], v[16:31]
    ds_read_b128 a[132:135], v206 offset:57344
    v_add_f32 v218, v218, v221
    v_cvt_pk_bf16_f32 v82, v220, v221
    v_exp_f32 v223, v39
    v_mfma_f32_32x32x16_bf16 a[0:15], a[164:167], v[68:71], a[0:15]
    v_add_f32 v218, v218, v222
    v_exp_f32 v220, v40
    v_add_f32 v218, v218, v223
    v_cvt_pk_bf16_f32 v83, v222, v223
    v_mfma_f32_32x32x16_bf16 a[16:31], a[164:167], v[76:79], a[16:31]
    ds_read_b64_tr_b16 a[164:165], v201 offset:28672
    ds_read_b64_tr_b16 a[166:167], v201 offset:29696
    v_exp_f32 v221, v41
    v_add_f32 v218, v218, v220
    v_mfma_f32_32x32x16_bf16 v[0:15], a[136:139], v[136:139], v[0:15]
    v_exp_f32 v222, v42
    v_add_f32 v218, v218, v221
    v_cvt_pk_bf16_f32 v84, v220, v221
    v_exp_f32 v223, v43
    v_mfma_f32_32x32x16_bf16 v[16:31], a[136:139], v[168:171], v[16:31]
    ds_read_b128 a[136:139], v207 offset:57344
    v_add_f32 v218, v218, v222
    v_exp_f32 v220, v44
    v_add_f32 v218, v218, v223
    v_mfma_f32_32x32x16_bf16 a[32:47], a[168:171], v[64:67], a[32:47]
    s_waitcnt lgkmcnt(7)
    v_cvt_pk_bf16_f32 v85, v222, v223
    v_exp_f32 v221, v45
    v_mfma_f32_32x32x16_bf16 a[48:63], a[168:171], v[72:75], a[48:63]
    ds_read_b64_tr_b16 a[168:169], v202 offset:24576
    ds_read_b64_tr_b16 a[170:171], v202 offset:25600
    v_add_f32 v218, v218, v220
    v_exp_f32 v222, v46
    v_mfma_f32_32x32x16_bf16 v[0:15], a[140:143], v[140:143], v[0:15]
    v_add_f32 v218, v218, v221
    v_cvt_pk_bf16_f32 v86, v220, v221
    v_exp_f32 v223, v47
    v_add_f32 v218, v218, v222
    v_mfma_f32_32x32x16_bf16 v[16:31], a[140:143], v[172:175], v[16:31]
    ds_read_b128 a[140:143], v208 offset:57344
    v_exp_f32 v220, v48
    v_add_f32 v218, v218, v223
    v_cvt_pk_bf16_f32 v87, v222, v223
    v_mfma_f32_32x32x16_bf16 a[32:47], a[172:175], v[68:71], a[32:47]
    v_exp_f32 v221, v49
    v_exp_f32 v222, v50
    v_add_f32 v219, v220, v221
    v_cvt_pk_bf16_f32 v88, v220, v221
    v_mfma_f32_32x32x16_bf16 a[48:63], a[172:175], v[76:79], a[48:63]
    ds_read_b64_tr_b16 a[172:173], v202 offset:28672
    ds_read_b64_tr_b16 a[174:175], v202 offset:29696
    v_exp_f32 v223, v51
    v_add_f32 v219, v219, v222
    s_waitcnt lgkmcnt(3)
    v_mfma_f32_32x32x16_bf16 v[0:15], a[144:147], v[144:147], v[0:15]
    v_exp_f32 v220, v52
    v_add_f32 v219, v219, v223
    v_cvt_pk_bf16_f32 v89, v222, v223
    v_exp_f32 v221, v53
    v_mfma_f32_32x32x16_bf16 v[16:31], a[144:147], v[176:179], v[16:31]
    ds_read_b128 a[144:147], v209 offset:57344
    v_add_f32 v219, v219, v220
    v_exp_f32 v222, v54
    v_add_f32 v219, v219, v221
    v_mfma_f32_32x32x16_bf16 a[64:79], a[176:179], v[64:67], a[64:79]
    v_cvt_pk_bf16_f32 v90, v220, v221
    v_exp_f32 v223, v55
    v_add_f32 v219, v219, v222
    v_exp_f32 v220, v56
    v_mfma_f32_32x32x16_bf16 a[80:95], a[176:179], v[72:75], a[80:95]
    ds_read_b64_tr_b16 a[176:177], v203 offset:24576
    ds_read_b64_tr_b16 a[178:179], v203 offset:25600
    v_add_f32 v219, v219, v223
    v_cvt_pk_bf16_f32 v91, v222, v223
    v_mfma_f32_32x32x16_bf16 v[0:15], a[148:151], v[148:151], v[0:15]
    v_exp_f32 v221, v57
    v_add_f32 v219, v219, v220
    v_exp_f32 v222, v58
    v_add_f32 v219, v219, v221
    v_mfma_f32_32x32x16_bf16 v[16:31], a[148:151], v[180:183], v[16:31]
    ds_read_b128 a[148:151], v210 offset:57344
    ds_read_b128 a[224:227], v224
    v_cvt_pk_bf16_f32 v92, v220, v221
    v_exp_f32 v223, v59
    v_mfma_f32_32x32x16_bf16 a[64:79], a[180:183], v[68:71], a[64:79]
    v_add_f32 v219, v219, v222
    v_exp_f32 v220, v60
    v_add_f32 v219, v219, v223
    v_cvt_pk_bf16_f32 v93, v222, v223
    v_mfma_f32_32x32x16_bf16 a[80:95], a[180:183], v[76:79], a[80:95]
    ds_read_b64_tr_b16 a[180:181], v203 offset:28672
    ds_read_b64_tr_b16 a[182:183], v203 offset:29696
    v_exp_f32 v221, v61
    v_add_f32 v219, v219, v220
    v_mfma_f32_32x32x16_bf16 v[0:15], a[152:155], v[152:155], v[0:15]
    v_exp_f32 v222, v62
    v_add_f32 v219, v219, v221
    v_cvt_pk_bf16_f32 v94, v220, v221
    v_exp_f32 v223, v63
    v_mfma_f32_32x32x16_bf16 v[16:31], a[152:155], v[184:187], v[16:31]
    ds_read_b128 a[152:155], v211 offset:57344
    v_add_f32 v219, v219, v222
    v_add_f32 v219, v219, v223
    v_cvt_pk_bf16_f32 v95, v222, v223
    v_add_f32 v220, v218, v219
    v_mfma_f32_32x32x16_bf16 a[96:111], a[184:187], v[64:67], a[96:111]
    v_cmp_nge_f32 s[94:95], s41, v220
    v_mfma_f32_32x32x16_bf16 a[112:127], a[184:187], v[72:75], a[112:127]
    ds_read_b64_tr_b16 a[184:185], v204 offset:24576
    ds_read_b64_tr_b16 a[186:187], v204 offset:25600
    v_mfma_f32_32x32x16_bf16 v[0:15], a[156:159], v[156:159], v[0:15]
    v_mfma_f32_32x32x16_bf16 v[16:31], a[156:159], v[188:191], v[16:31]
    ds_read_b128 a[156:159], v212 offset:57344
    v_mfma_f32_32x32x16_bf16 a[96:111], a[188:191], v[68:71], a[96:111]
    v_mfma_f32_32x32x16_bf16 a[112:127], a[188:191], v[76:79], a[112:127]
    ds_read_b64_tr_b16 a[188:189], v204 offset:28672
    ds_read_b64_tr_b16 a[190:191], v204 offset:29696
    s_cmp_lg_u64 s[94:95], 0
    s_cbranch_scc1 L_ka_trp13
L_ka_retp13:
    v_add_f32 v216, v216, v218
    v_add_f32 v217, v217, v219
    s_waitcnt vmcnt(6)
    s_barrier
    s_waitcnt lgkmcnt(3)
    v_mfma_f32_32x32x16_bf16 v[32:47], a[128:131], v[128:131], v[96:111]
    s_waitcnt vmcnt(0)
    v_exp_f32 v220, v0
    v_mfma_f32_32x32x16_bf16 v[48:63], a[128:131], v[160:163], v[112:127]
    s_lshl_b32 s3, s37, 12
    s_lshl_b32 s31, s28, 10
    s_add_u32 s33, s3, s31
    v_and_b32 v252, 31, v233
    v_lshlrev_b32 v252, 2, v252
    v_exp_f32 v221, v1
    v_mfma_f32_32x32x16_bf16 a[0:15], a[160:163], v[80:83], a[0:15]
    v_exp_f32 v222, v2
    v_add_f32 v218, v220, v221
    v_cvt_pk_bf16_f32 v64, v220, v221
    v_exp_f32 v223, v3
    v_mfma_f32_32x32x16_bf16 a[16:31], a[160:163], v[88:91], a[16:31]
    ds_read_b64_tr_b16 a[160:161], v201 offset:8192
    ds_read_b64_tr_b16 a[162:163], v201 offset:9216
    ds_read_b64_tr_b16 a[232:233], v197 offset:0
    v_add_f32 v218, v218, v222
    v_mfma_f32_32x32x16_bf16 v[32:47], a[132:135], v[132:135], v[32:47]
    v_exp_f32 v220, v4
    v_add_f32 v218, v218, v223
    v_cvt_pk_bf16_f32 v65, v222, v223
    v_exp_f32 v221, v5
    v_mfma_f32_32x32x16_bf16 v[48:63], a[132:135], v[164:167], v[48:63]
    ds_read_b64_tr_b16 a[234:235], v197 offset:2048
    v_add_f32 v218, v218, v220
    v_exp_f32 v222, v6
    v_add_f32 v218, v218, v221
    v_mfma_f32_32x32x16_bf16 a[0:15], a[164:167], v[84:87], a[0:15]
    v_cvt_pk_bf16_f32 v66, v220, v221
    v_exp_f32 v223, v7
    v_add_f32 v218, v218, v222
    v_exp_f32 v220, v8
    v_mfma_f32_32x32x16_bf16 a[16:31], a[164:167], v[92:95], a[16:31]
    ds_read_b64_tr_b16 a[164:165], v201 offset:12288
    ds_read_b64_tr_b16 a[166:167], v201 offset:13312
    ds_read_b64_tr_b16 a[236:237], v198 offset:0
    v_add_f32 v218, v218, v223
    v_cvt_pk_bf16_f32 v67, v222, v223
    v_mfma_f32_32x32x16_bf16 v[32:47], a[136:139], v[136:139], v[32:47]
    v_exp_f32 v221, v9
    v_add_f32 v218, v218, v220
    v_exp_f32 v222, v10
    v_add_f32 v218, v218, v221
    v_mfma_f32_32x32x16_bf16 v[48:63], a[136:139], v[168:171], v[48:63]
    ds_read_b64_tr_b16 a[238:239], v198 offset:2048
    v_cvt_pk_bf16_f32 v68, v220, v221
    v_exp_f32 v223, v11
    v_add_f32 v218, v218, v222
    v_mfma_f32_32x32x16_bf16 a[32:47], a[168:171], v[80:83], a[32:47]
    v_exp_f32 v220, v12
    v_add_f32 v218, v218, v223
    v_cvt_pk_bf16_f32 v69, v222, v223
    v_exp_f32 v221, v13
    v_mfma_f32_32x32x16_bf16 a[48:63], a[168:171], v[88:91], a[48:63]
    ds_read_b64_tr_b16 a[168:169], v202 offset:8192
    ds_read_b64_tr_b16 a[170:171], v202 offset:9216
    s_waitcnt lgkmcnt(6)
    v_mfma_f32_32x32x16_bf16 a[192:207], a[224:227], a[232:235], 0
    v_mfma_f32_32x32x16_bf16 v[32:47], a[140:143], v[140:143], v[32:47]
    v_add_f32 v218, v218, v220
    v_exp_f32 v222, v14
    v_add_f32 v218, v218, v221
    v_cvt_pk_bf16_f32 v70, v220, v221
    v_mfma_f32_32x32x16_bf16 v[48:63], a[140:143], v[172:175], v[48:63]
    ds_read_b64_tr_b16 a[232:233], v199 offset:0
    v_exp_f32 v223, v15
    v_add_f32 v218, v218, v222
    v_mfma_f32_32x32x16_bf16 a[32:47], a[172:175], v[84:87], a[32:47]
    v_exp_f32 v220, v16
    v_add_f32 v218, v218, v223
    v_cvt_pk_bf16_f32 v71, v222, v223
    v_exp_f32 v221, v17
    v_mfma_f32_32x32x16_bf16 a[48:63], a[172:175], v[92:95], a[48:63]
    ds_read_b64_tr_b16 a[172:173], v202 offset:12288
    ds_read_b64_tr_b16 a[174:175], v202 offset:13312
    ds_read_b64_tr_b16 a[234:235], v199 offset:2048
    v_exp_f32 v222, v18
    s_waitcnt lgkmcnt(3)
    v_mfma_f32_32x32x16_bf16 v[32:47], a[144:147], v[144:147], v[32:47]
    v_mfma_f32_32x32x16_bf16 a[208:223], a[224:227], a[236:239], 0
    v_add_f32 v219, v220, v221
    v_cvt_pk_bf16_f32 v72, v220, v221
    v_mfma_f32_32x32x16_bf16 v[48:63], a[144:147], v[176:179], v[48:63]
    v_exp_f32 v223, v19
    v_add_f32 v219, v219, v222
    v_exp_f32 v220, v20
    v_add_f32 v219, v219, v223
    v_mfma_f32_32x32x16_bf16 a[64:79], a[176:179], v[80:83], a[64:79]
    v_accvgpr_read_b32 v253, a192
    buffer_store_dword v253, v252, s[76:79], s33 offen offset:0 sc1
    v_cvt_pk_bf16_f32 v73, v222, v223
    v_exp_f32 v221, v21
    v_mfma_f32_32x32x16_bf16 a[80:95], a[176:179], v[88:91], a[80:95]
    ds_read_b64_tr_b16 a[176:177], v203 offset:8192
    ds_read_b64_tr_b16 a[178:179], v203 offset:9216
    v_add_f32 v219, v219, v220
    v_exp_f32 v222, v22
    v_mfma_f32_32x32x16_bf16 v[32:47], a[148:151], v[148:151], v[32:47]
    ds_read_b64_tr_b16 a[236:237], v200 offset:0
    v_add_f32 v219, v219, v221
    v_cvt_pk_bf16_f32 v74, v220, v221
    v_exp_f32 v223, v23
    v_mfma_f32_32x32x16_bf16 v[48:63], a[148:151], v[180:183], v[48:63]
    v_add_f32 v219, v219, v222
    v_exp_f32 v220, v24
    v_add_f32 v219, v219, v223
    v_cvt_pk_bf16_f32 v75, v222, v223
    v_mfma_f32_32x32x16_bf16 a[64:79], a[180:183], v[84:87], a[64:79]
    ds_read_b64_tr_b16 a[238:239], v200 offset:2048
    v_exp_f32 v221, v25
    v_add_f32 v219, v219, v220
    v_mfma_f32_32x32x16_bf16 a[80:95], a[180:183], v[92:95], a[80:95]
    ds_read_b64_tr_b16 a[180:181], v203 offset:12288
    ds_read_b64_tr_b16 a[182:183], v203 offset:13312
    v_exp_f32 v222, v26
    v_add_f32 v219, v219, v221
    v_mfma_f32_32x32x16_bf16 v[32:47], a[152:155], v[152:155], v[32:47]
    s_waitcnt lgkmcnt(6)
    v_mfma_f32_32x32x16_bf16 a[192:207], a[224:227], a[232:235], 0
    v_cvt_pk_bf16_f32 v76, v220, v221
    v_exp_f32 v223, v27
    v_mfma_f32_32x32x16_bf16 v[48:63], a[152:155], v[184:187], v[48:63]
    v_add_f32 v219, v219, v222
    v_exp_f32 v220, v28
    v_add_f32 v219, v219, v223
    v_cvt_pk_bf16_f32 v77, v222, v223
    v_mfma_f32_32x32x16_bf16 a[96:111], a[184:187], v[80:83], a[96:111]
    v_accvgpr_read_b32 v254, a208
    buffer_store_dword v254, v252, s[76:79], s33 offen offset:128 sc1
    v_exp_f32 v221, v29
    v_add_f32 v219, v219, v220
    v_mfma_f32_32x32x16_bf16 a[112:127], a[184:187], v[88:91], a[112:127]
    ds_read_b64_tr_b16 a[184:185], v204 offset:8192
    ds_read_b64_tr_b16 a[186:187], v204 offset:9216
    v_exp_f32 v222, v30
    v_add_f32 v219, v219, v221
    v_mfma_f32_32x32x16_bf16 v[32:47], a[156:159], v[156:159], v[32:47]
    ds_read_b64_tr_b16 a[232:233], v197 offset:256
    v_cvt_pk_bf16_f32 v78, v220, v221
    v_exp_f32 v223, v31
    v_add_f32 v219, v219, v222
    v_mfma_f32_32x32x16_bf16 v[48:63], a[156:159], v[188:191], v[48:63]
    v_add_f32 v219, v219, v223
    v_cvt_pk_bf16_f32 v79, v222, v223
    v_add_f32 v220, v218, v219
    v_cmp_nge_f32 s[94:95], s41, v220
    v_mfma_f32_32x32x16_bf16 a[96:111], a[188:191], v[84:87], a[96:111]
    ds_read_b64_tr_b16 a[234:235], v197 offset:2304
    v_mfma_f32_32x32x16_bf16 a[112:127], a[188:191], v[92:95], a[112:127]
    ds_read_b64_tr_b16 a[188:189], v204 offset:12288
    ds_read_b64_tr_b16 a[190:191], v204 offset:13312
    s_cmp_lg_u64 s[94:95], 0
    s_cbranch_scc1 L_ka_trp14
L_ka_retp14:
    v_add_f32 v216, v216, v218
    v_add_f32 v217, v217, v219
    s_waitcnt lgkmcnt(3)
    v_mfma_f32_32x32x16_bf16 a[0:15], a[160:163], v[64:67], a[0:15]
    v_mfma_f32_32x32x16_bf16 a[208:223], a[224:227], a[236:239], 0
    v_accvgpr_read_b32 v253, a192
    buffer_store_dword v253, v252, s[76:79], s33 offen offset:256 sc1
    v_exp_f32 v220, v32
    v_exp_f32 v221, v33
    v_exp_f32 v222, v34
    v_add_f32 v218, v220, v221
    v_mfma_f32_32x32x16_bf16 a[16:31], a[160:163], v[72:75], a[16:31]
    ds_read_b64_tr_b16 a[160:161], v201 offset:32768
    ds_read_b64_tr_b16 a[162:163], v201 offset:33792
    ds_read_b64_tr_b16 a[236:237], v198 offset:256
    v_cvt_pk_bf16_f32 v80, v220, v221
    v_exp_f32 v223, v35
    v_add_f32 v218, v218, v222
    v_exp_f32 v220, v36
    v_add_f32 v218, v218, v223
    v_cvt_pk_bf16_f32 v81, v222, v223
    v_mfma_f32_32x32x16_bf16 a[0:15], a[164:167], v[68:71], a[0:15]
    ds_read_b64_tr_b16 a[238:239], v198 offset:2304
    v_exp_f32 v221, v37
    v_add_f32 v218, v218, v220
    v_exp_f32 v222, v38
    v_add_f32 v218, v218, v221
    v_cvt_pk_bf16_f32 v82, v220, v221
    v_exp_f32 v223, v39
    v_add_f32 v218, v218, v222
    v_exp_f32 v220, v40
    v_mfma_f32_32x32x16_bf16 a[16:31], a[164:167], v[76:79], a[16:31]
    ds_read_b64_tr_b16 a[164:165], v201 offset:36864
    ds_read_b64_tr_b16 a[166:167], v201 offset:37888
    s_waitcnt lgkmcnt(8)
    v_mfma_f32_32x32x16_bf16 a[192:207], a[224:227], a[232:235], 0
    v_add_f32 v218, v218, v223
    v_cvt_pk_bf16_f32 v83, v222, v223
    v_exp_f32 v221, v41
    v_add_f32 v218, v218, v220
    v_exp_f32 v222, v42
    v_add_f32 v218, v218, v221
    v_mfma_f32_32x32x16_bf16 a[32:47], a[168:171], v[64:67], a[32:47]
    v_accvgpr_read_b32 v254, a208
    buffer_store_dword v254, v252, s[76:79], s33 offen offset:384 sc1
    ds_read_b64_tr_b16 a[232:233], v199 offset:256
    v_cvt_pk_bf16_f32 v84, v220, v221
    v_exp_f32 v223, v43
    v_add_f32 v218, v218, v222
    v_exp_f32 v220, v44
    v_add_f32 v218, v218, v223
    v_cvt_pk_bf16_f32 v85, v222, v223
    v_mfma_f32_32x32x16_bf16 a[48:63], a[168:171], v[72:75], a[48:63]
    ds_read_b64_tr_b16 a[168:169], v202 offset:32768
    ds_read_b64_tr_b16 a[170:171], v202 offset:33792
    v_exp_f32 v221, v45
    v_add_f32 v218, v218, v220
    v_exp_f32 v222, v46
    v_add_f32 v218, v218, v221
    v_cvt_pk_bf16_f32 v86, v220, v221
    v_exp_f32 v223, v47
    v_add_f32 v218, v218, v222
    v_mfma_f32_32x32x16_bf16 a[32:47], a[172:175], v[68:71], a[32:47]
    ds_read_b64_tr_b16 a[234:235], v199 offset:2304
    s_waitcnt lgkmcnt(6)
    v_mfma_f32_32x32x16_bf16 a[208:223], a[224:227], a[236:239], 0
    v_exp_f32 v220, v48
    v_add_f32 v218, v218, v223
    v_cvt_pk_bf16_f32 v87, v222, v223
    v_exp_f32 v221, v49
    v_exp_f32 v222, v50
    v_add_f32 v219, v220, v221
    v_mfma_f32_32x32x16_bf16 a[48:63], a[172:175], v[76:79], a[48:63]
    ds_read_b64_tr_b16 a[172:173], v202 offset:36864
    ds_read_b64_tr_b16 a[174:175], v202 offset:37888
    v_cvt_pk_bf16_f32 v88, v220, v221
    v_exp_f32 v223, v51
    v_add_f32 v219, v219, v222
    v_exp_f32 v220, v52
    v_add_f32 v219, v219, v223
    v_cvt_pk_bf16_f32 v89, v222, v223
    v_exp_f32 v221, v53
    v_add_f32 v219, v219, v220
    s_waitcnt lgkmcnt(3)
    v_mfma_f32_32x32x16_bf16 a[64:79], a[176:179], v[64:67], a[64:79]
    v_accvgpr_read_b32 v253, a192
    buffer_store_dword v253, v252, s[76:79], s33 offen offset:512 sc1
    ds_read_b64_tr_b16 a[236:237], v200 offset:256
    v_exp_f32 v222, v54
    v_add_f32 v219, v219, v221
    v_cvt_pk_bf16_f32 v90, v220, v221
    v_exp_f32 v223, v55
    v_add_f32 v219, v219, v222
    v_exp_f32 v220, v56
    v_mfma_f32_32x32x16_bf16 a[80:95], a[176:179], v[72:75], a[80:95]
    ds_read_b64_tr_b16 a[176:177], v203 offset:32768
    ds_read_b64_tr_b16 a[178:179], v203 offset:33792
    ds_read_b64_tr_b16 a[238:239], v200 offset:2304
    v_add_f32 v219, v219, v223
    v_cvt_pk_bf16_f32 v91, v222, v223
    v_exp_f32 v221, v57
    v_add_f32 v219, v219, v220
    v_exp_f32 v222, v58
    v_add_f32 v219, v219, v221
    v_cvt_pk_bf16_f32 v92, v220, v221
    v_mfma_f32_32x32x16_bf16 a[64:79], a[180:183], v[68:71], a[64:79]
    s_waitcnt lgkmcnt(6)
    v_mfma_f32_32x32x16_bf16 a[192:207], a[224:227], a[232:235], 0
    v_exp_f32 v223, v59
    v_add_f32 v219, v219, v222
    v_exp_f32 v220, v60
    v_add_f32 v219, v219, v223
    v_cvt_pk_bf16_f32 v93, v222, v223
    v_exp_f32 v221, v61
    v_add_f32 v219, v219, v220
    v_mfma_f32_32x32x16_bf16 a[80:95], a[180:183], v[76:79], a[80:95]
    ds_read_b64_tr_b16 a[180:181], v203 offset:36864
    ds_read_b64_tr_b16 a[182:183], v203 offset:37888
    v_accvgpr_read_b32 v254, a208
    buffer_store_dword v254, v252, s[76:79], s33 offen offset:640 sc1
    v_exp_f32 v222, v62
    v_add_f32 v219, v219, v221
    v_cvt_pk_bf16_f32 v94, v220, v221
    v_exp_f32 v223, v63
    v_add_f32 v219, v219, v222
    v_add_f32 v219, v219, v223
    v_mfma_f32_32x32x16_bf16 a[96:111], a[184:187], v[64:67], a[96:111]
    s_waitcnt lgkmcnt(2)
    v_mfma_f32_32x32x16_bf16 a[208:223], a[224:227], a[236:239], 0
    v_accvgpr_read_b32 v253, a192
    buffer_store_dword v253, v252, s[76:79], s33 offen offset:768 sc1
    v_cvt_pk_bf16_f32 v95, v222, v223
    v_add_f32 v220, v218, v219
    v_cmp_nge_f32 s[94:95], s41, v220
    v_mfma_f32_32x32x16_bf16 a[112:127], a[184:187], v[72:75], a[112:127]
    ds_read_b64_tr_b16 a[184:185], v204 offset:32768
    ds_read_b64_tr_b16 a[186:187], v204 offset:33792
    v_mfma_f32_32x32x16_bf16 a[96:111], a[188:191], v[68:71], a[96:111]
    s_nop 2
    v_accvgpr_read_b32 v254, a208
    buffer_store_dword v254, v252, s[76:79], s33 offen offset:896 sc1
    s_lshl_b32 s68, s30, 2
    s_add_u32 s68, s68, s28
    s_lshl_b32 s68, s68, 5
    s_add_u32 s68, s68, s29
    s_lshl_b32 s68, s68, 2
    s_add_u32 s68, s68, 4096
    s_mov_b32 s69, s43
    s_mov_b32 s70, s50
    v_mfma_f32_32x32x16_bf16 a[112:127], a[188:191], v[76:79], a[112:127]
    ds_read_b64_tr_b16 a[188:189], v204 offset:36864
    ds_read_b64_tr_b16 a[190:191], v204 offset:37888
    s_cmp_lg_u64 s[94:95], 0
    s_cbranch_scc1 L_ka_trp15
L_ka_retp15:
    v_add_f32 v216, v216, v218
    v_add_f32 v217, v217, v219
    s_waitcnt lgkmcnt(0)
    v_mov_b32 v52, v233
    s_bfe_u32 s34, s2, 0x10002
    s_and_b32 s3, s2, 1
    s_lshl_b32 s3, s3, 3
    s_bfe_u32 s29, s2, 0x30003
    s_add_u32 s29, s29, s3
    s_bfe_u32 s3, s2, 0x10001
    s_lshl_b32 s3, s3, 2
    s_lshr_b32 s30, s2, 6
    s_add_u32 s30, s30, s3
    v_lshrrev_b32 v53, 3, v52
    v_and_b32 v54, 7, v52
    v_and_b32 v55, 2, v53
    v_xor_b32 v54, v54, v55
    v_lshlrev_b32 v54, 4, v54
    v_lshl_add_u32 v208, v53, 11, v54
    v_add_u32 v209, 0x3c00, v208
    s_lshl_b32 s35, s34, 22
    s_lshl_b32 s3, s28, 15
    s_add_u32 s35, s35, s3
    s_lshl_b32 s3, s30, 8
    s_add_u32 s35, s35, s3
    s_lshl_b32 s3, s34, 7
    s_add_u32 s35, s35, s3
    s_xor_b32 s32, s35, 128
    s_lshl_b32 s33, s29, 2
    s_add_u32 s33, s33, s28
    s_lshl_b32 s31, s33, 5
    s_lshl_b32 s33, s33, 18
    s_lshl_b32 s3, s34, 17
    s_add_u32 s33, s33, s3
    s_lshl_b32 s37, s28, 11
    s_mov_b32 s38, s31
    s_bfe_u32 s39, s2, 0x10001
    s_lshl_b32 s3, s39, 21
    s_add_u32 s32, s32, s3
    s_add_u32 s35, s35, s3
    s_lshl_b32 s3, s39, 16
    s_add_u32 s33, s33, s3
    s_mov_b32 s8, s4
    s_mov_b32 s9, s5
    s_mov_b32 s10, 0x800000
    s_mov_b32 s11, 0x00020000
    v_and_b32 v60, 31, v52
    v_add_u32 v60, s38, v60
    v_lshlrev_b32 v61, 3, v60
    v_lshlrev_b32 v60, 11, v60
    v_lshrrev_b32 v62, 5, v52
    v_lshl_add_u32 v60, v62, 6, v60
    s_lshl_b32 s3, s30, 8
    s_lshl_b32 s31, s34, 7
    s_add_u32 s3, s3, s31
    buffer_load_dwordx4 v[96:99], v60, s[12:15], s3 offen offset:0
    buffer_load_dwordx4 v[100:103], v60, s[12:15], s3 offen offset:16
    buffer_load_dwordx4 v[104:107], v60, s[12:15], s3 offen offset:32
    buffer_load_dwordx4 v[108:111], v60, s[12:15], s3 offen offset:48
    buffer_load_dwordx2 v[112:113], v61, s[52:55], 0 offen sc1
    s_barrier
    v_mfma_f32_32x32x16_bf16 a[0:15], a[160:163], v[80:83], a[0:15]
    v_mov_b32 v220, v216
    v_mov_b32 v221, v217
    s_nop 0
    v_permlane32_swap_b32 v216, v220
    v_permlane32_swap_b32 v217, v221
    v_add_f32 v216, v216, v220
    v_rcp_f32 v216, v216
    v_add_f32 v217, v217, v221
    v_rcp_f32 v217, v217
    v_mfma_f32_32x32x16_bf16 a[16:31], a[160:163], v[88:91], a[16:31]
    v_mfma_f32_32x32x16_bf16 a[0:15], a[164:167], v[84:87], a[0:15]
    v_mfma_f32_32x32x16_bf16 a[16:31], a[164:167], v[92:95], a[16:31]
    v_mfma_f32_32x32x16_bf16 a[32:47], a[168:171], v[80:83], a[32:47]
    s_nop 0
    s_nop 0
    s_nop 0
    s_nop 0
    s_nop 0
    s_nop 0
    s_nop 0
    s_nop 0
    s_nop 0
    v_mfma_f32_32x32x16_bf16 a[48:63], a[168:171], v[88:91], a[48:63]
    v_accvgpr_read_b32 v0, a0
    v_accvgpr_read_b32 v1, a1
    v_accvgpr_read_b32 v2, a2
    v_accvgpr_read_b32 v3, a3
    v_accvgpr_read_b32 v4, a4
    v_accvgpr_read_b32 v5, a5
    v_accvgpr_read_b32 v6, a6
    v_accvgpr_read_b32 v7, a7
    v_pk_mul_f32 v[0:1], v[0:1], v[216:217] op_sel:[0,0] op_sel_hi:[1,0]
    v_mfma_f32_32x32x16_bf16 a[32:47], a[172:175], v[84:87], a[32:47]
    v_pk_mul_f32 v[2:3], v[2:3], v[216:217] op_sel:[0,0] op_sel_hi:[1,0]
    v_pk_mul_f32 v[4:5], v[4:5], v[216:217] op_sel:[0,0] op_sel_hi:[1,0]
    v_pk_mul_f32 v[6:7], v[6:7], v[216:217] op_sel:[0,0] op_sel_hi:[1,0]
    v_cvt_pk_bf16_f32 v8, v0, v1
    v_cvt_pk_bf16_f32 v9, v2, v3
    v_cvt_pk_bf16_f32 v10, v4, v5
    v_cvt_pk_bf16_f32 v11, v6, v7
    buffer_store_dwordx4 v[8:11], v196, s[24:27], s46 offen offset:0 sc1
    v_accvgpr_read_b32 v12, a8
    v_mfma_f32_32x32x16_bf16 a[48:63], a[172:175], v[92:95], a[48:63]
    v_accvgpr_read_b32 v13, a9
    v_accvgpr_read_b32 v14, a10
    v_accvgpr_read_b32 v15, a11
    v_accvgpr_read_b32 v16, a12
    v_accvgpr_read_b32 v17, a13
    v_accvgpr_read_b32 v18, a14
    v_accvgpr_read_b32 v19, a15
    v_pk_mul_f32 v[12:13], v[12:13], v[216:217] op_sel:[0,0] op_sel_hi:[1,0]
    v_pk_mul_f32 v[14:15], v[14:15], v[216:217] op_sel:[0,0] op_sel_hi:[1,0]
    v_mfma_f32_32x32x16_bf16 a[64:79], a[176:179], v[80:83], a[64:79]
    v_pk_mul_f32 v[16:17], v[16:17], v[216:217] op_sel:[0,0] op_sel_hi:[1,0]
    v_pk_mul_f32 v[18:19], v[18:19], v[216:217] op_sel:[0,0] op_sel_hi:[1,0]
    v_cvt_pk_bf16_f32 v20, v12, v13
    v_cvt_pk_bf16_f32 v21, v14, v15
    v_cvt_pk_bf16_f32 v22, v16, v17
    v_cvt_pk_bf16_f32 v23, v18, v19
    buffer_store_dwordx4 v[20:23], v196, s[24:27], s46 offen offset:1024 sc1
    v_accvgpr_read_b32 v24, a16
    v_accvgpr_read_b32 v25, a17
    v_mfma_f32_32x32x16_bf16 a[80:95], a[176:179], v[88:91], a[80:95]
    v_accvgpr_read_b32 v26, a18
    v_accvgpr_read_b32 v27, a19
    v_accvgpr_read_b32 v28, a20
    v_accvgpr_read_b32 v29, a21
    v_accvgpr_read_b32 v30, a22
    v_accvgpr_read_b32 v31, a23
    v_pk_mul_f32 v[24:25], v[24:25], v[216:217] op_sel:[0,1] op_sel_hi:[1,1]
    v_pk_mul_f32 v[26:27], v[26:27], v[216:217] op_sel:[0,1] op_sel_hi:[1,1]
    v_pk_mul_f32 v[28:29], v[28:29], v[216:217] op_sel:[0,1] op_sel_hi:[1,1]
    v_mfma_f32_32x32x16_bf16 a[64:79], a[180:183], v[84:87], a[64:79]
    v_pk_mul_f32 v[30:31], v[30:31], v[216:217] op_sel:[0,1] op_sel_hi:[1,1]
    v_cvt_pk_bf16_f32 v32, v24, v25
    v_cvt_pk_bf16_f32 v33, v26, v27
    v_cvt_pk_bf16_f32 v34, v28, v29
    v_cvt_pk_bf16_f32 v35, v30, v31
    buffer_store_dwordx4 v[32:35], v196, s[24:27], s47 offen offset:0 sc1
    v_accvgpr_read_b32 v36, a24
    v_accvgpr_read_b32 v37, a25
    v_accvgpr_read_b32 v38, a26
    v_mfma_f32_32x32x16_bf16 a[80:95], a[180:183], v[92:95], a[80:95]
    v_accvgpr_read_b32 v39, a27
    v_accvgpr_read_b32 v40, a28
    v_accvgpr_read_b32 v41, a29
    v_accvgpr_read_b32 v42, a30
    v_accvgpr_read_b32 v43, a31
    v_pk_mul_f32 v[36:37], v[36:37], v[216:217] op_sel:[0,1] op_sel_hi:[1,1]
    v_pk_mul_f32 v[38:39], v[38:39], v[216:217] op_sel:[0,1] op_sel_hi:[1,1]
    v_pk_mul_f32 v[40:41], v[40:41], v[216:217] op_sel:[0,1] op_sel_hi:[1,1]
    v_pk_mul_f32 v[42:43], v[42:43], v[216:217] op_sel:[0,1] op_sel_hi:[1,1]
    v_mfma_f32_32x32x16_bf16 a[96:111], a[184:187], v[80:83], a[96:111]
    v_cvt_pk_bf16_f32 v44, v36, v37
    v_cvt_pk_bf16_f32 v45, v38, v39
    v_cvt_pk_bf16_f32 v46, v40, v41
    v_cvt_pk_bf16_f32 v47, v42, v43
    buffer_store_dwordx4 v[44:47], v196, s[24:27], s47 offen offset:1024 sc1
    v_accvgpr_read_b32 v0, a32
    v_accvgpr_read_b32 v1, a33
    v_accvgpr_read_b32 v2, a34
    v_accvgpr_read_b32 v3, a35
    v_mfma_f32_32x32x16_bf16 a[112:127], a[184:187], v[88:91], a[112:127]
    v_accvgpr_read_b32 v4, a36
    v_accvgpr_read_b32 v5, a37
    v_accvgpr_read_b32 v6, a38
    v_accvgpr_read_b32 v7, a39
    v_pk_mul_f32 v[0:1], v[0:1], v[216:217] op_sel:[0,0] op_sel_hi:[1,0]
    v_pk_mul_f32 v[2:3], v[2:3], v[216:217] op_sel:[0,0] op_sel_hi:[1,0]
    v_pk_mul_f32 v[4:5], v[4:5], v[216:217] op_sel:[0,0] op_sel_hi:[1,0]
    v_pk_mul_f32 v[6:7], v[6:7], v[216:217] op_sel:[0,0] op_sel_hi:[1,0]
    v_cvt_pk_bf16_f32 v8, v0, v1
    v_mfma_f32_32x32x16_bf16 a[96:111], a[188:191], v[84:87], a[96:111]
    v_cvt_pk_bf16_f32 v9, v2, v3
    v_cvt_pk_bf16_f32 v10, v4, v5
    v_cvt_pk_bf16_f32 v11, v6, v7
    buffer_store_dwordx4 v[8:11], v196, s[24:27], s46 offen offset:2048 sc1
    v_accvgpr_read_b32 v12, a40
    v_accvgpr_read_b32 v13, a41
    v_accvgpr_read_b32 v14, a42
    v_accvgpr_read_b32 v15, a43
    v_accvgpr_read_b32 v16, a44
    v_mfma_f32_32x32x16_bf16 a[112:127], a[188:191], v[92:95], a[112:127]
    v_accvgpr_read_b32 v17, a45
    v_accvgpr_read_b32 v18, a46
    v_accvgpr_read_b32 v19, a47
    v_pk_mul_f32 v[12:13], v[12:13], v[216:217] op_sel:[0,0] op_sel_hi:[1,0]
    v_pk_mul_f32 v[14:15], v[14:15], v[216:217] op_sel:[0,0] op_sel_hi:[1,0]
    v_pk_mul_f32 v[16:17], v[16:17], v[216:217] op_sel:[0,0] op_sel_hi:[1,0]
    v_pk_mul_f32 v[18:19], v[18:19], v[216:217] op_sel:[0,0] op_sel_hi:[1,0]
    v_cvt_pk_bf16_f32 v20, v12, v13
    v_cvt_pk_bf16_f32 v21, v14, v15
    v_cvt_pk_bf16_f32 v22, v16, v17
    v_cvt_pk_bf16_f32 v23, v18, v19
    buffer_store_dwordx4 v[20:23], v196, s[24:27], s46 offen offset:3072 sc1
    v_accvgpr_read_b32 v24, a48
    v_accvgpr_read_b32 v25, a49
    v_accvgpr_read_b32 v26, a50
    v_accvgpr_read_b32 v27, a51
    v_accvgpr_read_b32 v28, a52
    v_accvgpr_read_b32 v29, a53
    v_accvgpr_read_b32 v30, a54
    v_accvgpr_read_b32 v31, a55
    v_pk_mul_f32 v[24:25], v[24:25], v[216:217] op_sel:[0,1] op_sel_hi:[1,1]
    v_pk_mul_f32 v[26:27], v[26:27], v[216:217] op_sel:[0,1] op_sel_hi:[1,1]
    v_pk_mul_f32 v[28:29], v[28:29], v[216:217] op_sel:[0,1] op_sel_hi:[1,1]
    v_pk_mul_f32 v[30:31], v[30:31], v[216:217] op_sel:[0,1] op_sel_hi:[1,1]
    v_cvt_pk_bf16_f32 v32, v24, v25
    v_cvt_pk_bf16_f32 v33, v26, v27
    v_cvt_pk_bf16_f32 v34, v28, v29
    v_cvt_pk_bf16_f32 v35, v30, v31
    buffer_store_dwordx4 v[32:35], v196, s[24:27], s47 offen offset:2048 sc1
    v_accvgpr_read_b32 v36, a56
    v_accvgpr_read_b32 v37, a57
    v_accvgpr_read_b32 v38, a58
    v_accvgpr_read_b32 v39, a59
    v_accvgpr_read_b32 v40, a60
    v_accvgpr_read_b32 v41, a61
    v_accvgpr_read_b32 v42, a62
    v_accvgpr_read_b32 v43, a63
    v_pk_mul_f32 v[36:37], v[36:37], v[216:217] op_sel:[0,1] op_sel_hi:[1,1]
    v_pk_mul_f32 v[38:39], v[38:39], v[216:217] op_sel:[0,1] op_sel_hi:[1,1]
    v_pk_mul_f32 v[40:41], v[40:41], v[216:217] op_sel:[0,1] op_sel_hi:[1,1]
    v_pk_mul_f32 v[42:43], v[42:43], v[216:217] op_sel:[0,1] op_sel_hi:[1,1]
    v_cvt_pk_bf16_f32 v44, v36, v37
    v_cvt_pk_bf16_f32 v45, v38, v39
    v_cvt_pk_bf16_f32 v46, v40, v41
    v_cvt_pk_bf16_f32 v47, v42, v43
    buffer_store_dwordx4 v[44:47], v196, s[24:27], s47 offen offset:3072 sc1
    v_accvgpr_read_b32 v0, a64
    v_accvgpr_read_b32 v1, a65
    v_accvgpr_read_b32 v2, a66
    v_accvgpr_read_b32 v3, a67
    v_accvgpr_read_b32 v4, a68
    v_accvgpr_read_b32 v5, a69
    v_accvgpr_read_b32 v6, a70
    v_accvgpr_read_b32 v7, a71
    v_pk_mul_f32 v[0:1], v[0:1], v[216:217] op_sel:[0,0] op_sel_hi:[1,0]
    v_pk_mul_f32 v[2:3], v[2:3], v[216:217] op_sel:[0,0] op_sel_hi:[1,0]
    v_pk_mul_f32 v[4:5], v[4:5], v[216:217] op_sel:[0,0] op_sel_hi:[1,0]
    v_pk_mul_f32 v[6:7], v[6:7], v[216:217] op_sel:[0,0] op_sel_hi:[1,0]
    v_cvt_pk_bf16_f32 v8, v0, v1
    v_cvt_pk_bf16_f32 v9, v2, v3
    v_cvt_pk_bf16_f32 v10, v4, v5
    v_cvt_pk_bf16_f32 v11, v6, v7
    buffer_store_dwordx4 v[8:11], v236, s[24:27], s46 offen offset:0 sc1
    v_accvgpr_read_b32 v12, a72
    v_accvgpr_read_b32 v13, a73
    v_accvgpr_read_b32 v14, a74
    v_accvgpr_read_b32 v15, a75
    v_accvgpr_read_b32 v16, a76
    v_accvgpr_read_b32 v17, a77
    v_accvgpr_read_b32 v18, a78
    v_accvgpr_read_b32 v19, a79
    v_pk_mul_f32 v[12:13], v[12:13], v[216:217] op_sel:[0,0] op_sel_hi:[1,0]
    v_pk_mul_f32 v[14:15], v[14:15], v[216:217] op_sel:[0,0] op_sel_hi:[1,0]
    v_pk_mul_f32 v[16:17], v[16:17], v[216:217] op_sel:[0,0] op_sel_hi:[1,0]
    v_pk_mul_f32 v[18:19], v[18:19], v[216:217] op_sel:[0,0] op_sel_hi:[1,0]
    v_cvt_pk_bf16_f32 v20, v12, v13
    v_cvt_pk_bf16_f32 v21, v14, v15
    v_cvt_pk_bf16_f32 v22, v16, v17
    v_cvt_pk_bf16_f32 v23, v18, v19
    buffer_store_dwordx4 v[20:23], v236, s[24:27], s46 offen offset:1024 sc1
    v_accvgpr_read_b32 v24, a80
    v_accvgpr_read_b32 v25, a81
    v_accvgpr_read_b32 v26, a82
    v_accvgpr_read_b32 v27, a83
    v_accvgpr_read_b32 v28, a84
    v_accvgpr_read_b32 v29, a85
    v_accvgpr_read_b32 v30, a86
    v_accvgpr_read_b32 v31, a87
    v_pk_mul_f32 v[24:25], v[24:25], v[216:217] op_sel:[0,1] op_sel_hi:[1,1]
    v_pk_mul_f32 v[26:27], v[26:27], v[216:217] op_sel:[0,1] op_sel_hi:[1,1]
    v_pk_mul_f32 v[28:29], v[28:29], v[216:217] op_sel:[0,1] op_sel_hi:[1,1]
    v_pk_mul_f32 v[30:31], v[30:31], v[216:217] op_sel:[0,1] op_sel_hi:[1,1]
    v_cvt_pk_bf16_f32 v32, v24, v25
    v_cvt_pk_bf16_f32 v33, v26, v27
    v_cvt_pk_bf16_f32 v34, v28, v29
    v_cvt_pk_bf16_f32 v35, v30, v31
    buffer_store_dwordx4 v[32:35], v236, s[24:27], s47 offen offset:0 sc1
    v_accvgpr_read_b32 v36, a88
    v_accvgpr_read_b32 v37, a89
    v_accvgpr_read_b32 v38, a90
    v_accvgpr_read_b32 v39, a91
    v_accvgpr_read_b32 v40, a92
    v_accvgpr_read_b32 v41, a93
    v_accvgpr_read_b32 v42, a94
    v_accvgpr_read_b32 v43, a95
    v_pk_mul_f32 v[36:37], v[36:37], v[216:217] op_sel:[0,1] op_sel_hi:[1,1]
    v_pk_mul_f32 v[38:39], v[38:39], v[216:217] op_sel:[0,1] op_sel_hi:[1,1]
    v_pk_mul_f32 v[40:41], v[40:41], v[216:217] op_sel:[0,1] op_sel_hi:[1,1]
    v_pk_mul_f32 v[42:43], v[42:43], v[216:217] op_sel:[0,1] op_sel_hi:[1,1]
    v_cvt_pk_bf16_f32 v44, v36, v37
    v_cvt_pk_bf16_f32 v45, v38, v39
    v_cvt_pk_bf16_f32 v46, v40, v41
    v_cvt_pk_bf16_f32 v47, v42, v43
    buffer_store_dwordx4 v[44:47], v236, s[24:27], s47 offen offset:1024 sc1
    v_accvgpr_read_b32 v0, a96
    v_accvgpr_read_b32 v1, a97
    v_accvgpr_read_b32 v2, a98
    v_accvgpr_read_b32 v3, a99
    v_accvgpr_read_b32 v4, a100
    v_accvgpr_read_b32 v5, a101
    v_accvgpr_read_b32 v6, a102
    v_accvgpr_read_b32 v7, a103
    v_pk_mul_f32 v[0:1], v[0:1], v[216:217] op_sel:[0,0] op_sel_hi:[1,0]
    v_pk_mul_f32 v[2:3], v[2:3], v[216:217] op_sel:[0,0] op_sel_hi:[1,0]
    v_pk_mul_f32 v[4:5], v[4:5], v[216:217] op_sel:[0,0] op_sel_hi:[1,0]
    v_pk_mul_f32 v[6:7], v[6:7], v[216:217] op_sel:[0,0] op_sel_hi:[1,0]
    v_cvt_pk_bf16_f32 v8, v0, v1
    v_cvt_pk_bf16_f32 v9, v2, v3
    v_cvt_pk_bf16_f32 v10, v4, v5
    v_cvt_pk_bf16_f32 v11, v6, v7
    buffer_store_dwordx4 v[8:11], v236, s[24:27], s46 offen offset:2048 sc1
    v_accvgpr_read_b32 v12, a104
    v_accvgpr_read_b32 v13, a105
    v_accvgpr_read_b32 v14, a106
    v_accvgpr_read_b32 v15, a107
    v_accvgpr_read_b32 v16, a108
    v_accvgpr_read_b32 v17, a109
    v_accvgpr_read_b32 v18, a110
    v_accvgpr_read_b32 v19, a111
    v_pk_mul_f32 v[12:13], v[12:13], v[216:217] op_sel:[0,0] op_sel_hi:[1,0]
    v_pk_mul_f32 v[14:15], v[14:15], v[216:217] op_sel:[0,0] op_sel_hi:[1,0]
    v_pk_mul_f32 v[16:17], v[16:17], v[216:217] op_sel:[0,0] op_sel_hi:[1,0]
    v_pk_mul_f32 v[18:19], v[18:19], v[216:217] op_sel:[0,0] op_sel_hi:[1,0]
    v_cvt_pk_bf16_f32 v20, v12, v13
    v_cvt_pk_bf16_f32 v21, v14, v15
    v_cvt_pk_bf16_f32 v22, v16, v17
    v_cvt_pk_bf16_f32 v23, v18, v19
    buffer_store_dwordx4 v[20:23], v236, s[24:27], s46 offen offset:3072 sc1
    v_accvgpr_read_b32 v24, a112
    v_accvgpr_read_b32 v25, a113
    v_accvgpr_read_b32 v26, a114
    v_accvgpr_read_b32 v27, a115
    v_accvgpr_read_b32 v28, a116
    v_accvgpr_read_b32 v29, a117
    v_accvgpr_read_b32 v30, a118
    v_accvgpr_read_b32 v31, a119
    v_pk_mul_f32 v[24:25], v[24:25], v[216:217] op_sel:[0,1] op_sel_hi:[1,1]
    v_pk_mul_f32 v[26:27], v[26:27], v[216:217] op_sel:[0,1] op_sel_hi:[1,1]
    v_pk_mul_f32 v[28:29], v[28:29], v[216:217] op_sel:[0,1] op_sel_hi:[1,1]
    v_pk_mul_f32 v[30:31], v[30:31], v[216:217] op_sel:[0,1] op_sel_hi:[1,1]
    v_cvt_pk_bf16_f32 v32, v24, v25
    v_cvt_pk_bf16_f32 v33, v26, v27
    v_cvt_pk_bf16_f32 v34, v28, v29
    v_cvt_pk_bf16_f32 v35, v30, v31
    buffer_store_dwordx4 v[32:35], v236, s[24:27], s47 offen offset:2048 sc1
    v_accvgpr_read_b32 v36, a120
    v_accvgpr_read_b32 v37, a121
    v_accvgpr_read_b32 v38, a122
    v_accvgpr_read_b32 v39, a123
    v_accvgpr_read_b32 v40, a124
    v_accvgpr_read_b32 v41, a125
    v_accvgpr_read_b32 v42, a126
    v_accvgpr_read_b32 v43, a127
    v_pk_mul_f32 v[36:37], v[36:37], v[216:217] op_sel:[0,1] op_sel_hi:[1,1]
    v_pk_mul_f32 v[38:39], v[38:39], v[216:217] op_sel:[0,1] op_sel_hi:[1,1]
    v_pk_mul_f32 v[40:41], v[40:41], v[216:217] op_sel:[0,1] op_sel_hi:[1,1]
    v_pk_mul_f32 v[42:43], v[42:43], v[216:217] op_sel:[0,1] op_sel_hi:[1,1]
    v_cvt_pk_bf16_f32 v44, v36, v37
    v_cvt_pk_bf16_f32 v45, v38, v39
    v_cvt_pk_bf16_f32 v46, v40, v41
    v_cvt_pk_bf16_f32 v47, v42, v43
    buffer_store_dwordx4 v[44:47], v236, s[24:27], s47 offen offset:3072 sc1
L_ka_fuse:
    v_mov_b32 v226, v52
    v_lshlrev_b32 v212, 4, v52
    s_mov_b64 s[44:45], s[12:13]
    s_mov_b64 s[46:47], s[96:97]
    s_add_u32 s12, s6, 0x400000
    s_addc_u32 s13, s7, 0
    s_mov_b32 s14, 0x1000000
    s_mov_b32 s15, 0x00020000
    s_mov_b32 s42, s69
    s_mov_b32 s43, s70
    s_mov_b32 s16, s44
    s_mov_b32 s17, s45
    s_mov_b32 s18, 0x400000
    s_mov_b32 s19, 0x00020000
    s_add_u32 s20, s6, 0x1c08000
    s_addc_u32 s21, s7, 0
    s_mov_b32 s22, 0x4000
    s_mov_b32 s23, 0x00020000
    s_mov_b32 s24, s46
    s_mov_b32 s25, s47
    s_mov_b32 s26, 0x400000
    s_mov_b32 s27, 0x00020000
    s_add_u32 s48, s6, 0x1d00000
    s_addc_u32 s49, s7, 0
    s_mov_b32 s50, 0xe0000
    s_mov_b32 s51, 0x00020000
    s_add_u32 s52, s6, 0x2800000
    s_addc_u32 s53, s7, 0
    s_mov_b32 s54, 0x800000
    s_mov_b32 s55, 0x00020000
    s_mov_b32 s41, 0xffff0000
    v_lshrrev_b32 v55, 5, v52
    v_bfe_u32 v56, v52, 2, 2
    v_lshl_add_u32 v57, v55, 3, v56
    v_lshlrev_b32 v57, 7, v57
    v_and_b32 v58, 1, v52
    v_lshl_add_u32 v57, v58, 6, v57
    v_bfe_u32 v58, v52, 4, 1
    v_lshl_add_u32 v57, v58, 4, v57
    v_bfe_u32 v58, v52, 1, 1
    v_lshl_add_u32 v57, v58, 3, v57
    v_bfe_u32 v58, v52, 3, 1
    v_lshl_add_u32 v215, v58, 5, v57
    v_xor_b32 v58, 1, v58
    v_lshl_add_u32 v216, v58, 5, v57
    v_add_u32 v213, 0x10000, v215
    v_add_u32 v214, 0x10000, v216
    v_add_u32 v217, 0x20000, v215
    v_add_u32 v218, 0x20000, v216
    v_and_b32 v56, 31, v52
    v_add_u32 v222, s38, v56
    s_lshl_b32 s63, s30, 7
    s_lshl_b32 s3, s34, 6
    s_add_u32 s63, s63, s3
    v_lshlrev_b32 v56, 11, v222
    v_lshl_add_u32 v56, v55, 6, v56
    s_lshl_b32 s3, s63, 1
    v_add_u32 v221, s3, v56
    s_lshl_b32 s3, s29, 3
    s_add_u32 s3, s3, s30
    s_lshl_b32 s3, s3, 1
    s_add_u32 s3, s3, s34
    s_lshl_b32 s3, s3, 2
    s_add_u32 s62, s3, s28
    s_xor_b32 s61, s62, 4
    s_add_u32 s56, s6, 0x1c10000
    s_addc_u32 s57, s7, 0
    s_mov_b32 s58, 0x2000
    s_mov_b32 s59, 0x00020000
    s_lshr_b32 s3, s42, 7
    s_cmp_eq_u32 s3, s29
    s_cselect_b32 s60, 1, 0
    v_mov_b32 v53, s68
    v_mov_b32 v54, 1
    s_lshl_b32 s3, s29, 2
    s_add_u32 s3, s3, s28
    s_lshr_b32 s3, s3, 1
    s_lshl_b32 s3, s3, 7
    s_lshl_b32 s31, s34, 6
    s_add_u32 s3, s3, s31
    s_add_u32 s3, s3, 4096
    v_and_b32 v55, 7, v52
    v_lshl_add_u32 v55, v55, 2, s3
    s_lshl_b32 s31, s39, 5
    v_add_u32 v55, s31, v55
    v_xor_b32 v246, 32, v55
    s_waitcnt vmcnt(0)
    s_mov_b64 exec, 1
    buffer_store_dword v54, v53, s[56:59], 0 offen sc1
    s_mov_b64 exec, -1
    s_add_u32 m0, s37, 0x0
    s_nop 0
    buffer_load_dwordx4 v208, s[8:11], s32 offen offset:0 lds
    buffer_load_dwordx4 v209, s[8:11], s32 offen offset:1024 lds
    s_add_u32 m0, s37, 0x10000
    s_nop 0
    buffer_load_dwordx4 v208, s[8:11], s35 offen offset:0 lds
    buffer_load_dwordx4 v209, s[8:11], s35 offen offset:1024 lds
    s_add_u32 s32, s32, 0x20000
    s_add_u32 m0, s37, 0x2000
    s_nop 0
    buffer_load_dwordx4 v208, s[8:11], s32 offen offset:0 lds
    buffer_load_dwordx4 v209, s[8:11], s32 offen offset:1024 lds
    s_add_u32 s35, s35, 0x20000
    s_add_u32 m0, s37, 0x12000
    s_nop 0
    buffer_load_dwordx4 v208, s[8:11], s35 offen offset:0 lds
    buffer_load_dwordx4 v209, s[8:11], s35 offen offset:1024 lds
    v_lshlrev_b32 v128, 16, v96
    v_and_b32 v129, s41, v96
    v_sub_f32 v228, v128, v112
    v_sub_f32 v229, v129, v112
    v_cvt_pk_bf16_f32 v230, v228, v229
    v_lshlrev_b32 v228, 16, v230
    v_and_b32 v229, s41, v230
    v_mul_f32 v228, v228, v113
    v_mul_f32 v229, v229, v113
    v_cvt_pk_bf16_f32 v230, v228, v229
    v_lshlrev_b32 v160, 16, v230
    v_and_b32 v161, s41, v230
    v_mul_f32 v228, 0xbfb8aa3b, v160
    v_mul_f32 v229, 0xbfb8aa3b, v161
    v_exp_f32 v228, v228
    v_exp_f32 v229, v229
    v_add_f32 v228, 1.0, v228
    v_add_f32 v229, 1.0, v229
    v_rcp_f32 v228, v228
    v_rcp_f32 v229, v229
    v_mul_f32 v228, v228, v160
    v_mul_f32 v229, v229, v161
    v_cvt_pk_bf16_f32 v230, v228, v229
    v_lshlrev_b32 v160, 16, v230
    v_and_b32 v161, s41, v230
    v_lshlrev_b32 v130, 16, v97
    v_and_b32 v131, s41, v97
    v_sub_f32 v232, v130, v112
    v_sub_f32 v233, v131, v112
    s_add_u32 s32, s32, 0x20000
    s_add_u32 m0, s37, 0x4000
    s_nop 0
    buffer_load_dwordx4 v208, s[8:11], s32 offen offset:0 lds
    buffer_load_dwordx4 v209, s[8:11], s32 offen offset:1024 lds
    v_cvt_pk_bf16_f32 v234, v232, v233
    v_lshlrev_b32 v232, 16, v234
    v_and_b32 v233, s41, v234
    v_mul_f32 v232, v232, v113
    v_mul_f32 v233, v233, v113
    v_cvt_pk_bf16_f32 v234, v232, v233
    v_lshlrev_b32 v162, 16, v234
    v_and_b32 v163, s41, v234
    v_mul_f32 v232, 0xbfb8aa3b, v162
    v_mul_f32 v233, 0xbfb8aa3b, v163
    v_exp_f32 v232, v232
    v_exp_f32 v233, v233
    v_add_f32 v232, 1.0, v232
    v_add_f32 v233, 1.0, v233
    v_rcp_f32 v232, v232
    v_rcp_f32 v233, v233
    v_mul_f32 v232, v232, v162
    v_mul_f32 v233, v233, v163
    v_cvt_pk_bf16_f32 v234, v232, v233
    v_lshlrev_b32 v162, 16, v234
    v_and_b32 v163, s41, v234
    v_lshlrev_b32 v132, 16, v98
    v_and_b32 v133, s41, v98
    v_sub_f32 v228, v132, v112
    v_sub_f32 v229, v133, v112
    v_cvt_pk_bf16_f32 v230, v228, v229
    v_lshlrev_b32 v228, 16, v230
    v_and_b32 v229, s41, v230
    v_mul_f32 v228, v228, v113
    v_mul_f32 v229, v229, v113
    s_add_u32 s35, s35, 0x20000
    s_add_u32 m0, s37, 0x14000
    s_nop 0
    buffer_load_dwordx4 v208, s[8:11], s35 offen offset:0 lds
    buffer_load_dwordx4 v209, s[8:11], s35 offen offset:1024 lds
    v_cvt_pk_bf16_f32 v230, v228, v229
    v_lshlrev_b32 v164, 16, v230
    v_and_b32 v165, s41, v230
    v_mul_f32 v228, 0xbfb8aa3b, v164
    v_mul_f32 v229, 0xbfb8aa3b, v165
    v_exp_f32 v228, v228
    v_exp_f32 v229, v229
    v_add_f32 v228, 1.0, v228
    v_add_f32 v229, 1.0, v229
    v_rcp_f32 v228, v228
    v_rcp_f32 v229, v229
    v_mul_f32 v228, v228, v164
    v_mul_f32 v229, v229, v165
    v_cvt_pk_bf16_f32 v230, v228, v229
    v_lshlrev_b32 v164, 16, v230
    v_and_b32 v165, s41, v230
    v_lshlrev_b32 v134, 16, v99
    v_and_b32 v135, s41, v99
    v_sub_f32 v232, v134, v112
    v_sub_f32 v233, v135, v112
    v_cvt_pk_bf16_f32 v234, v232, v233
    v_lshlrev_b32 v232, 16, v234
    v_and_b32 v233, s41, v234
    v_mul_f32 v232, v232, v113
    v_mul_f32 v233, v233, v113
    v_cvt_pk_bf16_f32 v234, v232, v233
    v_lshlrev_b32 v166, 16, v234
    v_and_b32 v167, s41, v234
    v_mul_f32 v232, 0xbfb8aa3b, v166
    v_mul_f32 v233, 0xbfb8aa3b, v167
    s_add_u32 s32, s32, 0x20000
    s_add_u32 m0, s37, 0x6000
    s_nop 0
    buffer_load_dwordx4 v208, s[8:11], s32 offen offset:0 lds
    buffer_load_dwordx4 v209, s[8:11], s32 offen offset:1024 lds
    v_exp_f32 v232, v232
    v_exp_f32 v233, v233
    v_add_f32 v232, 1.0, v232
    v_add_f32 v233, 1.0, v233
    v_rcp_f32 v232, v232
    v_rcp_f32 v233, v233
    v_mul_f32 v232, v232, v166
    v_mul_f32 v233, v233, v167
    v_cvt_pk_bf16_f32 v234, v232, v233
    v_lshlrev_b32 v166, 16, v234
    v_and_b32 v167, s41, v234
    v_lshlrev_b32 v136, 16, v100
    v_and_b32 v137, s41, v100
    v_sub_f32 v228, v136, v112
    v_sub_f32 v229, v137, v112
    v_cvt_pk_bf16_f32 v230, v228, v229
    v_lshlrev_b32 v228, 16, v230
    v_and_b32 v229, s41, v230
    v_mul_f32 v228, v228, v113
    v_mul_f32 v229, v229, v113
    v_cvt_pk_bf16_f32 v230, v228, v229
    v_lshlrev_b32 v168, 16, v230
    v_and_b32 v169, s41, v230
    v_mul_f32 v228, 0xbfb8aa3b, v168
    v_mul_f32 v229, 0xbfb8aa3b, v169
    v_exp_f32 v228, v228
    v_exp_f32 v229, v229
    v_add_f32 v228, 1.0, v228
    v_add_f32 v229, 1.0, v229
    v_rcp_f32 v228, v228
    s_add_u32 s35, s35, 0x20000
    s_add_u32 m0, s37, 0x16000
    s_nop 0
    buffer_load_dwordx4 v208, s[8:11], s35 offen offset:0 lds
    buffer_load_dwordx4 v209, s[8:11], s35 offen offset:1024 lds
    v_rcp_f32 v229, v229
    v_mul_f32 v228, v228, v168
    v_mul_f32 v229, v229, v169
    v_cvt_pk_bf16_f32 v230, v228, v229
    v_lshlrev_b32 v168, 16, v230
    v_and_b32 v169, s41, v230
    v_lshlrev_b32 v138, 16, v101
    v_and_b32 v139, s41, v101
    v_sub_f32 v232, v138, v112
    v_sub_f32 v233, v139, v112
    v_cvt_pk_bf16_f32 v234, v232, v233
    v_lshlrev_b32 v232, 16, v234
    v_and_b32 v233, s41, v234
    v_mul_f32 v232, v232, v113
    v_mul_f32 v233, v233, v113
    v_cvt_pk_bf16_f32 v234, v232, v233
    v_lshlrev_b32 v170, 16, v234
    v_and_b32 v171, s41, v234
    v_mul_f32 v232, 0xbfb8aa3b, v170
    v_mul_f32 v233, 0xbfb8aa3b, v171
    v_exp_f32 v232, v232
    v_exp_f32 v233, v233
    v_add_f32 v232, 1.0, v232
    v_add_f32 v233, 1.0, v233
    v_rcp_f32 v232, v232
    v_rcp_f32 v233, v233
    v_mul_f32 v232, v232, v170
    v_mul_f32 v233, v233, v171
    v_cvt_pk_bf16_f32 v234, v232, v233
    v_lshlrev_b32 v170, 16, v234
    s_add_u32 s32, s32, 0x20000
    s_add_u32 m0, s37, 0x8000
    s_nop 0
    buffer_load_dwordx4 v208, s[8:11], s32 offen offset:0 lds
    buffer_load_dwordx4 v209, s[8:11], s32 offen offset:1024 lds
    v_and_b32 v171, s41, v234
    v_lshlrev_b32 v140, 16, v102
    v_and_b32 v141, s41, v102
    v_sub_f32 v228, v140, v112
    v_sub_f32 v229, v141, v112
    v_cvt_pk_bf16_f32 v230, v228, v229
    v_lshlrev_b32 v228, 16, v230
    v_and_b32 v229, s41, v230
    v_mul_f32 v228, v228, v113
    v_mul_f32 v229, v229, v113
    v_cvt_pk_bf16_f32 v230, v228, v229
    v_lshlrev_b32 v172, 16, v230
    v_and_b32 v173, s41, v230
    v_mul_f32 v228, 0xbfb8aa3b, v172
    v_mul_f32 v229, 0xbfb8aa3b, v173
    v_exp_f32 v228, v228
    v_exp_f32 v229, v229
    v_add_f32 v228, 1.0, v228
    v_add_f32 v229, 1.0, v229
    v_rcp_f32 v228, v228
    v_rcp_f32 v229, v229
    v_mul_f32 v228, v228, v172
    v_mul_f32 v229, v229, v173
    v_cvt_pk_bf16_f32 v230, v228, v229
    v_lshlrev_b32 v172, 16, v230
    v_and_b32 v173, s41, v230
    v_lshlrev_b32 v142, 16, v103
    v_and_b32 v143, s41, v103
    v_sub_f32 v232, v142, v112
    v_sub_f32 v233, v143, v112
    s_add_u32 s35, s35, 0x20000
    s_add_u32 m0, s37, 0x18000
    s_nop 0
    buffer_load_dwordx4 v208, s[8:11], s35 offen offset:0 lds
    buffer_load_dwordx4 v209, s[8:11], s35 offen offset:1024 lds
    v_cvt_pk_bf16_f32 v234, v232, v233
    v_lshlrev_b32 v232, 16, v234
    v_and_b32 v233, s41, v234
    v_mul_f32 v232, v232, v113
    v_mul_f32 v233, v233, v113
    v_cvt_pk_bf16_f32 v234, v232, v233
    v_lshlrev_b32 v174, 16, v234
    v_and_b32 v175, s41, v234
    v_mul_f32 v232, 0xbfb8aa3b, v174
    v_mul_f32 v233, 0xbfb8aa3b, v175
    v_exp_f32 v232, v232
    v_exp_f32 v233, v233
    v_add_f32 v232, 1.0, v232
    v_add_f32 v233, 1.0, v233
    v_rcp_f32 v232, v232
    v_rcp_f32 v233, v233
    v_mul_f32 v232, v232, v174
    v_mul_f32 v233, v233, v175
    v_cvt_pk_bf16_f32 v234, v232, v233
    v_lshlrev_b32 v174, 16, v234
    v_and_b32 v175, s41, v234
    v_lshlrev_b32 v144, 16, v104
    v_and_b32 v145, s41, v104
    v_sub_f32 v228, v144, v112
    v_sub_f32 v229, v145, v112
    v_cvt_pk_bf16_f32 v230, v228, v229
    v_lshlrev_b32 v228, 16, v230
    v_and_b32 v229, s41, v230
    v_mul_f32 v228, v228, v113
    v_mul_f32 v229, v229, v113
    s_add_u32 s32, s32, 0x20000
    s_add_u32 m0, s37, 0xa000
    s_nop 0
    buffer_load_dwordx4 v208, s[8:11], s32 offen offset:0 lds
    buffer_load_dwordx4 v209, s[8:11], s32 offen offset:1024 lds
    v_cvt_pk_bf16_f32 v230, v228, v229
    v_lshlrev_b32 v176, 16, v230
    v_and_b32 v177, s41, v230
    v_mul_f32 v228, 0xbfb8aa3b, v176
    v_mul_f32 v229, 0xbfb8aa3b, v177
    v_exp_f32 v228, v228
    v_exp_f32 v229, v229
    v_add_f32 v228, 1.0, v228
    v_add_f32 v229, 1.0, v229
    v_rcp_f32 v228, v228
    v_rcp_f32 v229, v229
    v_mul_f32 v228, v228, v176
    v_mul_f32 v229, v229, v177
    v_cvt_pk_bf16_f32 v230, v228, v229
    v_lshlrev_b32 v176, 16, v230
    v_and_b32 v177, s41, v230
    v_lshlrev_b32 v146, 16, v105
    v_and_b32 v147, s41, v105
    v_sub_f32 v232, v146, v112
    v_sub_f32 v233, v147, v112
    v_cvt_pk_bf16_f32 v234, v232, v233
    v_lshlrev_b32 v232, 16, v234
    v_and_b32 v233, s41, v234
    v_mul_f32 v232, v232, v113
    v_mul_f32 v233, v233, v113
    v_cvt_pk_bf16_f32 v234, v232, v233
    v_lshlrev_b32 v178, 16, v234
    v_and_b32 v179, s41, v234
    v_mul_f32 v232, 0xbfb8aa3b, v178
    v_mul_f32 v233, 0xbfb8aa3b, v179
    s_add_u32 s35, s35, 0x20000
    s_add_u32 m0, s37, 0x1a000
    s_nop 0
    buffer_load_dwordx4 v208, s[8:11], s35 offen offset:0 lds
    buffer_load_dwordx4 v209, s[8:11], s35 offen offset:1024 lds
    v_exp_f32 v232, v232
    v_exp_f32 v233, v233
    v_add_f32 v232, 1.0, v232
    v_add_f32 v233, 1.0, v233
    v_rcp_f32 v232, v232
    v_rcp_f32 v233, v233
    v_mul_f32 v232, v232, v178
    v_mul_f32 v233, v233, v179
    v_cvt_pk_bf16_f32 v234, v232, v233
    v_lshlrev_b32 v178, 16, v234
    v_and_b32 v179, s41, v234
    v_lshlrev_b32 v148, 16, v106
    v_and_b32 v149, s41, v106
    v_sub_f32 v228, v148, v112
    v_sub_f32 v229, v149, v112
    v_cvt_pk_bf16_f32 v230, v228, v229
    v_lshlrev_b32 v228, 16, v230
    v_and_b32 v229, s41, v230
    v_mul_f32 v228, v228, v113
    v_mul_f32 v229, v229, v113
    v_cvt_pk_bf16_f32 v230, v228, v229
    v_lshlrev_b32 v180, 16, v230
    v_and_b32 v181, s41, v230
    v_mul_f32 v228, 0xbfb8aa3b, v180
    v_mul_f32 v229, 0xbfb8aa3b, v181
    v_exp_f32 v228, v228
    v_exp_f32 v229, v229
    v_add_f32 v228, 1.0, v228
    v_add_f32 v229, 1.0, v229
    v_rcp_f32 v228, v228
    buffer_load_dword v56, v55, s[56:59], 0 offen sc1
    v_rcp_f32 v229, v229
    v_mul_f32 v228, v228, v180
    v_mul_f32 v229, v229, v181
    v_cvt_pk_bf16_f32 v230, v228, v229
    v_lshlrev_b32 v180, 16, v230
    v_and_b32 v181, s41, v230
    v_lshlrev_b32 v150, 16, v107
    v_and_b32 v151, s41, v107
    v_sub_f32 v232, v150, v112
    v_sub_f32 v233, v151, v112
    v_cvt_pk_bf16_f32 v234, v232, v233
    v_lshlrev_b32 v232, 16, v234
    v_and_b32 v233, s41, v234
    v_mul_f32 v232, v232, v113
    v_mul_f32 v233, v233, v113
    v_cvt_pk_bf16_f32 v234, v232, v233
    v_lshlrev_b32 v182, 16, v234
    v_and_b32 v183, s41, v234
    v_mul_f32 v232, 0xbfb8aa3b, v182
    v_mul_f32 v233, 0xbfb8aa3b, v183
    v_exp_f32 v232, v232
    v_exp_f32 v233, v233
    v_add_f32 v232, 1.0, v232
    v_add_f32 v233, 1.0, v233
    v_rcp_f32 v232, v232
    v_rcp_f32 v233, v233
    v_mul_f32 v232, v232, v182
    v_mul_f32 v233, v233, v183
    v_cvt_pk_bf16_f32 v234, v232, v233
    v_lshlrev_b32 v182, 16, v234
    s_add_u32 s32, s32, 0x20000
    s_add_u32 m0, s37, 0xc000
    s_nop 0
    buffer_load_dwordx4 v208, s[8:11], s32 offen offset:0 lds
    buffer_load_dwordx4 v209, s[8:11], s32 offen offset:1024 lds
    v_and_b32 v183, s41, v234
    v_lshlrev_b32 v152, 16, v108
    v_and_b32 v153, s41, v108
    v_sub_f32 v228, v152, v112
    v_sub_f32 v229, v153, v112
    v_cvt_pk_bf16_f32 v230, v228, v229
    v_lshlrev_b32 v228, 16, v230
    v_and_b32 v229, s41, v230
    v_mul_f32 v228, v228, v113
    v_mul_f32 v229, v229, v113
    v_cvt_pk_bf16_f32 v230, v228, v229
    v_lshlrev_b32 v184, 16, v230
    v_and_b32 v185, s41, v230
    v_mul_f32 v228, 0xbfb8aa3b, v184
    v_mul_f32 v229, 0xbfb8aa3b, v185
    v_exp_f32 v228, v228
    v_exp_f32 v229, v229
    v_add_f32 v228, 1.0, v228
    v_add_f32 v229, 1.0, v229
    v_rcp_f32 v228, v228
    v_rcp_f32 v229, v229
    v_mul_f32 v228, v228, v184
    v_mul_f32 v229, v229, v185
    v_cvt_pk_bf16_f32 v230, v228, v229
    v_lshlrev_b32 v184, 16, v230
    v_and_b32 v185, s41, v230
    v_lshlrev_b32 v154, 16, v109
    v_and_b32 v155, s41, v109
    v_sub_f32 v232, v154, v112
    v_sub_f32 v233, v155, v112
    s_add_u32 s35, s35, 0x20000
    s_add_u32 m0, s37, 0x1c000
    s_nop 0
    buffer_load_dwordx4 v208, s[8:11], s35 offen offset:0 lds
    buffer_load_dwordx4 v209, s[8:11], s35 offen offset:1024 lds
    v_cvt_pk_bf16_f32 v234, v232, v233
    v_lshlrev_b32 v232, 16, v234
    v_and_b32 v233, s41, v234
    v_mul_f32 v232, v232, v113
    v_mul_f32 v233, v233, v113
    v_cvt_pk_bf16_f32 v234, v232, v233
    v_lshlrev_b32 v186, 16, v234
    v_and_b32 v187, s41, v234
    v_mul_f32 v232, 0xbfb8aa3b, v186
    v_mul_f32 v233, 0xbfb8aa3b, v187
    v_exp_f32 v232, v232
    v_exp_f32 v233, v233
    v_add_f32 v232, 1.0, v232
    v_add_f32 v233, 1.0, v233
    v_rcp_f32 v232, v232
    v_rcp_f32 v233, v233
    v_mul_f32 v232, v232, v186
    v_mul_f32 v233, v233, v187
    v_cvt_pk_bf16_f32 v234, v232, v233
    v_lshlrev_b32 v186, 16, v234
    v_and_b32 v187, s41, v234
    v_lshlrev_b32 v156, 16, v110
    v_and_b32 v157, s41, v110
    v_sub_f32 v228, v156, v112
    v_sub_f32 v229, v157, v112
    v_cvt_pk_bf16_f32 v230, v228, v229
    v_lshlrev_b32 v228, 16, v230
    v_and_b32 v229, s41, v230
    v_mul_f32 v228, v228, v113
    v_mul_f32 v229, v229, v113
    s_add_u32 s32, s32, 0x20000
    s_add_u32 m0, s37, 0xe000
    s_nop 0
    buffer_load_dwordx4 v208, s[8:11], s32 offen offset:0 lds
    buffer_load_dwordx4 v209, s[8:11], s32 offen offset:1024 lds
    v_cvt_pk_bf16_f32 v230, v228, v229
    v_lshlrev_b32 v188, 16, v230
    v_and_b32 v189, s41, v230
    v_mul_f32 v228, 0xbfb8aa3b, v188
    v_mul_f32 v229, 0xbfb8aa3b, v189
    v_exp_f32 v228, v228
    v_exp_f32 v229, v229
    v_add_f32 v228, 1.0, v228
    v_add_f32 v229, 1.0, v229
    v_rcp_f32 v228, v228
    v_rcp_f32 v229, v229
    v_mul_f32 v228, v228, v188
    v_mul_f32 v229, v229, v189
    v_cvt_pk_bf16_f32 v230, v228, v229
    v_lshlrev_b32 v188, 16, v230
    v_and_b32 v189, s41, v230
    v_lshlrev_b32 v158, 16, v111
    v_and_b32 v159, s41, v111
    v_sub_f32 v232, v158, v112
    v_sub_f32 v233, v159, v112
    v_cvt_pk_bf16_f32 v234, v232, v233
    v_lshlrev_b32 v232, 16, v234
    v_and_b32 v233, s41, v234
    v_mul_f32 v232, v232, v113
    v_mul_f32 v233, v233, v113
    v_cvt_pk_bf16_f32 v234, v232, v233
    v_lshlrev_b32 v190, 16, v234
    v_and_b32 v191, s41, v234
    v_mul_f32 v232, 0xbfb8aa3b, v190
    v_mul_f32 v233, 0xbfb8aa3b, v191
    s_add_u32 s35, s35, 0x20000
    s_add_u32 m0, s37, 0x1e000
    s_nop 0
    buffer_load_dwordx4 v208, s[8:11], s35 offen offset:0 lds
    buffer_load_dwordx4 v209, s[8:11], s35 offen offset:1024 lds
    v_exp_f32 v232, v232
    v_exp_f32 v233, v233
    v_add_f32 v232, 1.0, v232
    v_add_f32 v233, 1.0, v233
    v_rcp_f32 v232, v232
    v_rcp_f32 v233, v233
    v_mul_f32 v232, v232, v190
    v_mul_f32 v233, v233, v191
    v_cvt_pk_bf16_f32 v234, v232, v233
    v_lshlrev_b32 v190, 16, v234
    v_and_b32 v191, s41, v234
    s_waitcnt vmcnt(8)
    v_cmp_ne_u32 vcc, 1, v56
    s_cmp_lg_u64 vcc, 0
    s_cbranch_scc1 L_kb_o_do0
L_kb_o_rt0:
    buffer_load_dwordx4 a[0:3], v212, s[12:15], s33 offen offset:0 sc1
    buffer_load_dwordx4 a[4:7], v212, s[12:15], s33 offen offset:1024 sc1
    buffer_load_dwordx4 a[8:11], v212, s[12:15], s33 offen offset:2048 sc1
    buffer_load_dwordx4 a[12:15], v212, s[12:15], s33 offen offset:3072 sc1
    s_add_u32 s33, s33, 4096
    buffer_load_dwordx4 a[16:19], v212, s[12:15], s33 offen offset:0 sc1
    buffer_load_dwordx4 a[20:23], v212, s[12:15], s33 offen offset:1024 sc1
    buffer_load_dwordx4 a[24:27], v212, s[12:15], s33 offen offset:2048 sc1
    buffer_load_dwordx4 a[28:31], v212, s[12:15], s33 offen offset:3072 sc1
    s_barrier
    ds_read_b64_tr_b16 v[64:65], v215 offset:0
    ds_read_b64_tr_b16 v[66:67], v215 offset:512
    s_add_u32 s33, s33, 4096
    buffer_load_dwordx4 a[32:35], v212, s[12:15], s33 offen offset:0 sc1
    ds_read_b64_tr_b16 v[68:69], v216 offset:0
    ds_read_b64_tr_b16 v[70:71], v216 offset:512
    ds_read_b64_tr_b16 v[72:73], v213 offset:0
    ds_read_b64_tr_b16 v[74:75], v213 offset:512
    buffer_load_dwordx4 a[36:39], v212, s[12:15], s33 offen offset:1024 sc1
    ds_read_b64_tr_b16 v[76:77], v214 offset:0
    ds_read_b64_tr_b16 v[78:79], v214 offset:512
    ds_read_b64_tr_b16 v[80:81], v215 offset:2048
    ds_read_b64_tr_b16 v[82:83], v215 offset:2560
    buffer_load_dwordx4 a[40:43], v212, s[12:15], s33 offen offset:2048 sc1
    ds_read_b64_tr_b16 v[84:85], v216 offset:2048
    ds_read_b64_tr_b16 v[86:87], v216 offset:2560
    ds_read_b64_tr_b16 v[88:89], v213 offset:2048
    ds_read_b64_tr_b16 v[90:91], v213 offset:2560
    buffer_load_dwordx4 a[44:47], v212, s[12:15], s33 offen offset:3072 sc1
    ds_read_b64_tr_b16 v[92:93], v214 offset:2048
    ds_read_b64_tr_b16 v[94:95], v214 offset:2560
    s_waitcnt vmcnt(8)
    s_waitcnt lgkmcnt(8)
    v_mfma_f32_32x32x16_bf16 v[32:47], v[64:67], a[0:3], 0
    ds_read_b64_tr_b16 v[96:97], v215 offset:4096
    ds_read_b64_tr_b16 v[98:99], v215 offset:4608
    s_add_u32 s33, s33, 4096
    buffer_load_dwordx4 a[48:51], v212, s[12:15], s33 offen offset:0 sc1
    v_mfma_f32_32x32x16_bf16 v[48:63], v[68:71], a[0:3], 0
    ds_read_b64_tr_b16 v[100:101], v216 offset:4096
    ds_read_b64_tr_b16 v[102:103], v216 offset:4608
    v_mfma_f32_32x32x16_bf16 v[0:15], v[72:75], a[0:3], 0
    ds_read_b64_tr_b16 v[104:105], v213 offset:4096
    ds_read_b64_tr_b16 v[106:107], v213 offset:4608
    buffer_load_dwordx4 a[52:55], v212, s[12:15], s33 offen offset:1024 sc1
    v_mfma_f32_32x32x16_bf16 v[16:31], v[76:79], a[0:3], 0
    ds_read_b64_tr_b16 v[108:109], v214 offset:4096
    ds_read_b64_tr_b16 v[110:111], v214 offset:4608
    s_waitcnt lgkmcnt(8)
    v_mfma_f32_32x32x16_bf16 v[32:47], v[80:83], a[4:7], v[32:47]
    ds_read_b64_tr_b16 v[112:113], v215 offset:6144
    ds_read_b64_tr_b16 v[114:115], v215 offset:6656
    buffer_load_dwordx4 a[56:59], v212, s[12:15], s33 offen offset:2048 sc1
    v_mfma_f32_32x32x16_bf16 v[48:63], v[84:87], a[4:7], v[48:63]
    ds_read_b64_tr_b16 v[116:117], v216 offset:6144
    ds_read_b64_tr_b16 v[118:119], v216 offset:6656
    v_mfma_f32_32x32x16_bf16 v[0:15], v[88:91], a[4:7], v[0:15]
    ds_read_b64_tr_b16 v[120:121], v213 offset:6144
    ds_read_b64_tr_b16 v[122:123], v213 offset:6656
    buffer_load_dwordx4 a[60:63], v212, s[12:15], s33 offen offset:3072 sc1
    v_mfma_f32_32x32x16_bf16 v[16:31], v[92:95], a[4:7], v[16:31]
    ds_read_b64_tr_b16 v[124:125], v214 offset:6144
    ds_read_b64_tr_b16 v[126:127], v214 offset:6656
    s_barrier
    s_waitcnt lgkmcnt(8)
    v_mfma_f32_32x32x16_bf16 v[32:47], v[96:99], a[8:11], v[32:47]
    ds_read_b64_tr_b16 v[64:65], v215 offset:8192
    ds_read_b64_tr_b16 v[66:67], v215 offset:8704
    s_add_u32 s33, s33, 4096
    buffer_load_dwordx4 a[64:67], v212, s[12:15], s33 offen offset:0 sc1
    v_mfma_f32_32x32x16_bf16 v[48:63], v[100:103], a[8:11], v[48:63]
    ds_read_b64_tr_b16 v[68:69], v216 offset:8192
    ds_read_b64_tr_b16 v[70:71], v216 offset:8704
    v_mfma_f32_32x32x16_bf16 v[0:15], v[104:107], a[8:11], v[0:15]
    ds_read_b64_tr_b16 v[72:73], v213 offset:8192
    ds_read_b64_tr_b16 v[74:75], v213 offset:8704
    buffer_load_dwordx4 a[68:71], v212, s[12:15], s33 offen offset:1024 sc1
    v_mfma_f32_32x32x16_bf16 v[16:31], v[108:111], a[8:11], v[16:31]
    ds_read_b64_tr_b16 v[76:77], v214 offset:8192
    ds_read_b64_tr_b16 v[78:79], v214 offset:8704
    s_waitcnt lgkmcnt(8)
    v_mfma_f32_32x32x16_bf16 v[32:47], v[112:115], a[12:15], v[32:47]
    ds_read_b64_tr_b16 v[80:81], v215 offset:10240
    ds_read_b64_tr_b16 v[82:83], v215 offset:10752
    buffer_load_dwordx4 a[72:75], v212, s[12:15], s33 offen offset:2048 sc1
    v_mfma_f32_32x32x16_bf16 v[48:63], v[116:119], a[12:15], v[48:63]
    ds_read_b64_tr_b16 v[84:85], v216 offset:10240
    ds_read_b64_tr_b16 v[86:87], v216 offset:10752
    v_mfma_f32_32x32x16_bf16 v[0:15], v[120:123], a[12:15], v[0:15]
    ds_read_b64_tr_b16 v[88:89], v213 offset:10240
    ds_read_b64_tr_b16 v[90:91], v213 offset:10752
    buffer_load_dwordx4 a[76:79], v212, s[12:15], s33 offen offset:3072 sc1
    v_mfma_f32_32x32x16_bf16 v[16:31], v[124:127], a[12:15], v[16:31]
    ds_read_b64_tr_b16 v[92:93], v214 offset:10240
    ds_read_b64_tr_b16 v[94:95], v214 offset:10752
    s_waitcnt vmcnt(12)
    s_waitcnt lgkmcnt(8)
    v_mfma_f32_32x32x16_bf16 v[32:47], v[64:67], a[16:19], v[32:47]
    ds_read_b64_tr_b16 v[96:97], v215 offset:12288
    ds_read_b64_tr_b16 v[98:99], v215 offset:12800
    s_add_u32 s33, s33, 4096
    buffer_load_dwordx4 a[80:83], v212, s[12:15], s33 offen offset:0 sc1
    v_mfma_f32_32x32x16_bf16 v[48:63], v[68:71], a[16:19], v[48:63]
    ds_read_b64_tr_b16 v[100:101], v216 offset:12288
    ds_read_b64_tr_b16 v[102:103], v216 offset:12800
    v_mfma_f32_32x32x16_bf16 v[0:15], v[72:75], a[16:19], v[0:15]
    ds_read_b64_tr_b16 v[104:105], v213 offset:12288
    ds_read_b64_tr_b16 v[106:107], v213 offset:12800
    buffer_load_dwordx4 a[84:87], v212, s[12:15], s33 offen offset:1024 sc1
    v_mfma_f32_32x32x16_bf16 v[16:31], v[76:79], a[16:19], v[16:31]
    ds_read_b64_tr_b16 v[108:109], v214 offset:12288
    ds_read_b64_tr_b16 v[110:111], v214 offset:12800
    s_waitcnt lgkmcnt(8)
    v_mfma_f32_32x32x16_bf16 v[32:47], v[80:83], a[20:23], v[32:47]
    ds_read_b64_tr_b16 v[112:113], v215 offset:14336
    ds_read_b64_tr_b16 v[114:115], v215 offset:14848
    buffer_load_dwordx4 a[88:91], v212, s[12:15], s33 offen offset:2048 sc1
    v_mfma_f32_32x32x16_bf16 v[48:63], v[84:87], a[20:23], v[48:63]
    ds_read_b64_tr_b16 v[116:117], v216 offset:14336
    ds_read_b64_tr_b16 v[118:119], v216 offset:14848
    v_mfma_f32_32x32x16_bf16 v[0:15], v[88:91], a[20:23], v[0:15]
    ds_read_b64_tr_b16 v[120:121], v213 offset:14336
    ds_read_b64_tr_b16 v[122:123], v213 offset:14848
    buffer_load_dwordx4 a[92:95], v212, s[12:15], s33 offen offset:3072 sc1
    v_mfma_f32_32x32x16_bf16 v[16:31], v[92:95], a[20:23], v[16:31]
    ds_read_b64_tr_b16 v[124:125], v214 offset:14336
    ds_read_b64_tr_b16 v[126:127], v214 offset:14848
    s_barrier
    s_waitcnt lgkmcnt(8)
    v_mfma_f32_32x32x16_bf16 v[32:47], v[96:99], a[24:27], v[32:47]
    ds_read_b64_tr_b16 v[64:65], v215 offset:16384
    ds_read_b64_tr_b16 v[66:67], v215 offset:16896
    s_add_u32 s33, s33, 4096
    buffer_load_dwordx4 a[96:99], v212, s[12:15], s33 offen offset:0 sc1
    v_mfma_f32_32x32x16_bf16 v[48:63], v[100:103], a[24:27], v[48:63]
    ds_read_b64_tr_b16 v[68:69], v216 offset:16384
    ds_read_b64_tr_b16 v[70:71], v216 offset:16896
    v_mfma_f32_32x32x16_bf16 v[0:15], v[104:107], a[24:27], v[0:15]
    ds_read_b64_tr_b16 v[72:73], v213 offset:16384
    ds_read_b64_tr_b16 v[74:75], v213 offset:16896
    buffer_load_dwordx4 a[100:103], v212, s[12:15], s33 offen offset:1024 sc1
    v_mfma_f32_32x32x16_bf16 v[16:31], v[108:111], a[24:27], v[16:31]
    ds_read_b64_tr_b16 v[76:77], v214 offset:16384
    ds_read_b64_tr_b16 v[78:79], v214 offset:16896
    s_waitcnt lgkmcnt(8)
    v_mfma_f32_32x32x16_bf16 v[32:47], v[112:115], a[28:31], v[32:47]
    ds_read_b64_tr_b16 v[80:81], v215 offset:18432
    ds_read_b64_tr_b16 v[82:83], v215 offset:18944
    buffer_load_dwordx4 a[104:107], v212, s[12:15], s33 offen offset:2048 sc1
    v_mfma_f32_32x32x16_bf16 v[48:63], v[116:119], a[28:31], v[48:63]
    ds_read_b64_tr_b16 v[84:85], v216 offset:18432
    ds_read_b64_tr_b16 v[86:87], v216 offset:18944
    v_mfma_f32_32x32x16_bf16 v[0:15], v[120:123], a[28:31], v[0:15]
    ds_read_b64_tr_b16 v[88:89], v213 offset:18432
    ds_read_b64_tr_b16 v[90:91], v213 offset:18944
    buffer_load_dwordx4 a[108:111], v212, s[12:15], s33 offen offset:3072 sc1
    v_mfma_f32_32x32x16_bf16 v[16:31], v[124:127], a[28:31], v[16:31]
    ds_read_b64_tr_b16 v[92:93], v214 offset:18432
    ds_read_b64_tr_b16 v[94:95], v214 offset:18944
    s_waitcnt vmcnt(16)
    s_waitcnt lgkmcnt(8)
    v_mfma_f32_32x32x16_bf16 v[32:47], v[64:67], a[32:35], v[32:47]
    ds_read_b64_tr_b16 v[96:97], v215 offset:20480
    ds_read_b64_tr_b16 v[98:99], v215 offset:20992
    s_add_u32 s33, s33, 4096
    buffer_load_dwordx4 a[112:115], v212, s[12:15], s33 offen offset:0 sc1
    v_mfma_f32_32x32x16_bf16 v[48:63], v[68:71], a[32:35], v[48:63]
    ds_read_b64_tr_b16 v[100:101], v216 offset:20480
    ds_read_b64_tr_b16 v[102:103], v216 offset:20992
    v_mfma_f32_32x32x16_bf16 v[0:15], v[72:75], a[32:35], v[0:15]
    ds_read_b64_tr_b16 v[104:105], v213 offset:20480
    ds_read_b64_tr_b16 v[106:107], v213 offset:20992
    buffer_load_dwordx4 a[116:119], v212, s[12:15], s33 offen offset:1024 sc1
    v_mfma_f32_32x32x16_bf16 v[16:31], v[76:79], a[32:35], v[16:31]
    ds_read_b64_tr_b16 v[108:109], v214 offset:20480
    ds_read_b64_tr_b16 v[110:111], v214 offset:20992
    s_waitcnt lgkmcnt(8)
    v_mfma_f32_32x32x16_bf16 v[32:47], v[80:83], a[36:39], v[32:47]
    ds_read_b64_tr_b16 v[112:113], v215 offset:22528
    ds_read_b64_tr_b16 v[114:115], v215 offset:23040
    buffer_load_dwordx4 a[120:123], v212, s[12:15], s33 offen offset:2048 sc1
    v_mfma_f32_32x32x16_bf16 v[48:63], v[84:87], a[36:39], v[48:63]
    ds_read_b64_tr_b16 v[116:117], v216 offset:22528
    ds_read_b64_tr_b16 v[118:119], v216 offset:23040
    v_mfma_f32_32x32x16_bf16 v[0:15], v[88:91], a[36:39], v[0:15]
    ds_read_b64_tr_b16 v[120:121], v213 offset:22528
    ds_read_b64_tr_b16 v[122:123], v213 offset:23040
    buffer_load_dwordx4 a[124:127], v212, s[12:15], s33 offen offset:3072 sc1
    v_mfma_f32_32x32x16_bf16 v[16:31], v[92:95], a[36:39], v[16:31]
    ds_read_b64_tr_b16 v[124:125], v214 offset:22528
    ds_read_b64_tr_b16 v[126:127], v214 offset:23040
    s_barrier
    s_waitcnt lgkmcnt(8)
    v_mfma_f32_32x32x16_bf16 v[32:47], v[96:99], a[40:43], v[32:47]
    ds_read_b64_tr_b16 v[64:65], v215 offset:24576
    ds_read_b64_tr_b16 v[66:67], v215 offset:25088
    s_add_u32 s33, s33, 4096
    buffer_load_dwordx4 a[128:131], v212, s[12:15], s33 offen offset:0 sc1
    s_add_u32 s32, s32, 0x20000
    s_add_u32 m0, s37, 0x0
    s_nop 0
    buffer_load_dwordx4 v208, s[8:11], s32 offen offset:0 lds
    v_mfma_f32_32x32x16_bf16 v[48:63], v[100:103], a[40:43], v[48:63]
    ds_read_b64_tr_b16 v[68:69], v216 offset:24576
    ds_read_b64_tr_b16 v[70:71], v216 offset:25088
    v_mfma_f32_32x32x16_bf16 v[0:15], v[104:107], a[40:43], v[0:15]
    ds_read_b64_tr_b16 v[72:73], v213 offset:24576
    ds_read_b64_tr_b16 v[74:75], v213 offset:25088
    buffer_load_dwordx4 a[132:135], v212, s[12:15], s33 offen offset:1024 sc1
    buffer_load_dwordx4 v209, s[8:11], s32 offen offset:1024 lds
    v_mfma_f32_32x32x16_bf16 v[16:31], v[108:111], a[40:43], v[16:31]
    ds_read_b64_tr_b16 v[76:77], v214 offset:24576
    ds_read_b64_tr_b16 v[78:79], v214 offset:25088
    s_waitcnt lgkmcnt(8)
    v_mfma_f32_32x32x16_bf16 v[32:47], v[112:115], a[44:47], v[32:47]
    ds_read_b64_tr_b16 v[80:81], v215 offset:26624
    ds_read_b64_tr_b16 v[82:83], v215 offset:27136
    buffer_load_dwordx4 a[136:139], v212, s[12:15], s33 offen offset:2048 sc1
    s_add_u32 s35, s35, 0x20000
    s_add_u32 m0, s37, 0x10000
    s_nop 0
    buffer_load_dwordx4 v208, s[8:11], s35 offen offset:0 lds
    v_mfma_f32_32x32x16_bf16 v[48:63], v[116:119], a[44:47], v[48:63]
    ds_read_b64_tr_b16 v[84:85], v216 offset:26624
    ds_read_b64_tr_b16 v[86:87], v216 offset:27136
    v_mfma_f32_32x32x16_bf16 v[0:15], v[120:123], a[44:47], v[0:15]
    ds_read_b64_tr_b16 v[88:89], v213 offset:26624
    ds_read_b64_tr_b16 v[90:91], v213 offset:27136
    buffer_load_dwordx4 a[140:143], v212, s[12:15], s33 offen offset:3072 sc1
    buffer_load_dwordx4 v209, s[8:11], s35 offen offset:1024 lds
    v_mfma_f32_32x32x16_bf16 v[16:31], v[124:127], a[44:47], v[16:31]
    ds_read_b64_tr_b16 v[92:93], v214 offset:26624
    ds_read_b64_tr_b16 v[94:95], v214 offset:27136
    s_waitcnt vmcnt(24)
    s_waitcnt lgkmcnt(8)
    v_mfma_f32_32x32x16_bf16 v[32:47], v[64:67], a[48:51], v[32:47]
    ds_read_b64_tr_b16 v[96:97], v215 offset:28672
    ds_read_b64_tr_b16 v[98:99], v215 offset:29184
    s_add_u32 s33, s33, 4096
    buffer_load_dwordx4 a[144:147], v212, s[12:15], s33 offen offset:0 sc1
    s_add_u32 s32, s32, 0x20000
    s_add_u32 m0, s37, 0x2000
    s_nop 0
    buffer_load_dwordx4 v208, s[8:11], s32 offen offset:0 lds
    v_mfma_f32_32x32x16_bf16 v[48:63], v[68:71], a[48:51], v[48:63]
    ds_read_b64_tr_b16 v[100:101], v216 offset:28672
    ds_read_b64_tr_b16 v[102:103], v216 offset:29184
    v_mfma_f32_32x32x16_bf16 v[0:15], v[72:75], a[48:51], v[0:15]
    ds_read_b64_tr_b16 v[104:105], v213 offset:28672
    ds_read_b64_tr_b16 v[106:107], v213 offset:29184
    v_mfma_f32_32x32x16_bf16 v[16:31], v[76:79], a[48:51], v[16:31]
    ds_read_b64_tr_b16 v[108:109], v214 offset:28672
    ds_read_b64_tr_b16 v[110:111], v214 offset:29184
    s_waitcnt lgkmcnt(8)
    v_mfma_f32_32x32x16_bf16 v[32:47], v[80:83], a[52:55], v[32:47]
    ds_read_b64_tr_b16 v[112:113], v215 offset:30720
    ds_read_b64_tr_b16 v[114:115], v215 offset:31232
    buffer_load_dwordx4 a[148:151], v212, s[12:15], s33 offen offset:1024 sc1
    buffer_load_dwordx4 v209, s[8:11], s32 offen offset:1024 lds
    v_mfma_f32_32x32x16_bf16 v[48:63], v[84:87], a[52:55], v[48:63]
    ds_read_b64_tr_b16 v[116:117], v216 offset:30720
    ds_read_b64_tr_b16 v[118:119], v216 offset:31232
    v_mfma_f32_32x32x16_bf16 v[0:15], v[88:91], a[52:55], v[0:15]
    ds_read_b64_tr_b16 v[120:121], v213 offset:30720
    ds_read_b64_tr_b16 v[122:123], v213 offset:31232
    v_mfma_f32_32x32x16_bf16 v[16:31], v[92:95], a[52:55], v[16:31]
    ds_read_b64_tr_b16 v[124:125], v214 offset:30720
    ds_read_b64_tr_b16 v[126:127], v214 offset:31232
    s_barrier
    s_waitcnt lgkmcnt(8)
    v_mfma_f32_32x32x16_bf16 v[32:47], v[96:99], a[56:59], v[32:47]
    ds_read_b64_tr_b16 v[64:65], v215 offset:32768
    ds_read_b64_tr_b16 v[66:67], v215 offset:33280
    buffer_load_dwordx4 a[152:155], v212, s[12:15], s33 offen offset:2048 sc1
    s_add_u32 s35, s35, 0x20000
    s_add_u32 m0, s37, 0x12000
    s_nop 0
    buffer_load_dwordx4 v208, s[8:11], s35 offen offset:0 lds
    v_mfma_f32_32x32x16_bf16 v[48:63], v[100:103], a[56:59], v[48:63]
    ds_read_b64_tr_b16 v[68:69], v216 offset:32768
    ds_read_b64_tr_b16 v[70:71], v216 offset:33280
    v_mfma_f32_32x32x16_bf16 v[0:15], v[104:107], a[56:59], v[0:15]
    ds_read_b64_tr_b16 v[72:73], v213 offset:32768
    ds_read_b64_tr_b16 v[74:75], v213 offset:33280
    buffer_load_dwordx4 a[156:159], v212, s[12:15], s33 offen offset:3072 sc1
    buffer_load_dwordx4 v209, s[8:11], s35 offen offset:1024 lds
    v_mfma_f32_32x32x16_bf16 v[16:31], v[108:111], a[56:59], v[16:31]
    ds_read_b64_tr_b16 v[76:77], v214 offset:32768
    ds_read_b64_tr_b16 v[78:79], v214 offset:33280
    s_waitcnt lgkmcnt(8)
    v_mfma_f32_32x32x16_bf16 v[32:47], v[112:115], a[60:63], v[32:47]
    ds_read_b64_tr_b16 v[80:81], v215 offset:34816
    ds_read_b64_tr_b16 v[82:83], v215 offset:35328
    s_add_u32 s33, s33, 4096
    buffer_load_dwordx4 a[160:163], v212, s[12:15], s33 offen offset:0 sc1
    s_add_u32 s32, s32, 0x20000
    s_add_u32 m0, s37, 0x4000
    s_nop 0
    buffer_load_dwordx4 v208, s[8:11], s32 offen offset:0 lds
    v_mfma_f32_32x32x16_bf16 v[48:63], v[116:119], a[60:63], v[48:63]
    ds_read_b64_tr_b16 v[84:85], v216 offset:34816
    ds_read_b64_tr_b16 v[86:87], v216 offset:35328
    v_mfma_f32_32x32x16_bf16 v[0:15], v[120:123], a[60:63], v[0:15]
    ds_read_b64_tr_b16 v[88:89], v213 offset:34816
    ds_read_b64_tr_b16 v[90:91], v213 offset:35328
    v_mfma_f32_32x32x16_bf16 v[16:31], v[124:127], a[60:63], v[16:31]
    ds_read_b64_tr_b16 v[92:93], v214 offset:34816
    ds_read_b64_tr_b16 v[94:95], v214 offset:35328
    s_waitcnt vmcnt(30)
    s_waitcnt lgkmcnt(8)
    v_mfma_f32_32x32x16_bf16 v[32:47], v[64:67], a[64:67], v[32:47]
    ds_read_b64_tr_b16 v[96:97], v215 offset:36864
    ds_read_b64_tr_b16 v[98:99], v215 offset:37376
    buffer_load_dwordx4 a[164:167], v212, s[12:15], s33 offen offset:1024 sc1
    buffer_load_dwordx4 v209, s[8:11], s32 offen offset:1024 lds
    v_mfma_f32_32x32x16_bf16 v[48:63], v[68:71], a[64:67], v[48:63]
    ds_read_b64_tr_b16 v[100:101], v216 offset:36864
    ds_read_b64_tr_b16 v[102:103], v216 offset:37376
    v_mfma_f32_32x32x16_bf16 v[0:15], v[72:75], a[64:67], v[0:15]
    ds_read_b64_tr_b16 v[104:105], v213 offset:36864
    ds_read_b64_tr_b16 v[106:107], v213 offset:37376
    v_mfma_f32_32x32x16_bf16 v[16:31], v[76:79], a[64:67], v[16:31]
    ds_read_b64_tr_b16 v[108:109], v214 offset:36864
    ds_read_b64_tr_b16 v[110:111], v214 offset:37376
    s_waitcnt lgkmcnt(8)
    v_mfma_f32_32x32x16_bf16 v[32:47], v[80:83], a[68:71], v[32:47]
    ds_read_b64_tr_b16 v[112:113], v215 offset:38912
    ds_read_b64_tr_b16 v[114:115], v215 offset:39424
    buffer_load_dwordx4 a[168:171], v212, s[12:15], s33 offen offset:2048 sc1
    s_add_u32 s35, s35, 0x20000
    s_add_u32 m0, s37, 0x14000
    s_nop 0
    buffer_load_dwordx4 v208, s[8:11], s35 offen offset:0 lds
    v_mfma_f32_32x32x16_bf16 v[48:63], v[84:87], a[68:71], v[48:63]
    ds_read_b64_tr_b16 v[116:117], v216 offset:38912
    ds_read_b64_tr_b16 v[118:119], v216 offset:39424
    v_mfma_f32_32x32x16_bf16 v[0:15], v[88:91], a[68:71], v[0:15]
    ds_read_b64_tr_b16 v[120:121], v213 offset:38912
    ds_read_b64_tr_b16 v[122:123], v213 offset:39424
    v_mfma_f32_32x32x16_bf16 v[16:31], v[92:95], a[68:71], v[16:31]
    ds_read_b64_tr_b16 v[124:125], v214 offset:38912
    ds_read_b64_tr_b16 v[126:127], v214 offset:39424
    s_barrier
    s_cmp_lg_u32 s60, 0
    s_cbranch_scc1 L_kb_o_do1
L_kb_o_rt1:
    s_waitcnt lgkmcnt(8)
    v_mfma_f32_32x32x16_bf16 v[32:47], v[96:99], a[72:75], v[32:47]
    ds_read_b64_tr_b16 v[64:65], v215 offset:40960
    ds_read_b64_tr_b16 v[66:67], v215 offset:41472
    buffer_load_dwordx4 a[172:175], v212, s[12:15], s33 offen offset:3072 sc1
    buffer_load_dwordx4 v209, s[8:11], s35 offen offset:1024 lds
    v_mfma_f32_32x32x16_bf16 v[48:63], v[100:103], a[72:75], v[48:63]
    ds_read_b64_tr_b16 v[68:69], v216 offset:40960
    ds_read_b64_tr_b16 v[70:71], v216 offset:41472
    v_mfma_f32_32x32x16_bf16 v[0:15], v[104:107], a[72:75], v[0:15]
    ds_read_b64_tr_b16 v[72:73], v213 offset:40960
    ds_read_b64_tr_b16 v[74:75], v213 offset:41472
    s_add_u32 s33, s33, 4096
    buffer_load_dwordx4 a[176:179], v212, s[12:15], s33 offen offset:0 sc1
    s_add_u32 s32, s32, 0x20000
    s_add_u32 m0, s37, 0x6000
    s_nop 0
    buffer_load_dwordx4 v208, s[8:11], s32 offen offset:0 lds
    v_mfma_f32_32x32x16_bf16 v[16:31], v[108:111], a[72:75], v[16:31]
    ds_read_b64_tr_b16 v[76:77], v214 offset:40960
    ds_read_b64_tr_b16 v[78:79], v214 offset:41472
    s_waitcnt lgkmcnt(8)
    v_mfma_f32_32x32x16_bf16 v[32:47], v[112:115], a[76:79], v[32:47]
    ds_read_b64_tr_b16 v[80:81], v215 offset:43008
    ds_read_b64_tr_b16 v[82:83], v215 offset:43520
    buffer_load_dwordx4 a[180:183], v212, s[12:15], s33 offen offset:1024 sc1
    buffer_load_dwordx4 v209, s[8:11], s32 offen offset:1024 lds
    v_mfma_f32_32x32x16_bf16 v[48:63], v[116:119], a[76:79], v[48:63]
    ds_read_b64_tr_b16 v[84:85], v216 offset:43008
    ds_read_b64_tr_b16 v[86:87], v216 offset:43520
    v_mfma_f32_32x32x16_bf16 v[0:15], v[120:123], a[76:79], v[0:15]
    ds_read_b64_tr_b16 v[88:89], v213 offset:43008
    ds_read_b64_tr_b16 v[90:91], v213 offset:43520
    v_mfma_f32_32x32x16_bf16 v[16:31], v[124:127], a[76:79], v[16:31]
    ds_read_b64_tr_b16 v[92:93], v214 offset:43008
    ds_read_b64_tr_b16 v[94:95], v214 offset:43520
    s_waitcnt vmcnt(36)
    s_waitcnt lgkmcnt(8)
    v_mfma_f32_32x32x16_bf16 v[32:47], v[64:67], a[80:83], v[32:47]
    ds_read_b64_tr_b16 v[96:97], v215 offset:45056
    ds_read_b64_tr_b16 v[98:99], v215 offset:45568
    buffer_load_dwordx4 a[184:187], v212, s[12:15], s33 offen offset:2048 sc1
    s_add_u32 s35, s35, 0x20000
    s_add_u32 m0, s37, 0x16000
    s_nop 0
    buffer_load_dwordx4 v208, s[8:11], s35 offen offset:0 lds
    v_mfma_f32_32x32x16_bf16 v[48:63], v[68:71], a[80:83], v[48:63]
    ds_read_b64_tr_b16 v[100:101], v216 offset:45056
    ds_read_b64_tr_b16 v[102:103], v216 offset:45568
    v_mfma_f32_32x32x16_bf16 v[0:15], v[72:75], a[80:83], v[0:15]
    ds_read_b64_tr_b16 v[104:105], v213 offset:45056
    ds_read_b64_tr_b16 v[106:107], v213 offset:45568
    v_mfma_f32_32x32x16_bf16 v[16:31], v[76:79], a[80:83], v[16:31]
    ds_read_b64_tr_b16 v[108:109], v214 offset:45056
    ds_read_b64_tr_b16 v[110:111], v214 offset:45568
    s_waitcnt lgkmcnt(8)
    v_mfma_f32_32x32x16_bf16 v[32:47], v[80:83], a[84:87], v[32:47]
    ds_read_b64_tr_b16 v[112:113], v215 offset:47104
    ds_read_b64_tr_b16 v[114:115], v215 offset:47616
    buffer_load_dwordx4 a[188:191], v212, s[12:15], s33 offen offset:3072 sc1
    buffer_load_dwordx4 v209, s[8:11], s35 offen offset:1024 lds
    v_mfma_f32_32x32x16_bf16 v[48:63], v[84:87], a[84:87], v[48:63]
    ds_read_b64_tr_b16 v[116:117], v216 offset:47104
    ds_read_b64_tr_b16 v[118:119], v216 offset:47616
    v_mfma_f32_32x32x16_bf16 v[0:15], v[88:91], a[84:87], v[0:15]
    ds_read_b64_tr_b16 v[120:121], v213 offset:47104
    ds_read_b64_tr_b16 v[122:123], v213 offset:47616
    v_mfma_f32_32x32x16_bf16 v[16:31], v[92:95], a[84:87], v[16:31]
    ds_read_b64_tr_b16 v[124:125], v214 offset:47104
    ds_read_b64_tr_b16 v[126:127], v214 offset:47616
    s_barrier
    s_waitcnt lgkmcnt(8)
    v_mfma_f32_32x32x16_bf16 v[32:47], v[96:99], a[88:91], v[32:47]
    ds_read_b64_tr_b16 v[64:65], v215 offset:49152
    ds_read_b64_tr_b16 v[66:67], v215 offset:49664
    s_add_u32 s33, s33, 4096
    buffer_load_dwordx4 a[192:195], v212, s[12:15], s33 offen offset:0 sc1
    s_add_u32 s32, s32, 0x20000
    s_add_u32 m0, s37, 0x8000
    s_nop 0
    buffer_load_dwordx4 v208, s[8:11], s32 offen offset:0 lds
    v_mfma_f32_32x32x16_bf16 v[48:63], v[100:103], a[88:91], v[48:63]
    ds_read_b64_tr_b16 v[68:69], v216 offset:49152
    ds_read_b64_tr_b16 v[70:71], v216 offset:49664
    v_mfma_f32_32x32x16_bf16 v[0:15], v[104:107], a[88:91], v[0:15]
    ds_read_b64_tr_b16 v[72:73], v213 offset:49152
    ds_read_b64_tr_b16 v[74:75], v213 offset:49664
    v_mfma_f32_32x32x16_bf16 v[16:31], v[108:111], a[88:91], v[16:31]
    ds_read_b64_tr_b16 v[76:77], v214 offset:49152
    ds_read_b64_tr_b16 v[78:79], v214 offset:49664
    s_waitcnt lgkmcnt(8)
    v_mfma_f32_32x32x16_bf16 v[32:47], v[112:115], a[92:95], v[32:47]
    ds_read_b64_tr_b16 v[80:81], v215 offset:51200
    ds_read_b64_tr_b16 v[82:83], v215 offset:51712
    buffer_load_dwordx4 a[196:199], v212, s[12:15], s33 offen offset:1024 sc1
    buffer_load_dwordx4 v209, s[8:11], s32 offen offset:1024 lds
    v_mfma_f32_32x32x16_bf16 v[48:63], v[116:119], a[92:95], v[48:63]
    ds_read_b64_tr_b16 v[84:85], v216 offset:51200
    ds_read_b64_tr_b16 v[86:87], v216 offset:51712
    v_mfma_f32_32x32x16_bf16 v[0:15], v[120:123], a[92:95], v[0:15]
    ds_read_b64_tr_b16 v[88:89], v213 offset:51200
    ds_read_b64_tr_b16 v[90:91], v213 offset:51712
    v_mfma_f32_32x32x16_bf16 v[16:31], v[124:127], a[92:95], v[16:31]
    ds_read_b64_tr_b16 v[92:93], v214 offset:51200
    ds_read_b64_tr_b16 v[94:95], v214 offset:51712
    s_waitcnt vmcnt(40)
    s_waitcnt lgkmcnt(8)
    v_mfma_f32_32x32x16_bf16 v[32:47], v[64:67], a[96:99], v[32:47]
    ds_read_b64_tr_b16 v[96:97], v215 offset:53248
    ds_read_b64_tr_b16 v[98:99], v215 offset:53760
    buffer_load_dwordx4 a[200:203], v212, s[12:15], s33 offen offset:2048 sc1
    s_add_u32 s35, s35, 0x20000
    s_add_u32 m0, s37, 0x18000
    s_nop 0
    buffer_load_dwordx4 v208, s[8:11], s35 offen offset:0 lds
    v_mfma_f32_32x32x16_bf16 v[48:63], v[68:71], a[96:99], v[48:63]
    ds_read_b64_tr_b16 v[100:101], v216 offset:53248
    ds_read_b64_tr_b16 v[102:103], v216 offset:53760
    v_mfma_f32_32x32x16_bf16 v[0:15], v[72:75], a[96:99], v[0:15]
    ds_read_b64_tr_b16 v[104:105], v213 offset:53248
    ds_read_b64_tr_b16 v[106:107], v213 offset:53760
    v_mfma_f32_32x32x16_bf16 v[16:31], v[76:79], a[96:99], v[16:31]
    ds_read_b64_tr_b16 v[108:109], v214 offset:53248
    ds_read_b64_tr_b16 v[110:111], v214 offset:53760
    s_waitcnt lgkmcnt(8)
    v_mfma_f32_32x32x16_bf16 v[32:47], v[80:83], a[100:103], v[32:47]
    ds_read_b64_tr_b16 v[112:113], v215 offset:55296
    ds_read_b64_tr_b16 v[114:115], v215 offset:55808
    buffer_load_dwordx4 a[204:207], v212, s[12:15], s33 offen offset:3072 sc1
    buffer_load_dwordx4 v209, s[8:11], s35 offen offset:1024 lds
    v_mfma_f32_32x32x16_bf16 v[48:63], v[84:87], a[100:103], v[48:63]
    ds_read_b64_tr_b16 v[116:117], v216 offset:55296
    ds_read_b64_tr_b16 v[118:119], v216 offset:55808
    v_mfma_f32_32x32x16_bf16 v[0:15], v[88:91], a[100:103], v[0:15]
    ds_read_b64_tr_b16 v[120:121], v213 offset:55296
    ds_read_b64_tr_b16 v[122:123], v213 offset:55808
    v_mfma_f32_32x32x16_bf16 v[16:31], v[92:95], a[100:103], v[16:31]
    ds_read_b64_tr_b16 v[124:125], v214 offset:55296
    ds_read_b64_tr_b16 v[126:127], v214 offset:55808
    s_barrier
    s_waitcnt lgkmcnt(8)
    v_mfma_f32_32x32x16_bf16 v[32:47], v[96:99], a[104:107], v[32:47]
    ds_read_b64_tr_b16 v[64:65], v215 offset:57344
    ds_read_b64_tr_b16 v[66:67], v215 offset:57856
    buffer_load_dword v247, v246, s[56:59], 0 offen sc1
    s_add_u32 s33, s33, 4096
    buffer_load_dwordx4 a[208:211], v212, s[12:15], s33 offen offset:0 sc1
    s_add_u32 s32, s32, 0x20000
    s_add_u32 m0, s37, 0xa000
    s_nop 0
    buffer_load_dwordx4 v208, s[8:11], s32 offen offset:0 lds
    v_mfma_f32_32x32x16_bf16 v[48:63], v[100:103], a[104:107], v[48:63]
    ds_read_b64_tr_b16 v[68:69], v216 offset:57344
    ds_read_b64_tr_b16 v[70:71], v216 offset:57856
    v_mfma_f32_32x32x16_bf16 v[0:15], v[104:107], a[104:107], v[0:15]
    ds_read_b64_tr_b16 v[72:73], v213 offset:57344
    ds_read_b64_tr_b16 v[74:75], v213 offset:57856
    v_mfma_f32_32x32x16_bf16 v[16:31], v[108:111], a[104:107], v[16:31]
    ds_read_b64_tr_b16 v[76:77], v214 offset:57344
    ds_read_b64_tr_b16 v[78:79], v214 offset:57856
    s_waitcnt lgkmcnt(8)
    v_mfma_f32_32x32x16_bf16 v[32:47], v[112:115], a[108:111], v[32:47]
    ds_read_b64_tr_b16 v[80:81], v215 offset:59392
    ds_read_b64_tr_b16 v[82:83], v215 offset:59904
    buffer_load_dwordx4 a[212:215], v212, s[12:15], s33 offen offset:1024 sc1
    buffer_load_dwordx4 v209, s[8:11], s32 offen offset:1024 lds
    v_mfma_f32_32x32x16_bf16 v[48:63], v[116:119], a[108:111], v[48:63]
    ds_read_b64_tr_b16 v[84:85], v216 offset:59392
    ds_read_b64_tr_b16 v[86:87], v216 offset:59904
    v_mfma_f32_32x32x16_bf16 v[0:15], v[120:123], a[108:111], v[0:15]
    ds_read_b64_tr_b16 v[88:89], v213 offset:59392
    ds_read_b64_tr_b16 v[90:91], v213 offset:59904
    v_mfma_f32_32x32x16_bf16 v[16:31], v[124:127], a[108:111], v[16:31]
    ds_read_b64_tr_b16 v[92:93], v214 offset:59392
    ds_read_b64_tr_b16 v[94:95], v214 offset:59904
    s_waitcnt vmcnt(45)
    s_waitcnt lgkmcnt(8)
    v_mfma_f32_32x32x16_bf16 v[32:47], v[64:67], a[112:115], v[32:47]
    ds_read_b64_tr_b16 v[96:97], v215 offset:61440
    ds_read_b64_tr_b16 v[98:99], v215 offset:61952
    buffer_load_dwordx4 a[216:219], v212, s[12:15], s33 offen offset:2048 sc1
    s_add_u32 s35, s35, 0x20000
    s_add_u32 m0, s37, 0x1a000
    s_nop 0
    buffer_load_dwordx4 v208, s[8:11], s35 offen offset:0 lds
    v_mfma_f32_32x32x16_bf16 v[48:63], v[68:71], a[112:115], v[48:63]
    ds_read_b64_tr_b16 v[100:101], v216 offset:61440
    ds_read_b64_tr_b16 v[102:103], v216 offset:61952
    v_mfma_f32_32x32x16_bf16 v[0:15], v[72:75], a[112:115], v[0:15]
    ds_read_b64_tr_b16 v[104:105], v213 offset:61440
    ds_read_b64_tr_b16 v[106:107], v213 offset:61952
    v_mfma_f32_32x32x16_bf16 v[16:31], v[76:79], a[112:115], v[16:31]
    ds_read_b64_tr_b16 v[108:109], v214 offset:61440
    ds_read_b64_tr_b16 v[110:111], v214 offset:61952
    s_waitcnt lgkmcnt(8)
    v_mfma_f32_32x32x16_bf16 v[32:47], v[80:83], a[116:119], v[32:47]
    ds_read_b64_tr_b16 v[112:113], v215 offset:63488
    ds_read_b64_tr_b16 v[114:115], v215 offset:64000
    buffer_load_dwordx4 a[220:223], v212, s[12:15], s33 offen offset:3072 sc1
    buffer_load_dwordx4 v209, s[8:11], s35 offen offset:1024 lds
    v_mfma_f32_32x32x16_bf16 v[48:63], v[84:87], a[116:119], v[48:63]
    ds_read_b64_tr_b16 v[116:117], v216 offset:63488
    ds_read_b64_tr_b16 v[118:119], v216 offset:64000
    v_mfma_f32_32x32x16_bf16 v[0:15], v[88:91], a[116:119], v[0:15]
    ds_read_b64_tr_b16 v[120:121], v213 offset:63488
    ds_read_b64_tr_b16 v[122:123], v213 offset:64000
    v_mfma_f32_32x32x16_bf16 v[16:31], v[92:95], a[116:119], v[16:31]
    ds_read_b64_tr_b16 v[124:125], v214 offset:63488
    ds_read_b64_tr_b16 v[126:127], v214 offset:64000
    s_waitcnt vmcnt(41)
    s_barrier
    s_waitcnt lgkmcnt(8)
    v_mfma_f32_32x32x16_bf16 v[32:47], v[96:99], a[120:123], v[32:47]
    ds_read_b64_tr_b16 v[64:65], v215 offset:0
    ds_read_b64_tr_b16 v[66:67], v215 offset:512
    s_add_u32 s33, s33, 4096
    buffer_load_dwordx4 a[224:227], v212, s[12:15], s33 offen offset:0 sc1
    s_add_u32 s32, s32, 0x20000
    s_add_u32 m0, s37, 0xc000
    s_nop 0
    buffer_load_dwordx4 v208, s[8:11], s32 offen offset:0 lds
    v_mfma_f32_32x32x16_bf16 v[48:63], v[100:103], a[120:123], v[48:63]
    ds_read_b64_tr_b16 v[68:69], v216 offset:0
    ds_read_b64_tr_b16 v[70:71], v216 offset:512
    v_mfma_f32_32x32x16_bf16 v[0:15], v[104:107], a[120:123], v[0:15]
    ds_read_b64_tr_b16 v[72:73], v213 offset:0
    ds_read_b64_tr_b16 v[74:75], v213 offset:512
    v_mfma_f32_32x32x16_bf16 v[16:31], v[108:111], a[120:123], v[16:31]
    ds_read_b64_tr_b16 v[76:77], v214 offset:0
    ds_read_b64_tr_b16 v[78:79], v214 offset:512
    s_waitcnt lgkmcnt(8)
    v_mfma_f32_32x32x16_bf16 v[32:47], v[112:115], a[124:127], v[32:47]
    ds_read_b64_tr_b16 v[80:81], v215 offset:2048
    ds_read_b64_tr_b16 v[82:83], v215 offset:2560
    buffer_load_dwordx4 a[228:231], v212, s[12:15], s33 offen offset:1024 sc1
    buffer_load_dwordx4 v209, s[8:11], s32 offen offset:1024 lds
    v_mfma_f32_32x32x16_bf16 v[48:63], v[116:119], a[124:127], v[48:63]
    ds_read_b64_tr_b16 v[84:85], v216 offset:2048
    ds_read_b64_tr_b16 v[86:87], v216 offset:2560
    v_mfma_f32_32x32x16_bf16 v[0:15], v[120:123], a[124:127], v[0:15]
    ds_read_b64_tr_b16 v[88:89], v213 offset:2048
    ds_read_b64_tr_b16 v[90:91], v213 offset:2560
    v_mfma_f32_32x32x16_bf16 v[16:31], v[124:127], a[124:127], v[16:31]
    ds_read_b64_tr_b16 v[92:93], v214 offset:2048
    ds_read_b64_tr_b16 v[94:95], v214 offset:2560
    s_waitcnt lgkmcnt(8)
    v_mfma_f32_32x32x16_bf16 v[32:47], v[64:67], a[128:131], v[32:47]
    ds_read_b64_tr_b16 v[96:97], v215 offset:4096
    ds_read_b64_tr_b16 v[98:99], v215 offset:4608
    buffer_load_dwordx4 a[232:235], v212, s[12:15], s33 offen offset:2048 sc1
    s_add_u32 s35, s35, 0x20000
    s_add_u32 m0, s37, 0x1c000
    s_nop 0
    buffer_load_dwordx4 v208, s[8:11], s35 offen offset:0 lds
    v_mfma_f32_32x32x16_bf16 v[48:63], v[68:71], a[128:131], v[48:63]
    ds_read_b64_tr_b16 v[100:101], v216 offset:4096
    ds_read_b64_tr_b16 v[102:103], v216 offset:4608
    v_mfma_f32_32x32x16_bf16 v[0:15], v[72:75], a[128:131], v[0:15]
    ds_read_b64_tr_b16 v[104:105], v213 offset:4096
    ds_read_b64_tr_b16 v[106:107], v213 offset:4608
    v_mfma_f32_32x32x16_bf16 v[16:31], v[76:79], a[128:131], v[16:31]
    ds_read_b64_tr_b16 v[108:109], v214 offset:4096
    ds_read_b64_tr_b16 v[110:111], v214 offset:4608
    s_waitcnt lgkmcnt(8)
    v_mfma_f32_32x32x16_bf16 v[32:47], v[80:83], a[132:135], v[32:47]
    ds_read_b64_tr_b16 v[112:113], v215 offset:6144
    ds_read_b64_tr_b16 v[114:115], v215 offset:6656
    buffer_load_dwordx4 a[236:239], v212, s[12:15], s33 offen offset:3072 sc1
    buffer_load_dwordx4 v209, s[8:11], s35 offen offset:1024 lds
    v_mfma_f32_32x32x16_bf16 v[48:63], v[84:87], a[132:135], v[48:63]
    ds_read_b64_tr_b16 v[116:117], v216 offset:6144
    ds_read_b64_tr_b16 v[118:119], v216 offset:6656
    v_mfma_f32_32x32x16_bf16 v[0:15], v[88:91], a[132:135], v[0:15]
    ds_read_b64_tr_b16 v[120:121], v213 offset:6144
    ds_read_b64_tr_b16 v[122:123], v213 offset:6656
    v_mfma_f32_32x32x16_bf16 v[16:31], v[92:95], a[132:135], v[16:31]
    ds_read_b64_tr_b16 v[124:125], v214 offset:6144
    ds_read_b64_tr_b16 v[126:127], v214 offset:6656
    s_waitcnt vmcnt(41)
    s_barrier
    s_waitcnt lgkmcnt(8)
    v_mfma_f32_32x32x16_bf16 v[32:47], v[96:99], a[136:139], v[32:47]
    ds_read_b64_tr_b16 v[64:65], v215 offset:8192
    ds_read_b64_tr_b16 v[66:67], v215 offset:8704
    s_add_u32 s33, s33, 4096
    buffer_load_dwordx4 a[240:243], v212, s[12:15], s33 offen offset:0 sc1
    s_add_u32 s32, s32, 0x20000
    s_add_u32 m0, s37, 0xe000
    s_nop 0
    buffer_load_dwordx4 v208, s[8:11], s32 offen offset:0 lds
    v_mfma_f32_32x32x16_bf16 v[48:63], v[100:103], a[136:139], v[48:63]
    ds_read_b64_tr_b16 v[68:69], v216 offset:8192
    ds_read_b64_tr_b16 v[70:71], v216 offset:8704
    v_mfma_f32_32x32x16_bf16 v[0:15], v[104:107], a[136:139], v[0:15]
    ds_read_b64_tr_b16 v[72:73], v213 offset:8192
    ds_read_b64_tr_b16 v[74:75], v213 offset:8704
    v_mfma_f32_32x32x16_bf16 v[16:31], v[108:111], a[136:139], v[16:31]
    ds_read_b64_tr_b16 v[76:77], v214 offset:8192
    ds_read_b64_tr_b16 v[78:79], v214 offset:8704
    s_waitcnt lgkmcnt(8)
    v_mfma_f32_32x32x16_bf16 v[32:47], v[112:115], a[140:143], v[32:47]
    ds_read_b64_tr_b16 v[80:81], v215 offset:10240
    ds_read_b64_tr_b16 v[82:83], v215 offset:10752
    buffer_load_dwordx4 a[244:247], v212, s[12:15], s33 offen offset:1024 sc1
    buffer_load_dwordx4 v209, s[8:11], s32 offen offset:1024 lds
    v_mfma_f32_32x32x16_bf16 v[48:63], v[116:119], a[140:143], v[48:63]
    ds_read_b64_tr_b16 v[84:85], v216 offset:10240
    ds_read_b64_tr_b16 v[86:87], v216 offset:10752
    v_mfma_f32_32x32x16_bf16 v[0:15], v[120:123], a[140:143], v[0:15]
    ds_read_b64_tr_b16 v[88:89], v213 offset:10240
    ds_read_b64_tr_b16 v[90:91], v213 offset:10752
    v_mfma_f32_32x32x16_bf16 v[16:31], v[124:127], a[140:143], v[16:31]
    ds_read_b64_tr_b16 v[92:93], v214 offset:10240
    ds_read_b64_tr_b16 v[94:95], v214 offset:10752
    s_waitcnt lgkmcnt(8)
    v_mfma_f32_32x32x16_bf16 v[32:47], v[64:67], a[144:147], v[32:47]
    ds_read_b64_tr_b16 v[96:97], v215 offset:12288
    ds_read_b64_tr_b16 v[98:99], v215 offset:12800
    buffer_load_dwordx4 a[248:251], v212, s[12:15], s33 offen offset:2048 sc1
    s_add_u32 s35, s35, 0x20000
    s_add_u32 m0, s37, 0x1e000
    s_nop 0
    buffer_load_dwordx4 v208, s[8:11], s35 offen offset:0 lds
    v_mfma_f32_32x32x16_bf16 v[48:63], v[68:71], a[144:147], v[48:63]
    ds_read_b64_tr_b16 v[100:101], v216 offset:12288
    ds_read_b64_tr_b16 v[102:103], v216 offset:12800
    v_mfma_f32_32x32x16_bf16 v[0:15], v[72:75], a[144:147], v[0:15]
    ds_read_b64_tr_b16 v[104:105], v213 offset:12288
    ds_read_b64_tr_b16 v[106:107], v213 offset:12800
    v_mfma_f32_32x32x16_bf16 v[16:31], v[76:79], a[144:147], v[16:31]
    ds_read_b64_tr_b16 v[108:109], v214 offset:12288
    ds_read_b64_tr_b16 v[110:111], v214 offset:12800
    s_waitcnt lgkmcnt(8)
    v_mfma_f32_32x32x16_bf16 v[32:47], v[80:83], a[148:151], v[32:47]
    ds_read_b64_tr_b16 v[112:113], v215 offset:14336
    ds_read_b64_tr_b16 v[114:115], v215 offset:14848
    buffer_load_dwordx4 a[252:255], v212, s[12:15], s33 offen offset:3072 sc1
    buffer_load_dwordx4 v209, s[8:11], s35 offen offset:1024 lds
    v_mfma_f32_32x32x16_bf16 v[48:63], v[84:87], a[148:151], v[48:63]
    ds_read_b64_tr_b16 v[116:117], v216 offset:14336
    ds_read_b64_tr_b16 v[118:119], v216 offset:14848
    v_mfma_f32_32x32x16_bf16 v[0:15], v[88:91], a[148:151], v[0:15]
    ds_read_b64_tr_b16 v[120:121], v213 offset:14336
    ds_read_b64_tr_b16 v[122:123], v213 offset:14848
    v_mfma_f32_32x32x16_bf16 v[16:31], v[92:95], a[148:151], v[16:31]
    ds_read_b64_tr_b16 v[124:125], v214 offset:14336
    ds_read_b64_tr_b16 v[126:127], v214 offset:14848
    s_waitcnt vmcnt(41)
    s_barrier
    s_waitcnt lgkmcnt(8)
    v_mfma_f32_32x32x16_bf16 v[32:47], v[96:99], a[152:155], v[32:47]
    ds_read_b64_tr_b16 v[64:65], v215 offset:16384
    ds_read_b64_tr_b16 v[66:67], v215 offset:16896
    s_add_u32 s33, s33, 4096
    s_waitcnt vmcnt(24)
    v_cmp_ne_u32 vcc, 1, v247
    s_cmp_lg_u64 vcc, 0
    s_cbranch_scc1 L_kb_o_do2
L_kb_o_rt2:
    s_lshl_b32 s3, s39, 17
    s_sub_u32 s33, s33, s3
    buffer_load_dwordx4 a[0:3], v212, s[12:15], s33 offen offset:0 sc1
    s_add_u32 s32, s32, 0x20000
    s_lshl_b32 s3, s39, 22
    s_sub_u32 s32, s32, s3
    s_add_u32 m0, s37, 0x0
    s_nop 0
    buffer_load_dwordx4 v208, s[8:11], s32 offen offset:0 lds
    v_mfma_f32_32x32x16_bf16 v[48:63], v[100:103], a[152:155], v[48:63]
    ds_read_b64_tr_b16 v[68:69], v216 offset:16384
    ds_read_b64_tr_b16 v[70:71], v216 offset:16896
    v_mfma_f32_32x32x16_bf16 v[0:15], v[104:107], a[152:155], v[0:15]
    ds_read_b64_tr_b16 v[72:73], v213 offset:16384
    ds_read_b64_tr_b16 v[74:75], v213 offset:16896
    v_mfma_f32_32x32x16_bf16 v[16:31], v[108:111], a[152:155], v[16:31]
    ds_read_b64_tr_b16 v[76:77], v214 offset:16384
    ds_read_b64_tr_b16 v[78:79], v214 offset:16896
    s_waitcnt lgkmcnt(8)
    v_mfma_f32_32x32x16_bf16 v[32:47], v[112:115], a[156:159], v[32:47]
    ds_read_b64_tr_b16 v[80:81], v215 offset:18432
    ds_read_b64_tr_b16 v[82:83], v215 offset:18944
    buffer_load_dwordx4 a[4:7], v212, s[12:15], s33 offen offset:1024 sc1
    buffer_load_dwordx4 v209, s[8:11], s32 offen offset:1024 lds
    v_mfma_f32_32x32x16_bf16 v[48:63], v[116:119], a[156:159], v[48:63]
    ds_read_b64_tr_b16 v[84:85], v216 offset:18432
    ds_read_b64_tr_b16 v[86:87], v216 offset:18944
    v_mfma_f32_32x32x16_bf16 v[0:15], v[120:123], a[156:159], v[0:15]
    ds_read_b64_tr_b16 v[88:89], v213 offset:18432
    ds_read_b64_tr_b16 v[90:91], v213 offset:18944
    v_mfma_f32_32x32x16_bf16 v[16:31], v[124:127], a[156:159], v[16:31]
    ds_read_b64_tr_b16 v[92:93], v214 offset:18432
    ds_read_b64_tr_b16 v[94:95], v214 offset:18944
    s_waitcnt lgkmcnt(8)
    v_mfma_f32_32x32x16_bf16 v[32:47], v[64:67], a[160:163], v[32:47]
    ds_read_b64_tr_b16 v[96:97], v215 offset:20480
    ds_read_b64_tr_b16 v[98:99], v215 offset:20992
    buffer_load_dwordx4 a[8:11], v212, s[12:15], s33 offen offset:2048 sc1
    v_mfma_f32_32x32x16_bf16 v[48:63], v[68:71], a[160:163], v[48:63]
    ds_read_b64_tr_b16 v[100:101], v216 offset:20480
    ds_read_b64_tr_b16 v[102:103], v216 offset:20992
    v_mfma_f32_32x32x16_bf16 v[0:15], v[72:75], a[160:163], v[0:15]
    ds_read_b64_tr_b16 v[104:105], v213 offset:20480
    ds_read_b64_tr_b16 v[106:107], v213 offset:20992
    v_mfma_f32_32x32x16_bf16 v[16:31], v[76:79], a[160:163], v[16:31]
    ds_read_b64_tr_b16 v[108:109], v214 offset:20480
    ds_read_b64_tr_b16 v[110:111], v214 offset:20992
    s_waitcnt lgkmcnt(8)
    v_mfma_f32_32x32x16_bf16 v[32:47], v[80:83], a[164:167], v[32:47]
    ds_read_b64_tr_b16 v[112:113], v215 offset:22528
    ds_read_b64_tr_b16 v[114:115], v215 offset:23040
    buffer_load_dwordx4 a[12:15], v212, s[12:15], s33 offen offset:3072 sc1
    v_mfma_f32_32x32x16_bf16 v[48:63], v[84:87], a[164:167], v[48:63]
    ds_read_b64_tr_b16 v[116:117], v216 offset:22528
    ds_read_b64_tr_b16 v[118:119], v216 offset:23040
    v_mfma_f32_32x32x16_bf16 v[0:15], v[88:91], a[164:167], v[0:15]
    ds_read_b64_tr_b16 v[120:121], v213 offset:22528
    ds_read_b64_tr_b16 v[122:123], v213 offset:23040
    v_mfma_f32_32x32x16_bf16 v[16:31], v[92:95], a[164:167], v[16:31]
    ds_read_b64_tr_b16 v[124:125], v214 offset:22528
    ds_read_b64_tr_b16 v[126:127], v214 offset:23040
    s_barrier
    s_waitcnt lgkmcnt(8)
    v_mfma_f32_32x32x16_bf16 v[32:47], v[96:99], a[168:171], v[32:47]
    ds_read_b64_tr_b16 v[64:65], v215 offset:24576
    ds_read_b64_tr_b16 v[66:67], v215 offset:25088
    s_add_u32 s33, s33, 4096
    buffer_load_dwordx4 a[16:19], v212, s[12:15], s33 offen offset:0 sc1
    s_add_u32 s32, s32, 0x20000
    s_add_u32 m0, s37, 0x2000
    s_nop 0
    buffer_load_dwordx4 v208, s[8:11], s32 offen offset:0 lds
    v_mfma_f32_32x32x16_bf16 v[48:63], v[100:103], a[168:171], v[48:63]
    ds_read_b64_tr_b16 v[68:69], v216 offset:24576
    ds_read_b64_tr_b16 v[70:71], v216 offset:25088
    v_mfma_f32_32x32x16_bf16 v[0:15], v[104:107], a[168:171], v[0:15]
    ds_read_b64_tr_b16 v[72:73], v213 offset:24576
    ds_read_b64_tr_b16 v[74:75], v213 offset:25088
    v_mfma_f32_32x32x16_bf16 v[16:31], v[108:111], a[168:171], v[16:31]
    ds_read_b64_tr_b16 v[76:77], v214 offset:24576
    ds_read_b64_tr_b16 v[78:79], v214 offset:25088
    s_waitcnt lgkmcnt(8)
    v_mfma_f32_32x32x16_bf16 v[32:47], v[112:115], a[172:175], v[32:47]
    ds_read_b64_tr_b16 v[80:81], v215 offset:26624
    ds_read_b64_tr_b16 v[82:83], v215 offset:27136
    buffer_load_dwordx4 a[20:23], v212, s[12:15], s33 offen offset:1024 sc1
    buffer_load_dwordx4 v209, s[8:11], s32 offen offset:1024 lds
    v_mfma_f32_32x32x16_bf16 v[48:63], v[116:119], a[172:175], v[48:63]
    ds_read_b64_tr_b16 v[84:85], v216 offset:26624
    ds_read_b64_tr_b16 v[86:87], v216 offset:27136
    v_mfma_f32_32x32x16_bf16 v[0:15], v[120:123], a[172:175], v[0:15]
    ds_read_b64_tr_b16 v[88:89], v213 offset:26624
    ds_read_b64_tr_b16 v[90:91], v213 offset:27136
    v_mfma_f32_32x32x16_bf16 v[16:31], v[124:127], a[172:175], v[16:31]
    ds_read_b64_tr_b16 v[92:93], v214 offset:26624
    ds_read_b64_tr_b16 v[94:95], v214 offset:27136
    s_waitcnt lgkmcnt(8)
    v_mfma_f32_32x32x16_bf16 v[32:47], v[64:67], a[176:179], v[32:47]
    ds_read_b64_tr_b16 v[96:97], v215 offset:28672
    ds_read_b64_tr_b16 v[98:99], v215 offset:29184
    buffer_load_dwordx4 a[24:27], v212, s[12:15], s33 offen offset:2048 sc1
    v_mfma_f32_32x32x16_bf16 v[48:63], v[68:71], a[176:179], v[48:63]
    ds_read_b64_tr_b16 v[100:101], v216 offset:28672
    ds_read_b64_tr_b16 v[102:103], v216 offset:29184
    v_mfma_f32_32x32x16_bf16 v[0:15], v[72:75], a[176:179], v[0:15]
    ds_read_b64_tr_b16 v[104:105], v213 offset:28672
    ds_read_b64_tr_b16 v[106:107], v213 offset:29184
    v_mfma_f32_32x32x16_bf16 v[16:31], v[76:79], a[176:179], v[16:31]
    ds_read_b64_tr_b16 v[108:109], v214 offset:28672
    ds_read_b64_tr_b16 v[110:111], v214 offset:29184
    s_waitcnt lgkmcnt(8)
    v_mfma_f32_32x32x16_bf16 v[32:47], v[80:83], a[180:183], v[32:47]
    ds_read_b64_tr_b16 v[112:113], v215 offset:30720
    ds_read_b64_tr_b16 v[114:115], v215 offset:31232
    buffer_load_dwordx4 a[28:31], v212, s[12:15], s33 offen offset:3072 sc1
    v_mfma_f32_32x32x16_bf16 v[48:63], v[84:87], a[180:183], v[48:63]
    ds_read_b64_tr_b16 v[116:117], v216 offset:30720
    ds_read_b64_tr_b16 v[118:119], v216 offset:31232
    v_mfma_f32_32x32x16_bf16 v[0:15], v[88:91], a[180:183], v[0:15]
    ds_read_b64_tr_b16 v[120:121], v213 offset:30720
    ds_read_b64_tr_b16 v[122:123], v213 offset:31232
    v_mfma_f32_32x32x16_bf16 v[16:31], v[92:95], a[180:183], v[16:31]
    ds_read_b64_tr_b16 v[124:125], v214 offset:30720
    ds_read_b64_tr_b16 v[126:127], v214 offset:31232
    s_barrier
    s_waitcnt lgkmcnt(8)
    v_mfma_f32_32x32x16_bf16 v[32:47], v[96:99], a[184:187], v[32:47]
    ds_read_b64_tr_b16 v[64:65], v215 offset:32768
    ds_read_b64_tr_b16 v[66:67], v215 offset:33280
    s_add_u32 s33, s33, 4096
    buffer_load_dwordx4 a[32:35], v212, s[12:15], s33 offen offset:0 sc1
    s_add_u32 s32, s32, 0x20000
    s_add_u32 m0, s37, 0x4000
    s_nop 0
    buffer_load_dwordx4 v208, s[8:11], s32 offen offset:0 lds
    v_mfma_f32_32x32x16_bf16 v[48:63], v[100:103], a[184:187], v[48:63]
    ds_read_b64_tr_b16 v[68:69], v216 offset:32768
    ds_read_b64_tr_b16 v[70:71], v216 offset:33280
    v_mfma_f32_32x32x16_bf16 v[0:15], v[104:107], a[184:187], v[0:15]
    ds_read_b64_tr_b16 v[72:73], v213 offset:32768
    ds_read_b64_tr_b16 v[74:75], v213 offset:33280
    v_mfma_f32_32x32x16_bf16 v[16:31], v[108:111], a[184:187], v[16:31]
    ds_read_b64_tr_b16 v[76:77], v214 offset:32768
    ds_read_b64_tr_b16 v[78:79], v214 offset:33280
    s_waitcnt lgkmcnt(8)
    v_mfma_f32_32x32x16_bf16 v[32:47], v[112:115], a[188:191], v[32:47]
    ds_read_b64_tr_b16 v[80:81], v215 offset:34816
    ds_read_b64_tr_b16 v[82:83], v215 offset:35328
    buffer_load_dwordx4 a[36:39], v212, s[12:15], s33 offen offset:1024 sc1
    buffer_load_dwordx4 v209, s[8:11], s32 offen offset:1024 lds
    v_mfma_f32_32x32x16_bf16 v[48:63], v[116:119], a[188:191], v[48:63]
    ds_read_b64_tr_b16 v[84:85], v216 offset:34816
    ds_read_b64_tr_b16 v[86:87], v216 offset:35328
    v_mfma_f32_32x32x16_bf16 v[0:15], v[120:123], a[188:191], v[0:15]
    ds_read_b64_tr_b16 v[88:89], v213 offset:34816
    ds_read_b64_tr_b16 v[90:91], v213 offset:35328
    v_mfma_f32_32x32x16_bf16 v[16:31], v[124:127], a[188:191], v[16:31]
    ds_read_b64_tr_b16 v[92:93], v214 offset:34816
    ds_read_b64_tr_b16 v[94:95], v214 offset:35328
    s_waitcnt lgkmcnt(8)
    v_mfma_f32_32x32x16_bf16 v[32:47], v[64:67], a[192:195], v[32:47]
    ds_read_b64_tr_b16 v[96:97], v215 offset:36864
    ds_read_b64_tr_b16 v[98:99], v215 offset:37376
    buffer_load_dwordx4 a[40:43], v212, s[12:15], s33 offen offset:2048 sc1
    v_mfma_f32_32x32x16_bf16 v[48:63], v[68:71], a[192:195], v[48:63]
    ds_read_b64_tr_b16 v[100:101], v216 offset:36864
    ds_read_b64_tr_b16 v[102:103], v216 offset:37376
    v_mfma_f32_32x32x16_bf16 v[0:15], v[72:75], a[192:195], v[0:15]
    ds_read_b64_tr_b16 v[104:105], v213 offset:36864
    ds_read_b64_tr_b16 v[106:107], v213 offset:37376
    v_mfma_f32_32x32x16_bf16 v[16:31], v[76:79], a[192:195], v[16:31]
    ds_read_b64_tr_b16 v[108:109], v214 offset:36864
    ds_read_b64_tr_b16 v[110:111], v214 offset:37376
    s_waitcnt lgkmcnt(8)
    v_mfma_f32_32x32x16_bf16 v[32:47], v[80:83], a[196:199], v[32:47]
    ds_read_b64_tr_b16 v[112:113], v215 offset:38912
    ds_read_b64_tr_b16 v[114:115], v215 offset:39424
    buffer_load_dwordx4 a[44:47], v212, s[12:15], s33 offen offset:3072 sc1
    v_mfma_f32_32x32x16_bf16 v[48:63], v[84:87], a[196:199], v[48:63]
    ds_read_b64_tr_b16 v[116:117], v216 offset:38912
    ds_read_b64_tr_b16 v[118:119], v216 offset:39424
    v_mfma_f32_32x32x16_bf16 v[0:15], v[88:91], a[196:199], v[0:15]
    ds_read_b64_tr_b16 v[120:121], v213 offset:38912
    ds_read_b64_tr_b16 v[122:123], v213 offset:39424
    v_mfma_f32_32x32x16_bf16 v[16:31], v[92:95], a[196:199], v[16:31]
    ds_read_b64_tr_b16 v[124:125], v214 offset:38912
    ds_read_b64_tr_b16 v[126:127], v214 offset:39424
    s_waitcnt vmcnt(34)
    s_barrier
    s_waitcnt lgkmcnt(8)
    v_mfma_f32_32x32x16_bf16 v[32:47], v[96:99], a[200:203], v[32:47]
    ds_read_b64_tr_b16 v[64:65], v215 offset:40960
    ds_read_b64_tr_b16 v[66:67], v215 offset:41472
    s_add_u32 s33, s33, 4096
    buffer_load_dwordx4 a[48:51], v212, s[12:15], s33 offen offset:0 sc1
    s_add_u32 s32, s32, 0x20000
    s_add_u32 m0, s37, 0x6000
    s_nop 0
    buffer_load_dwordx4 v208, s[8:11], s32 offen offset:0 lds
    v_mfma_f32_32x32x16_bf16 v[48:63], v[100:103], a[200:203], v[48:63]
    ds_read_b64_tr_b16 v[68:69], v216 offset:40960
    ds_read_b64_tr_b16 v[70:71], v216 offset:41472
    v_mfma_f32_32x32x16_bf16 v[0:15], v[104:107], a[200:203], v[0:15]
    ds_read_b64_tr_b16 v[72:73], v213 offset:40960
    ds_read_b64_tr_b16 v[74:75], v213 offset:41472
    v_mfma_f32_32x32x16_bf16 v[16:31], v[108:111], a[200:203], v[16:31]
    ds_read_b64_tr_b16 v[76:77], v214 offset:40960
    ds_read_b64_tr_b16 v[78:79], v214 offset:41472
    s_waitcnt lgkmcnt(8)
    v_mfma_f32_32x32x16_bf16 v[32:47], v[112:115], a[204:207], v[32:47]
    ds_read_b64_tr_b16 v[80:81], v215 offset:43008
    ds_read_b64_tr_b16 v[82:83], v215 offset:43520
    buffer_load_dwordx4 a[52:55], v212, s[12:15], s33 offen offset:1024 sc1
    buffer_load_dwordx4 v209, s[8:11], s32 offen offset:1024 lds
    v_mfma_f32_32x32x16_bf16 v[48:63], v[116:119], a[204:207], v[48:63]
    ds_read_b64_tr_b16 v[84:85], v216 offset:43008
    ds_read_b64_tr_b16 v[86:87], v216 offset:43520
    v_mfma_f32_32x32x16_bf16 v[0:15], v[120:123], a[204:207], v[0:15]
    ds_read_b64_tr_b16 v[88:89], v213 offset:43008
    ds_read_b64_tr_b16 v[90:91], v213 offset:43520
    v_mfma_f32_32x32x16_bf16 v[16:31], v[124:127], a[204:207], v[16:31]
    ds_read_b64_tr_b16 v[92:93], v214 offset:43008
    ds_read_b64_tr_b16 v[94:95], v214 offset:43520
    s_waitcnt lgkmcnt(8)
    v_mfma_f32_32x32x16_bf16 v[32:47], v[64:67], a[208:211], v[32:47]
    ds_read_b64_tr_b16 v[96:97], v215 offset:45056
    ds_read_b64_tr_b16 v[98:99], v215 offset:45568
    buffer_load_dwordx4 a[56:59], v212, s[12:15], s33 offen offset:2048 sc1
    v_mfma_f32_32x32x16_bf16 v[48:63], v[68:71], a[208:211], v[48:63]
    ds_read_b64_tr_b16 v[100:101], v216 offset:45056
    ds_read_b64_tr_b16 v[102:103], v216 offset:45568
    v_mfma_f32_32x32x16_bf16 v[0:15], v[72:75], a[208:211], v[0:15]
    ds_read_b64_tr_b16 v[104:105], v213 offset:45056
    ds_read_b64_tr_b16 v[106:107], v213 offset:45568
    v_mfma_f32_32x32x16_bf16 v[16:31], v[76:79], a[208:211], v[16:31]
    ds_read_b64_tr_b16 v[108:109], v214 offset:45056
    ds_read_b64_tr_b16 v[110:111], v214 offset:45568
    s_waitcnt lgkmcnt(8)
    v_mfma_f32_32x32x16_bf16 v[32:47], v[80:83], a[212:215], v[32:47]
    ds_read_b64_tr_b16 v[112:113], v215 offset:47104
    ds_read_b64_tr_b16 v[114:115], v215 offset:47616
    buffer_load_dwordx4 a[60:63], v212, s[12:15], s33 offen offset:3072 sc1
    v_mfma_f32_32x32x16_bf16 v[48:63], v[84:87], a[212:215], v[48:63]
    ds_read_b64_tr_b16 v[116:117], v216 offset:47104
    ds_read_b64_tr_b16 v[118:119], v216 offset:47616
    v_mfma_f32_32x32x16_bf16 v[0:15], v[88:91], a[212:215], v[0:15]
    ds_read_b64_tr_b16 v[120:121], v213 offset:47104
    ds_read_b64_tr_b16 v[122:123], v213 offset:47616
    v_mfma_f32_32x32x16_bf16 v[16:31], v[92:95], a[212:215], v[16:31]
    ds_read_b64_tr_b16 v[124:125], v214 offset:47104
    ds_read_b64_tr_b16 v[126:127], v214 offset:47616
    s_waitcnt vmcnt(32)
    s_barrier
    s_waitcnt lgkmcnt(8)
    v_mfma_f32_32x32x16_bf16 v[32:47], v[96:99], a[216:219], v[32:47]
    ds_read_b64_tr_b16 v[64:65], v215 offset:49152
    ds_read_b64_tr_b16 v[66:67], v215 offset:49664
    s_add_u32 s33, s33, 4096
    buffer_load_dwordx4 a[64:67], v212, s[12:15], s33 offen offset:0 sc1
    s_add_u32 s32, s32, 0x20000
    s_add_u32 m0, s37, 0x8000
    s_nop 0
    buffer_load_dwordx4 v208, s[8:11], s32 offen offset:0 lds
    v_mfma_f32_32x32x16_bf16 v[48:63], v[100:103], a[216:219], v[48:63]
    ds_read_b64_tr_b16 v[68:69], v216 offset:49152
    ds_read_b64_tr_b16 v[70:71], v216 offset:49664
    v_mfma_f32_32x32x16_bf16 v[0:15], v[104:107], a[216:219], v[0:15]
    ds_read_b64_tr_b16 v[72:73], v213 offset:49152
    ds_read_b64_tr_b16 v[74:75], v213 offset:49664
    v_mfma_f32_32x32x16_bf16 v[16:31], v[108:111], a[216:219], v[16:31]
    ds_read_b64_tr_b16 v[76:77], v214 offset:49152
    ds_read_b64_tr_b16 v[78:79], v214 offset:49664
    s_waitcnt lgkmcnt(8)
    v_mfma_f32_32x32x16_bf16 v[32:47], v[112:115], a[220:223], v[32:47]
    ds_read_b64_tr_b16 v[80:81], v215 offset:51200
    ds_read_b64_tr_b16 v[82:83], v215 offset:51712
    buffer_load_dwordx4 a[68:71], v212, s[12:15], s33 offen offset:1024 sc1
    buffer_load_dwordx4 v209, s[8:11], s32 offen offset:1024 lds
    v_mfma_f32_32x32x16_bf16 v[48:63], v[116:119], a[220:223], v[48:63]
    ds_read_b64_tr_b16 v[84:85], v216 offset:51200
    ds_read_b64_tr_b16 v[86:87], v216 offset:51712
    v_mfma_f32_32x32x16_bf16 v[0:15], v[120:123], a[220:223], v[0:15]
    ds_read_b64_tr_b16 v[88:89], v213 offset:51200
    ds_read_b64_tr_b16 v[90:91], v213 offset:51712
    v_mfma_f32_32x32x16_bf16 v[16:31], v[124:127], a[220:223], v[16:31]
    ds_read_b64_tr_b16 v[92:93], v214 offset:51200
    ds_read_b64_tr_b16 v[94:95], v214 offset:51712
    s_waitcnt lgkmcnt(8)
    v_mfma_f32_32x32x16_bf16 v[32:47], v[64:67], a[224:227], v[32:47]
    ds_read_b64_tr_b16 v[96:97], v215 offset:53248
    ds_read_b64_tr_b16 v[98:99], v215 offset:53760
    buffer_load_dwordx4 a[72:75], v212, s[12:15], s33 offen offset:2048 sc1
    v_mfma_f32_32x32x16_bf16 v[48:63], v[68:71], a[224:227], v[48:63]
    ds_read_b64_tr_b16 v[100:101], v216 offset:53248
    ds_read_b64_tr_b16 v[102:103], v216 offset:53760
    v_mfma_f32_32x32x16_bf16 v[0:15], v[72:75], a[224:227], v[0:15]
    ds_read_b64_tr_b16 v[104:105], v213 offset:53248
    ds_read_b64_tr_b16 v[106:107], v213 offset:53760
    v_mfma_f32_32x32x16_bf16 v[16:31], v[76:79], a[224:227], v[16:31]
    ds_read_b64_tr_b16 v[108:109], v214 offset:53248
    ds_read_b64_tr_b16 v[110:111], v214 offset:53760
    s_waitcnt lgkmcnt(8)
    v_mfma_f32_32x32x16_bf16 v[32:47], v[80:83], a[228:231], v[32:47]
    ds_read_b64_tr_b16 v[112:113], v215 offset:55296
    ds_read_b64_tr_b16 v[114:115], v215 offset:55808
    buffer_load_dwordx4 a[76:79], v212, s[12:15], s33 offen offset:3072 sc1
    v_mfma_f32_32x32x16_bf16 v[48:63], v[84:87], a[228:231], v[48:63]
    ds_read_b64_tr_b16 v[116:117], v216 offset:55296
    ds_read_b64_tr_b16 v[118:119], v216 offset:55808
    v_mfma_f32_32x32x16_bf16 v[0:15], v[88:91], a[228:231], v[0:15]
    ds_read_b64_tr_b16 v[120:121], v213 offset:55296
    ds_read_b64_tr_b16 v[122:123], v213 offset:55808
    v_mfma_f32_32x32x16_bf16 v[16:31], v[92:95], a[228:231], v[16:31]
    ds_read_b64_tr_b16 v[124:125], v214 offset:55296
    ds_read_b64_tr_b16 v[126:127], v214 offset:55808
    s_waitcnt vmcnt(30)
    s_barrier
    s_waitcnt lgkmcnt(8)
    v_mfma_f32_32x32x16_bf16 v[32:47], v[96:99], a[232:235], v[32:47]
    ds_read_b64_tr_b16 v[64:65], v215 offset:57344
    ds_read_b64_tr_b16 v[66:67], v215 offset:57856
    s_add_u32 s33, s33, 4096
    buffer_load_dwordx4 a[80:83], v212, s[12:15], s33 offen offset:0 sc1
    s_add_u32 s32, s32, 0x20000
    s_add_u32 m0, s37, 0xa000
    s_nop 0
    buffer_load_dwordx4 v208, s[8:11], s32 offen offset:0 lds
    v_mfma_f32_32x32x16_bf16 v[48:63], v[100:103], a[232:235], v[48:63]
    ds_read_b64_tr_b16 v[68:69], v216 offset:57344
    ds_read_b64_tr_b16 v[70:71], v216 offset:57856
    v_mfma_f32_32x32x16_bf16 v[0:15], v[104:107], a[232:235], v[0:15]
    ds_read_b64_tr_b16 v[72:73], v213 offset:57344
    ds_read_b64_tr_b16 v[74:75], v213 offset:57856
    v_mfma_f32_32x32x16_bf16 v[16:31], v[108:111], a[232:235], v[16:31]
    ds_read_b64_tr_b16 v[76:77], v214 offset:57344
    ds_read_b64_tr_b16 v[78:79], v214 offset:57856
    s_waitcnt lgkmcnt(8)
    v_mfma_f32_32x32x16_bf16 v[32:47], v[112:115], a[236:239], v[32:47]
    ds_read_b64_tr_b16 v[80:81], v215 offset:59392
    ds_read_b64_tr_b16 v[82:83], v215 offset:59904
    buffer_load_dwordx4 a[84:87], v212, s[12:15], s33 offen offset:1024 sc1
    buffer_load_dwordx4 v209, s[8:11], s32 offen offset:1024 lds
    v_mfma_f32_32x32x16_bf16 v[48:63], v[116:119], a[236:239], v[48:63]
    ds_read_b64_tr_b16 v[84:85], v216 offset:59392
    ds_read_b64_tr_b16 v[86:87], v216 offset:59904
    v_mfma_f32_32x32x16_bf16 v[0:15], v[120:123], a[236:239], v[0:15]
    ds_read_b64_tr_b16 v[88:89], v213 offset:59392
    ds_read_b64_tr_b16 v[90:91], v213 offset:59904
    v_mfma_f32_32x32x16_bf16 v[16:31], v[124:127], a[236:239], v[16:31]
    ds_read_b64_tr_b16 v[92:93], v214 offset:59392
    ds_read_b64_tr_b16 v[94:95], v214 offset:59904
    s_waitcnt lgkmcnt(8)
    v_mfma_f32_32x32x16_bf16 v[32:47], v[64:67], a[240:243], v[32:47]
    ds_read_b64_tr_b16 v[96:97], v215 offset:61440
    ds_read_b64_tr_b16 v[98:99], v215 offset:61952
    buffer_load_dwordx4 a[88:91], v212, s[12:15], s33 offen offset:2048 sc1
    v_mfma_f32_32x32x16_bf16 v[48:63], v[68:71], a[240:243], v[48:63]
    ds_read_b64_tr_b16 v[100:101], v216 offset:61440
    ds_read_b64_tr_b16 v[102:103], v216 offset:61952
    v_mfma_f32_32x32x16_bf16 v[0:15], v[72:75], a[240:243], v[0:15]
    ds_read_b64_tr_b16 v[104:105], v213 offset:61440
    ds_read_b64_tr_b16 v[106:107], v213 offset:61952
    v_mfma_f32_32x32x16_bf16 v[16:31], v[76:79], a[240:243], v[16:31]
    ds_read_b64_tr_b16 v[108:109], v214 offset:61440
    ds_read_b64_tr_b16 v[110:111], v214 offset:61952
    s_waitcnt lgkmcnt(8)
    v_mfma_f32_32x32x16_bf16 v[32:47], v[80:83], a[244:247], v[32:47]
    ds_read_b64_tr_b16 v[112:113], v215 offset:63488
    ds_read_b64_tr_b16 v[114:115], v215 offset:64000
    buffer_load_dwordx4 a[92:95], v212, s[12:15], s33 offen offset:3072 sc1
    v_mfma_f32_32x32x16_bf16 v[48:63], v[84:87], a[244:247], v[48:63]
    ds_read_b64_tr_b16 v[116:117], v216 offset:63488
    ds_read_b64_tr_b16 v[118:119], v216 offset:64000
    v_mfma_f32_32x32x16_bf16 v[0:15], v[88:91], a[244:247], v[0:15]
    ds_read_b64_tr_b16 v[120:121], v213 offset:63488
    ds_read_b64_tr_b16 v[122:123], v213 offset:64000
    v_mfma_f32_32x32x16_bf16 v[16:31], v[92:95], a[244:247], v[16:31]
    ds_read_b64_tr_b16 v[124:125], v214 offset:63488
    ds_read_b64_tr_b16 v[126:127], v214 offset:64000
    s_waitcnt vmcnt(32)
    s_barrier
    s_waitcnt lgkmcnt(8)
    v_mfma_f32_32x32x16_bf16 v[32:47], v[96:99], a[248:251], v[32:47]
    ds_read_b64_tr_b16 v[64:65], v215 offset:0
    ds_read_b64_tr_b16 v[66:67], v215 offset:512
    s_add_u32 s33, s33, 4096
    buffer_load_dwordx4 a[96:99], v212, s[12:15], s33 offen offset:0 sc1
    s_add_u32 s32, s32, 0x20000
    s_add_u32 m0, s37, 0xc000
    s_nop 0
    buffer_load_dwordx4 v208, s[8:11], s32 offen offset:0 lds
    ds_read_b64_tr_b16 v[72:73], v215 offset:2048
    ds_read_b64_tr_b16 v[74:75], v215 offset:2560
    buffer_load_dwordx4 a[100:103], v212, s[12:15], s33 offen offset:1024 sc1
    buffer_load_dwordx4 v209, s[8:11], s32 offen offset:1024 lds
    v_mfma_f32_32x32x16_bf16 v[48:63], v[100:103], a[248:251], v[48:63]
    ds_read_b64_tr_b16 v[68:69], v216 offset:0
    ds_read_b64_tr_b16 v[70:71], v216 offset:512
    ds_read_b64_tr_b16 v[76:77], v216 offset:2048
    ds_read_b64_tr_b16 v[78:79], v216 offset:2560
    v_mfma_f32_32x32x16_bf16 v[0:15], v[104:107], a[248:251], v[0:15]
    v_mfma_f32_32x32x16_bf16 v[16:31], v[108:111], a[248:251], v[16:31]
    s_waitcnt lgkmcnt(8)
    v_mfma_f32_32x32x16_bf16 v[32:47], v[112:115], a[252:255], v[32:47]
    ds_read_b64_tr_b16 v[80:81], v215 offset:4096
    ds_read_b64_tr_b16 v[82:83], v215 offset:4608
    buffer_load_dwordx4 a[104:107], v212, s[12:15], s33 offen offset:2048 sc1
    ds_read_b64_tr_b16 v[88:89], v215 offset:6144
    ds_read_b64_tr_b16 v[90:91], v215 offset:6656
    buffer_load_dwordx4 a[108:111], v212, s[12:15], s33 offen offset:3072 sc1
    v_mfma_f32_32x32x16_bf16 v[48:63], v[116:119], a[252:255], v[48:63]
    ds_read_b64_tr_b16 v[84:85], v216 offset:4096
    ds_read_b64_tr_b16 v[86:87], v216 offset:4608
    ds_read_b64_tr_b16 v[92:93], v216 offset:6144
    ds_read_b64_tr_b16 v[94:95], v216 offset:6656
    v_mfma_f32_32x32x16_bf16 v[0:15], v[120:123], a[252:255], v[0:15]
    v_mfma_f32_32x32x16_bf16 v[16:31], v[124:127], a[252:255], v[16:31]
    s_waitcnt vmcnt(32)
    s_barrier
    s_waitcnt lgkmcnt(10)
    v_mfma_f32_32x32x16_bf16 v[32:47], v[64:67], a[0:3], v[32:47]
    ds_read_b64_tr_b16 v[96:97], v215 offset:8192
    ds_read_b64_tr_b16 v[98:99], v215 offset:8704
    s_add_u32 s33, s33, 4096
    buffer_load_dwordx4 a[112:115], v212, s[12:15], s33 offen offset:0 sc1
    s_add_u32 s32, s32, 0x20000
    s_add_u32 m0, s37, 0xe000
    s_nop 0
    buffer_load_dwordx4 v208, s[8:11], s32 offen offset:0 lds
    ds_read_b64_tr_b16 v[104:105], v215 offset:10240
    ds_read_b64_tr_b16 v[106:107], v215 offset:10752
    buffer_load_dwordx4 a[116:119], v212, s[12:15], s33 offen offset:1024 sc1
    buffer_load_dwordx4 v209, s[8:11], s32 offen offset:1024 lds
    v_mfma_f32_32x32x16_bf16 v[48:63], v[68:71], a[0:3], v[48:63]
    ds_read_b64_tr_b16 v[100:101], v216 offset:8192
    ds_read_b64_tr_b16 v[102:103], v216 offset:8704
    ds_read_b64_tr_b16 v[108:109], v216 offset:10240
    ds_read_b64_tr_b16 v[110:111], v216 offset:10752
    s_waitcnt lgkmcnt(15)
    v_mfma_f32_32x32x16_bf16 v[32:47], v[72:75], a[4:7], v[32:47]
    ds_read_b64_tr_b16 v[112:113], v215 offset:12288
    ds_read_b64_tr_b16 v[114:115], v215 offset:12800
    buffer_load_dwordx4 a[120:123], v212, s[12:15], s33 offen offset:2048 sc1
    v_mfma_f32_32x32x16_bf16 v[48:63], v[76:79], a[4:7], v[48:63]
    ds_read_b64_tr_b16 v[116:117], v216 offset:12288
    ds_read_b64_tr_b16 v[118:119], v216 offset:12800
    s_waitcnt lgkmcnt(14)
    v_mfma_f32_32x32x16_bf16 v[32:47], v[80:83], a[8:11], v[32:47]
    ds_read_b64_tr_b16 v[120:121], v215 offset:14336
    ds_read_b64_tr_b16 v[122:123], v215 offset:14848
    buffer_load_dwordx4 a[124:127], v212, s[12:15], s33 offen offset:3072 sc1
    v_mfma_f32_32x32x16_bf16 v[48:63], v[84:87], a[8:11], v[48:63]
    ds_read_b64_tr_b16 v[124:125], v216 offset:14336
    ds_read_b64_tr_b16 v[126:127], v216 offset:14848
    s_waitcnt vmcnt(32)
    s_waitcnt lgkmcnt(15)
    s_barrier
    v_mfma_f32_32x32x16_bf16 v[32:47], v[88:91], a[12:15], v[32:47]
    ds_read_b64_tr_b16 v[64:65], v215 offset:16384
    ds_read_b64_tr_b16 v[66:67], v215 offset:16896
    s_add_u32 s33, s33, 4096
    buffer_load_dwordx4 a[128:131], v212, s[12:15], s33 offen offset:0 sc1
    s_add_u32 s32, s32, 0x20000
    s_add_u32 m0, s37, 0x0
    s_nop 0
    buffer_load_dwordx4 v208, s[8:11], s32 offen offset:0 lds
    v_mfma_f32_32x32x16_bf16 v[48:63], v[92:95], a[12:15], v[48:63]
    ds_read_b64_tr_b16 v[68:69], v216 offset:16384
    ds_read_b64_tr_b16 v[70:71], v216 offset:16896
    s_waitcnt lgkmcnt(14)
    v_mfma_f32_32x32x16_bf16 v[32:47], v[96:99], a[16:19], v[32:47]
    ds_read_b64_tr_b16 v[72:73], v215 offset:18432
    ds_read_b64_tr_b16 v[74:75], v215 offset:18944
    buffer_load_dwordx4 a[132:135], v212, s[12:15], s33 offen offset:1024 sc1
    buffer_load_dwordx4 v209, s[8:11], s32 offen offset:1024 lds
    v_mfma_f32_32x32x16_bf16 v[48:63], v[100:103], a[16:19], v[48:63]
    ds_read_b64_tr_b16 v[76:77], v216 offset:18432
    ds_read_b64_tr_b16 v[78:79], v216 offset:18944
    s_waitcnt lgkmcnt(15)
    v_mfma_f32_32x32x16_bf16 v[32:47], v[104:107], a[20:23], v[32:47]
    ds_read_b64_tr_b16 v[80:81], v215 offset:20480
    ds_read_b64_tr_b16 v[82:83], v215 offset:20992
    buffer_load_dwordx4 a[136:139], v212, s[12:15], s33 offen offset:2048 sc1
    v_mfma_f32_32x32x16_bf16 v[48:63], v[108:111], a[20:23], v[48:63]
    ds_read_b64_tr_b16 v[84:85], v216 offset:20480
    ds_read_b64_tr_b16 v[86:87], v216 offset:20992
    s_waitcnt lgkmcnt(15)
    v_mfma_f32_32x32x16_bf16 v[32:47], v[112:115], a[24:27], v[32:47]
    ds_read_b64_tr_b16 v[88:89], v215 offset:22528
    ds_read_b64_tr_b16 v[90:91], v215 offset:23040
    buffer_load_dwordx4 a[140:143], v212, s[12:15], s33 offen offset:3072 sc1
    v_mfma_f32_32x32x16_bf16 v[48:63], v[116:119], a[24:27], v[48:63]
    ds_read_b64_tr_b16 v[92:93], v216 offset:22528
    ds_read_b64_tr_b16 v[94:95], v216 offset:23040
    s_waitcnt vmcnt(32)
    s_waitcnt lgkmcnt(15)
    s_barrier
    v_mfma_f32_32x32x16_bf16 v[32:47], v[120:123], a[28:31], v[32:47]
    ds_read_b64_tr_b16 v[96:97], v215 offset:24576
    ds_read_b64_tr_b16 v[98:99], v215 offset:25088
    s_add_u32 s33, s33, 4096
    buffer_load_dwordx4 a[144:147], v212, s[12:15], s33 offen offset:0 sc1
    s_add_u32 s32, s32, 0x20000
    s_add_u32 m0, s37, 0x2000
    s_nop 0
    buffer_load_dwordx4 v208, s[8:11], s32 offen offset:0 lds
    v_mfma_f32_32x32x16_bf16 v[48:63], v[124:127], a[28:31], v[48:63]
    ds_read_b64_tr_b16 v[100:101], v216 offset:24576
    ds_read_b64_tr_b16 v[102:103], v216 offset:25088
    s_waitcnt lgkmcnt(15)
    v_mfma_f32_32x32x16_bf16 v[32:47], v[64:67], a[32:35], v[32:47]
    ds_read_b64_tr_b16 v[104:105], v215 offset:26624
    ds_read_b64_tr_b16 v[106:107], v215 offset:27136
    buffer_load_dwordx4 a[148:151], v212, s[12:15], s33 offen offset:1024 sc1
    buffer_load_dwordx4 v209, s[8:11], s32 offen offset:1024 lds
    v_mfma_f32_32x32x16_bf16 v[48:63], v[68:71], a[32:35], v[48:63]
    ds_read_b64_tr_b16 v[108:109], v216 offset:26624
    ds_read_b64_tr_b16 v[110:111], v216 offset:27136
    s_waitcnt lgkmcnt(15)
    v_mfma_f32_32x32x16_bf16 v[32:47], v[72:75], a[36:39], v[32:47]
    ds_read_b64_tr_b16 v[112:113], v215 offset:28672
    ds_read_b64_tr_b16 v[114:115], v215 offset:29184
    buffer_load_dwordx4 a[152:155], v212, s[12:15], s33 offen offset:2048 sc1
    v_mfma_f32_32x32x16_bf16 v[48:63], v[76:79], a[36:39], v[48:63]
    ds_read_b64_tr_b16 v[116:117], v216 offset:28672
    ds_read_b64_tr_b16 v[118:119], v216 offset:29184
    s_waitcnt lgkmcnt(15)
    v_mfma_f32_32x32x16_bf16 v[32:47], v[80:83], a[40:43], v[32:47]
    ds_read_b64_tr_b16 v[120:121], v215 offset:30720
    ds_read_b64_tr_b16 v[122:123], v215 offset:31232
    buffer_load_dwordx4 a[156:159], v212, s[12:15], s33 offen offset:3072 sc1
    v_mfma_f32_32x32x16_bf16 v[48:63], v[84:87], a[40:43], v[48:63]
    ds_read_b64_tr_b16 v[124:125], v216 offset:30720
    ds_read_b64_tr_b16 v[126:127], v216 offset:31232
    s_waitcnt vmcnt(32)
    s_waitcnt lgkmcnt(15)
    s_barrier
    v_mfma_f32_32x32x16_bf16 v[32:47], v[88:91], a[44:47], v[32:47]
    ds_read_b64_tr_b16 v[64:65], v215 offset:32768
    ds_read_b64_tr_b16 v[66:67], v215 offset:33280
    s_add_u32 s33, s33, 4096
    buffer_load_dwordx4 a[160:163], v212, s[12:15], s33 offen offset:0 sc1
    s_add_u32 s32, s32, 0x20000
    s_add_u32 m0, s37, 0x4000
    s_nop 0
    buffer_load_dwordx4 v208, s[8:11], s32 offen offset:0 lds
    v_mfma_f32_32x32x16_bf16 v[48:63], v[92:95], a[44:47], v[48:63]
    ds_read_b64_tr_b16 v[68:69], v216 offset:32768
    ds_read_b64_tr_b16 v[70:71], v216 offset:33280
    s_waitcnt lgkmcnt(15)
    v_mfma_f32_32x32x16_bf16 v[32:47], v[96:99], a[48:51], v[32:47]
    ds_read_b64_tr_b16 v[72:73], v215 offset:34816
    ds_read_b64_tr_b16 v[74:75], v215 offset:35328
    buffer_load_dwordx4 a[164:167], v212, s[12:15], s33 offen offset:1024 sc1
    buffer_load_dwordx4 v209, s[8:11], s32 offen offset:1024 lds
    v_mfma_f32_32x32x16_bf16 v[48:63], v[100:103], a[48:51], v[48:63]
    ds_read_b64_tr_b16 v[76:77], v216 offset:34816
    ds_read_b64_tr_b16 v[78:79], v216 offset:35328
    s_waitcnt lgkmcnt(15)
    v_mfma_f32_32x32x16_bf16 v[32:47], v[104:107], a[52:55], v[32:47]
    ds_read_b64_tr_b16 v[80:81], v215 offset:36864
    ds_read_b64_tr_b16 v[82:83], v215 offset:37376
    buffer_load_dwordx4 a[168:171], v212, s[12:15], s33 offen offset:2048 sc1
    v_mfma_f32_32x32x16_bf16 v[48:63], v[108:111], a[52:55], v[48:63]
    ds_read_b64_tr_b16 v[84:85], v216 offset:36864
    ds_read_b64_tr_b16 v[86:87], v216 offset:37376
    s_waitcnt lgkmcnt(15)
    v_mfma_f32_32x32x16_bf16 v[32:47], v[112:115], a[56:59], v[32:47]
    ds_read_b64_tr_b16 v[88:89], v215 offset:38912
    ds_read_b64_tr_b16 v[90:91], v215 offset:39424
    buffer_load_dwordx4 a[172:175], v212, s[12:15], s33 offen offset:3072 sc1
    v_mfma_f32_32x32x16_bf16 v[48:63], v[116:119], a[56:59], v[48:63]
    ds_read_b64_tr_b16 v[92:93], v216 offset:38912
    ds_read_b64_tr_b16 v[94:95], v216 offset:39424
    s_waitcnt vmcnt(32)
    s_waitcnt lgkmcnt(15)
    s_barrier
    v_mfma_f32_32x32x16_bf16 v[32:47], v[120:123], a[60:63], v[32:47]
    ds_read_b64_tr_b16 v[96:97], v215 offset:40960
    ds_read_b64_tr_b16 v[98:99], v215 offset:41472
    s_add_u32 s33, s33, 4096
    buffer_load_dwordx4 a[176:179], v212, s[12:15], s33 offen offset:0 sc1
    s_add_u32 s32, s32, 0x20000
    s_add_u32 m0, s37, 0x6000
    s_nop 0
    buffer_load_dwordx4 v208, s[8:11], s32 offen offset:0 lds
    v_mfma_f32_32x32x16_bf16 v[48:63], v[124:127], a[60:63], v[48:63]
    ds_read_b64_tr_b16 v[100:101], v216 offset:40960
    ds_read_b64_tr_b16 v[102:103], v216 offset:41472
    s_waitcnt lgkmcnt(15)
    v_mfma_f32_32x32x16_bf16 v[32:47], v[64:67], a[64:67], v[32:47]
    ds_read_b64_tr_b16 v[104:105], v215 offset:43008
    ds_read_b64_tr_b16 v[106:107], v215 offset:43520
    buffer_load_dwordx4 a[180:183], v212, s[12:15], s33 offen offset:1024 sc1
    buffer_load_dwordx4 v209, s[8:11], s32 offen offset:1024 lds
    v_mfma_f32_32x32x16_bf16 v[48:63], v[68:71], a[64:67], v[48:63]
    ds_read_b64_tr_b16 v[108:109], v216 offset:43008
    ds_read_b64_tr_b16 v[110:111], v216 offset:43520
    s_waitcnt lgkmcnt(15)
    v_mfma_f32_32x32x16_bf16 v[32:47], v[72:75], a[68:71], v[32:47]
    ds_read_b64_tr_b16 v[112:113], v215 offset:45056
    ds_read_b64_tr_b16 v[114:115], v215 offset:45568
    buffer_load_dwordx4 a[184:187], v212, s[12:15], s33 offen offset:2048 sc1
    v_mfma_f32_32x32x16_bf16 v[48:63], v[76:79], a[68:71], v[48:63]
    ds_read_b64_tr_b16 v[116:117], v216 offset:45056
    ds_read_b64_tr_b16 v[118:119], v216 offset:45568
    s_waitcnt lgkmcnt(15)
    v_mfma_f32_32x32x16_bf16 v[32:47], v[80:83], a[72:75], v[32:47]
    ds_read_b64_tr_b16 v[120:121], v215 offset:47104
    ds_read_b64_tr_b16 v[122:123], v215 offset:47616
    buffer_load_dwordx4 a[188:191], v212, s[12:15], s33 offen offset:3072 sc1
    v_mfma_f32_32x32x16_bf16 v[48:63], v[84:87], a[72:75], v[48:63]
    ds_read_b64_tr_b16 v[124:125], v216 offset:47104
    ds_read_b64_tr_b16 v[126:127], v216 offset:47616
    s_waitcnt vmcnt(32)
    s_waitcnt lgkmcnt(15)
    s_barrier
    v_mfma_f32_32x32x16_bf16 v[32:47], v[88:91], a[76:79], v[32:47]
    ds_read_b64_tr_b16 v[64:65], v215 offset:49152
    ds_read_b64_tr_b16 v[66:67], v215 offset:49664
    s_add_u32 s33, s33, 4096
    buffer_load_dwordx4 a[192:195], v212, s[12:15], s33 offen offset:0 sc1
    s_add_u32 s32, s32, 0x20000
    s_add_u32 m0, s37, 0x8000
    s_nop 0
    buffer_load_dwordx4 v208, s[8:11], s32 offen offset:0 lds
    v_mfma_f32_32x32x16_bf16 v[48:63], v[92:95], a[76:79], v[48:63]
    ds_read_b64_tr_b16 v[68:69], v216 offset:49152
    ds_read_b64_tr_b16 v[70:71], v216 offset:49664
    s_waitcnt lgkmcnt(15)
    v_mfma_f32_32x32x16_bf16 v[32:47], v[96:99], a[80:83], v[32:47]
    ds_read_b64_tr_b16 v[72:73], v215 offset:51200
    ds_read_b64_tr_b16 v[74:75], v215 offset:51712
    buffer_load_dwordx4 a[196:199], v212, s[12:15], s33 offen offset:1024 sc1
    buffer_load_dwordx4 v209, s[8:11], s32 offen offset:1024 lds
    v_mfma_f32_32x32x16_bf16 v[48:63], v[100:103], a[80:83], v[48:63]
    ds_read_b64_tr_b16 v[76:77], v216 offset:51200
    ds_read_b64_tr_b16 v[78:79], v216 offset:51712
    s_waitcnt lgkmcnt(15)
    v_mfma_f32_32x32x16_bf16 v[32:47], v[104:107], a[84:87], v[32:47]
    ds_read_b64_tr_b16 v[80:81], v215 offset:53248
    ds_read_b64_tr_b16 v[82:83], v215 offset:53760
    buffer_load_dwordx4 a[200:203], v212, s[12:15], s33 offen offset:2048 sc1
    v_mfma_f32_32x32x16_bf16 v[48:63], v[108:111], a[84:87], v[48:63]
    ds_read_b64_tr_b16 v[84:85], v216 offset:53248
    ds_read_b64_tr_b16 v[86:87], v216 offset:53760
    s_waitcnt lgkmcnt(15)
    v_mfma_f32_32x32x16_bf16 v[32:47], v[112:115], a[88:91], v[32:47]
    ds_read_b64_tr_b16 v[88:89], v215 offset:55296
    ds_read_b64_tr_b16 v[90:91], v215 offset:55808
    buffer_load_dwordx4 a[204:207], v212, s[12:15], s33 offen offset:3072 sc1
    v_mfma_f32_32x32x16_bf16 v[48:63], v[116:119], a[88:91], v[48:63]
    ds_read_b64_tr_b16 v[92:93], v216 offset:55296
    ds_read_b64_tr_b16 v[94:95], v216 offset:55808
    s_waitcnt vmcnt(32)
    s_waitcnt lgkmcnt(15)
    s_barrier
    v_mfma_f32_32x32x16_bf16 v[32:47], v[120:123], a[92:95], v[32:47]
    ds_read_b64_tr_b16 v[96:97], v215 offset:57344
    ds_read_b64_tr_b16 v[98:99], v215 offset:57856
    s_add_u32 s33, s33, 4096
    buffer_load_dwordx4 a[208:211], v212, s[12:15], s33 offen offset:0 sc1
    s_add_u32 s32, s32, 0x20000
    s_add_u32 m0, s37, 0xa000
    s_nop 0
    buffer_load_dwordx4 v208, s[8:11], s32 offen offset:0 lds
    v_mfma_f32_32x32x16_bf16 v[48:63], v[124:127], a[92:95], v[48:63]
    ds_read_b64_tr_b16 v[100:101], v216 offset:57344
    ds_read_b64_tr_b16 v[102:103], v216 offset:57856
    s_waitcnt lgkmcnt(15)
    v_mfma_f32_32x32x16_bf16 v[32:47], v[64:67], a[96:99], v[32:47]
    ds_read_b64_tr_b16 v[104:105], v215 offset:59392
    ds_read_b64_tr_b16 v[106:107], v215 offset:59904
    buffer_load_dwordx4 a[212:215], v212, s[12:15], s33 offen offset:1024 sc1
    buffer_load_dwordx4 v209, s[8:11], s32 offen offset:1024 lds
    v_mfma_f32_32x32x16_bf16 v[48:63], v[68:71], a[96:99], v[48:63]
    ds_read_b64_tr_b16 v[108:109], v216 offset:59392
    ds_read_b64_tr_b16 v[110:111], v216 offset:59904
    s_waitcnt lgkmcnt(15)
    v_mfma_f32_32x32x16_bf16 v[32:47], v[72:75], a[100:103], v[32:47]
    ds_read_b64_tr_b16 v[112:113], v215 offset:61440
    ds_read_b64_tr_b16 v[114:115], v215 offset:61952
    buffer_load_dwordx4 a[216:219], v212, s[12:15], s33 offen offset:2048 sc1
    v_mfma_f32_32x32x16_bf16 v[48:63], v[76:79], a[100:103], v[48:63]
    ds_read_b64_tr_b16 v[116:117], v216 offset:61440
    ds_read_b64_tr_b16 v[118:119], v216 offset:61952
    s_waitcnt lgkmcnt(15)
    v_mfma_f32_32x32x16_bf16 v[32:47], v[80:83], a[104:107], v[32:47]
    ds_read_b64_tr_b16 v[120:121], v215 offset:63488
    ds_read_b64_tr_b16 v[122:123], v215 offset:64000
    buffer_load_dwordx4 a[220:223], v212, s[12:15], s33 offen offset:3072 sc1
    v_mfma_f32_32x32x16_bf16 v[48:63], v[84:87], a[104:107], v[48:63]
    ds_read_b64_tr_b16 v[124:125], v216 offset:63488
    ds_read_b64_tr_b16 v[126:127], v216 offset:64000
    s_waitcnt vmcnt(32)
    s_waitcnt lgkmcnt(15)
    s_barrier
    v_mfma_f32_32x32x16_bf16 v[32:47], v[88:91], a[108:111], v[32:47]
    ds_read_b64_tr_b16 v[64:65], v215 offset:0
    ds_read_b64_tr_b16 v[66:67], v215 offset:512
    s_add_u32 s33, s33, 4096
    buffer_load_dwordx4 a[224:227], v212, s[12:15], s33 offen offset:0 sc1
    s_add_u32 s32, s32, 0x20000
    s_add_u32 m0, s37, 0xc000
    s_nop 0
    buffer_load_dwordx4 v208, s[8:11], s32 offen offset:0 lds
    v_mfma_f32_32x32x16_bf16 v[48:63], v[92:95], a[108:111], v[48:63]
    ds_read_b64_tr_b16 v[68:69], v216 offset:0
    ds_read_b64_tr_b16 v[70:71], v216 offset:512
    s_waitcnt lgkmcnt(15)
    v_mfma_f32_32x32x16_bf16 v[32:47], v[96:99], a[112:115], v[32:47]
    ds_read_b64_tr_b16 v[72:73], v215 offset:2048
    ds_read_b64_tr_b16 v[74:75], v215 offset:2560
    buffer_load_dwordx4 a[228:231], v212, s[12:15], s33 offen offset:1024 sc1
    buffer_load_dwordx4 v209, s[8:11], s32 offen offset:1024 lds
    v_mfma_f32_32x32x16_bf16 v[48:63], v[100:103], a[112:115], v[48:63]
    ds_read_b64_tr_b16 v[76:77], v216 offset:2048
    ds_read_b64_tr_b16 v[78:79], v216 offset:2560
    s_waitcnt lgkmcnt(15)
    v_mfma_f32_32x32x16_bf16 v[32:47], v[104:107], a[116:119], v[32:47]
    ds_read_b64_tr_b16 v[80:81], v215 offset:4096
    ds_read_b64_tr_b16 v[82:83], v215 offset:4608
    buffer_load_dwordx4 a[232:235], v212, s[12:15], s33 offen offset:2048 sc1
    v_mfma_f32_32x32x16_bf16 v[48:63], v[108:111], a[116:119], v[48:63]
    ds_read_b64_tr_b16 v[84:85], v216 offset:4096
    ds_read_b64_tr_b16 v[86:87], v216 offset:4608
    s_waitcnt lgkmcnt(15)
    v_mfma_f32_32x32x16_bf16 v[32:47], v[112:115], a[120:123], v[32:47]
    ds_read_b64_tr_b16 v[88:89], v215 offset:6144
    ds_read_b64_tr_b16 v[90:91], v215 offset:6656
    buffer_load_dwordx4 a[236:239], v212, s[12:15], s33 offen offset:3072 sc1
    v_mfma_f32_32x32x16_bf16 v[48:63], v[116:119], a[120:123], v[48:63]
    ds_read_b64_tr_b16 v[92:93], v216 offset:6144
    ds_read_b64_tr_b16 v[94:95], v216 offset:6656
    s_waitcnt vmcnt(32)
    s_waitcnt lgkmcnt(15)
    s_barrier
    v_mfma_f32_32x32x16_bf16 v[32:47], v[120:123], a[124:127], v[32:47]
    ds_read_b64_tr_b16 v[96:97], v215 offset:8192
    ds_read_b64_tr_b16 v[98:99], v215 offset:8704
    s_add_u32 s33, s33, 4096
    buffer_load_dwordx4 a[240:243], v212, s[12:15], s33 offen offset:0 sc1
    s_add_u32 s32, s32, 0x20000
    s_add_u32 m0, s37, 0xe000
    s_nop 0
    buffer_load_dwordx4 v208, s[8:11], s32 offen offset:0 lds
    v_mfma_f32_32x32x16_bf16 v[48:63], v[124:127], a[124:127], v[48:63]
    ds_read_b64_tr_b16 v[100:101], v216 offset:8192
    ds_read_b64_tr_b16 v[102:103], v216 offset:8704
    s_waitcnt lgkmcnt(15)
    v_mfma_f32_32x32x16_bf16 v[32:47], v[64:67], a[128:131], v[32:47]
    ds_read_b64_tr_b16 v[104:105], v215 offset:10240
    ds_read_b64_tr_b16 v[106:107], v215 offset:10752
    buffer_load_dwordx4 a[244:247], v212, s[12:15], s33 offen offset:1024 sc1
    buffer_load_dwordx4 v209, s[8:11], s32 offen offset:1024 lds
    v_mfma_f32_32x32x16_bf16 v[48:63], v[68:71], a[128:131], v[48:63]
    ds_read_b64_tr_b16 v[108:109], v216 offset:10240
    ds_read_b64_tr_b16 v[110:111], v216 offset:10752
    s_waitcnt lgkmcnt(15)
    v_mfma_f32_32x32x16_bf16 v[32:47], v[72:75], a[132:135], v[32:47]
    ds_read_b64_tr_b16 v[112:113], v215 offset:12288
    ds_read_b64_tr_b16 v[114:115], v215 offset:12800
    buffer_load_dwordx4 a[248:251], v212, s[12:15], s33 offen offset:2048 sc1
    v_mfma_f32_32x32x16_bf16 v[48:63], v[76:79], a[132:135], v[48:63]
    ds_read_b64_tr_b16 v[116:117], v216 offset:12288
    ds_read_b64_tr_b16 v[118:119], v216 offset:12800
    s_waitcnt lgkmcnt(15)
    v_mfma_f32_32x32x16_bf16 v[32:47], v[80:83], a[136:139], v[32:47]
    ds_read_b64_tr_b16 v[120:121], v215 offset:14336
    ds_read_b64_tr_b16 v[122:123], v215 offset:14848
    buffer_load_dwordx4 a[252:255], v212, s[12:15], s33 offen offset:3072 sc1
    v_mfma_f32_32x32x16_bf16 v[48:63], v[84:87], a[136:139], v[48:63]
    ds_read_b64_tr_b16 v[124:125], v216 offset:14336
    ds_read_b64_tr_b16 v[126:127], v216 offset:14848
    s_waitcnt vmcnt(32)
    s_waitcnt lgkmcnt(15)
    s_barrier
    v_mfma_f32_32x32x16_bf16 v[32:47], v[88:91], a[140:143], v[32:47]
    ds_read_b64_tr_b16 v[64:65], v215 offset:16384
    ds_read_b64_tr_b16 v[66:67], v215 offset:16896
    v_mfma_f32_32x32x16_bf16 v[48:63], v[92:95], a[140:143], v[48:63]
    ds_read_b64_tr_b16 v[68:69], v216 offset:16384
    ds_read_b64_tr_b16 v[70:71], v216 offset:16896
    s_waitcnt lgkmcnt(15)
    v_mfma_f32_32x32x16_bf16 v[32:47], v[96:99], a[144:147], v[32:47]
    ds_read_b64_tr_b16 v[72:73], v215 offset:18432
    ds_read_b64_tr_b16 v[74:75], v215 offset:18944
    v_mfma_f32_32x32x16_bf16 v[48:63], v[100:103], a[144:147], v[48:63]
    ds_read_b64_tr_b16 v[76:77], v216 offset:18432
    ds_read_b64_tr_b16 v[78:79], v216 offset:18944
    s_waitcnt lgkmcnt(15)
    v_mfma_f32_32x32x16_bf16 v[32:47], v[104:107], a[148:151], v[32:47]
    ds_read_b64_tr_b16 v[80:81], v215 offset:20480
    ds_read_b64_tr_b16 v[82:83], v215 offset:20992
    v_mfma_f32_32x32x16_bf16 v[48:63], v[108:111], a[148:151], v[48:63]
    ds_read_b64_tr_b16 v[84:85], v216 offset:20480
    ds_read_b64_tr_b16 v[86:87], v216 offset:20992
    s_waitcnt lgkmcnt(15)
    v_mfma_f32_32x32x16_bf16 v[32:47], v[112:115], a[152:155], v[32:47]
    ds_read_b64_tr_b16 v[88:89], v215 offset:22528
    ds_read_b64_tr_b16 v[90:91], v215 offset:23040
    v_mfma_f32_32x32x16_bf16 v[48:63], v[116:119], a[152:155], v[48:63]
    ds_read_b64_tr_b16 v[92:93], v216 offset:22528
    ds_read_b64_tr_b16 v[94:95], v216 offset:23040
    s_waitcnt vmcnt(26)
    s_waitcnt lgkmcnt(15)
    s_barrier
    v_mfma_f32_32x32x16_bf16 v[32:47], v[120:123], a[156:159], v[32:47]
    ds_read_b64_tr_b16 v[96:97], v215 offset:24576
    ds_read_b64_tr_b16 v[98:99], v215 offset:25088
    v_mfma_f32_32x32x16_bf16 v[48:63], v[124:127], a[156:159], v[48:63]
    ds_read_b64_tr_b16 v[100:101], v216 offset:24576
    ds_read_b64_tr_b16 v[102:103], v216 offset:25088
    s_waitcnt lgkmcnt(15)
    v_mfma_f32_32x32x16_bf16 v[32:47], v[64:67], a[160:163], v[32:47]
    ds_read_b64_tr_b16 v[104:105], v215 offset:26624
    ds_read_b64_tr_b16 v[106:107], v215 offset:27136
    v_mfma_f32_32x32x16_bf16 v[48:63], v[68:71], a[160:163], v[48:63]
    ds_read_b64_tr_b16 v[108:109], v216 offset:26624
    ds_read_b64_tr_b16 v[110:111], v216 offset:27136
    s_waitcnt lgkmcnt(15)
    v_mfma_f32_32x32x16_bf16 v[32:47], v[72:75], a[164:167], v[32:47]
    ds_read_b64_tr_b16 v[112:113], v215 offset:28672
    ds_read_b64_tr_b16 v[114:115], v215 offset:29184
    v_mfma_f32_32x32x16_bf16 v[48:63], v[76:79], a[164:167], v[48:63]
    ds_read_b64_tr_b16 v[116:117], v216 offset:28672
    ds_read_b64_tr_b16 v[118:119], v216 offset:29184
    s_waitcnt lgkmcnt(15)
    v_mfma_f32_32x32x16_bf16 v[32:47], v[80:83], a[168:171], v[32:47]
    ds_read_b64_tr_b16 v[120:121], v215 offset:30720
    ds_read_b64_tr_b16 v[122:123], v215 offset:31232
    v_mfma_f32_32x32x16_bf16 v[48:63], v[84:87], a[168:171], v[48:63]
    ds_read_b64_tr_b16 v[124:125], v216 offset:30720
    ds_read_b64_tr_b16 v[126:127], v216 offset:31232
    s_waitcnt vmcnt(20)
    s_waitcnt lgkmcnt(15)
    s_barrier
    v_mfma_f32_32x32x16_bf16 v[32:47], v[88:91], a[172:175], v[32:47]
    ds_read_b64_tr_b16 v[64:65], v215 offset:32768
    ds_read_b64_tr_b16 v[66:67], v215 offset:33280
    s_add_u32 s35, s35, 0x20000
    s_lshl_b32 s3, s39, 22
    s_sub_u32 s35, s35, s3
    s_add_u32 m0, s37, 0x10000
    s_nop 0
    buffer_load_dwordx4 v208, s[8:11], s35 offen offset:0 lds
    v_mfma_f32_32x32x16_bf16 v[48:63], v[92:95], a[172:175], v[48:63]
    ds_read_b64_tr_b16 v[68:69], v216 offset:32768
    ds_read_b64_tr_b16 v[70:71], v216 offset:33280
    s_waitcnt lgkmcnt(15)
    v_mfma_f32_32x32x16_bf16 v[32:47], v[96:99], a[176:179], v[32:47]
    ds_read_b64_tr_b16 v[72:73], v215 offset:34816
    ds_read_b64_tr_b16 v[74:75], v215 offset:35328
    buffer_load_dwordx4 v209, s[8:11], s35 offen offset:1024 lds
    v_mfma_f32_32x32x16_bf16 v[48:63], v[100:103], a[176:179], v[48:63]
    ds_read_b64_tr_b16 v[76:77], v216 offset:34816
    ds_read_b64_tr_b16 v[78:79], v216 offset:35328
    s_waitcnt lgkmcnt(15)
    v_mfma_f32_32x32x16_bf16 v[32:47], v[104:107], a[180:183], v[32:47]
    ds_read_b64_tr_b16 v[80:81], v215 offset:36864
    ds_read_b64_tr_b16 v[82:83], v215 offset:37376
    s_add_u32 s35, s35, 0x20000
    s_add_u32 m0, s37, 0x12000
    s_nop 0
    buffer_load_dwordx4 v208, s[8:11], s35 offen offset:0 lds
    v_mfma_f32_32x32x16_bf16 v[48:63], v[108:111], a[180:183], v[48:63]
    ds_read_b64_tr_b16 v[84:85], v216 offset:36864
    ds_read_b64_tr_b16 v[86:87], v216 offset:37376
    s_waitcnt lgkmcnt(15)
    v_mfma_f32_32x32x16_bf16 v[32:47], v[112:115], a[184:187], v[32:47]
    ds_read_b64_tr_b16 v[88:89], v215 offset:38912
    ds_read_b64_tr_b16 v[90:91], v215 offset:39424
    buffer_load_dwordx4 v209, s[8:11], s35 offen offset:1024 lds
    v_mfma_f32_32x32x16_bf16 v[48:63], v[116:119], a[184:187], v[48:63]
    ds_read_b64_tr_b16 v[92:93], v216 offset:38912
    ds_read_b64_tr_b16 v[94:95], v216 offset:39424
    s_waitcnt vmcnt(18)
    s_waitcnt lgkmcnt(15)
    s_barrier
    v_mfma_f32_32x32x16_bf16 v[32:47], v[120:123], a[188:191], v[32:47]
    ds_read_b64_tr_b16 v[96:97], v215 offset:40960
    ds_read_b64_tr_b16 v[98:99], v215 offset:41472
    s_add_u32 s35, s35, 0x20000
    s_add_u32 m0, s37, 0x14000
    s_nop 0
    buffer_load_dwordx4 v208, s[8:11], s35 offen offset:0 lds
    v_mfma_f32_32x32x16_bf16 v[48:63], v[124:127], a[188:191], v[48:63]
    ds_read_b64_tr_b16 v[100:101], v216 offset:40960
    ds_read_b64_tr_b16 v[102:103], v216 offset:41472
    s_waitcnt lgkmcnt(15)
    v_mfma_f32_32x32x16_bf16 v[32:47], v[64:67], a[192:195], v[32:47]
    ds_read_b64_tr_b16 v[104:105], v215 offset:43008
    ds_read_b64_tr_b16 v[106:107], v215 offset:43520
    buffer_load_dwordx4 v209, s[8:11], s35 offen offset:1024 lds
    v_mfma_f32_32x32x16_bf16 v[48:63], v[68:71], a[192:195], v[48:63]
    ds_read_b64_tr_b16 v[108:109], v216 offset:43008
    ds_read_b64_tr_b16 v[110:111], v216 offset:43520
    s_waitcnt lgkmcnt(15)
    v_mfma_f32_32x32x16_bf16 v[32:47], v[72:75], a[196:199], v[32:47]
    ds_read_b64_tr_b16 v[112:113], v215 offset:45056
    ds_read_b64_tr_b16 v[114:115], v215 offset:45568
    s_add_u32 s35, s35, 0x20000
    s_add_u32 m0, s37, 0x16000
    s_nop 0
    buffer_load_dwordx4 v208, s[8:11], s35 offen offset:0 lds
    v_mfma_f32_32x32x16_bf16 v[48:63], v[76:79], a[196:199], v[48:63]
    ds_read_b64_tr_b16 v[116:117], v216 offset:45056
    ds_read_b64_tr_b16 v[118:119], v216 offset:45568
    s_waitcnt lgkmcnt(15)
    v_mfma_f32_32x32x16_bf16 v[32:47], v[80:83], a[200:203], v[32:47]
    ds_read_b64_tr_b16 v[120:121], v215 offset:47104
    ds_read_b64_tr_b16 v[122:123], v215 offset:47616
    buffer_load_dwordx4 v209, s[8:11], s35 offen offset:1024 lds
    v_mfma_f32_32x32x16_bf16 v[48:63], v[84:87], a[200:203], v[48:63]
    ds_read_b64_tr_b16 v[124:125], v216 offset:47104
    ds_read_b64_tr_b16 v[126:127], v216 offset:47616
    s_waitcnt vmcnt(16)
    s_waitcnt lgkmcnt(15)
    s_barrier
    v_mfma_f32_32x32x16_bf16 v[32:47], v[88:91], a[204:207], v[32:47]
    ds_read_b64_tr_b16 v[64:65], v215 offset:49152
    ds_read_b64_tr_b16 v[66:67], v215 offset:49664
    s_add_u32 s35, s35, 0x20000
    s_add_u32 m0, s37, 0x18000
    s_nop 0
    buffer_load_dwordx4 v208, s[8:11], s35 offen offset:0 lds
    v_mfma_f32_32x32x16_bf16 v[48:63], v[92:95], a[204:207], v[48:63]
    ds_read_b64_tr_b16 v[68:69], v216 offset:49152
    ds_read_b64_tr_b16 v[70:71], v216 offset:49664
    s_waitcnt lgkmcnt(15)
    v_mfma_f32_32x32x16_bf16 v[32:47], v[96:99], a[208:211], v[32:47]
    ds_read_b64_tr_b16 v[72:73], v215 offset:51200
    ds_read_b64_tr_b16 v[74:75], v215 offset:51712
    buffer_load_dwordx4 v209, s[8:11], s35 offen offset:1024 lds
    v_mfma_f32_32x32x16_bf16 v[48:63], v[100:103], a[208:211], v[48:63]
    ds_read_b64_tr_b16 v[76:77], v216 offset:51200
    ds_read_b64_tr_b16 v[78:79], v216 offset:51712
    s_waitcnt lgkmcnt(15)
    v_mfma_f32_32x32x16_bf16 v[32:47], v[104:107], a[212:215], v[32:47]
    ds_read_b64_tr_b16 v[80:81], v215 offset:53248
    ds_read_b64_tr_b16 v[82:83], v215 offset:53760
    s_add_u32 s35, s35, 0x20000
    s_add_u32 m0, s37, 0x1a000
    s_nop 0
    buffer_load_dwordx4 v208, s[8:11], s35 offen offset:0 lds
    v_mfma_f32_32x32x16_bf16 v[48:63], v[108:111], a[212:215], v[48:63]
    ds_read_b64_tr_b16 v[84:85], v216 offset:53248
    ds_read_b64_tr_b16 v[86:87], v216 offset:53760
    s_waitcnt lgkmcnt(15)
    v_mfma_f32_32x32x16_bf16 v[32:47], v[112:115], a[216:219], v[32:47]
    ds_read_b64_tr_b16 v[88:89], v215 offset:55296
    ds_read_b64_tr_b16 v[90:91], v215 offset:55808
    buffer_load_dwordx4 v209, s[8:11], s35 offen offset:1024 lds
    v_mfma_f32_32x32x16_bf16 v[48:63], v[116:119], a[216:219], v[48:63]
    ds_read_b64_tr_b16 v[92:93], v216 offset:55296
    ds_read_b64_tr_b16 v[94:95], v216 offset:55808
    s_waitcnt vmcnt(14)
    s_waitcnt lgkmcnt(15)
    s_barrier
    v_mfma_f32_32x32x16_bf16 v[32:47], v[120:123], a[220:223], v[32:47]
    ds_read_b64_tr_b16 v[96:97], v215 offset:57344
    ds_read_b64_tr_b16 v[98:99], v215 offset:57856
    s_add_u32 s35, s35, 0x20000
    s_add_u32 m0, s37, 0x1c000
    s_nop 0
    buffer_load_dwordx4 v208, s[8:11], s35 offen offset:0 lds
    v_mfma_f32_32x32x16_bf16 v[48:63], v[124:127], a[220:223], v[48:63]
    ds_read_b64_tr_b16 v[100:101], v216 offset:57344
    ds_read_b64_tr_b16 v[102:103], v216 offset:57856
    s_waitcnt lgkmcnt(15)
    v_mfma_f32_32x32x16_bf16 v[32:47], v[64:67], a[224:227], v[32:47]
    ds_read_b64_tr_b16 v[104:105], v215 offset:59392
    ds_read_b64_tr_b16 v[106:107], v215 offset:59904
    buffer_load_dwordx4 v209, s[8:11], s35 offen offset:1024 lds
    v_mfma_f32_32x32x16_bf16 v[48:63], v[68:71], a[224:227], v[48:63]
    ds_read_b64_tr_b16 v[108:109], v216 offset:59392
    ds_read_b64_tr_b16 v[110:111], v216 offset:59904
    s_waitcnt lgkmcnt(15)
    v_mfma_f32_32x32x16_bf16 v[32:47], v[72:75], a[228:231], v[32:47]
    ds_read_b64_tr_b16 v[112:113], v215 offset:61440
    ds_read_b64_tr_b16 v[114:115], v215 offset:61952
    s_add_u32 s35, s35, 0x20000
    s_add_u32 m0, s37, 0x1e000
    s_nop 0
    buffer_load_dwordx4 v208, s[8:11], s35 offen offset:0 lds
    v_mfma_f32_32x32x16_bf16 v[48:63], v[76:79], a[228:231], v[48:63]
    ds_read_b64_tr_b16 v[116:117], v216 offset:61440
    ds_read_b64_tr_b16 v[118:119], v216 offset:61952
    s_waitcnt lgkmcnt(15)
    v_mfma_f32_32x32x16_bf16 v[32:47], v[80:83], a[232:235], v[32:47]
    ds_read_b64_tr_b16 v[120:121], v215 offset:63488
    ds_read_b64_tr_b16 v[122:123], v215 offset:64000
    buffer_load_dwordx4 v209, s[8:11], s35 offen offset:1024 lds
    v_mfma_f32_32x32x16_bf16 v[48:63], v[84:87], a[232:235], v[48:63]
    ds_read_b64_tr_b16 v[124:125], v216 offset:63488
    ds_read_b64_tr_b16 v[126:127], v216 offset:64000
    s_waitcnt vmcnt(8)
    s_waitcnt lgkmcnt(15)
    s_barrier
    v_mfma_f32_32x32x16_bf16 v[32:47], v[88:91], a[236:239], v[32:47]
    ds_read_b64_tr_b16 v[64:65], v213 offset:0
    ds_read_b64_tr_b16 v[66:67], v213 offset:512
    v_mfma_f32_32x32x16_bf16 v[48:63], v[92:95], a[236:239], v[48:63]
    ds_read_b64_tr_b16 v[68:69], v214 offset:0
    ds_read_b64_tr_b16 v[70:71], v214 offset:512
    s_waitcnt lgkmcnt(15)
    v_mfma_f32_32x32x16_bf16 v[32:47], v[96:99], a[240:243], v[32:47]
    ds_read_b64_tr_b16 v[72:73], v213 offset:2048
    ds_read_b64_tr_b16 v[74:75], v213 offset:2560
    v_mfma_f32_32x32x16_bf16 v[48:63], v[100:103], a[240:243], v[48:63]
    ds_read_b64_tr_b16 v[76:77], v214 offset:2048
    ds_read_b64_tr_b16 v[78:79], v214 offset:2560
    s_waitcnt lgkmcnt(15)
    v_mfma_f32_32x32x16_bf16 v[32:47], v[104:107], a[244:247], v[32:47]
    ds_read_b64_tr_b16 v[80:81], v213 offset:4096
    ds_read_b64_tr_b16 v[82:83], v213 offset:4608
    v_mfma_f32_32x32x16_bf16 v[48:63], v[108:111], a[244:247], v[48:63]
    ds_read_b64_tr_b16 v[84:85], v214 offset:4096
    ds_read_b64_tr_b16 v[86:87], v214 offset:4608
    s_waitcnt lgkmcnt(15)
    v_mfma_f32_32x32x16_bf16 v[32:47], v[112:115], a[248:251], v[32:47]
    ds_read_b64_tr_b16 v[88:89], v213 offset:6144
    ds_read_b64_tr_b16 v[90:91], v213 offset:6656
    v_mfma_f32_32x32x16_bf16 v[48:63], v[116:119], a[248:251], v[48:63]
    ds_read_b64_tr_b16 v[92:93], v214 offset:6144
    ds_read_b64_tr_b16 v[94:95], v214 offset:6656
    s_waitcnt lgkmcnt(15)
    v_mfma_f32_32x32x16_bf16 v[32:47], v[120:123], a[252:255], v[32:47]
    ds_read_b64_tr_b16 v[96:97], v213 offset:8192
    ds_read_b64_tr_b16 v[98:99], v213 offset:8704
    v_mfma_f32_32x32x16_bf16 v[48:63], v[124:127], a[252:255], v[48:63]
    ds_read_b64_tr_b16 v[100:101], v214 offset:8192
    ds_read_b64_tr_b16 v[102:103], v214 offset:8704
    s_waitcnt lgkmcnt(15)
    v_mfma_f32_32x32x16_bf16 v[0:15], v[64:67], a[0:3], v[0:15]
    ds_read_b64_tr_b16 v[104:105], v213 offset:10240
    ds_read_b64_tr_b16 v[106:107], v213 offset:10752
    v_mfma_f32_32x32x16_bf16 v[16:31], v[68:71], a[0:3], v[16:31]
    ds_read_b64_tr_b16 v[108:109], v214 offset:10240
    ds_read_b64_tr_b16 v[110:111], v214 offset:10752
    s_waitcnt lgkmcnt(15)
    v_mfma_f32_32x32x16_bf16 v[0:15], v[72:75], a[4:7], v[0:15]
    ds_read_b64_tr_b16 v[112:113], v213 offset:12288
    ds_read_b64_tr_b16 v[114:115], v213 offset:12800
    v_mfma_f32_32x32x16_bf16 v[16:31], v[76:79], a[4:7], v[16:31]
    ds_read_b64_tr_b16 v[116:117], v214 offset:12288
    ds_read_b64_tr_b16 v[118:119], v214 offset:12800
    s_lshl_b32 s3, s61, 13
    s_add_u32 s31, s3, 4096
    v_cvt_pk_bf16_f32 v32, v32, v33
    v_cvt_pk_bf16_f32 v33, v34, v35
    v_cvt_pk_bf16_f32 v34, v36, v37
    v_cvt_pk_bf16_f32 v35, v38, v39
    v_cvt_pk_bf16_f32 v36, v40, v41
    v_cvt_pk_bf16_f32 v37, v42, v43
    v_cvt_pk_bf16_f32 v38, v44, v45
    v_cvt_pk_bf16_f32 v39, v46, v47
    v_cvt_pk_bf16_f32 v40, v48, v49
    v_cvt_pk_bf16_f32 v41, v50, v51
    v_cvt_pk_bf16_f32 v42, v52, v53
    v_cvt_pk_bf16_f32 v43, v54, v55
    v_cvt_pk_bf16_f32 v44, v56, v57
    v_cvt_pk_bf16_f32 v45, v58, v59
    v_cvt_pk_bf16_f32 v46, v60, v61
    v_cvt_pk_bf16_f32 v47, v62, v63
    buffer_store_dwordx4 v[32:35], v212, s[52:55], s3 offen offset:0 sc1
    buffer_store_dwordx4 v[36:39], v212, s[52:55], s3 offen offset:1024 sc1
    buffer_store_dwordx4 v[40:43], v212, s[52:55], s3 offen offset:2048 sc1
    buffer_store_dwordx4 v[44:47], v212, s[52:55], s3 offen offset:3072 sc1
    s_lshl_b32 s3, s61, 2
    v_mov_b32 v244, s3
    v_mov_b32 v245, 1
    s_lshl_b32 s3, s62, 2
    v_mov_b32 v246, s3
    s_waitcnt lgkmcnt(15)
    v_mfma_f32_32x32x16_bf16 v[0:15], v[80:83], a[8:11], v[0:15]
    ds_read_b64_tr_b16 v[120:121], v213 offset:14336
    ds_read_b64_tr_b16 v[122:123], v213 offset:14848
    v_mfma_f32_32x32x16_bf16 v[16:31], v[84:87], a[8:11], v[16:31]
    ds_read_b64_tr_b16 v[124:125], v214 offset:14336
    ds_read_b64_tr_b16 v[126:127], v214 offset:14848
    s_waitcnt lgkmcnt(15)
    v_mfma_f32_32x32x16_bf16 v[0:15], v[88:91], a[12:15], v[0:15]
    ds_read_b64_tr_b16 v[64:65], v213 offset:16384
    ds_read_b64_tr_b16 v[66:67], v213 offset:16896
    s_add_u32 s35, s35, 0x20000
    s_add_u32 m0, s37, 0x0
    s_nop 0
    buffer_load_dwordx4 v208, s[8:11], s35 offen offset:0 lds
    v_mfma_f32_32x32x16_bf16 v[16:31], v[92:95], a[12:15], v[16:31]
    ds_read_b64_tr_b16 v[68:69], v214 offset:16384
    ds_read_b64_tr_b16 v[70:71], v214 offset:16896
    s_waitcnt lgkmcnt(15)
    v_mfma_f32_32x32x16_bf16 v[0:15], v[96:99], a[16:19], v[0:15]
    ds_read_b64_tr_b16 v[72:73], v213 offset:18432
    ds_read_b64_tr_b16 v[74:75], v213 offset:18944
    buffer_load_dwordx4 v209, s[8:11], s35 offen offset:1024 lds
    v_mfma_f32_32x32x16_bf16 v[16:31], v[100:103], a[16:19], v[16:31]
    ds_read_b64_tr_b16 v[76:77], v214 offset:18432
    ds_read_b64_tr_b16 v[78:79], v214 offset:18944
    s_waitcnt lgkmcnt(15)
    v_mfma_f32_32x32x16_bf16 v[0:15], v[104:107], a[20:23], v[0:15]
    ds_read_b64_tr_b16 v[80:81], v213 offset:20480
    ds_read_b64_tr_b16 v[82:83], v213 offset:20992
    s_add_u32 s35, s35, 0x20000
    s_add_u32 m0, s37, 0x2000
    s_nop 0
    buffer_load_dwordx4 v208, s[8:11], s35 offen offset:0 lds
    v_mfma_f32_32x32x16_bf16 v[16:31], v[108:111], a[20:23], v[16:31]
    ds_read_b64_tr_b16 v[84:85], v214 offset:20480
    ds_read_b64_tr_b16 v[86:87], v214 offset:20992
    s_waitcnt lgkmcnt(15)
    v_mfma_f32_32x32x16_bf16 v[0:15], v[112:115], a[24:27], v[0:15]
    ds_read_b64_tr_b16 v[88:89], v213 offset:22528
    ds_read_b64_tr_b16 v[90:91], v213 offset:23040
    buffer_load_dwordx4 v209, s[8:11], s35 offen offset:1024 lds
    v_mfma_f32_32x32x16_bf16 v[16:31], v[116:119], a[24:27], v[16:31]
    ds_read_b64_tr_b16 v[92:93], v214 offset:22528
    ds_read_b64_tr_b16 v[94:95], v214 offset:23040
    s_waitcnt lgkmcnt(15)
    v_mfma_f32_32x32x16_bf16 v[0:15], v[120:123], a[28:31], v[0:15]
    ds_read_b64_tr_b16 v[96:97], v213 offset:24576
    ds_read_b64_tr_b16 v[98:99], v213 offset:25088
    s_add_u32 s35, s35, 0x20000
    s_add_u32 m0, s37, 0x4000
    s_nop 0
    buffer_load_dwordx4 v208, s[8:11], s35 offen offset:0 lds
    v_mfma_f32_32x32x16_bf16 v[16:31], v[124:127], a[28:31], v[16:31]
    ds_read_b64_tr_b16 v[100:101], v214 offset:24576
    ds_read_b64_tr_b16 v[102:103], v214 offset:25088
    s_waitcnt lgkmcnt(15)
    v_mfma_f32_32x32x16_bf16 v[0:15], v[64:67], a[32:35], v[0:15]
    ds_read_b64_tr_b16 v[104:105], v213 offset:26624
    ds_read_b64_tr_b16 v[106:107], v213 offset:27136
    buffer_load_dwordx4 v209, s[8:11], s35 offen offset:1024 lds
    v_mfma_f32_32x32x16_bf16 v[16:31], v[68:71], a[32:35], v[16:31]
    ds_read_b64_tr_b16 v[108:109], v214 offset:26624
    ds_read_b64_tr_b16 v[110:111], v214 offset:27136
    s_waitcnt lgkmcnt(15)
    v_mfma_f32_32x32x16_bf16 v[0:15], v[72:75], a[36:39], v[0:15]
    ds_read_b64_tr_b16 v[112:113], v213 offset:28672
    ds_read_b64_tr_b16 v[114:115], v213 offset:29184
    s_add_u32 s35, s35, 0x20000
    s_add_u32 m0, s37, 0x6000
    s_nop 0
    buffer_load_dwordx4 v208, s[8:11], s35 offen offset:0 lds
    v_mfma_f32_32x32x16_bf16 v[16:31], v[76:79], a[36:39], v[16:31]
    ds_read_b64_tr_b16 v[116:117], v214 offset:28672
    ds_read_b64_tr_b16 v[118:119], v214 offset:29184
    s_waitcnt lgkmcnt(15)
    v_mfma_f32_32x32x16_bf16 v[0:15], v[80:83], a[40:43], v[0:15]
    ds_read_b64_tr_b16 v[120:121], v213 offset:30720
    ds_read_b64_tr_b16 v[122:123], v213 offset:31232
    buffer_load_dwordx4 v209, s[8:11], s35 offen offset:1024 lds
    v_mfma_f32_32x32x16_bf16 v[16:31], v[84:87], a[40:43], v[16:31]
    ds_read_b64_tr_b16 v[124:125], v214 offset:30720
    ds_read_b64_tr_b16 v[126:127], v214 offset:31232
    s_waitcnt vmcnt(12)
    s_waitcnt lgkmcnt(15)
    s_barrier
    v_mfma_f32_32x32x16_bf16 v[0:15], v[88:91], a[44:47], v[0:15]
    ds_read_b64_tr_b16 v[64:65], v213 offset:32768
    ds_read_b64_tr_b16 v[66:67], v213 offset:33280
    s_add_u32 s35, s35, 0x20000
    s_add_u32 m0, s37, 0x8000
    s_nop 0
    buffer_load_dwordx4 v208, s[8:11], s35 offen offset:0 lds
    v_mfma_f32_32x32x16_bf16 v[16:31], v[92:95], a[44:47], v[16:31]
    ds_read_b64_tr_b16 v[68:69], v214 offset:32768
    ds_read_b64_tr_b16 v[70:71], v214 offset:33280
    s_waitcnt lgkmcnt(15)
    v_mfma_f32_32x32x16_bf16 v[0:15], v[96:99], a[48:51], v[0:15]
    ds_read_b64_tr_b16 v[72:73], v213 offset:34816
    ds_read_b64_tr_b16 v[74:75], v213 offset:35328
    buffer_load_dwordx4 v209, s[8:11], s35 offen offset:1024 lds
    v_mfma_f32_32x32x16_bf16 v[16:31], v[100:103], a[48:51], v[16:31]
    ds_read_b64_tr_b16 v[76:77], v214 offset:34816
    ds_read_b64_tr_b16 v[78:79], v214 offset:35328
    s_waitcnt lgkmcnt(15)
    v_mfma_f32_32x32x16_bf16 v[0:15], v[104:107], a[52:55], v[0:15]
    ds_read_b64_tr_b16 v[80:81], v213 offset:36864
    ds_read_b64_tr_b16 v[82:83], v213 offset:37376
    s_add_u32 s35, s35, 0x20000
    s_add_u32 m0, s37, 0xa000
    s_nop 0
    buffer_load_dwordx4 v208, s[8:11], s35 offen offset:0 lds
    v_mfma_f32_32x32x16_bf16 v[16:31], v[108:111], a[52:55], v[16:31]
    ds_read_b64_tr_b16 v[84:85], v214 offset:36864
    ds_read_b64_tr_b16 v[86:87], v214 offset:37376
    s_waitcnt lgkmcnt(15)
    v_mfma_f32_32x32x16_bf16 v[0:15], v[112:115], a[56:59], v[0:15]
    ds_read_b64_tr_b16 v[88:89], v213 offset:38912
    ds_read_b64_tr_b16 v[90:91], v213 offset:39424
    buffer_load_dwordx4 v209, s[8:11], s35 offen offset:1024 lds
    v_mfma_f32_32x32x16_bf16 v[16:31], v[116:119], a[56:59], v[16:31]
    ds_read_b64_tr_b16 v[92:93], v214 offset:38912
    ds_read_b64_tr_b16 v[94:95], v214 offset:39424
    s_waitcnt lgkmcnt(15)
    v_mfma_f32_32x32x16_bf16 v[0:15], v[120:123], a[60:63], v[0:15]
    ds_read_b64_tr_b16 v[96:97], v213 offset:40960
    ds_read_b64_tr_b16 v[98:99], v213 offset:41472
    s_add_u32 s35, s35, 0x20000
    s_add_u32 m0, s37, 0x20000
    s_nop 0
    buffer_load_dwordx4 v208, s[8:11], s35 offen offset:0 lds
    v_mfma_f32_32x32x16_bf16 v[16:31], v[124:127], a[60:63], v[16:31]
    ds_read_b64_tr_b16 v[100:101], v214 offset:40960
    ds_read_b64_tr_b16 v[102:103], v214 offset:41472
    s_waitcnt lgkmcnt(15)
    v_mfma_f32_32x32x16_bf16 v[0:15], v[64:67], a[64:67], v[0:15]
    ds_read_b64_tr_b16 v[104:105], v213 offset:43008
    ds_read_b64_tr_b16 v[106:107], v213 offset:43520
    buffer_load_dwordx4 v209, s[8:11], s35 offen offset:1024 lds
    v_mfma_f32_32x32x16_bf16 v[16:31], v[68:71], a[64:67], v[16:31]
    ds_read_b64_tr_b16 v[108:109], v214 offset:43008
    ds_read_b64_tr_b16 v[110:111], v214 offset:43520
    s_waitcnt lgkmcnt(15)
    v_mfma_f32_32x32x16_bf16 v[0:15], v[72:75], a[68:71], v[0:15]
    ds_read_b64_tr_b16 v[112:113], v213 offset:45056
    ds_read_b64_tr_b16 v[114:115], v213 offset:45568
    s_add_u32 s35, s35, 0x20000
    s_add_u32 m0, s37, 0x22000
    s_nop 0
    buffer_load_dwordx4 v208, s[8:11], s35 offen offset:0 lds
    v_mfma_f32_32x32x16_bf16 v[16:31], v[76:79], a[68:71], v[16:31]
    ds_read_b64_tr_b16 v[116:117], v214 offset:45056
    ds_read_b64_tr_b16 v[118:119], v214 offset:45568
    s_waitcnt lgkmcnt(15)
    v_mfma_f32_32x32x16_bf16 v[0:15], v[80:83], a[72:75], v[0:15]
    ds_read_b64_tr_b16 v[120:121], v213 offset:47104
    ds_read_b64_tr_b16 v[122:123], v213 offset:47616
    buffer_load_dwordx4 v209, s[8:11], s35 offen offset:1024 lds
    v_mfma_f32_32x32x16_bf16 v[16:31], v[84:87], a[72:75], v[16:31]
    ds_read_b64_tr_b16 v[124:125], v214 offset:47104
    ds_read_b64_tr_b16 v[126:127], v214 offset:47616
    s_waitcnt lgkmcnt(15)
    v_mfma_f32_32x32x16_bf16 v[0:15], v[88:91], a[76:79], v[0:15]
    ds_read_b64_tr_b16 v[64:65], v213 offset:49152
    ds_read_b64_tr_b16 v[66:67], v213 offset:49664
    v_mfma_f32_32x32x16_bf16 v[16:31], v[92:95], a[76:79], v[16:31]
    ds_read_b64_tr_b16 v[68:69], v214 offset:49152
    ds_read_b64_tr_b16 v[70:71], v214 offset:49664
    s_waitcnt lgkmcnt(15)
    v_mfma_f32_32x32x16_bf16 v[0:15], v[96:99], a[80:83], v[0:15]
    ds_read_b64_tr_b16 v[72:73], v213 offset:51200
    ds_read_b64_tr_b16 v[74:75], v213 offset:51712
    v_mfma_f32_32x32x16_bf16 v[16:31], v[100:103], a[80:83], v[16:31]
    ds_read_b64_tr_b16 v[76:77], v214 offset:51200
    ds_read_b64_tr_b16 v[78:79], v214 offset:51712
    s_waitcnt lgkmcnt(15)
    v_mfma_f32_32x32x16_bf16 v[0:15], v[104:107], a[84:87], v[0:15]
    ds_read_b64_tr_b16 v[80:81], v213 offset:53248
    ds_read_b64_tr_b16 v[82:83], v213 offset:53760
    v_mfma_f32_32x32x16_bf16 v[16:31], v[108:111], a[84:87], v[16:31]
    ds_read_b64_tr_b16 v[84:85], v214 offset:53248
    ds_read_b64_tr_b16 v[86:87], v214 offset:53760
    s_waitcnt lgkmcnt(15)
    v_mfma_f32_32x32x16_bf16 v[0:15], v[112:115], a[88:91], v[0:15]
    ds_read_b64_tr_b16 v[88:89], v213 offset:55296
    ds_read_b64_tr_b16 v[90:91], v213 offset:55808
    v_mfma_f32_32x32x16_bf16 v[16:31], v[116:119], a[88:91], v[16:31]
    ds_read_b64_tr_b16 v[92:93], v214 offset:55296
    ds_read_b64_tr_b16 v[94:95], v214 offset:55808
    s_waitcnt lgkmcnt(15)
    v_mfma_f32_32x32x16_bf16 v[0:15], v[120:123], a[92:95], v[0:15]
    ds_read_b64_tr_b16 v[96:97], v213 offset:57344
    ds_read_b64_tr_b16 v[98:99], v213 offset:57856
    v_mfma_f32_32x32x16_bf16 v[16:31], v[124:127], a[92:95], v[16:31]
    ds_read_b64_tr_b16 v[100:101], v214 offset:57344
    ds_read_b64_tr_b16 v[102:103], v214 offset:57856
    s_waitcnt lgkmcnt(15)
    v_mfma_f32_32x32x16_bf16 v[0:15], v[64:67], a[96:99], v[0:15]
    ds_read_b64_tr_b16 v[104:105], v213 offset:59392
    ds_read_b64_tr_b16 v[106:107], v213 offset:59904
    v_mfma_f32_32x32x16_bf16 v[16:31], v[68:71], a[96:99], v[16:31]
    ds_read_b64_tr_b16 v[108:109], v214 offset:59392
    ds_read_b64_tr_b16 v[110:111], v214 offset:59904
    s_waitcnt vmcnt(16)
    s_mov_b64 exec, 1
    buffer_store_dword v245, v244, s[56:59], 0 offen sc1
    s_mov_b64 exec, -1
    s_waitcnt lgkmcnt(15)
    v_mfma_f32_32x32x16_bf16 v[0:15], v[72:75], a[100:103], v[0:15]
    ds_read_b64_tr_b16 v[112:113], v213 offset:61440
    ds_read_b64_tr_b16 v[114:115], v213 offset:61952
    v_mfma_f32_32x32x16_bf16 v[16:31], v[76:79], a[100:103], v[16:31]
    ds_read_b64_tr_b16 v[116:117], v214 offset:61440
    ds_read_b64_tr_b16 v[118:119], v214 offset:61952
    s_waitcnt lgkmcnt(15)
    v_mfma_f32_32x32x16_bf16 v[0:15], v[80:83], a[104:107], v[0:15]
    ds_read_b64_tr_b16 v[120:121], v213 offset:63488
    ds_read_b64_tr_b16 v[122:123], v213 offset:64000
    v_mfma_f32_32x32x16_bf16 v[16:31], v[84:87], a[104:107], v[16:31]
    ds_read_b64_tr_b16 v[124:125], v214 offset:63488
    ds_read_b64_tr_b16 v[126:127], v214 offset:64000
    s_waitcnt vmcnt(9)
    s_waitcnt lgkmcnt(15)
    s_barrier
    v_mfma_f32_32x32x16_bf16 v[0:15], v[88:91], a[108:111], v[0:15]
    ds_read_b64_tr_b16 v[64:65], v215 offset:0
    ds_read_b64_tr_b16 v[66:67], v215 offset:512
    v_mfma_f32_32x32x16_bf16 v[16:31], v[92:95], a[108:111], v[16:31]
    ds_read_b64_tr_b16 v[68:69], v216 offset:0
    ds_read_b64_tr_b16 v[70:71], v216 offset:512
    s_waitcnt lgkmcnt(15)
    v_mfma_f32_32x32x16_bf16 v[0:15], v[96:99], a[112:115], v[0:15]
    ds_read_b64_tr_b16 v[72:73], v215 offset:2048
    ds_read_b64_tr_b16 v[74:75], v215 offset:2560
    v_mfma_f32_32x32x16_bf16 v[16:31], v[100:103], a[112:115], v[16:31]
    ds_read_b64_tr_b16 v[76:77], v216 offset:2048
    ds_read_b64_tr_b16 v[78:79], v216 offset:2560
    s_waitcnt lgkmcnt(15)
    v_mfma_f32_32x32x16_bf16 v[0:15], v[104:107], a[116:119], v[0:15]
    ds_read_b64_tr_b16 v[80:81], v215 offset:4096
    ds_read_b64_tr_b16 v[82:83], v215 offset:4608
    v_mfma_f32_32x32x16_bf16 v[16:31], v[108:111], a[116:119], v[16:31]
    ds_read_b64_tr_b16 v[84:85], v216 offset:4096
    ds_read_b64_tr_b16 v[86:87], v216 offset:4608
    s_waitcnt lgkmcnt(15)
    v_mfma_f32_32x32x16_bf16 v[0:15], v[112:115], a[120:123], v[0:15]
    ds_read_b64_tr_b16 v[88:89], v215 offset:6144
    ds_read_b64_tr_b16 v[90:91], v215 offset:6656
    v_mfma_f32_32x32x16_bf16 v[16:31], v[116:119], a[120:123], v[16:31]
    ds_read_b64_tr_b16 v[92:93], v216 offset:6144
    ds_read_b64_tr_b16 v[94:95], v216 offset:6656
    s_waitcnt lgkmcnt(15)
    v_mfma_f32_32x32x16_bf16 v[0:15], v[120:123], a[124:127], v[0:15]
    ds_read_b64_tr_b16 v[96:97], v215 offset:8192
    ds_read_b64_tr_b16 v[98:99], v215 offset:8704
    v_mfma_f32_32x32x16_bf16 v[16:31], v[124:127], a[124:127], v[16:31]
    ds_read_b64_tr_b16 v[100:101], v216 offset:8192
    ds_read_b64_tr_b16 v[102:103], v216 offset:8704
    s_waitcnt lgkmcnt(15)
    v_mfma_f32_32x32x16_bf16 v[0:15], v[64:67], a[128:131], v[0:15]
    ds_read_b64_tr_b16 v[104:105], v215 offset:10240
    ds_read_b64_tr_b16 v[106:107], v215 offset:10752
    v_mfma_f32_32x32x16_bf16 v[16:31], v[68:71], a[128:131], v[16:31]
    ds_read_b64_tr_b16 v[108:109], v216 offset:10240
    ds_read_b64_tr_b16 v[110:111], v216 offset:10752
    s_waitcnt lgkmcnt(15)
    v_mfma_f32_32x32x16_bf16 v[0:15], v[72:75], a[132:135], v[0:15]
    ds_read_b64_tr_b16 v[112:113], v215 offset:12288
    ds_read_b64_tr_b16 v[114:115], v215 offset:12800
    v_mfma_f32_32x32x16_bf16 v[16:31], v[76:79], a[132:135], v[16:31]
    ds_read_b64_tr_b16 v[116:117], v216 offset:12288
    ds_read_b64_tr_b16 v[118:119], v216 offset:12800
    s_waitcnt lgkmcnt(15)
    v_mfma_f32_32x32x16_bf16 v[0:15], v[80:83], a[136:139], v[0:15]
    ds_read_b64_tr_b16 v[120:121], v215 offset:14336
    ds_read_b64_tr_b16 v[122:123], v215 offset:14848
    v_mfma_f32_32x32x16_bf16 v[16:31], v[84:87], a[136:139], v[16:31]
    ds_read_b64_tr_b16 v[124:125], v216 offset:14336
    ds_read_b64_tr_b16 v[126:127], v216 offset:14848
    s_waitcnt lgkmcnt(15)
    v_mfma_f32_32x32x16_bf16 v[0:15], v[88:91], a[140:143], v[0:15]
    ds_read_b64_tr_b16 v[64:65], v215 offset:16384
    ds_read_b64_tr_b16 v[66:67], v215 offset:16896
    v_mfma_f32_32x32x16_bf16 v[16:31], v[92:95], a[140:143], v[16:31]
    ds_read_b64_tr_b16 v[68:69], v216 offset:16384
    ds_read_b64_tr_b16 v[70:71], v216 offset:16896
    s_waitcnt lgkmcnt(15)
    v_mfma_f32_32x32x16_bf16 v[0:15], v[96:99], a[144:147], v[0:15]
    ds_read_b64_tr_b16 v[72:73], v215 offset:18432
    ds_read_b64_tr_b16 v[74:75], v215 offset:18944
    v_mfma_f32_32x32x16_bf16 v[16:31], v[100:103], a[144:147], v[16:31]
    ds_read_b64_tr_b16 v[76:77], v216 offset:18432
    ds_read_b64_tr_b16 v[78:79], v216 offset:18944
    s_waitcnt lgkmcnt(15)
    v_mfma_f32_32x32x16_bf16 v[0:15], v[104:107], a[148:151], v[0:15]
    ds_read_b64_tr_b16 v[80:81], v215 offset:20480
    ds_read_b64_tr_b16 v[82:83], v215 offset:20992
    v_mfma_f32_32x32x16_bf16 v[16:31], v[108:111], a[148:151], v[16:31]
    ds_read_b64_tr_b16 v[84:85], v216 offset:20480
    ds_read_b64_tr_b16 v[86:87], v216 offset:20992
    s_waitcnt lgkmcnt(15)
    v_mfma_f32_32x32x16_bf16 v[0:15], v[112:115], a[152:155], v[0:15]
    ds_read_b64_tr_b16 v[88:89], v215 offset:22528
    ds_read_b64_tr_b16 v[90:91], v215 offset:23040
    v_mfma_f32_32x32x16_bf16 v[16:31], v[116:119], a[152:155], v[16:31]
    ds_read_b64_tr_b16 v[92:93], v216 offset:22528
    ds_read_b64_tr_b16 v[94:95], v216 offset:23040
    s_waitcnt lgkmcnt(15)
    v_mfma_f32_32x32x16_bf16 v[0:15], v[120:123], a[156:159], v[0:15]
    ds_read_b64_tr_b16 v[96:97], v215 offset:24576
    ds_read_b64_tr_b16 v[98:99], v215 offset:25088
    v_mfma_f32_32x32x16_bf16 v[16:31], v[124:127], a[156:159], v[16:31]
    ds_read_b64_tr_b16 v[100:101], v216 offset:24576
    ds_read_b64_tr_b16 v[102:103], v216 offset:25088
    s_waitcnt lgkmcnt(15)
    v_mfma_f32_32x32x16_bf16 v[0:15], v[64:67], a[160:163], v[0:15]
    ds_read_b64_tr_b16 v[104:105], v215 offset:26624
    ds_read_b64_tr_b16 v[106:107], v215 offset:27136
    v_mfma_f32_32x32x16_bf16 v[16:31], v[68:71], a[160:163], v[16:31]
    ds_read_b64_tr_b16 v[108:109], v216 offset:26624
    ds_read_b64_tr_b16 v[110:111], v216 offset:27136
    s_waitcnt lgkmcnt(15)
    v_mfma_f32_32x32x16_bf16 v[0:15], v[72:75], a[164:167], v[0:15]
    ds_read_b64_tr_b16 v[112:113], v215 offset:28672
    ds_read_b64_tr_b16 v[114:115], v215 offset:29184
    v_mfma_f32_32x32x16_bf16 v[16:31], v[76:79], a[164:167], v[16:31]
    ds_read_b64_tr_b16 v[116:117], v216 offset:28672
    ds_read_b64_tr_b16 v[118:119], v216 offset:29184
    s_waitcnt lgkmcnt(15)
    v_mfma_f32_32x32x16_bf16 v[0:15], v[80:83], a[168:171], v[0:15]
    ds_read_b64_tr_b16 v[120:121], v215 offset:30720
    ds_read_b64_tr_b16 v[122:123], v215 offset:31232
    v_mfma_f32_32x32x16_bf16 v[16:31], v[84:87], a[168:171], v[16:31]
    ds_read_b64_tr_b16 v[124:125], v216 offset:30720
    ds_read_b64_tr_b16 v[126:127], v216 offset:31232
    buffer_load_dword v247, v246, s[56:59], 0 offen sc1
    s_waitcnt vmcnt(2)
    s_waitcnt lgkmcnt(15)
    s_barrier
    v_mfma_f32_32x32x16_bf16 v[0:15], v[88:91], a[172:175], v[0:15]
    ds_read_b64_tr_b16 v[64:65], v215 offset:32768
    ds_read_b64_tr_b16 v[66:67], v215 offset:33280
    v_mfma_f32_32x32x16_bf16 v[16:31], v[92:95], a[172:175], v[16:31]
    ds_read_b64_tr_b16 v[68:69], v216 offset:32768
    ds_read_b64_tr_b16 v[70:71], v216 offset:33280
    s_waitcnt lgkmcnt(15)
    v_mfma_f32_32x32x16_bf16 v[0:15], v[96:99], a[176:179], v[0:15]
    ds_read_b64_tr_b16 v[72:73], v215 offset:34816
    ds_read_b64_tr_b16 v[74:75], v215 offset:35328
    v_mfma_f32_32x32x16_bf16 v[16:31], v[100:103], a[176:179], v[16:31]
    ds_read_b64_tr_b16 v[76:77], v216 offset:34816
    ds_read_b64_tr_b16 v[78:79], v216 offset:35328
    s_waitcnt lgkmcnt(15)
    v_mfma_f32_32x32x16_bf16 v[0:15], v[104:107], a[180:183], v[0:15]
    ds_read_b64_tr_b16 v[80:81], v215 offset:36864
    ds_read_b64_tr_b16 v[82:83], v215 offset:37376
    v_mfma_f32_32x32x16_bf16 v[16:31], v[108:111], a[180:183], v[16:31]
    ds_read_b64_tr_b16 v[84:85], v216 offset:36864
    ds_read_b64_tr_b16 v[86:87], v216 offset:37376
    s_waitcnt lgkmcnt(15)
    v_mfma_f32_32x32x16_bf16 v[0:15], v[112:115], a[184:187], v[0:15]
    ds_read_b64_tr_b16 v[88:89], v215 offset:38912
    ds_read_b64_tr_b16 v[90:91], v215 offset:39424
    v_mfma_f32_32x32x16_bf16 v[16:31], v[116:119], a[184:187], v[16:31]
    ds_read_b64_tr_b16 v[92:93], v216 offset:38912
    ds_read_b64_tr_b16 v[94:95], v216 offset:39424
    s_waitcnt lgkmcnt(15)
    v_mfma_f32_32x32x16_bf16 v[0:15], v[120:123], a[188:191], v[0:15]
    ds_read_b64_tr_b16 v[96:97], v215 offset:40960
    ds_read_b64_tr_b16 v[98:99], v215 offset:41472
    v_mfma_f32_32x32x16_bf16 v[16:31], v[124:127], a[188:191], v[16:31]
    ds_read_b64_tr_b16 v[100:101], v216 offset:40960
    ds_read_b64_tr_b16 v[102:103], v216 offset:41472
    s_waitcnt lgkmcnt(15)
    v_mfma_f32_32x32x16_bf16 v[0:15], v[64:67], a[192:195], v[0:15]
    ds_read_b64_tr_b16 v[104:105], v215 offset:43008
    ds_read_b64_tr_b16 v[106:107], v215 offset:43520
    v_mfma_f32_32x32x16_bf16 v[16:31], v[68:71], a[192:195], v[16:31]
    ds_read_b64_tr_b16 v[108:109], v216 offset:43008
    ds_read_b64_tr_b16 v[110:111], v216 offset:43520
    s_waitcnt lgkmcnt(15)
    v_mfma_f32_32x32x16_bf16 v[0:15], v[72:75], a[196:199], v[0:15]
    ds_read_b64_tr_b16 v[112:113], v215 offset:45056
    ds_read_b64_tr_b16 v[114:115], v215 offset:45568
    v_mfma_f32_32x32x16_bf16 v[16:31], v[76:79], a[196:199], v[16:31]
    ds_read_b64_tr_b16 v[116:117], v216 offset:45056
    ds_read_b64_tr_b16 v[118:119], v216 offset:45568
    s_waitcnt lgkmcnt(15)
    v_mfma_f32_32x32x16_bf16 v[0:15], v[80:83], a[200:203], v[0:15]
    ds_read_b64_tr_b16 v[120:121], v215 offset:47104
    ds_read_b64_tr_b16 v[122:123], v215 offset:47616
    v_mfma_f32_32x32x16_bf16 v[16:31], v[84:87], a[200:203], v[16:31]
    ds_read_b64_tr_b16 v[124:125], v216 offset:47104
    ds_read_b64_tr_b16 v[126:127], v216 offset:47616
    s_waitcnt lgkmcnt(15)
    v_mfma_f32_32x32x16_bf16 v[0:15], v[88:91], a[204:207], v[0:15]
    ds_read_b64_tr_b16 v[64:65], v217 offset:0
    ds_read_b64_tr_b16 v[66:67], v217 offset:512
    v_mfma_f32_32x32x16_bf16 v[16:31], v[92:95], a[204:207], v[16:31]
    ds_read_b64_tr_b16 v[68:69], v218 offset:0
    ds_read_b64_tr_b16 v[70:71], v218 offset:512
    s_waitcnt lgkmcnt(15)
    v_mfma_f32_32x32x16_bf16 v[0:15], v[96:99], a[208:211], v[0:15]
    ds_read_b64_tr_b16 v[72:73], v217 offset:2048
    ds_read_b64_tr_b16 v[74:75], v217 offset:2560
    v_mfma_f32_32x32x16_bf16 v[16:31], v[100:103], a[208:211], v[16:31]
    ds_read_b64_tr_b16 v[76:77], v218 offset:2048
    ds_read_b64_tr_b16 v[78:79], v218 offset:2560
    s_waitcnt vmcnt(0)
    v_readfirstlane_b32 s36, v247
    s_cmp_eq_u32 s36, 1
    s_cselect_b32 s36, 0, 0x40000000
    s_lshl_b32 s3, s62, 13
    s_add_u32 s3, s3, s36
    s_add_u32 s31, s3, 4096
    buffer_load_dwordx4 v[32:35], v212, s[52:55], s3 offen offset:0 sc1
    buffer_load_dwordx4 v[36:39], v212, s[52:55], s3 offen offset:1024 sc1
    buffer_load_dwordx4 v[40:43], v212, s[52:55], s3 offen offset:2048 sc1
    buffer_load_dwordx4 v[44:47], v212, s[52:55], s3 offen offset:3072 sc1
    s_waitcnt lgkmcnt(15)
    v_mfma_f32_32x32x16_bf16 v[0:15], v[104:107], a[212:215], v[0:15]
    ds_read_b64_tr_b16 v[80:81], v217 offset:4096
    ds_read_b64_tr_b16 v[82:83], v217 offset:4608
    v_mfma_f32_32x32x16_bf16 v[16:31], v[108:111], a[212:215], v[16:31]
    ds_read_b64_tr_b16 v[84:85], v218 offset:4096
    ds_read_b64_tr_b16 v[86:87], v218 offset:4608
    s_waitcnt lgkmcnt(15)
    v_mfma_f32_32x32x16_bf16 v[0:15], v[112:115], a[216:219], v[0:15]
    ds_read_b64_tr_b16 v[88:89], v217 offset:6144
    ds_read_b64_tr_b16 v[90:91], v217 offset:6656
    v_mfma_f32_32x32x16_bf16 v[16:31], v[116:119], a[216:219], v[16:31]
    ds_read_b64_tr_b16 v[92:93], v218 offset:6144
    ds_read_b64_tr_b16 v[94:95], v218 offset:6656
    s_waitcnt lgkmcnt(15)
    v_mfma_f32_32x32x16_bf16 v[0:15], v[120:123], a[220:223], v[0:15]
    ds_read_b64_tr_b16 v[96:97], v217 offset:8192
    ds_read_b64_tr_b16 v[98:99], v217 offset:8704
    v_mfma_f32_32x32x16_bf16 v[16:31], v[124:127], a[220:223], v[16:31]
    ds_read_b64_tr_b16 v[100:101], v218 offset:8192
    ds_read_b64_tr_b16 v[102:103], v218 offset:8704
    s_waitcnt lgkmcnt(15)
    v_mfma_f32_32x32x16_bf16 v[0:15], v[64:67], a[224:227], v[0:15]
    ds_read_b64_tr_b16 v[104:105], v217 offset:10240
    ds_read_b64_tr_b16 v[106:107], v217 offset:10752
    v_mfma_f32_32x32x16_bf16 v[16:31], v[68:71], a[224:227], v[16:31]
    ds_read_b64_tr_b16 v[108:109], v218 offset:10240
    ds_read_b64_tr_b16 v[110:111], v218 offset:10752
    s_waitcnt lgkmcnt(15)
    v_mfma_f32_32x32x16_bf16 v[0:15], v[72:75], a[228:231], v[0:15]
    ds_read_b64_tr_b16 v[112:113], v217 offset:12288
    ds_read_b64_tr_b16 v[114:115], v217 offset:12800
    v_mfma_f32_32x32x16_bf16 v[16:31], v[76:79], a[228:231], v[16:31]
    ds_read_b64_tr_b16 v[116:117], v218 offset:12288
    ds_read_b64_tr_b16 v[118:119], v218 offset:12800
    s_waitcnt lgkmcnt(15)
    v_mfma_f32_32x32x16_bf16 v[0:15], v[80:83], a[232:235], v[0:15]
    ds_read_b64_tr_b16 v[120:121], v217 offset:14336
    ds_read_b64_tr_b16 v[122:123], v217 offset:14848
    v_mfma_f32_32x32x16_bf16 v[16:31], v[84:87], a[232:235], v[16:31]
    ds_read_b64_tr_b16 v[124:125], v218 offset:14336
    ds_read_b64_tr_b16 v[126:127], v218 offset:14848
    s_waitcnt lgkmcnt(15)
    v_mfma_f32_32x32x16_bf16 v[0:15], v[88:91], a[236:239], v[0:15]
    v_mfma_f32_32x32x16_bf16 v[16:31], v[92:95], a[236:239], v[16:31]
    s_waitcnt lgkmcnt(12)
    v_mfma_f32_32x32x16_bf16 v[0:15], v[96:99], a[240:243], v[0:15]
    v_mfma_f32_32x32x16_bf16 v[16:31], v[100:103], a[240:243], v[16:31]
    s_waitcnt lgkmcnt(8)
    v_mfma_f32_32x32x16_bf16 v[0:15], v[104:107], a[244:247], v[0:15]
    v_mfma_f32_32x32x16_bf16 v[16:31], v[108:111], a[244:247], v[16:31]
    s_waitcnt lgkmcnt(4)
    v_mfma_f32_32x32x16_bf16 v[0:15], v[112:115], a[248:251], v[0:15]
    v_mfma_f32_32x32x16_bf16 v[16:31], v[116:119], a[248:251], v[16:31]
    s_waitcnt lgkmcnt(0)
    v_mfma_f32_32x32x16_bf16 v[0:15], v[120:123], a[252:255], v[0:15]
    v_mfma_f32_32x32x16_bf16 v[16:31], v[124:127], a[252:255], v[16:31]
    s_cmp_eq_u32 s60, 0
    s_cbranch_scc1 L_kb_nopatch
    v_cmp_eq_u32 vcc, s42, v222
    v_lshrrev_b32 v228, 5, v226
    v_lshlrev_b32 v228, 7, v228
    v_add_u32 v228, 0x25000, v228
    s_and_saveexec_b64 s[68:69], vcc
    s_cbranch_execz L_kb_rest
    ds_read_b128 v[160:163], v228 offset:0
    ds_read_b128 v[164:167], v228 offset:16
    ds_read_b128 v[168:171], v228 offset:32
    ds_read_b128 v[172:175], v228 offset:48
    ds_read_b128 v[176:179], v228 offset:64
    ds_read_b128 v[180:183], v228 offset:80
    ds_read_b128 v[184:187], v228 offset:96
    ds_read_b128 v[188:191], v228 offset:112
    s_waitcnt lgkmcnt(0)
L_kb_rest:
    s_mov_b64 exec, s[68:69]
L_kb_nopatch:
    s_cmp_lg_u32 s36, 0
    s_cbranch_scc1 L_kb_late
L_kb_got:
    s_waitcnt vmcnt(3)
    v_lshlrev_b32 v228, 16, v32
    v_and_b32 v229, s41, v32
    v_lshlrev_b32 v230, 16, v33
    v_and_b32 v231, s41, v33
    v_lshlrev_b32 v232, 16, v34
    v_and_b32 v233, s41, v34
    v_lshlrev_b32 v234, 16, v35
    v_and_b32 v235, s41, v35
    v_add_f32 v0, v0, v228
    v_add_f32 v1, v1, v229
    v_add_f32 v2, v2, v230
    v_add_f32 v3, v3, v231
    v_add_f32 v4, v4, v232
    v_add_f32 v5, v5, v233
    v_add_f32 v6, v6, v234
    v_add_f32 v7, v7, v235
    v_fmac_f32 v128, v0, v160
    v_fmac_f32 v129, v1, v161
    v_fmac_f32 v130, v2, v162
    v_fmac_f32 v131, v3, v163
    v_fmac_f32 v132, v4, v164
    v_fmac_f32 v133, v5, v165
    v_fmac_f32 v134, v6, v166
    v_fmac_f32 v135, v7, v167
    v_cvt_pk_bf16_f32 v192, v128, v129
    v_cvt_pk_bf16_f32 v193, v130, v131
    v_cvt_pk_bf16_f32 v194, v132, v133
    v_cvt_pk_bf16_f32 v195, v134, v135
    buffer_store_dwordx4 v[192:195], v221, s[24:27], 0 offen offset:0
    s_waitcnt vmcnt(3)
    v_lshlrev_b32 v228, 16, v36
    v_and_b32 v229, s41, v36
    v_lshlrev_b32 v230, 16, v37
    v_and_b32 v231, s41, v37
    v_lshlrev_b32 v232, 16, v38
    v_and_b32 v233, s41, v38
    v_lshlrev_b32 v234, 16, v39
    v_and_b32 v235, s41, v39
    v_add_f32 v8, v8, v228
    v_add_f32 v9, v9, v229
    v_add_f32 v10, v10, v230
    v_add_f32 v11, v11, v231
    v_add_f32 v12, v12, v232
    v_add_f32 v13, v13, v233
    v_add_f32 v14, v14, v234
    v_add_f32 v15, v15, v235
    v_fmac_f32 v136, v8, v168
    v_fmac_f32 v137, v9, v169
    v_fmac_f32 v138, v10, v170
    v_fmac_f32 v139, v11, v171
    v_fmac_f32 v140, v12, v172
    v_fmac_f32 v141, v13, v173
    v_fmac_f32 v142, v14, v174
    v_fmac_f32 v143, v15, v175
    v_cvt_pk_bf16_f32 v196, v136, v137
    v_cvt_pk_bf16_f32 v197, v138, v139
    v_cvt_pk_bf16_f32 v198, v140, v141
    v_cvt_pk_bf16_f32 v199, v142, v143
    buffer_store_dwordx4 v[196:199], v221, s[24:27], 0 offen offset:16
    s_waitcnt vmcnt(3)
    v_lshlrev_b32 v228, 16, v40
    v_and_b32 v229, s41, v40
    v_lshlrev_b32 v230, 16, v41
    v_and_b32 v231, s41, v41
    v_lshlrev_b32 v232, 16, v42
    v_and_b32 v233, s41, v42
    v_lshlrev_b32 v234, 16, v43
    v_and_b32 v235, s41, v43
    v_add_f32 v16, v16, v228
    v_add_f32 v17, v17, v229
    v_add_f32 v18, v18, v230
    v_add_f32 v19, v19, v231
    v_add_f32 v20, v20, v232
    v_add_f32 v21, v21, v233
    v_add_f32 v22, v22, v234
    v_add_f32 v23, v23, v235
    v_fmac_f32 v144, v16, v176
    v_fmac_f32 v145, v17, v177
    v_fmac_f32 v146, v18, v178
    v_fmac_f32 v147, v19, v179
    v_fmac_f32 v148, v20, v180
    v_fmac_f32 v149, v21, v181
    v_fmac_f32 v150, v22, v182
    v_fmac_f32 v151, v23, v183
    v_cvt_pk_bf16_f32 v200, v144, v145
    v_cvt_pk_bf16_f32 v201, v146, v147
    v_cvt_pk_bf16_f32 v202, v148, v149
    v_cvt_pk_bf16_f32 v203, v150, v151
    buffer_store_dwordx4 v[200:203], v221, s[24:27], 0 offen offset:32
    s_waitcnt vmcnt(3)
    v_lshlrev_b32 v228, 16, v44
    v_and_b32 v229, s41, v44
    v_lshlrev_b32 v230, 16, v45
    v_and_b32 v231, s41, v45
    v_lshlrev_b32 v232, 16, v46
    v_and_b32 v233, s41, v46
    v_lshlrev_b32 v234, 16, v47
    v_and_b32 v235, s41, v47
    v_add_f32 v24, v24, v228
    v_add_f32 v25, v25, v229
    v_add_f32 v26, v26, v230
    v_add_f32 v27, v27, v231
    v_add_f32 v28, v28, v232
    v_add_f32 v29, v29, v233
    v_add_f32 v30, v30, v234
    v_add_f32 v31, v31, v235
    v_fmac_f32 v152, v24, v184
    v_fmac_f32 v153, v25, v185
    v_fmac_f32 v154, v26, v186
    v_fmac_f32 v155, v27, v187
    v_fmac_f32 v156, v28, v188
    v_fmac_f32 v157, v29, v189
    v_fmac_f32 v158, v30, v190
    v_fmac_f32 v159, v31, v191
    v_cvt_pk_bf16_f32 v204, v152, v153
    v_cvt_pk_bf16_f32 v205, v154, v155
    v_cvt_pk_bf16_f32 v206, v156, v157
    v_cvt_pk_bf16_f32 v207, v158, v159
    buffer_store_dwordx4 v[204:207], v221, s[24:27], 0 offen offset:48
L_kb_end:
    s_endpgm
L_kb_late:
    s_mov_b32 s40, 0
L_kb_spin:
    buffer_load_dword v247, v246, s[56:59], 0 offen sc1
    s_waitcnt vmcnt(0)
    v_cmp_eq_u32 vcc, 1, v247
    s_cbranch_vccnz L_kb_got2
    s_sleep 2
    s_add_u32 s40, s40, 1
    s_cmp_lt_u32 s40, 0x400000
    s_cbranch_scc1 L_kb_spin
L_kb_got2:
    s_lshl_b32 s3, s62, 13
    s_add_u32 s31, s3, 4096
    buffer_load_dwordx4 v[32:35], v212, s[52:55], s3 offen offset:0 sc1
    buffer_load_dwordx4 v[36:39], v212, s[52:55], s3 offen offset:1024 sc1
    buffer_load_dwordx4 v[40:43], v212, s[52:55], s3 offen offset:2048 sc1
    buffer_load_dwordx4 v[44:47], v212, s[52:55], s3 offen offset:3072 sc1
    s_branch L_kb_got
L_kb_o_do0:
    s_mov_b32 s40, 0
L_kb_spino:
    buffer_load_dword v56, v55, s[56:59], 0 offen sc1
    s_waitcnt vmcnt(0)
    v_cmp_ne_u32 vcc, 1, v56
    s_cbranch_vccz L_kb_spino_ok
    s_sleep 1
    s_add_u32 s40, s40, 1
    s_cmp_lt_u32 s40, 0x80000
    s_cbranch_scc1 L_kb_spino
L_kb_spino_ok:
    s_branch L_kb_o_rt0
L_kb_o_do1:
    v_add_u32 v229, 4096, v212
    s_mov_b32 s40, 0
L_kb_spinall:
    buffer_load_dwordx4 v[192:195], v229, s[56:59], 0 offen offset:0 sc1
    buffer_load_dwordx4 v[196:199], v229, s[56:59], 0 offen offset:1024 sc1
    buffer_load_dwordx4 v[200:203], v229, s[56:59], 0 offen offset:2048 sc1
    buffer_load_dwordx4 v[204:207], v229, s[56:59], 0 offen offset:3072 sc1
    s_waitcnt vmcnt(0)
    v_and_b32 v192, v192, v193
    v_and_b32 v192, v192, v194
    v_and_b32 v192, v192, v195
    v_and_b32 v192, v192, v196
    v_and_b32 v192, v192, v197
    v_and_b32 v192, v192, v198
    v_and_b32 v192, v192, v199
    v_and_b32 v192, v192, v200
    v_and_b32 v192, v192, v201
    v_and_b32 v192, v192, v202
    v_and_b32 v192, v192, v203
    v_and_b32 v192, v192, v204
    v_and_b32 v192, v192, v205
    v_and_b32 v192, v192, v206
    v_and_b32 v192, v192, v207
    v_cmp_ne_u32 vcc, 1, v192
    s_cbranch_vccz L_kb_spinall_ok
    s_sleep 1
    s_add_u32 s40, s40, 1
    s_cmp_lt_u32 s40, 0x80000
    s_cbranch_scc1 L_kb_spinall
L_kb_spinall_ok:
    v_lshrrev_b32 v229, 4, v226
    v_and_b32 v230, 15, v226
    v_lshlrev_b32 v230, 4, v230
    v_lshl_add_u32 v231, v229, 12, v230
    s_mul_i32 s3, s28, 229376
    s_lshl_b32 s31, s63, 2
    s_add_u32 s3, s3, s31
    buffer_load_dwordx4 a[200:203], v231, s[48:51], s3 offen sc1
    s_add_u32 s3, s3, 16384
    buffer_load_dwordx4 a[204:207], v231, s[48:51], s3 offen sc1
    s_add_u32 s3, s3, 16384
    buffer_load_dwordx4 a[208:211], v231, s[48:51], s3 offen sc1
    s_add_u32 s3, s3, 16384
    buffer_load_dwordx4 a[212:215], v231, s[48:51], s3 offen sc1
    s_add_u32 s3, s3, 16384
    buffer_load_dwordx4 a[216:219], v231, s[48:51], s3 offen sc1
    s_add_u32 s3, s3, 16384
    buffer_load_dwordx4 a[220:223], v231, s[48:51], s3 offen sc1
    s_add_u32 s3, s3, 16384
    buffer_load_dwordx4 a[224:227], v231, s[48:51], s3 offen sc1
    s_add_u32 s3, s3, 16384
    buffer_load_dwordx4 a[228:231], v231, s[48:51], s3 offen sc1
    s_add_u32 s3, s3, 16384
    buffer_load_dwordx4 a[232:235], v231, s[48:51], s3 offen sc1
    s_add_u32 s3, s3, 16384
    buffer_load_dwordx4 a[236:239], v231, s[48:51], s3 offen sc1
    s_add_u32 s3, s3, 16384
    buffer_load_dwordx4 a[240:243], v231, s[48:51], s3 offen sc1
    s_add_u32 s3, s3, 16384
    buffer_load_dwordx4 a[244:247], v231, s[48:51], s3 offen sc1
    s_add_u32 s3, s3, 16384
    buffer_load_dwordx4 a[248:251], v231, s[48:51], s3 offen sc1
    s_add_u32 s3, s3, 16384
    buffer_load_dwordx4 a[252:255], v231, s[48:51], s3 offen sc1
    s_add_u32 s3, s3, 16384
    s_lshl_b32 s3, s42, 11
    s_lshl_b32 s31, s63, 1
    s_add_u32 s3, s3, s31
    v_lshlrev_b32 v232, 1, v226
    buffer_load_ushort v234, v232, s[16:19], s3 offen
    s_lshl_b32 s3, s42, 3
    v_mov_b32 v232, s3
    buffer_load_dwordx2 v[236:237], v232, s[20:23], 0 offen sc1
    s_waitcnt vmcnt(0)
    v_accvgpr_read_b32 v192, a200
    v_accvgpr_read_b32 v193, a201
    v_accvgpr_read_b32 v194, a202
    v_accvgpr_read_b32 v195, a203
    v_accvgpr_read_b32 v196, a204
    v_accvgpr_read_b32 v197, a205
    v_accvgpr_read_b32 v198, a206
    v_accvgpr_read_b32 v199, a207
    v_add_f32 v192, v192, v196
    v_add_f32 v193, v193, v197
    v_add_f32 v194, v194, v198
    v_add_f32 v195, v195, v199
    v_accvgpr_read_b32 v196, a208
    v_accvgpr_read_b32 v197, a209
    v_accvgpr_read_b32 v198, a210
    v_accvgpr_read_b32 v199, a211
    v_add_f32 v192, v192, v196
    v_add_f32 v193, v193, v197
    v_add_f32 v194, v194, v198
    v_add_f32 v195, v195, v199
    v_accvgpr_read_b32 v196, a212
    v_accvgpr_read_b32 v197, a213
    v_accvgpr_read_b32 v198, a214
    v_accvgpr_read_b32 v199, a215
    v_add_f32 v192, v192, v196
    v_add_f32 v193, v193, v197
    v_add_f32 v194, v194, v198
    v_add_f32 v195, v195, v199
    v_accvgpr_read_b32 v196, a216
    v_accvgpr_read_b32 v197, a217
    v_accvgpr_read_b32 v198, a218
    v_accvgpr_read_b32 v199, a219
    v_add_f32 v192, v192, v196
    v_add_f32 v193, v193, v197
    v_add_f32 v194, v194, v198
    v_add_f32 v195, v195, v199
    v_accvgpr_read_b32 v196, a220
    v_accvgpr_read_b32 v197, a221
    v_accvgpr_read_b32 v198, a222
    v_accvgpr_read_b32 v199, a223
    v_add_f32 v192, v192, v196
    v_add_f32 v193, v193, v197
    v_add_f32 v194, v194, v198
    v_add_f32 v195, v195, v199
    v_accvgpr_read_b32 v196, a224
    v_accvgpr_read_b32 v197, a225
    v_accvgpr_read_b32 v198, a226
    v_accvgpr_read_b32 v199, a227
    v_add_f32 v192, v192, v196
    v_add_f32 v193, v193, v197
    v_add_f32 v194, v194, v198
    v_add_f32 v195, v195, v199
    v_accvgpr_read_b32 v196, a228
    v_accvgpr_read_b32 v197, a229
    v_accvgpr_read_b32 v198, a230
    v_accvgpr_read_b32 v199, a231
    v_add_f32 v192, v192, v196
    v_add_f32 v193, v193, v197
    v_add_f32 v194, v194, v198
    v_add_f32 v195, v195, v199
    v_accvgpr_read_b32 v196, a232
    v_accvgpr_read_b32 v197, a233
    v_accvgpr_read_b32 v198, a234
    v_accvgpr_read_b32 v199, a235
    v_add_f32 v192, v192, v196
    v_add_f32 v193, v193, v197
    v_add_f32 v194, v194, v198
    v_add_f32 v195, v195, v199
    v_accvgpr_read_b32 v196, a236
    v_accvgpr_read_b32 v197, a237
    v_accvgpr_read_b32 v198, a238
    v_accvgpr_read_b32 v199, a239
    v_add_f32 v192, v192, v196
    v_add_f32 v193, v193, v197
    v_add_f32 v194, v194, v198
    v_add_f32 v195, v195, v199
    v_accvgpr_read_b32 v196, a240
    v_accvgpr_read_b32 v197, a241
    v_accvgpr_read_b32 v198, a242
    v_accvgpr_read_b32 v199, a243
    v_add_f32 v192, v192, v196
    v_add_f32 v193, v193, v197
    v_add_f32 v194, v194, v198
    v_add_f32 v195, v195, v199
    v_accvgpr_read_b32 v196, a244
    v_accvgpr_read_b32 v197, a245
    v_accvgpr_read_b32 v198, a246
    v_accvgpr_read_b32 v199, a247
    v_add_f32 v192, v192, v196
    v_add_f32 v193, v193, v197
    v_add_f32 v194, v194, v198
    v_add_f32 v195, v195, v199
    v_accvgpr_read_b32 v196, a248
    v_accvgpr_read_b32 v197, a249
    v_accvgpr_read_b32 v198, a250
    v_accvgpr_read_b32 v199, a251
    v_add_f32 v192, v192, v196
    v_add_f32 v193, v193, v197
    v_add_f32 v194, v194, v198
    v_add_f32 v195, v195, v199
    v_accvgpr_read_b32 v196, a252
    v_accvgpr_read_b32 v197, a253
    v_accvgpr_read_b32 v198, a254
    v_accvgpr_read_b32 v199, a255
    v_add_f32 v192, v192, v196
    v_add_f32 v193, v193, v197
    v_add_f32 v194, v194, v198
    v_add_f32 v195, v195, v199
    s_lshl_b32 s3, s28, 10
    v_lshl_add_u32 v231, v229, 8, v230
    s_add_u32 s3, s3, 0x24000
    v_add_u32 v231, s3, v231
    ds_write_b128 v231, v[192:195]
    s_waitcnt lgkmcnt(0)
    s_barrier
    v_lshlrev_b32 v231, 2, v226
    v_add_u32 v231, 0x24000, v231
    ds_read_b32 v192, v231 offset:0
    ds_read_b32 v193, v231 offset:256
    ds_read_b32 v194, v231 offset:512
    ds_read_b32 v195, v231 offset:768
    ds_read_b32 v196, v231 offset:1024
    ds_read_b32 v197, v231 offset:1280
    ds_read_b32 v198, v231 offset:1536
    ds_read_b32 v199, v231 offset:1792
    ds_read_b32 v200, v231 offset:2048
    ds_read_b32 v201, v231 offset:2304
    ds_read_b32 v202, v231 offset:2560
    ds_read_b32 v203, v231 offset:2816
    ds_read_b32 v204, v231 offset:3072
    ds_read_b32 v205, v231 offset:3328
    ds_read_b32 v206, v231 offset:3584
    ds_read_b32 v207, v231 offset:3840
    v_lshlrev_b32 v234, 16, v234
    v_sub_f32 v234, v234, v236
    v_cvt_pk_bf16_f32 v234, v234, v234
    v_and_b32 v234, s41, v234
    v_mul_f32 v234, v234, v237
    v_cvt_pk_bf16_f32 v234, v234, v234
    v_and_b32 v234, s41, v234
    s_waitcnt lgkmcnt(0)
    v_add_f32 v192, v192, v193
    v_add_f32 v192, v192, v194
    v_add_f32 v192, v192, v195
    v_add_f32 v192, v192, v196
    v_add_f32 v192, v192, v197
    v_add_f32 v192, v192, v198
    v_add_f32 v192, v192, v199
    v_add_f32 v192, v192, v200
    v_add_f32 v192, v192, v201
    v_add_f32 v192, v192, v202
    v_add_f32 v192, v192, v203
    v_add_f32 v192, v192, v204
    v_add_f32 v192, v192, v205
    v_add_f32 v192, v192, v206
    v_add_f32 v192, v192, v207
    s_lshr_b32 s3, s43, 16
    s_and_b32 s31, s3, 0x8000
    s_cmp_lg_u32 s31, 0
    s_mov_b32 s36, 0xffff
    s_cselect_b32 s31, 0x8000, s36
    s_xor_b32 s3, s3, s31
    s_lshl_b32 s3, s3, 16
    v_mov_b32 v232, s3
    v_mul_f32 v232, 0xbfb8aa3b, v232
    v_exp_f32 v232, v232
    s_nop 0
    v_add_f32 v232, 1.0, v232
    v_rcp_f32 v232, v232
    s_nop 0
    v_cvt_pk_bf16_f32 v232, v232, v192
    v_lshlrev_b32 v233, 16, v232
    v_and_b32 v232, s41, v232
    v_mul_f32 v232, v232, v233
    v_cvt_pk_bf16_f32 v232, v232, v232
    v_and_b32 v232, s41, v232
    v_add_f32 v232, v232, v234
    v_cvt_pk_bf16_f32 v232, v232, v232
    v_and_b32 v232, s41, v232
    v_mul_f32 v233, 0xbfb8aa3b, v232
    v_exp_f32 v233, v233
    s_nop 0
    v_add_f32 v233, 1.0, v233
    v_rcp_f32 v233, v233
    s_nop 0
    v_mul_f32 v232, v232, v233
    v_cvt_pk_bf16_f32 v232, v232, v232
    v_and_b32 v232, s41, v232
    ds_write_b32 v231, v232 offset:4096
    s_waitcnt lgkmcnt(0)
    s_branch L_kb_o_rt1
L_kb_o_do2:
    s_mov_b32 s40, 0
L_kb_spin2:
    buffer_load_dword v247, v246, s[56:59], 0 offen sc1
    s_waitcnt vmcnt(0)
    v_cmp_ne_u32 vcc, 1, v247
    s_cbranch_vccz L_kb_spin2_ok
    s_sleep 1
    s_add_u32 s40, s40, 1
    s_cmp_lt_u32 s40, 0x80000
    s_cbranch_scc1 L_kb_spin2
L_kb_spin2_ok:
    s_branch L_kb_o_rt2
L_kb_end2:
L_ka_end:
    s_endpgm
L_ka_o_do0:
    v_lshrrev_b32 v235, 3, v233
    v_and_b32 v255, 7, v233
    v_min_u32 v255, 6, v255
    v_lshlrev_b32 v255, 7, v255
    s_movk_i32 vcc_lo, 7168
    v_mad_u32_u24 v235, v235, vcc_lo, v255
    s_lshr_b32 vcc_lo, s2, 3
    s_lshl_b32 vcc_lo, vcc_lo, 2
    s_add_u32 vcc_lo, vcc_lo, s28
    s_mul_i32 vcc_lo, vcc_lo, 57344
    s_and_b32 vcc_hi, s2, 7
    s_mul_i32 vcc_hi, vcc_hi, 896
    s_add_u32 vcc_lo, vcc_lo, vcc_hi
    buffer_load_dword v234, v235, s[64:67], vcc_lo offen
    s_branch L_ka_o_rt0
L_ka_o_do1:
    v_lshrrev_b32 v235, 3, v233
    v_and_b32 v255, 7, v233
    v_min_u32 v255, 6, v255
    v_lshlrev_b32 v255, 7, v255
    s_movk_i32 vcc_lo, 7168
    v_mad_u32_u24 v235, v235, vcc_lo, v255
    s_lshr_b32 vcc_lo, s2, 3
    s_lshl_b32 vcc_lo, vcc_lo, 2
    s_add_u32 vcc_lo, vcc_lo, s28
    s_mul_i32 vcc_lo, vcc_lo, 57344
    s_and_b32 vcc_hi, s2, 7
    s_mul_i32 vcc_hi, vcc_hi, 896
    s_add_u32 vcc_lo, vcc_lo, vcc_hi
    buffer_load_dword v234, v235, s[64:67], vcc_lo offen
    s_branch L_ka_o_rt1
L_ka_o_do2:
    s_mov_b64 exec, 1
    buffer_atomic_add v220, v221, s[56:59], 0 offen sc1
    s_mov_b64 exec, -1
    s_branch L_ka_o_rt2
L_ka_o_do3:
    s_mov_b64 exec, 1
    buffer_atomic_add v220, v221, s[56:59], 0 offen sc1
    s_mov_b64 exec, -1
    s_branch L_ka_o_rt3
L_ka_o_do4:
    v_lshrrev_b32 v235, 3, v233
    v_and_b32 v255, 7, v233
    v_min_u32 v255, 6, v255
    v_lshlrev_b32 v255, 7, v255
    s_movk_i32 vcc_lo, 7168
    v_mad_u32_u24 v235, v235, vcc_lo, v255
    s_lshr_b32 vcc_lo, s2, 3
    s_lshl_b32 vcc_lo, vcc_lo, 2
    s_add_u32 vcc_lo, vcc_lo, s28
    s_mul_i32 vcc_lo, vcc_lo, 57344
    s_and_b32 vcc_hi, s2, 7
    s_mul_i32 vcc_hi, vcc_hi, 896
    s_add_u32 vcc_lo, vcc_lo, vcc_hi
    buffer_load_dword v234, v235, s[64:67], vcc_lo offen
    s_branch L_ka_o_rt4
L_ka_o_do5:
    s_mov_b64 exec, 1
    buffer_atomic_add v220, v221, s[56:59], 0 offen sc1
    s_mov_b64 exec, -1
    s_branch L_ka_o_rt5
L_ka_o_do6:
    s_mov_b64 exec, 1
    buffer_atomic_add v220, v221, s[56:59], 0 offen sc1
    s_mov_b64 exec, -1
    s_branch L_ka_o_rt6
L_ka_o_do7:
    s_mov_b64 exec, 1
    buffer_atomic_add v220, v221, s[56:59], 0 offen sc1
    s_mov_b64 exec, -1
    s_branch L_ka_o_rt7
L_ka_o_do8:
    s_mov_b64 exec, 1
    buffer_atomic_add v220, v221, s[56:59], 0 offen sc1
    s_mov_b64 exec, -1
    s_branch L_ka_o_rt8
L_ka_o_do9:
    v_lshrrev_b32 v235, 3, v233
    v_and_b32 v255, 7, v233
    v_min_u32 v255, 6, v255
    v_lshlrev_b32 v255, 7, v255
    s_movk_i32 vcc_lo, 7168
    v_mad_u32_u24 v235, v235, vcc_lo, v255
    s_lshr_b32 vcc_lo, s2, 3
    s_lshl_b32 vcc_lo, vcc_lo, 2
    s_add_u32 vcc_lo, vcc_lo, s28
    s_mul_i32 vcc_lo, vcc_lo, 57344
    s_and_b32 vcc_hi, s2, 7
    s_mul_i32 vcc_hi, vcc_hi, 896
    s_add_u32 vcc_lo, vcc_lo, vcc_hi
    buffer_load_dword v234, v235, s[64:67], vcc_lo offen
    s_branch L_ka_o_rt9
L_ka_o_do10:
    s_mov_b64 exec, 1
    buffer_atomic_add v220, v221, s[56:59], 0 offen sc1
    s_mov_b64 exec, -1
    s_branch L_ka_o_rt10
L_ka_o_do11:
    s_mov_b64 exec, 1
    buffer_atomic_add v220, v221, s[56:59], 0 offen sc1
    s_mov_b64 exec, -1
    s_branch L_ka_o_rt11
L_ka_o_do12:
    s_mov_b64 exec, 1
    buffer_atomic_add v220, v221, s[56:59], 0 offen sc1
    s_mov_b64 exec, -1
    s_branch L_ka_o_rt12
L_ka_o_do13:
    s_mov_b64 exec, 1
    buffer_atomic_add v220, v221, s[56:59], 0 offen sc1
    s_mov_b64 exec, -1
    s_branch L_ka_o_rt13
L_ka_o_do14:
    v_lshrrev_b32 v235, 3, v233
    v_and_b32 v255, 7, v233
    v_min_u32 v255, 6, v255
    v_lshlrev_b32 v255, 7, v255
    s_movk_i32 vcc_lo, 7168
    v_mad_u32_u24 v235, v235, vcc_lo, v255
    s_lshr_b32 vcc_lo, s2, 3
    s_lshl_b32 vcc_lo, vcc_lo, 2
    s_add_u32 vcc_lo, vcc_lo, s28
    s_mul_i32 vcc_lo, vcc_lo, 57344
    s_and_b32 vcc_hi, s2, 7
    s_mul_i32 vcc_hi, vcc_hi, 896
    s_add_u32 vcc_lo, vcc_lo, vcc_hi
    buffer_load_dword v234, v235, s[64:67], vcc_lo offen
    s_branch L_ka_o_rt14
L_ka_o_do15:
    s_mov_b64 exec, 1
    buffer_atomic_add v220, v221, s[56:59], 0 offen sc1
    s_mov_b64 exec, -1
    s_branch L_ka_o_rt15
L_ka_o_do16:
    s_mov_b64 exec, 1
    buffer_atomic_add v220, v221, s[56:59], 0 offen sc1
    s_mov_b64 exec, -1
    s_branch L_ka_o_rt16
L_ka_o_do17:
    s_mov_b64 exec, 1
    buffer_atomic_add v220, v221, s[56:59], 0 offen sc1
    s_mov_b64 exec, -1
    s_branch L_ka_o_rt17
L_ka_o_do18:
    s_mov_b64 exec, 1
    buffer_atomic_add v220, v221, s[56:59], 0 offen sc1
    s_mov_b64 exec, -1
    s_branch L_ka_o_rt18
L_ka_o_do19:
    v_lshrrev_b32 v235, 3, v233
    v_and_b32 v255, 7, v233
    v_min_u32 v255, 6, v255
    v_lshlrev_b32 v255, 7, v255
    s_movk_i32 vcc_lo, 7168
    v_mad_u32_u24 v235, v235, vcc_lo, v255
    s_lshr_b32 vcc_lo, s2, 3
    s_lshl_b32 vcc_lo, vcc_lo, 2
    s_add_u32 vcc_lo, vcc_lo, s28
    s_mul_i32 vcc_lo, vcc_lo, 57344
    s_and_b32 vcc_hi, s2, 7
    s_mul_i32 vcc_hi, vcc_hi, 896
    s_add_u32 vcc_lo, vcc_lo, vcc_hi
    buffer_load_dword v234, v235, s[64:67], vcc_lo offen
    s_branch L_ka_o_rt19
L_ka_o_do20:
    s_mov_b64 exec, 1
    buffer_atomic_add v220, v221, s[56:59], 0 offen sc1
    s_mov_b64 exec, -1
    s_branch L_ka_o_rt20
L_ka_o_do21:
    s_mov_b64 exec, 1
    buffer_atomic_add v220, v221, s[56:59], 0 offen sc1
    s_mov_b64 exec, -1
    s_branch L_ka_o_rt21
L_ka_o_do22:
    v_lshrrev_b32 v235, 3, v233
    v_and_b32 v255, 7, v233
    v_min_u32 v255, 6, v255
    v_lshlrev_b32 v255, 7, v255
    s_movk_i32 vcc_lo, 7168
    v_mad_u32_u24 v235, v235, vcc_lo, v255
    s_lshr_b32 vcc_lo, s2, 3
    s_lshl_b32 vcc_lo, vcc_lo, 2
    s_add_u32 vcc_lo, vcc_lo, s28
    s_mul_i32 vcc_lo, vcc_lo, 57344
    s_and_b32 vcc_hi, s2, 7
    s_mul_i32 vcc_hi, vcc_hi, 896
    s_add_u32 vcc_lo, vcc_lo, vcc_hi
    buffer_load_dword v234, v235, s[64:67], vcc_lo offen
    s_branch L_ka_o_rt22
L_ka_o_do23:
    v_lshrrev_b32 v235, 3, v233
    v_and_b32 v255, 7, v233
    v_min_u32 v255, 6, v255
    v_lshlrev_b32 v255, 7, v255
    s_movk_i32 vcc_lo, 7168
    v_mad_u32_u24 v235, v235, vcc_lo, v255
    s_lshr_b32 vcc_lo, s2, 3
    s_lshl_b32 vcc_lo, vcc_lo, 2
    s_add_u32 vcc_lo, vcc_lo, s28
    s_mul_i32 vcc_lo, vcc_lo, 57344
    s_and_b32 vcc_hi, s2, 7
    s_mul_i32 vcc_hi, vcc_hi, 896
    s_add_u32 vcc_lo, vcc_lo, vcc_hi
    buffer_load_dword v234, v235, s[64:67], vcc_lo offen
    s_branch L_ka_o_rt23
L_ka_o_do24:
    v_lshrrev_b32 v235, 3, v233
    v_and_b32 v255, 7, v233
    v_min_u32 v255, 6, v255
    v_lshlrev_b32 v255, 7, v255
    s_movk_i32 vcc_lo, 7168
    v_mad_u32_u24 v235, v235, vcc_lo, v255
    s_lshr_b32 vcc_lo, s2, 3
    s_lshl_b32 vcc_lo, vcc_lo, 2
    s_add_u32 vcc_lo, vcc_lo, s28
    s_mul_i32 vcc_lo, vcc_lo, 57344
    s_and_b32 vcc_hi, s2, 7
    s_mul_i32 vcc_hi, vcc_hi, 896
    s_add_u32 vcc_lo, vcc_lo, vcc_hi
    buffer_load_dword v234, v235, s[68:71], vcc_lo offen
    s_branch L_ka_o_rt24
L_ka_o_do25:
    v_lshrrev_b32 v235, 3, v233
    v_and_b32 v255, 7, v233
    v_min_u32 v255, 6, v255
    v_lshlrev_b32 v255, 7, v255
    s_movk_i32 vcc_lo, 7168
    v_mad_u32_u24 v235, v235, vcc_lo, v255
    s_lshr_b32 vcc_lo, s2, 3
    s_lshl_b32 vcc_lo, vcc_lo, 2
    s_add_u32 vcc_lo, vcc_lo, s28
    s_mul_i32 vcc_lo, vcc_lo, 57344
    s_and_b32 vcc_hi, s2, 7
    s_mul_i32 vcc_hi, vcc_hi, 896
    s_add_u32 vcc_lo, vcc_lo, vcc_hi
    buffer_load_dword v234, v235, s[68:71], vcc_lo offen
    s_branch L_ka_o_rt25
L_ka_o_do26:
    v_lshrrev_b32 v235, 3, v233
    v_and_b32 v255, 7, v233
    v_min_u32 v255, 6, v255
    v_lshlrev_b32 v255, 7, v255
    s_movk_i32 vcc_lo, 7168
    v_mad_u32_u24 v235, v235, vcc_lo, v255
    s_lshr_b32 vcc_lo, s2, 3
    s_lshl_b32 vcc_lo, vcc_lo, 2
    s_add_u32 vcc_lo, vcc_lo, s28
    s_mul_i32 vcc_lo, vcc_lo, 57344
    s_and_b32 vcc_hi, s2, 7
    s_mul_i32 vcc_hi, vcc_hi, 896
    s_add_u32 vcc_lo, vcc_lo, vcc_hi
    buffer_load_dword v234, v235, s[68:71], vcc_lo offen
    s_branch L_ka_o_rt26
L_ka_o_do27:
    v_lshrrev_b32 v235, 3, v233
    v_and_b32 v255, 7, v233
    v_min_u32 v255, 6, v255
    v_lshlrev_b32 v255, 7, v255
    s_movk_i32 vcc_lo, 7168
    v_mad_u32_u24 v235, v235, vcc_lo, v255
    s_lshr_b32 vcc_lo, s2, 3
    s_lshl_b32 vcc_lo, vcc_lo, 2
    s_add_u32 vcc_lo, vcc_lo, s28
    s_mul_i32 vcc_lo, vcc_lo, 57344
    s_and_b32 vcc_hi, s2, 7
    s_mul_i32 vcc_hi, vcc_hi, 896
    s_add_u32 vcc_lo, vcc_lo, vcc_hi
    buffer_load_dword v234, v235, s[68:71], vcc_lo offen
    s_branch L_ka_o_rt27
L_ka_o_do28:
    v_lshrrev_b32 v235, 3, v233
    v_and_b32 v255, 7, v233
    v_min_u32 v255, 6, v255
    v_lshlrev_b32 v255, 7, v255
    s_movk_i32 vcc_lo, 7168
    v_mad_u32_u24 v235, v235, vcc_lo, v255
    s_lshr_b32 vcc_lo, s2, 3
    s_lshl_b32 vcc_lo, vcc_lo, 2
    s_add_u32 vcc_lo, vcc_lo, s28
    s_mul_i32 vcc_lo, vcc_lo, 57344
    s_and_b32 vcc_hi, s2, 7
    s_mul_i32 vcc_hi, vcc_hi, 896
    s_add_u32 vcc_lo, vcc_lo, vcc_hi
    buffer_load_dword v234, v235, s[68:71], vcc_lo offen
    s_branch L_ka_o_rt28
L_ka_o_do29:
    v_lshrrev_b32 v235, 3, v233
    v_and_b32 v255, 7, v233
    v_min_u32 v255, 6, v255
    v_lshlrev_b32 v255, 7, v255
    s_movk_i32 vcc_lo, 7168
    v_mad_u32_u24 v235, v235, vcc_lo, v255
    s_lshr_b32 vcc_lo, s2, 3
    s_lshl_b32 vcc_lo, vcc_lo, 2
    s_add_u32 vcc_lo, vcc_lo, s28
    s_mul_i32 vcc_lo, vcc_lo, 57344
    s_and_b32 vcc_hi, s2, 7
    s_mul_i32 vcc_hi, vcc_hi, 896
    s_add_u32 vcc_lo, vcc_lo, vcc_hi
    buffer_load_dword v234, v235, s[68:71], vcc_lo offen
    s_branch L_ka_o_rt29
L_ka_o_do30:
    v_lshrrev_b32 v235, 3, v233
    v_and_b32 v255, 7, v233
    v_min_u32 v255, 6, v255
    v_lshlrev_b32 v255, 7, v255
    s_movk_i32 vcc_lo, 7168
    v_mad_u32_u24 v235, v235, vcc_lo, v255
    s_lshr_b32 vcc_lo, s2, 3
    s_lshl_b32 vcc_lo, vcc_lo, 2
    s_add_u32 vcc_lo, vcc_lo, s28
    s_mul_i32 vcc_lo, vcc_lo, 57344
    s_and_b32 vcc_hi, s2, 7
    s_mul_i32 vcc_hi, vcc_hi, 896
    s_add_u32 vcc_lo, vcc_lo, vcc_hi
    buffer_load_dword v234, v235, s[68:71], vcc_lo offen
    s_branch L_ka_o_rt30
L_ka_o_do31:
    v_lshrrev_b32 v235, 3, v233
    v_and_b32 v255, 7, v233
    v_min_u32 v255, 6, v255
    v_lshlrev_b32 v255, 7, v255
    s_movk_i32 vcc_lo, 7168
    v_mad_u32_u24 v235, v235, vcc_lo, v255
    s_lshr_b32 vcc_lo, s2, 3
    s_lshl_b32 vcc_lo, vcc_lo, 2
    s_add_u32 vcc_lo, vcc_lo, s28
    s_mul_i32 vcc_lo, vcc_lo, 57344
    s_and_b32 vcc_hi, s2, 7
    s_mul_i32 vcc_hi, vcc_hi, 896
    s_add_u32 vcc_lo, vcc_lo, vcc_hi
    buffer_load_dword v234, v235, s[68:71], vcc_lo offen
    s_branch L_ka_o_rt31
L_ka_o_do32:
    v_lshrrev_b32 v235, 2, v233
    v_and_b32 v255, 3, v233
    v_lshlrev_b32 v255, 7, v255
    v_lshl_add_u32 v235, v235, 11, v255
    buffer_load_dword v234, v235, s[72:75], s33 offen
    s_branch L_ka_o_rt32
L_ka_o_do33:
    v_lshrrev_b32 v235, 2, v233
    v_and_b32 v255, 3, v233
    v_lshlrev_b32 v255, 7, v255
    v_lshl_add_u32 v235, v235, 11, v255
    buffer_load_dword v234, v235, s[72:75], s33 offen
    s_branch L_ka_o_rt33
L_ka_o_do34:
    v_lshrrev_b32 v235, 2, v233
    v_and_b32 v255, 3, v233
    v_lshlrev_b32 v255, 7, v255
    v_lshl_add_u32 v235, v235, 11, v255
    buffer_load_dword v234, v235, s[72:75], s33 offen
    s_branch L_ka_o_rt34
L_ka_o_do35:
    v_lshrrev_b32 v235, 2, v233
    v_and_b32 v255, 3, v233
    v_lshlrev_b32 v255, 7, v255
    v_lshl_add_u32 v235, v235, 11, v255
    buffer_load_dword v234, v235, s[72:75], s33 offen
    s_branch L_ka_o_rt35
L_ka_o_do36:
    v_lshrrev_b32 v235, 2, v233
    v_and_b32 v255, 3, v233
    v_lshlrev_b32 v255, 7, v255
    v_lshl_add_u32 v235, v235, 11, v255
    buffer_load_dword v234, v235, s[72:75], s33 offen
    s_branch L_ka_o_rt36
L_ka_o_do37:
    v_lshrrev_b32 v235, 3, v233
    v_and_b32 v255, 7, v233
    v_lshlrev_b32 v255, 7, v255
    v_lshl_add_u32 v235, v235, 11, v255
    s_bfe_u32 vcc_lo, s2, 0x30003
    s_lshl_b32 vcc_lo, vcc_lo, 2
    s_lshr_b32 vcc_hi, s2, 6
    s_add_u32 vcc_lo, vcc_lo, vcc_hi
    s_lshl_b32 vcc_lo, vcc_lo, 2
    s_add_u32 vcc_lo, vcc_lo, s28
    s_and_b32 vcc_hi, vcc_lo, 7
    s_lshl_b32 vcc_hi, vcc_hi, 14
    s_lshr_b32 vcc_lo, vcc_lo, 3
    s_lshl_b32 vcc_lo, vcc_lo, 18
    s_add_u32 vcc_lo, vcc_lo, vcc_hi
    s_and_b32 vcc_hi, s2, 1
    s_lshl_b32 vcc_hi, vcc_hi, 17
    s_add_u32 vcc_lo, vcc_lo, vcc_hi
    s_bfe_u32 vcc_hi, s2, 0x10002
    s_lshl_b32 vcc_hi, vcc_hi, 22
    s_add_u32 vcc_lo, vcc_lo, vcc_hi
    s_bfe_u32 vcc_hi, s2, 0x10001
    s_mul_i32 vcc_hi, vcc_hi, 0x200400
    s_xor_b32 vcc_lo, vcc_lo, vcc_hi
    buffer_load_dword v234, v235, s[60:63], vcc_lo offen
    s_branch L_ka_o_rt37
L_ka_o_do38:
    v_lshrrev_b32 v235, 3, v233
    v_and_b32 v255, 7, v233
    v_lshlrev_b32 v255, 7, v255
    v_lshl_add_u32 v235, v235, 11, v255
    s_bfe_u32 vcc_lo, s2, 0x30003
    s_lshl_b32 vcc_lo, vcc_lo, 2
    s_lshr_b32 vcc_hi, s2, 6
    s_add_u32 vcc_lo, vcc_lo, vcc_hi
    s_lshl_b32 vcc_lo, vcc_lo, 2
    s_add_u32 vcc_lo, vcc_lo, s28
    s_and_b32 vcc_hi, vcc_lo, 7
    s_lshl_b32 vcc_hi, vcc_hi, 14
    s_lshr_b32 vcc_lo, vcc_lo, 3
    s_lshl_b32 vcc_lo, vcc_lo, 18
    s_add_u32 vcc_lo, vcc_lo, vcc_hi
    s_and_b32 vcc_hi, s2, 1
    s_lshl_b32 vcc_hi, vcc_hi, 17
    s_add_u32 vcc_lo, vcc_lo, vcc_hi
    s_bfe_u32 vcc_hi, s2, 0x10002
    s_lshl_b32 vcc_hi, vcc_hi, 22
    s_add_u32 vcc_lo, vcc_lo, vcc_hi
    s_bfe_u32 vcc_hi, s2, 0x10001
    s_mul_i32 vcc_hi, vcc_hi, 0x200400
    s_xor_b32 vcc_lo, vcc_lo, vcc_hi
    buffer_load_dword v234, v235, s[60:63], vcc_lo offen
    s_branch L_ka_o_rt38
L_ka_o_do39:
    v_lshrrev_b32 v235, 2, v233
    v_and_b32 v255, 3, v233
    v_lshlrev_b32 v255, 7, v255
    v_lshl_add_u32 v235, v235, 11, v255
    buffer_load_dword v234, v235, s[72:75], s33 offen
    s_branch L_ka_o_rt39
L_ka_o_do40:
    v_lshrrev_b32 v235, 2, v233
    v_and_b32 v255, 3, v233
    v_lshlrev_b32 v255, 7, v255
    v_lshl_add_u32 v235, v235, 11, v255
    buffer_load_dword v234, v235, s[72:75], s33 offen
    s_branch L_ka_o_rt40
L_ka_o_do41:
    v_lshrrev_b32 v235, 3, v233
    v_and_b32 v255, 7, v233
    v_lshlrev_b32 v255, 7, v255
    v_lshl_add_u32 v235, v235, 11, v255
    s_bfe_u32 vcc_lo, s2, 0x30003
    s_lshl_b32 vcc_lo, vcc_lo, 2
    s_lshr_b32 vcc_hi, s2, 6
    s_add_u32 vcc_lo, vcc_lo, vcc_hi
    s_lshl_b32 vcc_lo, vcc_lo, 2
    s_add_u32 vcc_lo, vcc_lo, s28
    s_and_b32 vcc_hi, vcc_lo, 7
    s_lshl_b32 vcc_hi, vcc_hi, 14
    s_lshr_b32 vcc_lo, vcc_lo, 3
    s_lshl_b32 vcc_lo, vcc_lo, 18
    s_add_u32 vcc_lo, vcc_lo, vcc_hi
    s_and_b32 vcc_hi, s2, 1
    s_lshl_b32 vcc_hi, vcc_hi, 17
    s_add_u32 vcc_lo, vcc_lo, vcc_hi
    s_bfe_u32 vcc_hi, s2, 0x10002
    s_lshl_b32 vcc_hi, vcc_hi, 22
    s_add_u32 vcc_lo, vcc_lo, vcc_hi
    s_bfe_u32 vcc_hi, s2, 0x10001
    s_mul_i32 vcc_hi, vcc_hi, 0x200400
    s_xor_b32 vcc_lo, vcc_lo, vcc_hi
    buffer_load_dword v234, v235, s[60:63], vcc_lo offen
    s_branch L_ka_o_rt41
L_ka_o_do42:
    v_lshrrev_b32 v235, 2, v233
    v_and_b32 v255, 3, v233
    v_lshlrev_b32 v255, 7, v255
    v_lshl_add_u32 v235, v235, 11, v255
    buffer_load_dword v234, v235, s[72:75], s33 offen
    s_branch L_ka_o_rt42
L_ka_o_do43:
    v_lshrrev_b32 v235, 3, v233
    v_and_b32 v255, 7, v233
    v_lshlrev_b32 v255, 7, v255
    v_lshl_add_u32 v235, v235, 11, v255
    s_bfe_u32 vcc_lo, s2, 0x30003
    s_lshl_b32 vcc_lo, vcc_lo, 2
    s_lshr_b32 vcc_hi, s2, 6
    s_add_u32 vcc_lo, vcc_lo, vcc_hi
    s_lshl_b32 vcc_lo, vcc_lo, 2
    s_add_u32 vcc_lo, vcc_lo, s28
    s_and_b32 vcc_hi, vcc_lo, 7
    s_lshl_b32 vcc_hi, vcc_hi, 14
    s_lshr_b32 vcc_lo, vcc_lo, 3
    s_lshl_b32 vcc_lo, vcc_lo, 18
    s_add_u32 vcc_lo, vcc_lo, vcc_hi
    s_and_b32 vcc_hi, s2, 1
    s_lshl_b32 vcc_hi, vcc_hi, 17
    s_add_u32 vcc_lo, vcc_lo, vcc_hi
    s_bfe_u32 vcc_hi, s2, 0x10002
    s_lshl_b32 vcc_hi, vcc_hi, 22
    s_add_u32 vcc_lo, vcc_lo, vcc_hi
    s_bfe_u32 vcc_hi, s2, 0x10001
    s_mul_i32 vcc_hi, vcc_hi, 0x200400
    s_xor_b32 vcc_lo, vcc_lo, vcc_hi
    buffer_load_dword v234, v235, s[60:63], vcc_lo offen
    s_branch L_ka_o_rt43
L_ka_o_do44:
    v_lshrrev_b32 v235, 3, v233
    v_and_b32 v255, 7, v233
    v_lshlrev_b32 v255, 7, v255
    v_lshl_add_u32 v235, v235, 11, v255
    s_bfe_u32 vcc_lo, s2, 0x30003
    s_lshl_b32 vcc_lo, vcc_lo, 2
    s_lshr_b32 vcc_hi, s2, 6
    s_add_u32 vcc_lo, vcc_lo, vcc_hi
    s_lshl_b32 vcc_lo, vcc_lo, 2
    s_add_u32 vcc_lo, vcc_lo, s28
    s_and_b32 vcc_hi, vcc_lo, 7
    s_lshl_b32 vcc_hi, vcc_hi, 14
    s_lshr_b32 vcc_lo, vcc_lo, 3
    s_lshl_b32 vcc_lo, vcc_lo, 18
    s_add_u32 vcc_lo, vcc_lo, vcc_hi
    s_and_b32 vcc_hi, s2, 1
    s_lshl_b32 vcc_hi, vcc_hi, 17
    s_add_u32 vcc_lo, vcc_lo, vcc_hi
    s_bfe_u32 vcc_hi, s2, 0x10002
    s_lshl_b32 vcc_hi, vcc_hi, 22
    s_add_u32 vcc_lo, vcc_lo, vcc_hi
    s_bfe_u32 vcc_hi, s2, 0x10001
    s_mul_i32 vcc_hi, vcc_hi, 0x200400
    s_xor_b32 vcc_lo, vcc_lo, vcc_hi
    buffer_load_dword v234, v235, s[60:63], vcc_lo offen
    s_branch L_ka_o_rt44
L_ka_o_do45:
    s_getpc_b64 vcc
L_kb_pc:
    s_sub_u32 vcc_lo, vcc_lo, L_kb_pc-recurrent_scan__sliding_block_cached__moe_arch_mod__prompt_kernel
    s_subb_u32 vcc_hi, vcc_hi, 0
    s_bfe_u32 s3, s2, 0x30003
    s_lshl_b32 s3, s3, 13
    s_add_u32 s3, s3, L_ka_fuse-recurrent_scan__sliding_block_cached__moe_arch_mod__prompt_kernel
    v_lshl_add_u32 v235, v233, 7, s3
    s_mov_b32 s31, L_kb_end2-recurrent_scan__sliding_block_cached__moe_arch_mod__prompt_kernel-4
    v_min_u32 v235, s31, v235
    global_load_dword v234, v235, vcc
    s_branch L_ka_o_rt45
L_ka_o_do46:
    v_lshrrev_b32 v235, 3, v233
    v_and_b32 v255, 7, v233
    v_lshlrev_b32 v255, 7, v255
    v_lshl_add_u32 v235, v235, 11, v255
    s_bfe_u32 vcc_lo, s2, 0x30003
    s_lshl_b32 vcc_lo, vcc_lo, 2
    s_lshr_b32 vcc_hi, s2, 6
    s_add_u32 vcc_lo, vcc_lo, vcc_hi
    s_lshl_b32 vcc_lo, vcc_lo, 2
    s_add_u32 vcc_lo, vcc_lo, s28
    s_and_b32 vcc_hi, vcc_lo, 7
    s_lshl_b32 vcc_hi, vcc_hi, 14
    s_lshr_b32 vcc_lo, vcc_lo, 3
    s_lshl_b32 vcc_lo, vcc_lo, 18
    s_add_u32 vcc_lo, vcc_lo, vcc_hi
    s_and_b32 vcc_hi, s2, 1
    s_lshl_b32 vcc_hi, vcc_hi, 17
    s_add_u32 vcc_lo, vcc_lo, vcc_hi
    s_bfe_u32 vcc_hi, s2, 0x10002
    s_lshl_b32 vcc_hi, vcc_hi, 22
    s_add_u32 vcc_lo, vcc_lo, vcc_hi
    s_bfe_u32 vcc_hi, s2, 0x10001
    s_mul_i32 vcc_hi, vcc_hi, 0x200400
    s_xor_b32 vcc_lo, vcc_lo, vcc_hi
    buffer_load_dword v234, v235, s[60:63], vcc_lo offen
    s_branch L_ka_o_rt46
L_ka_o_do47:
    v_lshrrev_b32 v235, 3, v233
    v_and_b32 v255, 7, v233
    v_lshlrev_b32 v255, 7, v255
    v_lshl_add_u32 v235, v235, 11, v255
    s_bfe_u32 vcc_lo, s2, 0x30003
    s_lshl_b32 vcc_lo, vcc_lo, 2
    s_lshr_b32 vcc_hi, s2, 6
    s_add_u32 vcc_lo, vcc_lo, vcc_hi
    s_lshl_b32 vcc_lo, vcc_lo, 2
    s_add_u32 vcc_lo, vcc_lo, s28
    s_and_b32 vcc_hi, vcc_lo, 7
    s_lshl_b32 vcc_hi, vcc_hi, 14
    s_lshr_b32 vcc_lo, vcc_lo, 3
    s_lshl_b32 vcc_lo, vcc_lo, 18
    s_add_u32 vcc_lo, vcc_lo, vcc_hi
    s_and_b32 vcc_hi, s2, 1
    s_lshl_b32 vcc_hi, vcc_hi, 17
    s_add_u32 vcc_lo, vcc_lo, vcc_hi
    s_bfe_u32 vcc_hi, s2, 0x10002
    s_lshl_b32 vcc_hi, vcc_hi, 22
    s_add_u32 vcc_lo, vcc_lo, vcc_hi
    s_bfe_u32 vcc_hi, s2, 0x10001
    s_mul_i32 vcc_hi, vcc_hi, 0x200400
    s_xor_b32 vcc_lo, vcc_lo, vcc_hi
    buffer_load_dword v234, v235, s[60:63], vcc_lo offen
    s_branch L_ka_o_rt47
L_ka_o_do48:
    v_lshrrev_b32 v235, 3, v233
    v_and_b32 v255, 7, v233
    v_lshlrev_b32 v255, 7, v255
    v_lshl_add_u32 v235, v235, 11, v255
    s_bfe_u32 vcc_lo, s2, 0x30003
    s_lshl_b32 vcc_lo, vcc_lo, 2
    s_lshr_b32 vcc_hi, s2, 6
    s_add_u32 vcc_lo, vcc_lo, vcc_hi
    s_lshl_b32 vcc_lo, vcc_lo, 2
    s_add_u32 vcc_lo, vcc_lo, s28
    s_and_b32 vcc_hi, vcc_lo, 7
    s_lshl_b32 vcc_hi, vcc_hi, 14
    s_lshr_b32 vcc_lo, vcc_lo, 3
    s_lshl_b32 vcc_lo, vcc_lo, 18
    s_add_u32 vcc_lo, vcc_lo, vcc_hi
    s_and_b32 vcc_hi, s2, 1
    s_lshl_b32 vcc_hi, vcc_hi, 17
    s_add_u32 vcc_lo, vcc_lo, vcc_hi
    s_bfe_u32 vcc_hi, s2, 0x10002
    s_lshl_b32 vcc_hi, vcc_hi, 22
    s_add_u32 vcc_lo, vcc_lo, vcc_hi
    s_bfe_u32 vcc_hi, s2, 0x10001
    s_mul_i32 vcc_hi, vcc_hi, 0x200400
    s_xor_b32 vcc_lo, vcc_lo, vcc_hi
    buffer_load_dword v234, v235, s[60:63], vcc_lo offen
    s_branch L_ka_o_rt48
L_ka_slow:
    s_mov_b32 s50, 0
    v_and_b32 v237, 1, v233
    v_lshlrev_b32 v237, 7, v237
L_ka_spin:
    buffer_load_dword v250, v237, s[56:59], 0 offen sc1
    s_waitcnt vmcnt(0)
    v_cmp_gt_u32 vcc, 0x80, v250
    s_cbranch_vccz L_ka_spindone
    s_sleep 8
    s_add_u32 s50, s50, 1
    s_cmp_lt_u32 s50, 2097152
    s_cbranch_scc1 L_ka_spin
L_ka_spindone:
    v_and_b32 v237, 31, v233
    v_lshlrev_b32 v237, 3, v237
    buffer_load_dwordx2 v[246:247], v237, s[52:55], s51 offen offset:0 sc1
    buffer_load_dwordx2 v[248:249], v237, s[52:55], s51 offen offset:256 sc1
    s_movk_i32 s3, 0x4000
    buffer_load_dwordx4 v[172:175], v196, s[52:55], s3 offen offset:0 sc1
    buffer_load_dwordx4 v[176:179], v196, s[52:55], s3 offen offset:1024 sc1
    buffer_load_dwordx4 v[180:183], v196, s[52:55], s3 offen offset:2048 sc1
    buffer_load_dwordx4 v[184:187], v196, s[52:55], s3 offen offset:3072 sc1
    s_waitcnt vmcnt(0)
    s_branch L_ka_slowret
L_ka_trp1:
    s_call_b64 s[44:45], L_ka_fix1
    s_branch L_ka_retp1
L_ka_trp2:
    s_call_b64 s[44:45], L_ka_fix0
    s_branch L_ka_retp2
L_ka_trp3:
    s_call_b64 s[44:45], L_ka_fix1
    s_branch L_ka_retp3
L_ka_trp4:
    s_call_b64 s[44:45], L_ka_fix0
    s_branch L_ka_retp4
L_ka_trp5:
    s_call_b64 s[44:45], L_ka_fix1
    s_branch L_ka_retp5
L_ka_trp6:
    s_call_b64 s[44:45], L_ka_fix0
    s_branch L_ka_retp6
L_ka_trp7:
    s_call_b64 s[44:45], L_ka_fix1
    s_branch L_ka_retp7
L_ka_trp8:
    s_call_b64 s[44:45], L_ka_fix0
    s_branch L_ka_retp8
L_ka_trp9:
    s_call_b64 s[44:45], L_ka_fix1
    s_branch L_ka_retp9
L_ka_trp10:
    s_call_b64 s[44:45], L_ka_fix0
    s_branch L_ka_retp10
L_ka_trp11:
    s_call_b64 s[44:45], L_ka_fix1
    s_branch L_ka_retp11
L_ka_trp12:
    s_call_b64 s[44:45], L_ka_fix0
    s_branch L_ka_retp12
L_ka_trp13:
    s_call_b64 s[44:45], L_ka_fix1
    s_branch L_ka_retp13
L_ka_trp14:
    s_call_b64 s[44:45], L_ka_fix0
    s_branch L_ka_retp14
L_ka_trp15:
    s_call_b64 s[44:45], L_ka_fix1
    s_branch L_ka_retp15
L_ka_fix0:
    s_nop 15
    s_nop 15
    v_max3_f32 v238, v0, v1, v2
    v_max3_f32 v238, v238, v3, v4
    v_max3_f32 v238, v238, v5, v6
    v_max3_f32 v238, v238, v7, v8
    v_max3_f32 v238, v238, v9, v10
    v_max3_f32 v238, v238, v11, v12
    v_max3_f32 v238, v238, v13, v14
    v_max3_f32 v238, v238, v15, 0
    v_mov_b32 v240, v238
    v_max3_f32 v239, v16, v17, v18
    v_max3_f32 v239, v239, v19, v20
    v_max3_f32 v239, v239, v21, v22
    v_max3_f32 v239, v239, v23, v24
    v_max3_f32 v239, v239, v25, v26
    v_max3_f32 v239, v239, v27, v28
    v_max3_f32 v239, v239, v29, v30
    v_max3_f32 v239, v239, v31, 0
    v_mov_b32 v241, v239
    v_permlane32_swap_b32 v238, v240
    s_nop 0
    v_permlane32_swap_b32 v239, v241
    v_max_f32 v238, v238, v240
    v_exp_f32 v240, -v238
    v_sub_f32 v96, v96, v238
    v_sub_f32 v32, v32, v238
    v_sub_f32 v0, v0, v238
    v_sub_f32 v97, v97, v238
    v_sub_f32 v33, v33, v238
    v_sub_f32 v1, v1, v238
    v_sub_f32 v98, v98, v238
    v_sub_f32 v34, v34, v238
    v_sub_f32 v2, v2, v238
    v_sub_f32 v99, v99, v238
    v_sub_f32 v35, v35, v238
    v_sub_f32 v3, v3, v238
    v_sub_f32 v100, v100, v238
    v_sub_f32 v36, v36, v238
    v_sub_f32 v4, v4, v238
    v_sub_f32 v101, v101, v238
    v_sub_f32 v37, v37, v238
    v_sub_f32 v5, v5, v238
    v_sub_f32 v102, v102, v238
    v_sub_f32 v38, v38, v238
    v_sub_f32 v6, v6, v238
    v_sub_f32 v103, v103, v238
    v_sub_f32 v39, v39, v238
    v_sub_f32 v7, v7, v238
    v_sub_f32 v104, v104, v238
    v_sub_f32 v40, v40, v238
    v_sub_f32 v8, v8, v238
    v_sub_f32 v105, v105, v238
    v_sub_f32 v41, v41, v238
    v_sub_f32 v9, v9, v238
    v_sub_f32 v106, v106, v238
    v_sub_f32 v42, v42, v238
    v_sub_f32 v10, v10, v238
    v_sub_f32 v107, v107, v238
    v_sub_f32 v43, v43, v238
    v_sub_f32 v11, v11, v238
    v_sub_f32 v108, v108, v238
    v_sub_f32 v44, v44, v238
    v_sub_f32 v12, v12, v238
    v_sub_f32 v109, v109, v238
    v_sub_f32 v45, v45, v238
    v_sub_f32 v13, v13, v238
    v_sub_f32 v110, v110, v238
    v_sub_f32 v46, v46, v238
    v_sub_f32 v14, v14, v238
    v_sub_f32 v111, v111, v238
    v_sub_f32 v47, v47, v238
    v_sub_f32 v15, v15, v238
    v_mul_f32 v216, v216, v240
    v_exp_f32 v242, v0
    v_exp_f32 v243, v1
    s_nop 0
    v_add_f32 v218, v242, v243
    v_cvt_pk_bf16_f32 v64, v242, v243
    v_exp_f32 v242, v2
    v_exp_f32 v243, v3
    v_add_f32 v218, v218, v242
    v_add_f32 v218, v218, v243
    v_cvt_pk_bf16_f32 v65, v242, v243
    v_exp_f32 v242, v4
    v_exp_f32 v243, v5
    v_add_f32 v218, v218, v242
    v_add_f32 v218, v218, v243
    v_cvt_pk_bf16_f32 v66, v242, v243
    v_exp_f32 v242, v6
    v_exp_f32 v243, v7
    v_add_f32 v218, v218, v242
    v_add_f32 v218, v218, v243
    v_cvt_pk_bf16_f32 v67, v242, v243
    v_exp_f32 v242, v8
    v_exp_f32 v243, v9
    v_add_f32 v218, v218, v242
    v_add_f32 v218, v218, v243
    v_cvt_pk_bf16_f32 v68, v242, v243
    v_exp_f32 v242, v10
    v_exp_f32 v243, v11
    v_add_f32 v218, v218, v242
    v_add_f32 v218, v218, v243
    v_cvt_pk_bf16_f32 v69, v242, v243
    v_exp_f32 v242, v12
    v_exp_f32 v243, v13
    v_add_f32 v218, v218, v242
    v_add_f32 v218, v218, v243
    v_cvt_pk_bf16_f32 v70, v242, v243
    v_exp_f32 v242, v14
    v_exp_f32 v243, v15
    v_add_f32 v218, v218, v242
    v_add_f32 v218, v218, v243
    v_cvt_pk_bf16_f32 v71, v242, v243
    v_accvgpr_read_b32 v242, a0
    v_mul_f32 v242, v242, v240
    v_accvgpr_write_b32 a0, v242
    v_accvgpr_read_b32 v243, a1
    v_mul_f32 v243, v243, v240
    v_accvgpr_write_b32 a1, v243
    v_accvgpr_read_b32 v244, a2
    v_mul_f32 v244, v244, v240
    v_accvgpr_write_b32 a2, v244
    v_accvgpr_read_b32 v245, a3
    v_mul_f32 v245, v245, v240
    v_accvgpr_write_b32 a3, v245
    v_accvgpr_read_b32 v242, a4
    v_mul_f32 v242, v242, v240
    v_accvgpr_write_b32 a4, v242
    v_accvgpr_read_b32 v243, a5
    v_mul_f32 v243, v243, v240
    v_accvgpr_write_b32 a5, v243
    v_accvgpr_read_b32 v244, a6
    v_mul_f32 v244, v244, v240
    v_accvgpr_write_b32 a6, v244
    v_accvgpr_read_b32 v245, a7
    v_mul_f32 v245, v245, v240
    v_accvgpr_write_b32 a7, v245
    v_accvgpr_read_b32 v242, a8
    v_mul_f32 v242, v242, v240
    v_accvgpr_write_b32 a8, v242
    v_accvgpr_read_b32 v243, a9
    v_mul_f32 v243, v243, v240
    v_accvgpr_write_b32 a9, v243
    v_accvgpr_read_b32 v244, a10
    v_mul_f32 v244, v244, v240
    v_accvgpr_write_b32 a10, v244
    v_accvgpr_read_b32 v245, a11
    v_mul_f32 v245, v245, v240
    v_accvgpr_write_b32 a11, v245
    v_accvgpr_read_b32 v242, a12
    v_mul_f32 v242, v242, v240
    v_accvgpr_write_b32 a12, v242
    v_accvgpr_read_b32 v243, a13
    v_mul_f32 v243, v243, v240
    v_accvgpr_write_b32 a13, v243
    v_accvgpr_read_b32 v244, a14
    v_mul_f32 v244, v244, v240
    v_accvgpr_write_b32 a14, v244
    v_accvgpr_read_b32 v245, a15
    v_mul_f32 v245, v245, v240
    v_accvgpr_write_b32 a15, v245
    v_accvgpr_read_b32 v242, a32
    v_mul_f32 v242, v242, v240
    v_accvgpr_write_b32 a32, v242
    v_accvgpr_read_b32 v243, a33
    v_mul_f32 v243, v243, v240
    v_accvgpr_write_b32 a33, v243
    v_accvgpr_read_b32 v244, a34
    v_mul_f32 v244, v244, v240
    v_accvgpr_write_b32 a34, v244
    v_accvgpr_read_b32 v245, a35
    v_mul_f32 v245, v245, v240
    v_accvgpr_write_b32 a35, v245
    v_accvgpr_read_b32 v242, a36
    v_mul_f32 v242, v242, v240
    v_accvgpr_write_b32 a36, v242
    v_accvgpr_read_b32 v243, a37
    v_mul_f32 v243, v243, v240
    v_accvgpr_write_b32 a37, v243
    v_accvgpr_read_b32 v244, a38
    v_mul_f32 v244, v244, v240
    v_accvgpr_write_b32 a38, v244
    v_accvgpr_read_b32 v245, a39
    v_mul_f32 v245, v245, v240
    v_accvgpr_write_b32 a39, v245
    v_accvgpr_read_b32 v242, a40
    v_mul_f32 v242, v242, v240
    v_accvgpr_write_b32 a40, v242
    v_accvgpr_read_b32 v243, a41
    v_mul_f32 v243, v243, v240
    v_accvgpr_write_b32 a41, v243
    v_accvgpr_read_b32 v244, a42
    v_mul_f32 v244, v244, v240
    v_accvgpr_write_b32 a42, v244
    v_accvgpr_read_b32 v245, a43
    v_mul_f32 v245, v245, v240
    v_accvgpr_write_b32 a43, v245
    v_accvgpr_read_b32 v242, a44
    v_mul_f32 v242, v242, v240
    v_accvgpr_write_b32 a44, v242
    v_accvgpr_read_b32 v243, a45
    v_mul_f32 v243, v243, v240
    v_accvgpr_write_b32 a45, v243
    v_accvgpr_read_b32 v244, a46
    v_mul_f32 v244, v244, v240
    v_accvgpr_write_b32 a46, v244
    v_accvgpr_read_b32 v245, a47
    v_mul_f32 v245, v245, v240
    v_accvgpr_write_b32 a47, v245
    v_accvgpr_read_b32 v242, a64
    v_mul_f32 v242, v242, v240
    v_accvgpr_write_b32 a64, v242
    v_accvgpr_read_b32 v243, a65
    v_mul_f32 v243, v243, v240
    v_accvgpr_write_b32 a65, v243
    v_accvgpr_read_b32 v244, a66
    v_mul_f32 v244, v244, v240
    v_accvgpr_write_b32 a66, v244
    v_accvgpr_read_b32 v245, a67
    v_mul_f32 v245, v245, v240
    v_accvgpr_write_b32 a67, v245
    v_accvgpr_read_b32 v242, a68
    v_mul_f32 v242, v242, v240
    v_accvgpr_write_b32 a68, v242
    v_accvgpr_read_b32 v243, a69
    v_mul_f32 v243, v243, v240
    v_accvgpr_write_b32 a69, v243
    v_accvgpr_read_b32 v244, a70
    v_mul_f32 v244, v244, v240
    v_accvgpr_write_b32 a70, v244
    v_accvgpr_read_b32 v245, a71
    v_mul_f32 v245, v245, v240
    v_accvgpr_write_b32 a71, v245
    v_accvgpr_read_b32 v242, a72
    v_mul_f32 v242, v242, v240
    v_accvgpr_write_b32 a72, v242
    v_accvgpr_read_b32 v243, a73
    v_mul_f32 v243, v243, v240
    v_accvgpr_write_b32 a73, v243
    v_accvgpr_read_b32 v244, a74
    v_mul_f32 v244, v244, v240
    v_accvgpr_write_b32 a74, v244
    v_accvgpr_read_b32 v245, a75
    v_mul_f32 v245, v245, v240
    v_accvgpr_write_b32 a75, v245
    v_accvgpr_read_b32 v242, a76
    v_mul_f32 v242, v242, v240
    v_accvgpr_write_b32 a76, v242
    v_accvgpr_read_b32 v243, a77
    v_mul_f32 v243, v243, v240
    v_accvgpr_write_b32 a77, v243
    v_accvgpr_read_b32 v244, a78
    v_mul_f32 v244, v244, v240
    v_accvgpr_write_b32 a78, v244
    v_accvgpr_read_b32 v245, a79
    v_mul_f32 v245, v245, v240
    v_accvgpr_write_b32 a79, v245
    v_accvgpr_read_b32 v242, a96
    v_mul_f32 v242, v242, v240
    v_accvgpr_write_b32 a96, v242
    v_accvgpr_read_b32 v243, a97
    v_mul_f32 v243, v243, v240
    v_accvgpr_write_b32 a97, v243
    v_accvgpr_read_b32 v244, a98
    v_mul_f32 v244, v244, v240
    v_accvgpr_write_b32 a98, v244
    v_accvgpr_read_b32 v245, a99
    v_mul_f32 v245, v245, v240
    v_accvgpr_write_b32 a99, v245
    v_accvgpr_read_b32 v242, a100
    v_mul_f32 v242, v242, v240
    v_accvgpr_write_b32 a100, v242
    v_accvgpr_read_b32 v243, a101
    v_mul_f32 v243, v243, v240
    v_accvgpr_write_b32 a101, v243
    v_accvgpr_read_b32 v244, a102
    v_mul_f32 v244, v244, v240
    v_accvgpr_write_b32 a102, v244
    v_accvgpr_read_b32 v245, a103
    v_mul_f32 v245, v245, v240
    v_accvgpr_write_b32 a103, v245
    v_accvgpr_read_b32 v242, a104
    v_mul_f32 v242, v242, v240
    v_accvgpr_write_b32 a104, v242
    v_accvgpr_read_b32 v243, a105
    v_mul_f32 v243, v243, v240
    v_accvgpr_write_b32 a105, v243
    v_accvgpr_read_b32 v244, a106
    v_mul_f32 v244, v244, v240
    v_accvgpr_write_b32 a106, v244
    v_accvgpr_read_b32 v245, a107
    v_mul_f32 v245, v245, v240
    v_accvgpr_write_b32 a107, v245
    v_accvgpr_read_b32 v242, a108
    v_mul_f32 v242, v242, v240
    v_accvgpr_write_b32 a108, v242
    v_accvgpr_read_b32 v243, a109
    v_mul_f32 v243, v243, v240
    v_accvgpr_write_b32 a109, v243
    v_accvgpr_read_b32 v244, a110
    v_mul_f32 v244, v244, v240
    v_accvgpr_write_b32 a110, v244
    v_accvgpr_read_b32 v245, a111
    v_mul_f32 v245, v245, v240
    v_accvgpr_write_b32 a111, v245
    v_max_f32 v239, v239, v241
    v_exp_f32 v241, -v239
    v_sub_f32 v112, v112, v239
    v_sub_f32 v48, v48, v239
    v_sub_f32 v16, v16, v239
    v_sub_f32 v113, v113, v239
    v_sub_f32 v49, v49, v239
    v_sub_f32 v17, v17, v239
    v_sub_f32 v114, v114, v239
    v_sub_f32 v50, v50, v239
    v_sub_f32 v18, v18, v239
    v_sub_f32 v115, v115, v239
    v_sub_f32 v51, v51, v239
    v_sub_f32 v19, v19, v239
    v_sub_f32 v116, v116, v239
    v_sub_f32 v52, v52, v239
    v_sub_f32 v20, v20, v239
    v_sub_f32 v117, v117, v239
    v_sub_f32 v53, v53, v239
    v_sub_f32 v21, v21, v239
    v_sub_f32 v118, v118, v239
    v_sub_f32 v54, v54, v239
    v_sub_f32 v22, v22, v239
    v_sub_f32 v119, v119, v239
    v_sub_f32 v55, v55, v239
    v_sub_f32 v23, v23, v239
    v_sub_f32 v120, v120, v239
    v_sub_f32 v56, v56, v239
    v_sub_f32 v24, v24, v239
    v_sub_f32 v121, v121, v239
    v_sub_f32 v57, v57, v239
    v_sub_f32 v25, v25, v239
    v_sub_f32 v122, v122, v239
    v_sub_f32 v58, v58, v239
    v_sub_f32 v26, v26, v239
    v_sub_f32 v123, v123, v239
    v_sub_f32 v59, v59, v239
    v_sub_f32 v27, v27, v239
    v_sub_f32 v124, v124, v239
    v_sub_f32 v60, v60, v239
    v_sub_f32 v28, v28, v239
    v_sub_f32 v125, v125, v239
    v_sub_f32 v61, v61, v239
    v_sub_f32 v29, v29, v239
    v_sub_f32 v126, v126, v239
    v_sub_f32 v62, v62, v239
    v_sub_f32 v30, v30, v239
    v_sub_f32 v127, v127, v239
    v_sub_f32 v63, v63, v239
    v_sub_f32 v31, v31, v239
    v_mul_f32 v217, v217, v241
    v_exp_f32 v242, v16
    v_exp_f32 v243, v17
    s_nop 0
    v_add_f32 v219, v242, v243
    v_cvt_pk_bf16_f32 v72, v242, v243
    v_exp_f32 v242, v18
    v_exp_f32 v243, v19
    v_add_f32 v219, v219, v242
    v_add_f32 v219, v219, v243
    v_cvt_pk_bf16_f32 v73, v242, v243
    v_exp_f32 v242, v20
    v_exp_f32 v243, v21
    v_add_f32 v219, v219, v242
    v_add_f32 v219, v219, v243
    v_cvt_pk_bf16_f32 v74, v242, v243
    v_exp_f32 v242, v22
    v_exp_f32 v243, v23
    v_add_f32 v219, v219, v242
    v_add_f32 v219, v219, v243
    v_cvt_pk_bf16_f32 v75, v242, v243
    v_exp_f32 v242, v24
    v_exp_f32 v243, v25
    v_add_f32 v219, v219, v242
    v_add_f32 v219, v219, v243
    v_cvt_pk_bf16_f32 v76, v242, v243
    v_exp_f32 v242, v26
    v_exp_f32 v243, v27
    v_add_f32 v219, v219, v242
    v_add_f32 v219, v219, v243
    v_cvt_pk_bf16_f32 v77, v242, v243
    v_exp_f32 v242, v28
    v_exp_f32 v243, v29
    v_add_f32 v219, v219, v242
    v_add_f32 v219, v219, v243
    v_cvt_pk_bf16_f32 v78, v242, v243
    v_exp_f32 v242, v30
    v_exp_f32 v243, v31
    v_add_f32 v219, v219, v242
    v_add_f32 v219, v219, v243
    v_cvt_pk_bf16_f32 v79, v242, v243
    v_accvgpr_read_b32 v242, a16
    v_mul_f32 v242, v242, v241
    v_accvgpr_write_b32 a16, v242
    v_accvgpr_read_b32 v243, a17
    v_mul_f32 v243, v243, v241
    v_accvgpr_write_b32 a17, v243
    v_accvgpr_read_b32 v244, a18
    v_mul_f32 v244, v244, v241
    v_accvgpr_write_b32 a18, v244
    v_accvgpr_read_b32 v245, a19
    v_mul_f32 v245, v245, v241
    v_accvgpr_write_b32 a19, v245
    v_accvgpr_read_b32 v242, a20
    v_mul_f32 v242, v242, v241
    v_accvgpr_write_b32 a20, v242
    v_accvgpr_read_b32 v243, a21
    v_mul_f32 v243, v243, v241
    v_accvgpr_write_b32 a21, v243
    v_accvgpr_read_b32 v244, a22
    v_mul_f32 v244, v244, v241
    v_accvgpr_write_b32 a22, v244
    v_accvgpr_read_b32 v245, a23
    v_mul_f32 v245, v245, v241
    v_accvgpr_write_b32 a23, v245
    v_accvgpr_read_b32 v242, a24
    v_mul_f32 v242, v242, v241
    v_accvgpr_write_b32 a24, v242
    v_accvgpr_read_b32 v243, a25
    v_mul_f32 v243, v243, v241
    v_accvgpr_write_b32 a25, v243
    v_accvgpr_read_b32 v244, a26
    v_mul_f32 v244, v244, v241
    v_accvgpr_write_b32 a26, v244
    v_accvgpr_read_b32 v245, a27
    v_mul_f32 v245, v245, v241
    v_accvgpr_write_b32 a27, v245
    v_accvgpr_read_b32 v242, a28
    v_mul_f32 v242, v242, v241
    v_accvgpr_write_b32 a28, v242
    v_accvgpr_read_b32 v243, a29
    v_mul_f32 v243, v243, v241
    v_accvgpr_write_b32 a29, v243
    v_accvgpr_read_b32 v244, a30
    v_mul_f32 v244, v244, v241
    v_accvgpr_write_b32 a30, v244
    v_accvgpr_read_b32 v245, a31
    v_mul_f32 v245, v245, v241
    v_accvgpr_write_b32 a31, v245
    v_accvgpr_read_b32 v242, a48
    v_mul_f32 v242, v242, v241
    v_accvgpr_write_b32 a48, v242
    v_accvgpr_read_b32 v243, a49
    v_mul_f32 v243, v243, v241
    v_accvgpr_write_b32 a49, v243
    v_accvgpr_read_b32 v244, a50
    v_mul_f32 v244, v244, v241
    v_accvgpr_write_b32 a50, v244
    v_accvgpr_read_b32 v245, a51
    v_mul_f32 v245, v245, v241
    v_accvgpr_write_b32 a51, v245
    v_accvgpr_read_b32 v242, a52
    v_mul_f32 v242, v242, v241
    v_accvgpr_write_b32 a52, v242
    v_accvgpr_read_b32 v243, a53
    v_mul_f32 v243, v243, v241
    v_accvgpr_write_b32 a53, v243
    v_accvgpr_read_b32 v244, a54
    v_mul_f32 v244, v244, v241
    v_accvgpr_write_b32 a54, v244
    v_accvgpr_read_b32 v245, a55
    v_mul_f32 v245, v245, v241
    v_accvgpr_write_b32 a55, v245
    v_accvgpr_read_b32 v242, a56
    v_mul_f32 v242, v242, v241
    v_accvgpr_write_b32 a56, v242
    v_accvgpr_read_b32 v243, a57
    v_mul_f32 v243, v243, v241
    v_accvgpr_write_b32 a57, v243
    v_accvgpr_read_b32 v244, a58
    v_mul_f32 v244, v244, v241
    v_accvgpr_write_b32 a58, v244
    v_accvgpr_read_b32 v245, a59
    v_mul_f32 v245, v245, v241
    v_accvgpr_write_b32 a59, v245
    v_accvgpr_read_b32 v242, a60
    v_mul_f32 v242, v242, v241
    v_accvgpr_write_b32 a60, v242
    v_accvgpr_read_b32 v243, a61
    v_mul_f32 v243, v243, v241
    v_accvgpr_write_b32 a61, v243
    v_accvgpr_read_b32 v244, a62
    v_mul_f32 v244, v244, v241
    v_accvgpr_write_b32 a62, v244
    v_accvgpr_read_b32 v245, a63
    v_mul_f32 v245, v245, v241
    v_accvgpr_write_b32 a63, v245
    v_accvgpr_read_b32 v242, a80
    v_mul_f32 v242, v242, v241
    v_accvgpr_write_b32 a80, v242
    v_accvgpr_read_b32 v243, a81
    v_mul_f32 v243, v243, v241
    v_accvgpr_write_b32 a81, v243
    v_accvgpr_read_b32 v244, a82
    v_mul_f32 v244, v244, v241
    v_accvgpr_write_b32 a82, v244
    v_accvgpr_read_b32 v245, a83
    v_mul_f32 v245, v245, v241
    v_accvgpr_write_b32 a83, v245
    v_accvgpr_read_b32 v242, a84
    v_mul_f32 v242, v242, v241
    v_accvgpr_write_b32 a84, v242
    v_accvgpr_read_b32 v243, a85
    v_mul_f32 v243, v243, v241
    v_accvgpr_write_b32 a85, v243
    v_accvgpr_read_b32 v244, a86
    v_mul_f32 v244, v244, v241
    v_accvgpr_write_b32 a86, v244
    v_accvgpr_read_b32 v245, a87
    v_mul_f32 v245, v245, v241
    v_accvgpr_write_b32 a87, v245
    v_accvgpr_read_b32 v242, a88
    v_mul_f32 v242, v242, v241
    v_accvgpr_write_b32 a88, v242
    v_accvgpr_read_b32 v243, a89
    v_mul_f32 v243, v243, v241
    v_accvgpr_write_b32 a89, v243
    v_accvgpr_read_b32 v244, a90
    v_mul_f32 v244, v244, v241
    v_accvgpr_write_b32 a90, v244
    v_accvgpr_read_b32 v245, a91
    v_mul_f32 v245, v245, v241
    v_accvgpr_write_b32 a91, v245
    v_accvgpr_read_b32 v242, a92
    v_mul_f32 v242, v242, v241
    v_accvgpr_write_b32 a92, v242
    v_accvgpr_read_b32 v243, a93
    v_mul_f32 v243, v243, v241
    v_accvgpr_write_b32 a93, v243
    v_accvgpr_read_b32 v244, a94
    v_mul_f32 v244, v244, v241
    v_accvgpr_write_b32 a94, v244
    v_accvgpr_read_b32 v245, a95
    v_mul_f32 v245, v245, v241
    v_accvgpr_write_b32 a95, v245
    v_accvgpr_read_b32 v242, a112
    v_mul_f32 v242, v242, v241
    v_accvgpr_write_b32 a112, v242
    v_accvgpr_read_b32 v243, a113
    v_mul_f32 v243, v243, v241
    v_accvgpr_write_b32 a113, v243
    v_accvgpr_read_b32 v244, a114
    v_mul_f32 v244, v244, v241
    v_accvgpr_write_b32 a114, v244
    v_accvgpr_read_b32 v245, a115
    v_mul_f32 v245, v245, v241
    v_accvgpr_write_b32 a115, v245
    v_accvgpr_read_b32 v242, a116
    v_mul_f32 v242, v242, v241
    v_accvgpr_write_b32 a116, v242
    v_accvgpr_read_b32 v243, a117
    v_mul_f32 v243, v243, v241
    v_accvgpr_write_b32 a117, v243
    v_accvgpr_read_b32 v244, a118
    v_mul_f32 v244, v244, v241
    v_accvgpr_write_b32 a118, v244
    v_accvgpr_read_b32 v245, a119
    v_mul_f32 v245, v245, v241
    v_accvgpr_write_b32 a119, v245
    v_accvgpr_read_b32 v242, a120
    v_mul_f32 v242, v242, v241
    v_accvgpr_write_b32 a120, v242
    v_accvgpr_read_b32 v243, a121
    v_mul_f32 v243, v243, v241
    v_accvgpr_write_b32 a121, v243
    v_accvgpr_read_b32 v244, a122
    v_mul_f32 v244, v244, v241
    v_accvgpr_write_b32 a122, v244
    v_accvgpr_read_b32 v245, a123
    v_mul_f32 v245, v245, v241
    v_accvgpr_write_b32 a123, v245
    v_accvgpr_read_b32 v242, a124
    v_mul_f32 v242, v242, v241
    v_accvgpr_write_b32 a124, v242
    v_accvgpr_read_b32 v243, a125
    v_mul_f32 v243, v243, v241
    v_accvgpr_write_b32 a125, v243
    v_accvgpr_read_b32 v244, a126
    v_mul_f32 v244, v244, v241
    v_accvgpr_write_b32 a126, v244
    v_accvgpr_read_b32 v245, a127
    v_mul_f32 v245, v245, v241
    v_accvgpr_write_b32 a127, v245
    s_nop 3
    s_setpc_b64 s[44:45]
L_ka_fix1:
    s_nop 15
    s_nop 15
    v_max3_f32 v238, v32, v33, v34
    v_max3_f32 v238, v238, v35, v36
    v_max3_f32 v238, v238, v37, v38
    v_max3_f32 v238, v238, v39, v40
    v_max3_f32 v238, v238, v41, v42
    v_max3_f32 v238, v238, v43, v44
    v_max3_f32 v238, v238, v45, v46
    v_max3_f32 v238, v238, v47, 0
    v_mov_b32 v240, v238
    v_max3_f32 v239, v48, v49, v50
    v_max3_f32 v239, v239, v51, v52
    v_max3_f32 v239, v239, v53, v54
    v_max3_f32 v239, v239, v55, v56
    v_max3_f32 v239, v239, v57, v58
    v_max3_f32 v239, v239, v59, v60
    v_max3_f32 v239, v239, v61, v62
    v_max3_f32 v239, v239, v63, 0
    v_mov_b32 v241, v239
    v_permlane32_swap_b32 v238, v240
    s_nop 0
    v_permlane32_swap_b32 v239, v241
    v_max_f32 v238, v238, v240
    v_exp_f32 v240, -v238
    v_sub_f32 v96, v96, v238
    v_sub_f32 v0, v0, v238
    v_sub_f32 v32, v32, v238
    v_sub_f32 v97, v97, v238
    v_sub_f32 v1, v1, v238
    v_sub_f32 v33, v33, v238
    v_sub_f32 v98, v98, v238
    v_sub_f32 v2, v2, v238
    v_sub_f32 v34, v34, v238
    v_sub_f32 v99, v99, v238
    v_sub_f32 v3, v3, v238
    v_sub_f32 v35, v35, v238
    v_sub_f32 v100, v100, v238
    v_sub_f32 v4, v4, v238
    v_sub_f32 v36, v36, v238
    v_sub_f32 v101, v101, v238
    v_sub_f32 v5, v5, v238
    v_sub_f32 v37, v37, v238
    v_sub_f32 v102, v102, v238
    v_sub_f32 v6, v6, v238
    v_sub_f32 v38, v38, v238
    v_sub_f32 v103, v103, v238
    v_sub_f32 v7, v7, v238
    v_sub_f32 v39, v39, v238
    v_sub_f32 v104, v104, v238
    v_sub_f32 v8, v8, v238
    v_sub_f32 v40, v40, v238
    v_sub_f32 v105, v105, v238
    v_sub_f32 v9, v9, v238
    v_sub_f32 v41, v41, v238
    v_sub_f32 v106, v106, v238
    v_sub_f32 v10, v10, v238
    v_sub_f32 v42, v42, v238
    v_sub_f32 v107, v107, v238
    v_sub_f32 v11, v11, v238
    v_sub_f32 v43, v43, v238
    v_sub_f32 v108, v108, v238
    v_sub_f32 v12, v12, v238
    v_sub_f32 v44, v44, v238
    v_sub_f32 v109, v109, v238
    v_sub_f32 v13, v13, v238
    v_sub_f32 v45, v45, v238
    v_sub_f32 v110, v110, v238
    v_sub_f32 v14, v14, v238
    v_sub_f32 v46, v46, v238
    v_sub_f32 v111, v111, v238
    v_sub_f32 v15, v15, v238
    v_sub_f32 v47, v47, v238
    v_mul_f32 v216, v216, v240
    v_exp_f32 v242, v32
    v_exp_f32 v243, v33
    s_nop 0
    v_add_f32 v218, v242, v243
    v_cvt_pk_bf16_f32 v80, v242, v243
    v_exp_f32 v242, v34
    v_exp_f32 v243, v35
    v_add_f32 v218, v218, v242
    v_add_f32 v218, v218, v243
    v_cvt_pk_bf16_f32 v81, v242, v243
    v_exp_f32 v242, v36
    v_exp_f32 v243, v37
    v_add_f32 v218, v218, v242
    v_add_f32 v218, v218, v243
    v_cvt_pk_bf16_f32 v82, v242, v243
    v_exp_f32 v242, v38
    v_exp_f32 v243, v39
    v_add_f32 v218, v218, v242
    v_add_f32 v218, v218, v243
    v_cvt_pk_bf16_f32 v83, v242, v243
    v_exp_f32 v242, v40
    v_exp_f32 v243, v41
    v_add_f32 v218, v218, v242
    v_add_f32 v218, v218, v243
    v_cvt_pk_bf16_f32 v84, v242, v243
    v_exp_f32 v242, v42
    v_exp_f32 v243, v43
    v_add_f32 v218, v218, v242
    v_add_f32 v218, v218, v243
    v_cvt_pk_bf16_f32 v85, v242, v243
    v_exp_f32 v242, v44
    v_exp_f32 v243, v45
    v_add_f32 v218, v218, v242
    v_add_f32 v218, v218, v243
    v_cvt_pk_bf16_f32 v86, v242, v243
    v_exp_f32 v242, v46
    v_exp_f32 v243, v47
    v_add_f32 v218, v218, v242
    v_add_f32 v218, v218, v243
    v_cvt_pk_bf16_f32 v87, v242, v243
    v_accvgpr_read_b32 v242, a0
    v_mul_f32 v242, v242, v240
    v_accvgpr_write_b32 a0, v242
    v_accvgpr_read_b32 v243, a1
    v_mul_f32 v243, v243, v240
    v_accvgpr_write_b32 a1, v243
    v_accvgpr_read_b32 v244, a2
    v_mul_f32 v244, v244, v240
    v_accvgpr_write_b32 a2, v244
    v_accvgpr_read_b32 v245, a3
    v_mul_f32 v245, v245, v240
    v_accvgpr_write_b32 a3, v245
    v_accvgpr_read_b32 v242, a4
    v_mul_f32 v242, v242, v240
    v_accvgpr_write_b32 a4, v242
    v_accvgpr_read_b32 v243, a5
    v_mul_f32 v243, v243, v240
    v_accvgpr_write_b32 a5, v243
    v_accvgpr_read_b32 v244, a6
    v_mul_f32 v244, v244, v240
    v_accvgpr_write_b32 a6, v244
    v_accvgpr_read_b32 v245, a7
    v_mul_f32 v245, v245, v240
    v_accvgpr_write_b32 a7, v245
    v_accvgpr_read_b32 v242, a8
    v_mul_f32 v242, v242, v240
    v_accvgpr_write_b32 a8, v242
    v_accvgpr_read_b32 v243, a9
    v_mul_f32 v243, v243, v240
    v_accvgpr_write_b32 a9, v243
    v_accvgpr_read_b32 v244, a10
    v_mul_f32 v244, v244, v240
    v_accvgpr_write_b32 a10, v244
    v_accvgpr_read_b32 v245, a11
    v_mul_f32 v245, v245, v240
    v_accvgpr_write_b32 a11, v245
    v_accvgpr_read_b32 v242, a12
    v_mul_f32 v242, v242, v240
    v_accvgpr_write_b32 a12, v242
    v_accvgpr_read_b32 v243, a13
    v_mul_f32 v243, v243, v240
    v_accvgpr_write_b32 a13, v243
    v_accvgpr_read_b32 v244, a14
    v_mul_f32 v244, v244, v240
    v_accvgpr_write_b32 a14, v244
    v_accvgpr_read_b32 v245, a15
    v_mul_f32 v245, v245, v240
    v_accvgpr_write_b32 a15, v245
    v_accvgpr_read_b32 v242, a32
    v_mul_f32 v242, v242, v240
    v_accvgpr_write_b32 a32, v242
    v_accvgpr_read_b32 v243, a33
    v_mul_f32 v243, v243, v240
    v_accvgpr_write_b32 a33, v243
    v_accvgpr_read_b32 v244, a34
    v_mul_f32 v244, v244, v240
    v_accvgpr_write_b32 a34, v244
    v_accvgpr_read_b32 v245, a35
    v_mul_f32 v245, v245, v240
    v_accvgpr_write_b32 a35, v245
    v_accvgpr_read_b32 v242, a36
    v_mul_f32 v242, v242, v240
    v_accvgpr_write_b32 a36, v242
    v_accvgpr_read_b32 v243, a37
    v_mul_f32 v243, v243, v240
    v_accvgpr_write_b32 a37, v243
    v_accvgpr_read_b32 v244, a38
    v_mul_f32 v244, v244, v240
    v_accvgpr_write_b32 a38, v244
    v_accvgpr_read_b32 v245, a39
    v_mul_f32 v245, v245, v240
    v_accvgpr_write_b32 a39, v245
    v_accvgpr_read_b32 v242, a40
    v_mul_f32 v242, v242, v240
    v_accvgpr_write_b32 a40, v242
    v_accvgpr_read_b32 v243, a41
    v_mul_f32 v243, v243, v240
    v_accvgpr_write_b32 a41, v243
    v_accvgpr_read_b32 v244, a42
    v_mul_f32 v244, v244, v240
    v_accvgpr_write_b32 a42, v244
    v_accvgpr_read_b32 v245, a43
    v_mul_f32 v245, v245, v240
    v_accvgpr_write_b32 a43, v245
    v_accvgpr_read_b32 v242, a44
    v_mul_f32 v242, v242, v240
    v_accvgpr_write_b32 a44, v242
    v_accvgpr_read_b32 v243, a45
    v_mul_f32 v243, v243, v240
    v_accvgpr_write_b32 a45, v243
    v_accvgpr_read_b32 v244, a46
    v_mul_f32 v244, v244, v240
    v_accvgpr_write_b32 a46, v244
    v_accvgpr_read_b32 v245, a47
    v_mul_f32 v245, v245, v240
    v_accvgpr_write_b32 a47, v245
    v_accvgpr_read_b32 v242, a64
    v_mul_f32 v242, v242, v240
    v_accvgpr_write_b32 a64, v242
    v_accvgpr_read_b32 v243, a65
    v_mul_f32 v243, v243, v240
    v_accvgpr_write_b32 a65, v243
    v_accvgpr_read_b32 v244, a66
    v_mul_f32 v244, v244, v240
    v_accvgpr_write_b32 a66, v244
    v_accvgpr_read_b32 v245, a67
    v_mul_f32 v245, v245, v240
    v_accvgpr_write_b32 a67, v245
    v_accvgpr_read_b32 v242, a68
    v_mul_f32 v242, v242, v240
    v_accvgpr_write_b32 a68, v242
    v_accvgpr_read_b32 v243, a69
    v_mul_f32 v243, v243, v240
    v_accvgpr_write_b32 a69, v243
    v_accvgpr_read_b32 v244, a70
    v_mul_f32 v244, v244, v240
    v_accvgpr_write_b32 a70, v244
    v_accvgpr_read_b32 v245, a71
    v_mul_f32 v245, v245, v240
    v_accvgpr_write_b32 a71, v245
    v_accvgpr_read_b32 v242, a72
    v_mul_f32 v242, v242, v240
    v_accvgpr_write_b32 a72, v242
    v_accvgpr_read_b32 v243, a73
    v_mul_f32 v243, v243, v240
    v_accvgpr_write_b32 a73, v243
    v_accvgpr_read_b32 v244, a74
    v_mul_f32 v244, v244, v240
    v_accvgpr_write_b32 a74, v244
    v_accvgpr_read_b32 v245, a75
    v_mul_f32 v245, v245, v240
    v_accvgpr_write_b32 a75, v245
    v_accvgpr_read_b32 v242, a76
    v_mul_f32 v242, v242, v240
    v_accvgpr_write_b32 a76, v242
    v_accvgpr_read_b32 v243, a77
    v_mul_f32 v243, v243, v240
    v_accvgpr_write_b32 a77, v243
    v_accvgpr_read_b32 v244, a78
    v_mul_f32 v244, v244, v240
    v_accvgpr_write_b32 a78, v244
    v_accvgpr_read_b32 v245, a79
    v_mul_f32 v245, v245, v240
    v_accvgpr_write_b32 a79, v245
    v_accvgpr_read_b32 v242, a96
    v_mul_f32 v242, v242, v240
    v_accvgpr_write_b32 a96, v242
    v_accvgpr_read_b32 v243, a97
    v_mul_f32 v243, v243, v240
    v_accvgpr_write_b32 a97, v243
    v_accvgpr_read_b32 v244, a98
    v_mul_f32 v244, v244, v240
    v_accvgpr_write_b32 a98, v244
    v_accvgpr_read_b32 v245, a99
    v_mul_f32 v245, v245, v240
    v_accvgpr_write_b32 a99, v245
    v_accvgpr_read_b32 v242, a100
    v_mul_f32 v242, v242, v240
    v_accvgpr_write_b32 a100, v242
    v_accvgpr_read_b32 v243, a101
    v_mul_f32 v243, v243, v240
    v_accvgpr_write_b32 a101, v243
    v_accvgpr_read_b32 v244, a102
    v_mul_f32 v244, v244, v240
    v_accvgpr_write_b32 a102, v244
    v_accvgpr_read_b32 v245, a103
    v_mul_f32 v245, v245, v240
    v_accvgpr_write_b32 a103, v245
    v_accvgpr_read_b32 v242, a104
    v_mul_f32 v242, v242, v240
    v_accvgpr_write_b32 a104, v242
    v_accvgpr_read_b32 v243, a105
    v_mul_f32 v243, v243, v240
    v_accvgpr_write_b32 a105, v243
    v_accvgpr_read_b32 v244, a106
    v_mul_f32 v244, v244, v240
    v_accvgpr_write_b32 a106, v244
    v_accvgpr_read_b32 v245, a107
    v_mul_f32 v245, v245, v240
    v_accvgpr_write_b32 a107, v245
    v_accvgpr_read_b32 v242, a108
    v_mul_f32 v242, v242, v240
    v_accvgpr_write_b32 a108, v242
    v_accvgpr_read_b32 v243, a109
    v_mul_f32 v243, v243, v240
    v_accvgpr_write_b32 a109, v243
    v_accvgpr_read_b32 v244, a110
    v_mul_f32 v244, v244, v240
    v_accvgpr_write_b32 a110, v244
    v_accvgpr_read_b32 v245, a111
    v_mul_f32 v245, v245, v240
    v_accvgpr_write_b32 a111, v245
    v_max_f32 v239, v239, v241
    v_exp_f32 v241, -v239
    v_sub_f32 v112, v112, v239
    v_sub_f32 v16, v16, v239
    v_sub_f32 v48, v48, v239
    v_sub_f32 v113, v113, v239
    v_sub_f32 v17, v17, v239
    v_sub_f32 v49, v49, v239
    v_sub_f32 v114, v114, v239
    v_sub_f32 v18, v18, v239
    v_sub_f32 v50, v50, v239
    v_sub_f32 v115, v115, v239
    v_sub_f32 v19, v19, v239
    v_sub_f32 v51, v51, v239
    v_sub_f32 v116, v116, v239
    v_sub_f32 v20, v20, v239
    v_sub_f32 v52, v52, v239
    v_sub_f32 v117, v117, v239
    v_sub_f32 v21, v21, v239
    v_sub_f32 v53, v53, v239
    v_sub_f32 v118, v118, v239
    v_sub_f32 v22, v22, v239
    v_sub_f32 v54, v54, v239
    v_sub_f32 v119, v119, v239
    v_sub_f32 v23, v23, v239
    v_sub_f32 v55, v55, v239
    v_sub_f32 v120, v120, v239
    v_sub_f32 v24, v24, v239
    v_sub_f32 v56, v56, v239
    v_sub_f32 v121, v121, v239
    v_sub_f32 v25, v25, v239
    v_sub_f32 v57, v57, v239
    v_sub_f32 v122, v122, v239
    v_sub_f32 v26, v26, v239
    v_sub_f32 v58, v58, v239
    v_sub_f32 v123, v123, v239
    v_sub_f32 v27, v27, v239
    v_sub_f32 v59, v59, v239
    v_sub_f32 v124, v124, v239
    v_sub_f32 v28, v28, v239
    v_sub_f32 v60, v60, v239
    v_sub_f32 v125, v125, v239
    v_sub_f32 v29, v29, v239
    v_sub_f32 v61, v61, v239
    v_sub_f32 v126, v126, v239
    v_sub_f32 v30, v30, v239
    v_sub_f32 v62, v62, v239
    v_sub_f32 v127, v127, v239
    v_sub_f32 v31, v31, v239
    v_sub_f32 v63, v63, v239
    v_mul_f32 v217, v217, v241
    v_exp_f32 v242, v48
    v_exp_f32 v243, v49
    s_nop 0
    v_add_f32 v219, v242, v243
    v_cvt_pk_bf16_f32 v88, v242, v243
    v_exp_f32 v242, v50
    v_exp_f32 v243, v51
    v_add_f32 v219, v219, v242
    v_add_f32 v219, v219, v243
    v_cvt_pk_bf16_f32 v89, v242, v243
    v_exp_f32 v242, v52
    v_exp_f32 v243, v53
    v_add_f32 v219, v219, v242
    v_add_f32 v219, v219, v243
    v_cvt_pk_bf16_f32 v90, v242, v243
    v_exp_f32 v242, v54
    v_exp_f32 v243, v55
    v_add_f32 v219, v219, v242
    v_add_f32 v219, v219, v243
    v_cvt_pk_bf16_f32 v91, v242, v243
    v_exp_f32 v242, v56
    v_exp_f32 v243, v57
    v_add_f32 v219, v219, v242
    v_add_f32 v219, v219, v243
    v_cvt_pk_bf16_f32 v92, v242, v243
    v_exp_f32 v242, v58
    v_exp_f32 v243, v59
    v_add_f32 v219, v219, v242
    v_add_f32 v219, v219, v243
    v_cvt_pk_bf16_f32 v93, v242, v243
    v_exp_f32 v242, v60
    v_exp_f32 v243, v61
    v_add_f32 v219, v219, v242
    v_add_f32 v219, v219, v243
    v_cvt_pk_bf16_f32 v94, v242, v243
    v_exp_f32 v242, v62
    v_exp_f32 v243, v63
    v_add_f32 v219, v219, v242
    v_add_f32 v219, v219, v243
    v_cvt_pk_bf16_f32 v95, v242, v243
    v_accvgpr_read_b32 v242, a16
    v_mul_f32 v242, v242, v241
    v_accvgpr_write_b32 a16, v242
    v_accvgpr_read_b32 v243, a17
    v_mul_f32 v243, v243, v241
    v_accvgpr_write_b32 a17, v243
    v_accvgpr_read_b32 v244, a18
    v_mul_f32 v244, v244, v241
    v_accvgpr_write_b32 a18, v244
    v_accvgpr_read_b32 v245, a19
    v_mul_f32 v245, v245, v241
    v_accvgpr_write_b32 a19, v245
    v_accvgpr_read_b32 v242, a20
    v_mul_f32 v242, v242, v241
    v_accvgpr_write_b32 a20, v242
    v_accvgpr_read_b32 v243, a21
    v_mul_f32 v243, v243, v241
    v_accvgpr_write_b32 a21, v243
    v_accvgpr_read_b32 v244, a22
    v_mul_f32 v244, v244, v241
    v_accvgpr_write_b32 a22, v244
    v_accvgpr_read_b32 v245, a23
    v_mul_f32 v245, v245, v241
    v_accvgpr_write_b32 a23, v245
    v_accvgpr_read_b32 v242, a24
    v_mul_f32 v242, v242, v241
    v_accvgpr_write_b32 a24, v242
    v_accvgpr_read_b32 v243, a25
    v_mul_f32 v243, v243, v241
    v_accvgpr_write_b32 a25, v243
    v_accvgpr_read_b32 v244, a26
    v_mul_f32 v244, v244, v241
    v_accvgpr_write_b32 a26, v244
    v_accvgpr_read_b32 v245, a27
    v_mul_f32 v245, v245, v241
    v_accvgpr_write_b32 a27, v245
    v_accvgpr_read_b32 v242, a28
    v_mul_f32 v242, v242, v241
    v_accvgpr_write_b32 a28, v242
    v_accvgpr_read_b32 v243, a29
    v_mul_f32 v243, v243, v241
    v_accvgpr_write_b32 a29, v243
    v_accvgpr_read_b32 v244, a30
    v_mul_f32 v244, v244, v241
    v_accvgpr_write_b32 a30, v244
    v_accvgpr_read_b32 v245, a31
    v_mul_f32 v245, v245, v241
    v_accvgpr_write_b32 a31, v245
    v_accvgpr_read_b32 v242, a48
    v_mul_f32 v242, v242, v241
    v_accvgpr_write_b32 a48, v242
    v_accvgpr_read_b32 v243, a49
    v_mul_f32 v243, v243, v241
    v_accvgpr_write_b32 a49, v243
    v_accvgpr_read_b32 v244, a50
    v_mul_f32 v244, v244, v241
    v_accvgpr_write_b32 a50, v244
    v_accvgpr_read_b32 v245, a51
    v_mul_f32 v245, v245, v241
    v_accvgpr_write_b32 a51, v245
    v_accvgpr_read_b32 v242, a52
    v_mul_f32 v242, v242, v241
    v_accvgpr_write_b32 a52, v242
    v_accvgpr_read_b32 v243, a53
    v_mul_f32 v243, v243, v241
    v_accvgpr_write_b32 a53, v243
    v_accvgpr_read_b32 v244, a54
    v_mul_f32 v244, v244, v241
    v_accvgpr_write_b32 a54, v244
    v_accvgpr_read_b32 v245, a55
    v_mul_f32 v245, v245, v241
    v_accvgpr_write_b32 a55, v245
    v_accvgpr_read_b32 v242, a56
    v_mul_f32 v242, v242, v241
    v_accvgpr_write_b32 a56, v242
    v_accvgpr_read_b32 v243, a57
    v_mul_f32 v243, v243, v241
    v_accvgpr_write_b32 a57, v243
    v_accvgpr_read_b32 v244, a58
    v_mul_f32 v244, v244, v241
    v_accvgpr_write_b32 a58, v244
    v_accvgpr_read_b32 v245, a59
    v_mul_f32 v245, v245, v241
    v_accvgpr_write_b32 a59, v245
    v_accvgpr_read_b32 v242, a60
    v_mul_f32 v242, v242, v241
    v_accvgpr_write_b32 a60, v242
    v_accvgpr_read_b32 v243, a61
    v_mul_f32 v243, v243, v241
    v_accvgpr_write_b32 a61, v243
    v_accvgpr_read_b32 v244, a62
    v_mul_f32 v244, v244, v241
    v_accvgpr_write_b32 a62, v244
    v_accvgpr_read_b32 v245, a63
    v_mul_f32 v245, v245, v241
    v_accvgpr_write_b32 a63, v245
    v_accvgpr_read_b32 v242, a80
    v_mul_f32 v242, v242, v241
    v_accvgpr_write_b32 a80, v242
    v_accvgpr_read_b32 v243, a81
    v_mul_f32 v243, v243, v241
    v_accvgpr_write_b32 a81, v243
    v_accvgpr_read_b32 v244, a82
    v_mul_f32 v244, v244, v241
    v_accvgpr_write_b32 a82, v244
    v_accvgpr_read_b32 v245, a83
    v_mul_f32 v245, v245, v241
    v_accvgpr_write_b32 a83, v245
    v_accvgpr_read_b32 v242, a84
    v_mul_f32 v242, v242, v241
    v_accvgpr_write_b32 a84, v242
    v_accvgpr_read_b32 v243, a85
    v_mul_f32 v243, v243, v241
    v_accvgpr_write_b32 a85, v243
    v_accvgpr_read_b32 v244, a86
    v_mul_f32 v244, v244, v241
    v_accvgpr_write_b32 a86, v244
    v_accvgpr_read_b32 v245, a87
    v_mul_f32 v245, v245, v241
    v_accvgpr_write_b32 a87, v245
    v_accvgpr_read_b32 v242, a88
    v_mul_f32 v242, v242, v241
    v_accvgpr_write_b32 a88, v242
    v_accvgpr_read_b32 v243, a89
    v_mul_f32 v243, v243, v241
    v_accvgpr_write_b32 a89, v243
    v_accvgpr_read_b32 v244, a90
    v_mul_f32 v244, v244, v241
    v_accvgpr_write_b32 a90, v244
    v_accvgpr_read_b32 v245, a91
    v_mul_f32 v245, v245, v241
    v_accvgpr_write_b32 a91, v245
    v_accvgpr_read_b32 v242, a92
    v_mul_f32 v242, v242, v241
    v_accvgpr_write_b32 a92, v242
    v_accvgpr_read_b32 v243, a93
    v_mul_f32 v243, v243, v241
    v_accvgpr_write_b32 a93, v243
    v_accvgpr_read_b32 v244, a94
    v_mul_f32 v244, v244, v241
    v_accvgpr_write_b32 a94, v244
    v_accvgpr_read_b32 v245, a95
    v_mul_f32 v245, v245, v241
    v_accvgpr_write_b32 a95, v245
    v_accvgpr_read_b32 v242, a112
    v_mul_f32 v242, v242, v241
    v_accvgpr_write_b32 a112, v242
    v_accvgpr_read_b32 v243, a113
    v_mul_f32 v243, v243, v241
    v_accvgpr_write_b32 a113, v243
    v_accvgpr_read_b32 v244, a114
    v_mul_f32 v244, v244, v241
    v_accvgpr_write_b32 a114, v244
    v_accvgpr_read_b32 v245, a115
    v_mul_f32 v245, v245, v241
    v_accvgpr_write_b32 a115, v245
    v_accvgpr_read_b32 v242, a116
    v_mul_f32 v242, v242, v241
    v_accvgpr_write_b32 a116, v242
    v_accvgpr_read_b32 v243, a117
    v_mul_f32 v243, v243, v241
    v_accvgpr_write_b32 a117, v243
    v_accvgpr_read_b32 v244, a118
    v_mul_f32 v244, v244, v241
    v_accvgpr_write_b32 a118, v244
    v_accvgpr_read_b32 v245, a119
    v_mul_f32 v245, v245, v241
    v_accvgpr_write_b32 a119, v245
    v_accvgpr_read_b32 v242, a120
    v_mul_f32 v242, v242, v241
    v_accvgpr_write_b32 a120, v242
    v_accvgpr_read_b32 v243, a121
    v_mul_f32 v243, v243, v241
    v_accvgpr_write_b32 a121, v243
    v_accvgpr_read_b32 v244, a122
    v_mul_f32 v244, v244, v241
    v_accvgpr_write_b32 a122, v244
    v_accvgpr_read_b32 v245, a123
    v_mul_f32 v245, v245, v241
    v_accvgpr_write_b32 a123, v245
    v_accvgpr_read_b32 v242, a124
    v_mul_f32 v242, v242, v241
    v_accvgpr_write_b32 a124, v242
    v_accvgpr_read_b32 v243, a125
    v_mul_f32 v243, v243, v241
    v_accvgpr_write_b32 a125, v243
    v_accvgpr_read_b32 v244, a126
    v_mul_f32 v244, v244, v241
    v_accvgpr_write_b32 a126, v244
    v_accvgpr_read_b32 v245, a127
    v_mul_f32 v245, v245, v241
    v_accvgpr_write_b32 a127, v245
    s_nop 3
    s_setpc_b64 s[44:45]
.section .rodata,"a"
.p2align 6
.amdhsa_kernel recurrent_scan__sliding_block_cached__moe_arch_mod__prompt_kernel
  .amdhsa_next_free_vgpr 512
  .amdhsa_next_free_sgpr 102
  .amdhsa_accum_offset 256
  .amdhsa_group_segment_fixed_size 0
  .amdhsa_kernarg_size 104
  .amdhsa_user_sgpr_count 2
  .amdhsa_user_sgpr_kernarg_segment_ptr 1
  .amdhsa_system_sgpr_workgroup_id_x 1
  .amdhsa_float_denorm_mode_32 3
.end_amdhsa_kernel
```
